```python
import torch

def _softmax(x, axis=-1):
    return torch.softmax(x, dim=axis)
def _gelu(x):
    return torch.nn.functional.gelu(x, approximate="tanh")
def _silu(x):
    return torch.nn.functional.silu(x)
def _sigmoid(x):
    return torch.sigmoid(x)
def _layernorm(x, axis=-1, eps=1e-5):
    m = x.mean(dim=axis, keepdim=True)
    v = x.var(dim=axis, keepdim=True, unbiased=False)
    return (x - m) / torch.sqrt(v + eps)
def _scatter_add(tgt, idx, src, axis=0):
    return tgt.clone().index_add_(axis, idx, src)
def _segment_sum(src, seg, n):
    out = torch.zeros((n,) + src.shape[1:], dtype=src.dtype)
    return out.index_add_(0, seg, src)
def _pad(x, pw):
    flat = tuple(v for pair in reversed(pw) for v in pair)
    return torch.nn.functional.pad(x, flat)

kernel_name = 'parallel_sum__mha_block__glu_gated_bilinear__prompt'

def setup_inputs():

    _w = (lambda a: (lambda t: t.to(torch.bfloat16) if t.is_floating_point() else t)(torch.as_tensor(a)))
    def _A_setup():
        B, S, D, H = 1, 2048, 1024, 32
        return {
            "x": _w((lambda *s: torch.randn(*s, dtype=torch.bfloat16) * 0.05)(B, S, D)),
            "wqkv": _w((lambda *s: torch.randn(*s, dtype=torch.bfloat16) * 0.05)(D, 3 * D)),
            "wo": _w((lambda *s: torch.randn(*s, dtype=torch.bfloat16) * 0.05)(D, D)),
        }
    _A_in = _A_setup()

    def _B_setup():
        B, S, D, F = 1, 2048, 1024, 3584
        return {
            "x": _w((lambda *s: torch.randn(*s, dtype=torch.bfloat16) * 0.05)(B, S, D)),
            "w_gate": _w((lambda *s: torch.randn(*s, dtype=torch.bfloat16) * 0.8)(D, F) * (D ** -0.5)),
            "w_up": _w((lambda *s: torch.randn(*s, dtype=torch.bfloat16) * 0.8)(D, F) * (D ** -0.5)),
            "w_down": _w((lambda *s: torch.randn(*s, dtype=torch.bfloat16) * 0.8)(F, D) * (F ** -0.5)),
        }
    _B_in = _B_setup()

    return {
        "A_x": _A_in["x"],
        "A_wqkv": _A_in["wqkv"],
        "A_wo": _A_in["wo"],
        "B_x": _B_in["x"],
        "B_w_gate": _B_in["w_gate"],
        "B_w_up": _B_in["w_up"],
        "B_w_down": _B_in["w_down"],
    }

def reference(A_x, A_wqkv, A_wo, B_x, B_w_gate, B_w_up, B_w_down):
    def _A_ref(x, wqkv, wo):
        B, S, D = x.shape
        H = 32
        Dh = D // H
        qkv = (lambda x, *d: x.permute(*d))((x @ wqkv).reshape(B, S, 3, H, Dh), 2, 0, 3, 1, 4)
        q, k, v = qkv[0], qkv[1], qkv[2]
        scores = torch.einsum("bhqd,bhkd->bhqk", q, k) * (Dh ** -0.5)
        p = _softmax(scores, axis=-1)
        o = torch.einsum("bhqk,bhkd->bhqd", p, v)
        return (lambda x, *d: x.permute(*d))(o, 0, 2, 1, 3).reshape(B, S, D) @ wo

    def _B_ref(x, w_gate, w_up, w_down):
        g = torch.einsum("bsd,df->bsf", x, w_gate)
        u = torch.einsum("bsd,df->bsf", x, w_up)
        h = g * u
        return torch.einsum("bsf,fd->bsd", h, w_down)

    x = A_x
    xn = _layernorm(x, axis=-1)
    return x + _A_ref(xn, A_wqkv, A_wo) + _B_ref(xn, B_w_gate, B_w_up, B_w_down)
```

```asm
; @launch grid=(256,1,1) block=(256,1,1) lds=163840
.amdgcn_target "amdgcn-amd-amdhsa--gfx950"
.text
.macro mf d,dn,x,xn,y,yn
v_mfma_f32_16x16x32_bf16 \d[\dn:\dn+3], \x[\xn:\xn+3], \y[\yn:\yn+3], \d[\dn:\dn+3]
.endm
.macro mg d,dn,x,xn,y,yn
v_mfma_f32_32x32x16_bf16 \d[\dn:\dn+15], \x[\xn:\xn+3], \y[\yn:\yn+3], \d[\dn:\dn+15]
.endm
.macro tr d,dn,ad,of
ds_read_b64_tr_b16 \d[\dn:\dn+1], v\ad offset:\of
.endm

.globl parallel_sum__mha_block__glu_gated_bilinear__prompt_kernel
.p2align 8
.type parallel_sum__mha_block__glu_gated_bilinear__prompt_kernel,@function
parallel_sum__mha_block__glu_gated_bilinear__prompt_kernel:
 s_cmp_ge_u32 s2, 256
 s_cbranch_scc0 f_go
 s_endpgm
f_go:
 s_load_dwordx2 s[40:41], s[0:1], 0
 s_load_dwordx2 s[24:25], s[0:1], 72
 s_getpc_b64 s[36:37]
f_base:
 v_lshrrev_b32 v1, 6, v0
 s_lshr_b32 s61, s2, 3
 s_mov_b32 s38, f_last-f_base
 s_mov_b32 s39, 0x00020000
 v_lshlrev_b32 v4, 7, v1
 s_lshl_b32 s71, s61, 9
 v_and_b32 v2, 63, v0
 buffer_load_dword v146, v4, s[36:39], s71 offen
 s_load_dwordx2 s[54:55], s[0:1], 8
 s_load_dwordx4 s[56:59], s[0:1], 32
 v_lshlrev_b32 v128, 4, v2
 s_lshl_b32 s42, s39, 5
 s_mov_b32 s43, s39
 v_lshl_add_u32 v3, v1, 12, v128
 s_lshl_b32 s45, s2, 14
 v_readfirstlane_b32 s3, v1
 s_waitcnt lgkmcnt(0)
 buffer_load_dwordx4 v[16:19], v3, s[40:43], s45 offen offset:0
 buffer_load_dwordx4 v[20:23], v3, s[40:43], s45 offen offset:1024
 buffer_load_dwordx4 v[24:27], v3, s[40:43], s45 offen offset:2048
 buffer_load_dwordx4 v[28:31], v3, s[40:43], s45 offen offset:3072
 s_lshl2_add_u32 s77, s2, s3
 s_and_b32 s62, s61, 3
 s_mov_b32 s26, 268435456
 s_mov_b32 s27, s39
 s_mov_b32 s47, 42270720
 s_load_dword s76, s[24:25], s47
 s_and_b32 s60, s2, 7
 s_lshr_b32 s63, s61, 2
 s_mul_i32 s64, s60, 7
 s_lshl_b32 s65, s62, 1
 s_add_u32 s64, s64, s65
 s_lshl_b32 s65, s64, 7
 s_lshl_b32 s66, s60, 8
 s_barrier
 s_movk_i32 s67, 7168
 s_movk_i32 s68, 6144
 s_cmp_eq_u32 s62, 3
 s_cbranch_scc1 f_sC
 s_lshl_b32 s70, s62, 7
 s_cmp_eq_u32 s62, 2
 s_cselect_b32 s70, 2176, s70
 s_add_u32 s70, s70, s66
 s_add_u32 s4, s54, s70
 s_addc_u32 s5, s55, 0
 s_sub_u32 s6, 6291456, s70
 s_mov_b32 s7, 0x00020000
 s_add_u32 s8, s56, s65
 s_addc_u32 s9, s57, 0
 s_sub_u32 s10, 7340032, s65
 s_mov_b32 s11, 0x00020000
 s_add_u32 s12, s58, s65
 s_addc_u32 s13, s59, 0
 s_sub_u32 s14, 7340032, s65
 s_mov_b32 s15, 0x00020000
 s_add_u32 s65, s65, 128
 s_cmp_eq_u32 s3, 0
 s_cselect_b32 s71, s68, s67
 s_branch f_sJ
f_sC:
 s_add_u32 s70, s66, 4096
 s_add_u32 s4, s54, s70
 s_addc_u32 s5, s55, 0
 s_sub_u32 s6, 6291456, s70
 s_mov_b32 s7, 0x00020000
 s_add_u32 s70, s66, 4224
 s_add_u32 s8, s54, s70
 s_addc_u32 s9, s55, 0
 s_sub_u32 s10, 6291456, s70
 s_mov_b32 s11, 0x00020000
 s_add_u32 s70, s66, 2048
 s_add_u32 s12, s54, s70
 s_addc_u32 s13, s55, 0
 s_sub_u32 s14, 6291456, s70
 s_mov_b32 s15, 0x00020000
 s_mov_b32 s71, s68
f_sJ:
 s_cmp_eq_u32 s3, 0
 s_cselect_b64 s[32:33], s[4:5], s[8:9]
 s_cselect_b64 s[34:35], s[6:7], s[10:11]
 s_cmp_ge_u32 s3, 2
 s_cselect_b64 s[32:33], s[12:13], s[32:33]
 s_cselect_b64 s[34:35], s[14:15], s[34:35]
 v_lshl_add_u32 v3, s63, 6, v2
 s_cmp_eq_u32 s3, 3
 s_cselect_b32 s70, 8, s63
 s_cselect_b32 s72, 0, s71
 v_mul_u32_u24 v5, 2, v3
 v_lshrrev_b32 v5, 3, v5
 v_mul_u32_u24 v120, s72, v5
 v_mul_u32_u24 v216, s71, v3
 s_lshl_b32 s71, s71, 9
 s_cmp_ge_u32 s70, 2
 v_mov_b32 v218, s71
 s_cselect_b32 s70, 0, s71
 v_add_u32 v216, s70, v216
 s_lshl_b32 s71, s61, 9
 s_add_u32 s71, s71, f_lbC-f_base
 v_add_u32 v121, s71, v4
 v_and_b32 v3, 1, v2
 s_lshl_b32 s70, s77, 7
 v_lshl_add_u32 v122, v3, 17, s70
 s_add_u32 s16, s56, s65
 s_addc_u32 s17, s57, 0
 s_sub_u32 s18, 7340032, s65
 s_mov_b32 s19, 0x00020000
 s_add_u32 s20, s58, s65
 s_addc_u32 s21, s59, 0
 s_sub_u32 s22, 7340032, s65
 s_mov_b32 s23, 0x00020000
 v_and_b32 v9, 15, v0
 v_lshlrev_b32 v142, 7, v9
 v_lshl_add_u32 v155, v1, 11, v142
 s_bitcmp1_b32 s3, 0
 s_cselect_b64 s[28:29], s[20:21], s[16:17]
 s_mov_b64 s[30:31], s[18:19]
 s_lshr_b32 s70, s3, 1
 s_lshl1_add_u32 s70, s63, s70
 s_lshl_b32 s70, s70, 6
 s_sub_u32 s70, 960, s70
 v_add_u32 v3, s70, v2
 v_mul_u32_u24 v217, s67, v3
 s_lshl_b32 s52, s3, 10
 v_lshrrev_b32 v3, 3, v2
 v_lshl_add_u32 v3, v1, 3, v3
 v_bfe_u32 v4, v2, 4, 1
 v_and_b32 v5, 1, v1
 v_lshl_or_b32 v4, v5, 1, v4
 v_lshlrev_b32 v4, 1, v4
 v_and_b32 v5, 7, v2
 v_xor_b32 v4, v4, v5
 v_lshlrev_b32 v4, 4, v4
 v_mad_u32_u24 v129, v3, s67, v4
 v_mad_u32_u24 v130, v3, s68, v4
 s_lshl_b32 s69, s63, 4
 s_lshl_b32 s70, s3, 2
 s_add_u32 s69, s69, s70
 s_lshl_b32 s48, s69, 15
 s_add_u32 s49, s48, 0x8000
 s_add_u32 s50, s48, 0x10000
 s_add_u32 s51, s48, 0x18000
 s_mov_b32 s44, 0
 s_mov_b32 s46, 0
 s_lshl_b32 s47, s69, 8
 s_add_u32 s47, s47, 41975808
 v_lshrrev_b32 v3, 4, v2
 v_bfe_u32 v4, v2, 2, 2
 v_lshl_add_u32 v5, v3, 3, v4
 v_lshlrev_b32 v5, 7, v5
 v_and_b32 v6, 3, v2
 v_lshl_add_u32 v5, v6, 3, v5
 v_bfe_u32 v7, v2, 3, 2
 v_xor_b32 v8, 0, v7
 v_lshl_add_u32 v131, v8, 5, v5
 v_add_u32 v135, 24576, v131
 v_xor_b32 v8, 1, v7
 v_lshl_add_u32 v132, v8, 5, v5
 v_add_u32 v136, 24576, v132
 v_xor_b32 v8, 2, v7
 v_lshl_add_u32 v133, v8, 5, v5
 v_add_u32 v137, 24576, v133
 v_xor_b32 v8, 3, v7
 v_lshl_add_u32 v134, v8, 5, v5
 v_add_u32 v138, 24576, v134
 s_mul_i32 s53, s3, 40960
 v_lshrrev_b32 v5, 2, v2
 v_lshlrev_b32 v5, 7, v5
 v_lshl_add_u32 v5, v6, 3, v5
 s_and_b32 s70, s60, 1
 s_and_b32 s71, s3, 1
 s_lshl1_add_u32 s70, s70, s71
 s_mul_i32 s70, s70, 40960
 v_add_u32 v5, s70, v5
 v_lshl_add_u32 v151, v7, 5, v5
 v_bfe_u32 v7, v2, 3, 1
 v_and_b32 v9, 15, v2
 v_lshlrev_b32 v5, 9, v3
 v_lshl_add_u32 v141, v9, 4, v5
 v_and_b32 v10, 7, v2
 v_lshl_add_u32 v5, v10, 4, v5
 v_lshl_add_u32 v5, v7, 8, v5
 s_cmp_ge_u32 s62, 2
 s_cselect_b64 vcc, -1, 0
 s_cselect_b32 s70, 1, 2
 s_lshl_b32 s70, s70, 7
 v_cndmask_b32 v139, v141, v5, vcc
 v_add_u32 v140, s70, v139
 v_and_b32 v8, 31, v2
 v_lshlrev_b32 v145, 5, v8
 v_bfe_u32 v11, v2, 4, 1
 v_lshrrev_b32 v5, 3, v2
 v_lshlrev_b32 v8, 1, v3
 v_xor_b32 v8, v8, v10
 v_lshlrev_b32 v8, 4, v8
 v_lshl_add_u32 v147, v5, 11, v8
 v_add_u32 v148, 0x4000, v147
 v_add_u32 v149, 0x8000, v147
 v_add_u32 v150, 0xc000, v147
 v_lshlrev_b32 v5, 11, v9
 v_lshl_add_u32 v5, v11, 5, v5
 v_lshrrev_b32 v8, 5, v2
 v_lshl_add_u32 v153, v8, 4, v5
 v_bfe_u32 v5, v2, 2, 1
 v_xor_b32 v5, v5, v11
 v_and_or_b32 v5, v6, 2, v5
 v_mov_b32 v8, 0x3f803f80
 v_cmp_eq_u32 vcc, 0, v5
 s_mul_i32 s67, s69, 147456
 s_lshl_b32 s70, s64, 11
 s_add_u32 s67, s67, s70
 s_add_u32 s67, s67, 4194304
 v_cndmask_b32 v156, 0, v8, vcc
 v_cndmask_b32 v157, 0, v8, vcc
 v_cndmask_b32 v158, 0, v8, vcc
 v_cndmask_b32 v159, 0, v8, vcc
 v_and_b32 v5, 6, v2
 v_cmp_eq_u32 vcc, 0, v5
 v_cmp_eq_u32 s[78:79], 4, v5
 s_nop 1
 v_cndmask_b32 v156, 0, v8, vcc
 v_cndmask_b32 v157, 0, v8, vcc
 v_cndmask_b32 v158, 0, v8, s[78:79]
 v_cndmask_b32 v159, 0, v8, s[78:79]
 s_lshl_b32 s68, s69, 10
 s_lshl_b32 s70, s60, 19
 s_add_u32 s68, s68, s70
 s_lshl_b32 s70, s62, 18
 s_add_u32 s70, s70, 25165824
 s_cmp_eq_u32 s62, 2
 s_cselect_b32 s70, 29622272, s70
 s_cmp_eq_u32 s62, 3
 s_cselect_b32 s70, 29360128, s70
 s_add_u32 s68, s68, s70
 s_lshl_b32 s73, s60, 12
 s_add_u32 s73, s73, 41943040
 s_lshl_b32 s70, s61, 5
 s_add_u32 s72, s73, s70
 s_lshl_b32 s54, s60, 2
 s_add_u32 s54, s54, s62
 s_lshr_b32 s55, s3, 1
 s_and_b32 s56, s3, 1
 s_lshl_b32 s57, s63, 1
 s_add_u32 s58, s57, s55
 s_lshl_b32 s58, s58, 10
 s_add_u32 s58, s58, s56
 s_lshl_b32 s59, s54, 2
 s_add_u32 s58, s58, s59
 s_lshl_b32 s58, s58, 2
 s_add_u32 s74, s58, 42008576
 s_add_u32 s57, s57, s56
 s_lshl_b32 s58, s57, 10
 s_add_u32 s58, s58, s55
 s_add_u32 s58, s58, s59
 s_lshl_b32 s58, s58, 2
 s_add_u32 s75, s58, 42074112
 s_cmp_lt_u32 s62, 2
 s_cselect_b32 s70, 0x3e8293ee, 1.0
 s_mov_b32 s71, s70
 s_lshl_b32 s58, s54, 17
 s_lshl_b32 s59, s57, 13
 s_add_u32 s59, s59, s58
 s_add_u32 s59, s59, 25165824
 s_lshl_b32 s69, s55, 12
 s_add_u32 s66, s59, s69
 s_xor_b32 s65, s66, 4096
 s_lshl_b32 s69, s55, 16
 s_add_u32 s58, s58, s69
 s_add_u32 s63, s58, 29360128
 s_add_u32 s64, s58, 33554432
 v_and_b32 v3, 7, v2
 v_lshlrev_b32 v4, 1, v1
 v_xor_b32 v4, v4, v3
 v_xor_b32 v5, 1, v4
 v_lshlrev_b32 v6, 7, v2
 v_add_u32 v6, 147456, v6
 v_lshl_add_u32 v112, v4, 4, v6
 v_lshl_add_u32 v113, v5, 4, v6
 v_lshrrev_b32 v4, 3, v0
 v_and_b32 v5, 7, v4
 v_xor_b32 v5, v5, v3
 v_lshlrev_b32 v5, 4, v5
 v_lshl_add_u32 v5, v4, 7, v5
 v_add_u32 v114, 147456, v5
 v_lshlrev_b32 v5, 4, v3
 v_lshl_add_u32 v115, v4, 8, v5
 v_add_u32 v116, 0x2000, v115
 v_add_u32 v117, 0x4000, v115
 v_add_u32 v118, 0x6000, v115
 s_lshr_b32 s71, s2, 1
 s_lshl_b32 s71, s71, 15
 s_and_b32 s45, s2, 1
 s_lshl_b32 s45, s45, 7
 s_add_u32 s71, s71, s45
 s_mov_b32 s45, 0xffff0000
f_lw0:
 s_waitcnt vmcnt(2)
f_lx0:
 v_lshlrev_b32 v32, 16, v16
 v_and_b32 v33, s45, v16
 v_lshlrev_b32 v34, 16, v17
 v_and_b32 v35, s45, v17
 v_lshlrev_b32 v36, 16, v18
 v_and_b32 v37, s45, v18
 v_lshlrev_b32 v38, 16, v19
 v_and_b32 v39, s45, v19
 v_lshlrev_b32 v40, 16, v20
 v_and_b32 v41, s45, v20
 v_lshlrev_b32 v42, 16, v21
 v_and_b32 v43, s45, v21
 v_lshlrev_b32 v44, 16, v22
 v_and_b32 v45, s45, v22
 v_lshlrev_b32 v46, 16, v23
 v_and_b32 v47, s45, v23
 v_pk_add_f32 v[64:65], v[32:33], v[40:41]
 v_pk_add_f32 v[66:67], v[34:35], v[42:43]
 v_pk_add_f32 v[68:69], v[36:37], v[44:45]
 v_pk_add_f32 v[70:71], v[38:39], v[46:47]
 v_pk_add_f32 v[64:65], v[64:65], v[68:69]
 v_pk_add_f32 v[66:67], v[66:67], v[70:71]
 v_pk_add_f32 v[64:65], v[64:65], v[66:67]
 v_add_f32 v64, v64, v65
f_lw1:
 s_waitcnt vmcnt(0)
f_lx1:
 buffer_load_dword v146, v120, s[32:35], 0 offen
 buffer_load_dword v146, v121, s[36:39], 0 offen
 v_lshlrev_b32 v48, 16, v24
 v_and_b32 v49, s45, v24
 v_lshlrev_b32 v50, 16, v25
 v_and_b32 v51, s45, v25
 v_lshlrev_b32 v52, 16, v26
 v_and_b32 v53, s45, v26
 v_lshlrev_b32 v54, 16, v27
 v_and_b32 v55, s45, v27
 v_lshlrev_b32 v56, 16, v28
 v_and_b32 v57, s45, v28
 v_lshlrev_b32 v58, 16, v29
 v_and_b32 v59, s45, v29
 v_lshlrev_b32 v60, 16, v30
 v_and_b32 v61, s45, v30
 v_lshlrev_b32 v62, 16, v31
 v_and_b32 v63, s45, v31
 v_pk_add_f32 v[72:73], v[48:49], v[56:57]
 v_pk_add_f32 v[74:75], v[50:51], v[58:59]
 v_pk_add_f32 v[76:77], v[52:53], v[60:61]
 v_pk_add_f32 v[78:79], v[54:55], v[62:63]
 v_pk_add_f32 v[72:73], v[72:73], v[76:77]
 v_pk_add_f32 v[74:75], v[74:75], v[78:79]
 v_pk_add_f32 v[72:73], v[72:73], v[74:75]
 v_add_f32 v72, v72, v73
 s_nop 1
 v_add_f32_dpp v64, v64, v64 quad_perm:[1,0,3,2] row_mask:0xf bank_mask:0xf
 v_add_f32_dpp v72, v72, v72 quad_perm:[1,0,3,2] row_mask:0xf bank_mask:0xf
 s_nop 1
 v_add_f32_dpp v64, v64, v64 quad_perm:[2,3,0,1] row_mask:0xf bank_mask:0xf
 v_add_f32_dpp v72, v72, v72 quad_perm:[2,3,0,1] row_mask:0xf bank_mask:0xf
 s_nop 1
 v_add_f32_dpp v64, v64, v64 row_half_mirror row_mask:0xf bank_mask:0xf
 v_add_f32_dpp v72, v72, v72 row_half_mirror row_mask:0xf bank_mask:0xf
 s_nop 1
 v_add_f32_dpp v64, v64, v64 row_mirror row_mask:0xf bank_mask:0xf
 v_add_f32_dpp v72, v72, v72 row_mirror row_mask:0xf bank_mask:0xf
 v_mov_b32 v65, v64
 v_mov_b32 v73, v72
 s_nop 1
 v_permlane16_swap_b32 v64, v65
 v_permlane16_swap_b32 v72, v73
 v_add_f32 v64, v64, v65
 v_add_f32 v72, v72, v73
 v_mov_b32 v65, v64
 v_mov_b32 v73, v72
 s_nop 1
 v_permlane32_swap_b32 v64, v65
 v_permlane32_swap_b32 v72, v73
 v_add_f32 v64, v64, v65
 v_add_f32 v72, v72, v73
 v_mul_f32 v64, 0x3a800000, v64
 v_mul_f32 v72, 0x3a800000, v72
 v_pk_add_f32 v[80:81], v[32:33], v[64:65] op_sel_hi:[1,0] neg_lo:[0,1] neg_hi:[0,1]
 v_pk_add_f32 v[82:83], v[34:35], v[64:65] op_sel_hi:[1,0] neg_lo:[0,1] neg_hi:[0,1]
 v_pk_add_f32 v[84:85], v[36:37], v[64:65] op_sel_hi:[1,0] neg_lo:[0,1] neg_hi:[0,1]
 v_pk_add_f32 v[86:87], v[38:39], v[64:65] op_sel_hi:[1,0] neg_lo:[0,1] neg_hi:[0,1]
 v_pk_add_f32 v[88:89], v[40:41], v[64:65] op_sel_hi:[1,0] neg_lo:[0,1] neg_hi:[0,1]
 v_pk_add_f32 v[90:91], v[42:43], v[64:65] op_sel_hi:[1,0] neg_lo:[0,1] neg_hi:[0,1]
 v_pk_add_f32 v[92:93], v[44:45], v[64:65] op_sel_hi:[1,0] neg_lo:[0,1] neg_hi:[0,1]
 v_pk_add_f32 v[94:95], v[46:47], v[64:65] op_sel_hi:[1,0] neg_lo:[0,1] neg_hi:[0,1]
 v_pk_mul_f32 v[66:67], v[80:81], v[80:81]
 v_pk_mul_f32 v[68:69], v[82:83], v[82:83]
 v_pk_fma_f32 v[66:67], v[84:85], v[84:85], v[66:67]
 v_pk_fma_f32 v[68:69], v[86:87], v[86:87], v[68:69]
 v_pk_fma_f32 v[66:67], v[88:89], v[88:89], v[66:67]
 v_pk_fma_f32 v[68:69], v[90:91], v[90:91], v[68:69]
 v_pk_fma_f32 v[66:67], v[92:93], v[92:93], v[66:67]
 v_pk_fma_f32 v[68:69], v[94:95], v[94:95], v[68:69]
 v_add_f32 v66, v66, v67
 v_add_f32 v68, v68, v69
 v_add_f32 v66, v66, v68
 v_pk_add_f32 v[96:97], v[48:49], v[72:73] op_sel_hi:[1,0] neg_lo:[0,1] neg_hi:[0,1]
 v_pk_add_f32 v[98:99], v[50:51], v[72:73] op_sel_hi:[1,0] neg_lo:[0,1] neg_hi:[0,1]
 v_pk_add_f32 v[100:101], v[52:53], v[72:73] op_sel_hi:[1,0] neg_lo:[0,1] neg_hi:[0,1]
 v_pk_add_f32 v[102:103], v[54:55], v[72:73] op_sel_hi:[1,0] neg_lo:[0,1] neg_hi:[0,1]
 v_pk_add_f32 v[104:105], v[56:57], v[72:73] op_sel_hi:[1,0] neg_lo:[0,1] neg_hi:[0,1]
 v_pk_add_f32 v[106:107], v[58:59], v[72:73] op_sel_hi:[1,0] neg_lo:[0,1] neg_hi:[0,1]
 v_pk_add_f32 v[108:109], v[60:61], v[72:73] op_sel_hi:[1,0] neg_lo:[0,1] neg_hi:[0,1]
 v_pk_add_f32 v[110:111], v[62:63], v[72:73] op_sel_hi:[1,0] neg_lo:[0,1] neg_hi:[0,1]
 v_pk_mul_f32 v[74:75], v[96:97], v[96:97]
 v_pk_mul_f32 v[76:77], v[98:99], v[98:99]
 v_pk_fma_f32 v[74:75], v[100:101], v[100:101], v[74:75]
 v_pk_fma_f32 v[76:77], v[102:103], v[102:103], v[76:77]
 v_pk_fma_f32 v[74:75], v[104:105], v[104:105], v[74:75]
 v_pk_fma_f32 v[76:77], v[106:107], v[106:107], v[76:77]
 v_pk_fma_f32 v[74:75], v[108:109], v[108:109], v[74:75]
 v_pk_fma_f32 v[76:77], v[110:111], v[110:111], v[76:77]
 v_add_f32 v74, v74, v75
 v_add_f32 v76, v76, v77
 v_add_f32 v74, v74, v76
 s_nop 1
 v_add_f32_dpp v66, v66, v66 quad_perm:[1,0,3,2] row_mask:0xf bank_mask:0xf
 v_add_f32_dpp v74, v74, v74 quad_perm:[1,0,3,2] row_mask:0xf bank_mask:0xf
 s_nop 1
 v_add_f32_dpp v66, v66, v66 quad_perm:[2,3,0,1] row_mask:0xf bank_mask:0xf
 v_add_f32_dpp v74, v74, v74 quad_perm:[2,3,0,1] row_mask:0xf bank_mask:0xf
 s_nop 1
 v_add_f32_dpp v66, v66, v66 row_half_mirror row_mask:0xf bank_mask:0xf
 v_add_f32_dpp v74, v74, v74 row_half_mirror row_mask:0xf bank_mask:0xf
 s_nop 1
 v_add_f32_dpp v66, v66, v66 row_mirror row_mask:0xf bank_mask:0xf
 v_add_f32_dpp v74, v74, v74 row_mirror row_mask:0xf bank_mask:0xf
 v_mov_b32 v67, v66
 v_mov_b32 v75, v74
 s_nop 1
 v_permlane16_swap_b32 v66, v67
 v_permlane16_swap_b32 v74, v75
 v_add_f32 v66, v66, v67
 v_add_f32 v74, v74, v75
 v_mov_b32 v67, v66
 v_mov_b32 v75, v74
 s_nop 1
 v_permlane32_swap_b32 v66, v67
 v_permlane32_swap_b32 v74, v75
 v_add_f32 v66, v66, v67
 v_add_f32 v74, v74, v75
 v_mul_f32 v66, 0x3a800000, v66
 v_mul_f32 v74, 0x3a800000, v74
 v_cvt_pk_bf16_f32 v64, v64, v72
 v_cvt_pk_bf16_f32 v66, v66, v74
 v_and_b32 v72, s45, v64
 v_lshlrev_b32 v64, 16, v64
 v_and_b32 v74, s45, v66
 v_lshlrev_b32 v66, 16, v66
 v_add_f32 v66, 0x3727c5ac, v66
 v_add_f32 v74, 0x3727c5ac, v74
 v_cvt_pk_bf16_f32 v66, v66, v74
 v_and_b32 v74, s45, v66
 v_lshlrev_b32 v66, 16, v66
 v_sqrt_f32 v74, v74
 v_sqrt_f32 v66, v66
 s_nop 0
 v_cvt_pk_bf16_f32 v66, v66, v74
 v_and_b32 v74, s45, v66
 v_lshlrev_b32 v66, 16, v66
 v_rcp_f32 v74, v74
 v_rcp_f32 v66, v66
 v_pk_add_f32 v[32:33], v[32:33], v[64:65] op_sel_hi:[1,0] neg_lo:[0,1] neg_hi:[0,1]
 v_pk_add_f32 v[34:35], v[34:35], v[64:65] op_sel_hi:[1,0] neg_lo:[0,1] neg_hi:[0,1]
 v_pk_add_f32 v[36:37], v[36:37], v[64:65] op_sel_hi:[1,0] neg_lo:[0,1] neg_hi:[0,1]
 v_pk_add_f32 v[38:39], v[38:39], v[64:65] op_sel_hi:[1,0] neg_lo:[0,1] neg_hi:[0,1]
 v_pk_add_f32 v[40:41], v[40:41], v[64:65] op_sel_hi:[1,0] neg_lo:[0,1] neg_hi:[0,1]
 v_pk_add_f32 v[42:43], v[42:43], v[64:65] op_sel_hi:[1,0] neg_lo:[0,1] neg_hi:[0,1]
 v_pk_add_f32 v[44:45], v[44:45], v[64:65] op_sel_hi:[1,0] neg_lo:[0,1] neg_hi:[0,1]
 v_pk_add_f32 v[46:47], v[46:47], v[64:65] op_sel_hi:[1,0] neg_lo:[0,1] neg_hi:[0,1]
 v_cvt_pk_bf16_f32 v80, v32, v33
 v_cvt_pk_bf16_f32 v81, v34, v35
 v_cvt_pk_bf16_f32 v82, v36, v37
 v_cvt_pk_bf16_f32 v83, v38, v39
 v_cvt_pk_bf16_f32 v84, v40, v41
 v_cvt_pk_bf16_f32 v85, v42, v43
 v_cvt_pk_bf16_f32 v86, v44, v45
 v_cvt_pk_bf16_f32 v87, v46, v47
 v_lshlrev_b32 v32, 16, v80
 v_and_b32 v33, s45, v80
 v_lshlrev_b32 v34, 16, v81
 v_and_b32 v35, s45, v81
 v_lshlrev_b32 v36, 16, v82
 v_and_b32 v37, s45, v82
 v_lshlrev_b32 v38, 16, v83
 v_and_b32 v39, s45, v83
 v_lshlrev_b32 v40, 16, v84
 v_and_b32 v41, s45, v84
 v_lshlrev_b32 v42, 16, v85
 v_and_b32 v43, s45, v85
 v_lshlrev_b32 v44, 16, v86
 v_and_b32 v45, s45, v86
 v_lshlrev_b32 v46, 16, v87
 v_and_b32 v47, s45, v87
 v_pk_mul_f32 v[32:33], v[32:33], v[66:67] op_sel_hi:[1,0]
 v_pk_mul_f32 v[34:35], v[34:35], v[66:67] op_sel_hi:[1,0]
 v_pk_mul_f32 v[36:37], v[36:37], v[66:67] op_sel_hi:[1,0]
 v_pk_mul_f32 v[38:39], v[38:39], v[66:67] op_sel_hi:[1,0]
 v_pk_mul_f32 v[40:41], v[40:41], v[66:67] op_sel_hi:[1,0]
 v_pk_mul_f32 v[42:43], v[42:43], v[66:67] op_sel_hi:[1,0]
 v_pk_mul_f32 v[44:45], v[44:45], v[66:67] op_sel_hi:[1,0]
 v_pk_mul_f32 v[46:47], v[46:47], v[66:67] op_sel_hi:[1,0]
 v_cvt_pk_bf16_f32 v88, v32, v33
 v_cvt_pk_bf16_f32 v89, v34, v35
 v_cvt_pk_bf16_f32 v90, v36, v37
 v_cvt_pk_bf16_f32 v91, v38, v39
 v_cvt_pk_bf16_f32 v92, v40, v41
 v_cvt_pk_bf16_f32 v93, v42, v43
 v_cvt_pk_bf16_f32 v94, v44, v45
 v_cvt_pk_bf16_f32 v95, v46, v47
 ds_write_b128 v112, v[88:91]
 ds_write_b128 v112, v[92:95] offset:8192
 v_pk_add_f32 v[48:49], v[48:49], v[72:73] op_sel_hi:[1,0] neg_lo:[0,1] neg_hi:[0,1]
 v_pk_add_f32 v[50:51], v[50:51], v[72:73] op_sel_hi:[1,0] neg_lo:[0,1] neg_hi:[0,1]
 v_pk_add_f32 v[52:53], v[52:53], v[72:73] op_sel_hi:[1,0] neg_lo:[0,1] neg_hi:[0,1]
 v_pk_add_f32 v[54:55], v[54:55], v[72:73] op_sel_hi:[1,0] neg_lo:[0,1] neg_hi:[0,1]
 v_pk_add_f32 v[56:57], v[56:57], v[72:73] op_sel_hi:[1,0] neg_lo:[0,1] neg_hi:[0,1]
 v_pk_add_f32 v[58:59], v[58:59], v[72:73] op_sel_hi:[1,0] neg_lo:[0,1] neg_hi:[0,1]
 v_pk_add_f32 v[60:61], v[60:61], v[72:73] op_sel_hi:[1,0] neg_lo:[0,1] neg_hi:[0,1]
 v_pk_add_f32 v[62:63], v[62:63], v[72:73] op_sel_hi:[1,0] neg_lo:[0,1] neg_hi:[0,1]
 v_cvt_pk_bf16_f32 v96, v48, v49
 v_cvt_pk_bf16_f32 v97, v50, v51
 v_cvt_pk_bf16_f32 v98, v52, v53
 v_cvt_pk_bf16_f32 v99, v54, v55
 v_cvt_pk_bf16_f32 v100, v56, v57
 v_cvt_pk_bf16_f32 v101, v58, v59
 v_cvt_pk_bf16_f32 v102, v60, v61
 v_cvt_pk_bf16_f32 v103, v62, v63
 v_lshlrev_b32 v48, 16, v96
 v_and_b32 v49, s45, v96
 v_lshlrev_b32 v50, 16, v97
 v_and_b32 v51, s45, v97
 v_lshlrev_b32 v52, 16, v98
 v_and_b32 v53, s45, v98
 v_lshlrev_b32 v54, 16, v99
 v_and_b32 v55, s45, v99
 v_lshlrev_b32 v56, 16, v100
 v_and_b32 v57, s45, v100
 v_lshlrev_b32 v58, 16, v101
 v_and_b32 v59, s45, v101
 v_lshlrev_b32 v60, 16, v102
 v_and_b32 v61, s45, v102
 v_lshlrev_b32 v62, 16, v103
 v_and_b32 v63, s45, v103
 v_pk_mul_f32 v[48:49], v[48:49], v[74:75] op_sel_hi:[1,0]
 v_pk_mul_f32 v[50:51], v[50:51], v[74:75] op_sel_hi:[1,0]
 v_pk_mul_f32 v[52:53], v[52:53], v[74:75] op_sel_hi:[1,0]
 v_pk_mul_f32 v[54:55], v[54:55], v[74:75] op_sel_hi:[1,0]
 v_pk_mul_f32 v[56:57], v[56:57], v[74:75] op_sel_hi:[1,0]
 v_pk_mul_f32 v[58:59], v[58:59], v[74:75] op_sel_hi:[1,0]
 v_pk_mul_f32 v[60:61], v[60:61], v[74:75] op_sel_hi:[1,0]
 v_pk_mul_f32 v[62:63], v[62:63], v[74:75] op_sel_hi:[1,0]
 v_cvt_pk_bf16_f32 v104, v48, v49
 v_cvt_pk_bf16_f32 v105, v50, v51
 v_cvt_pk_bf16_f32 v106, v52, v53
 v_cvt_pk_bf16_f32 v107, v54, v55
 v_cvt_pk_bf16_f32 v108, v56, v57
 v_cvt_pk_bf16_f32 v109, v58, v59
 v_cvt_pk_bf16_f32 v110, v60, v61
 v_cvt_pk_bf16_f32 v111, v62, v63
 ds_write_b128 v113, v[104:107]
 ds_write_b128 v113, v[108:111] offset:8192
f_lc:
 s_waitcnt lgkmcnt(0)
 s_barrier
f_ld:
 ds_read_b128 v[16:19], v114 offset:0
 ds_read_b128 v[20:23], v114 offset:4096
 ds_read_b128 v[24:27], v114 offset:8192
 ds_read_b128 v[28:31], v114 offset:12288
 s_mul_i32 s76, s76, 0x9e3779b1
 s_add_u32 s76, s76, 0x7f4a7c15
 v_mov_b32 v144, s76
 s_waitcnt lgkmcnt(3)
 buffer_store_dwordx4 v[16:19], v115, s[24:27], s71 offen sc1
 s_waitcnt lgkmcnt(2)
 buffer_store_dwordx4 v[20:23], v116, s[24:27], s71 offen sc1
 s_waitcnt lgkmcnt(1)
 buffer_store_dwordx4 v[24:27], v117, s[24:27], s71 offen sc1
 s_waitcnt lgkmcnt(0)
 buffer_store_dwordx4 v[28:31], v118, s[24:27], s71 offen sc1
 v_mov_b32 v5, 0x7ffffff0
 v_cmp_eq_u32 vcc, 0, v2
 s_lshl_b32 s45, s2, 5
 s_add_u32 s45, s45, s3
 s_lshl_b32 s45, s45, 2
 s_add_u32 s45, s45, 41975808
 v_cndmask_b32 v143, v5, v2, vcc
f_la:
 s_waitcnt vmcnt(0)
 buffer_store_dword v144, v143, s[24:27], s45 offen sc1
 v_and_b32 v3, 7, v2
 v_lshlrev_b32 v119, 7, v3
 v_bfe_u32 v3, v2, 3, 2
 v_lshl_add_u32 v119, v3, 2, v119
 s_lshl_b32 s77, s77, 11
 s_mov_b32 s69, 0
 s_and_b32 s71, s61, 3
 s_cmp_eq_u32 s71, 3
 s_cbranch_scc1 f_lbC
f_lbA:
 s_add_u32 m0, s52, 0
 s_nop 0
 buffer_load_dwordx4 v130, s[4:7], s46 offen lds
 s_add_u32 m0, s52, 8192
 s_nop 0
 buffer_load_dwordx4 v129, s[8:11], s44 offen lds
 s_add_u32 m0, s52, 16384
 s_nop 0
 buffer_load_dwordx4 v129, s[12:15], s44 offen lds
 s_add_u32 s44, s44, 229376
 s_add_u32 s46, s46, 196608
 s_add_u32 m0, s52, 4096
 s_nop 0
 buffer_load_dwordx4 v130, s[4:7], s46 offen lds
 s_add_u32 m0, s52, 12288
 s_nop 0
 buffer_load_dwordx4 v129, s[8:11], s44 offen lds
 s_add_u32 m0, s52, 20480
 s_nop 0
 buffer_load_dwordx4 v129, s[12:15], s44 offen lds
 s_add_u32 s44, s44, 229376
 s_add_u32 s46, s46, 196608
 s_add_u32 m0, s52, 24576
 s_nop 0
 buffer_load_dwordx4 v130, s[4:7], s46 offen lds
 s_add_u32 m0, s52, 32768
 s_nop 0
 buffer_load_dwordx4 v129, s[8:11], s44 offen lds
 s_add_u32 m0, s52, 40960
 s_nop 0
 buffer_load_dwordx4 v129, s[12:15], s44 offen lds
 s_add_u32 s44, s44, 229376
 s_add_u32 s46, s46, 196608
 s_add_u32 m0, s52, 28672
 s_nop 0
 buffer_load_dwordx4 v130, s[4:7], s46 offen lds
 s_add_u32 m0, s52, 36864
 s_nop 0
 buffer_load_dwordx4 v129, s[8:11], s44 offen lds
 s_add_u32 m0, s52, 45056
 s_nop 0
 buffer_load_dwordx4 v129, s[12:15], s44 offen lds
 s_add_u32 s44, s44, 229376
 s_add_u32 s46, s46, 196608
 s_lshr_b32 s71, s61, 2
 s_cmp_eq_u32 s3, 3
 s_cselect_b32 s45, 0, 0x101
 s_lshl_b32 s45, s45, s71
 s_lshr_b32 s45, s45, 2
 s_add_u32 s71, s71, 16
 s_bitset1_b32 s45, s71
 s_and_b32 s71, s61, 3
 s_lshl_b32 s71, s71, 15
 s_add_u32 s71, s71, s48
 s_branch f_pmA
f_plA:
 s_sleep 2
f_pmA:
 buffer_load_dword v154, v119, s[24:27], s47 offen sc1
 s_add_u32 s69, s69, 1
 s_cmp_lt_u32 s69, 0x8000
 s_waitcnt vmcnt(0)
 v_cmp_ne_u32 vcc, v144, v154
 s_cbranch_scc0 f_pkA
 s_cbranch_vccnz f_plA
f_pkA:
 buffer_load_dwordx4 v[0:3], v128, s[24:27], s48 offen offset:0 sc1
 buffer_load_dwordx4 v[4:7], v128, s[24:27], s49 offen offset:0 sc1
 buffer_load_dwordx4 v[8:11], v128, s[24:27], s50 offen offset:0 sc1
 buffer_load_dwordx4 v[12:15], v128, s[24:27], s51 offen offset:0 sc1
 buffer_load_dwordx4 v[16:19], v128, s[24:27], s48 offen offset:1024 sc1
 buffer_load_dwordx4 v[20:23], v128, s[24:27], s49 offen offset:1024 sc1
 buffer_load_dwordx4 v[24:27], v128, s[24:27], s50 offen offset:1024 sc1
 buffer_load_dwordx4 v[28:31], v128, s[24:27], s51 offen offset:1024 sc1
 s_barrier
 tr v,192,131,0
 tr v,194,131,512
 tr v,196,131,4096
 tr v,198,131,4608
 tr v,200,132,0
 tr v,202,132,512
 tr v,204,132,4096
 tr v,206,132,4608
 buffer_load_dwordx4 v[32:35], v128, s[24:27], s48 offen offset:2048 sc1
 buffer_load_dwordx4 v[36:39], v128, s[24:27], s49 offen offset:2048 sc1
 buffer_load_dwordx4 v[40:43], v128, s[24:27], s50 offen offset:2048 sc1
 buffer_load_dwordx4 v[44:47], v128, s[24:27], s51 offen offset:2048 sc1
 buffer_load_dwordx4 v[48:51], v128, s[24:27], s48 offen offset:3072 sc1
 s_add_u32 s48, s48, 4096
 buffer_load_dwordx4 v[52:55], v128, s[24:27], s49 offen offset:3072 sc1
 s_add_u32 s49, s49, 4096
 buffer_load_dwordx4 v[56:59], v128, s[24:27], s50 offen offset:3072 sc1
 s_add_u32 s50, s50, 4096
 buffer_load_dwordx4 v[60:63], v128, s[24:27], s51 offen offset:3072 sc1
 s_add_u32 s51, s51, 4096
 s_waitcnt vmcnt(8) lgkmcnt(4)
f_A0:
 v_mfma_f32_16x16x32_bf16 a[0:3], v[192:195], v[0:3], 0
 tr v,208,133,0
 mf a,0,v,196,v,16
 tr v,210,133,512
 s_add_u32 m0, s52, 49152
 v_mfma_f32_16x16x32_bf16 a[4:7], v[192:195], v[4:7], 0
 buffer_load_dwordx4 v130, s[4:7], s46 offen lds
 mf a,4,v,196,v,20
 v_mfma_f32_16x16x32_bf16 a[8:11], v[192:195], v[8:11], 0
 tr v,212,133,4096
 mf a,8,v,196,v,24
 tr v,214,133,4608
 s_add_u32 m0, s52, 57344
 v_mfma_f32_16x16x32_bf16 a[12:15], v[192:195], v[12:15], 0
 buffer_load_dwordx4 v129, s[8:11], s44 offen lds
 mf a,12,v,196,v,28
 s_waitcnt lgkmcnt(4)
 v_mfma_f32_16x16x32_bf16 a[16:19], v[200:203], v[0:3], 0
 tr v,192,134,0
 mf a,16,v,204,v,16
 tr v,194,134,512
 s_add_u32 m0, s52, 65536
 v_mfma_f32_16x16x32_bf16 a[20:23], v[200:203], v[4:7], 0
 buffer_load_dwordx4 v129, s[12:15], s44 offen lds
 s_add_u32 s44, s44, 229376
 mf a,20,v,204,v,20
 s_add_u32 s46, s46, 196608
 s_bitcmp1_b32 s45, 0
 s_cbranch_scc0 f_wA0
 buffer_load_dword v146, v216, s[32:35], 0 offen
 v_add_u32 v216, v218, v216
f_wA0:
 v_mfma_f32_16x16x32_bf16 a[24:27], v[200:203], v[8:11], 0
 tr v,196,134,4096
 mf a,24,v,204,v,24
 tr v,198,134,4608
 s_add_u32 m0, s52, 53248
 v_mfma_f32_16x16x32_bf16 a[28:31], v[200:203], v[12:15], 0
 buffer_load_dwordx4 v130, s[4:7], s46 offen lds
 mf a,28,v,204,v,28
 s_waitcnt lgkmcnt(4)
 v_mfma_f32_16x16x32_bf16 a[32:35], v[208:211], v[0:3], 0
 tr v,200,131,8192
 mf a,32,v,212,v,16
 tr v,202,131,8704
 s_add_u32 m0, s52, 61440
 v_mfma_f32_16x16x32_bf16 a[36:39], v[208:211], v[4:7], 0
 buffer_load_dwordx4 v129, s[8:11], s44 offen lds
 mf a,36,v,212,v,20
 v_mfma_f32_16x16x32_bf16 a[40:43], v[208:211], v[8:11], 0
 tr v,204,131,12288
 mf a,40,v,212,v,24
 tr v,206,131,12800
 v_mfma_f32_16x16x32_bf16 a[44:47], v[208:211], v[12:15], 0
 mf a,44,v,212,v,28
 s_waitcnt lgkmcnt(4)
 v_mfma_f32_16x16x32_bf16 a[48:51], v[192:195], v[0:3], 0
 tr v,208,132,8192
 mf a,48,v,196,v,16
 tr v,210,132,8704
 s_add_u32 m0, s52, 69632
 v_mfma_f32_16x16x32_bf16 a[52:55], v[192:195], v[4:7], 0
 buffer_load_dwordx4 v129, s[12:15], s44 offen lds
 s_add_u32 s44, s44, 229376
 mf a,52,v,196,v,20
 s_add_u32 s46, s46, 196608
 v_mfma_f32_16x16x32_bf16 a[56:59], v[192:195], v[8:11], 0
 tr v,212,132,12288
 mf a,56,v,196,v,24
 tr v,214,132,12800
 v_mfma_f32_16x16x32_bf16 a[60:63], v[192:195], v[12:15], 0
 buffer_load_dwordx4 v[64:67], v128, s[24:27], s48 offen offset:0 sc1
 mf a,60,v,196,v,28
 s_waitcnt lgkmcnt(4)
 v_mfma_f32_16x16x32_bf16 a[64:67], v[200:203], v[0:3], 0
 tr v,192,133,8192
 mf a,64,v,204,v,16
 tr v,194,133,8704
 v_mfma_f32_16x16x32_bf16 a[68:71], v[200:203], v[4:7], 0
 buffer_load_dwordx4 v[68:71], v128, s[24:27], s49 offen offset:0 sc1
 mf a,68,v,204,v,20
 v_mfma_f32_16x16x32_bf16 a[72:75], v[200:203], v[8:11], 0
 tr v,196,133,12288
 mf a,72,v,204,v,24
 tr v,198,133,12800
 v_mfma_f32_16x16x32_bf16 a[76:79], v[200:203], v[12:15], 0
 buffer_load_dwordx4 v[72:75], v128, s[24:27], s50 offen offset:0 sc1
 mf a,76,v,204,v,28
 s_waitcnt lgkmcnt(4)
 v_mfma_f32_16x16x32_bf16 a[80:83], v[208:211], v[0:3], 0
 tr v,200,134,8192
 mf a,80,v,212,v,16
 tr v,202,134,8704
 v_mfma_f32_16x16x32_bf16 a[84:87], v[208:211], v[4:7], 0
 buffer_load_dwordx4 v[76:79], v128, s[24:27], s51 offen offset:0 sc1
 mf a,84,v,212,v,20
 v_mfma_f32_16x16x32_bf16 a[88:91], v[208:211], v[8:11], 0
 tr v,204,134,12288
 mf a,88,v,212,v,24
 tr v,206,134,12800
 v_mfma_f32_16x16x32_bf16 a[92:95], v[208:211], v[12:15], 0
 mf a,92,v,212,v,28
 s_waitcnt lgkmcnt(4)
 v_mfma_f32_16x16x32_bf16 a[96:99], v[192:195], v[0:3], 0
 tr v,208,131,16384
 mf a,96,v,196,v,16
 tr v,210,131,16896
 v_mfma_f32_16x16x32_bf16 a[100:103], v[192:195], v[4:7], 0
 buffer_load_dwordx4 v[80:83], v128, s[24:27], s48 offen offset:1024 sc1
 mf a,100,v,196,v,20
 v_mfma_f32_16x16x32_bf16 a[104:107], v[192:195], v[8:11], 0
 tr v,212,131,20480
 mf a,104,v,196,v,24
 tr v,214,131,20992
 v_mfma_f32_16x16x32_bf16 a[108:111], v[192:195], v[12:15], 0
 buffer_load_dwordx4 v[84:87], v128, s[24:27], s49 offen offset:1024 sc1
 mf a,108,v,196,v,28
 s_waitcnt lgkmcnt(4)
 v_mfma_f32_16x16x32_bf16 a[112:115], v[200:203], v[0:3], 0
 tr v,192,132,16384
 mf a,112,v,204,v,16
 tr v,194,132,16896
 v_mfma_f32_16x16x32_bf16 a[116:119], v[200:203], v[4:7], 0
 buffer_load_dwordx4 v[88:91], v128, s[24:27], s50 offen offset:1024 sc1
 mf a,116,v,204,v,20
 s_bitcmp1_b32 s45, 1
 s_cbranch_scc0 f_wA1
 buffer_load_dword v146, v216, s[32:35], 0 offen
 v_add_u32 v216, v218, v216
f_wA1:
 v_mfma_f32_16x16x32_bf16 a[120:123], v[200:203], v[8:11], 0
 tr v,196,132,20480
 mf a,120,v,204,v,24
 tr v,198,132,20992
 v_mfma_f32_16x16x32_bf16 a[124:127], v[200:203], v[12:15], 0
 buffer_load_dwordx4 v[92:95], v128, s[24:27], s51 offen offset:1024 sc1
 mf a,124,v,204,v,28
 s_waitcnt lgkmcnt(4)
 v_mfma_f32_16x16x32_bf16 a[128:131], v[208:211], v[0:3], 0
 tr v,200,133,16384
 mf a,128,v,212,v,16
 tr v,202,133,16896
 v_mfma_f32_16x16x32_bf16 a[132:135], v[208:211], v[4:7], 0
 buffer_load_dwordx4 v[96:99], v128, s[24:27], s48 offen offset:2048 sc1
 mf a,132,v,212,v,20
 v_mfma_f32_16x16x32_bf16 a[136:139], v[208:211], v[8:11], 0
 tr v,204,133,20480
 mf a,136,v,212,v,24
 tr v,206,133,20992
 v_mfma_f32_16x16x32_bf16 a[140:143], v[208:211], v[12:15], 0
 buffer_load_dwordx4 v[100:103], v128, s[24:27], s49 offen offset:2048 sc1
 mf a,140,v,212,v,28
 s_waitcnt lgkmcnt(4)
 v_mfma_f32_16x16x32_bf16 a[144:147], v[192:195], v[0:3], 0
 tr v,208,134,16384
 mf a,144,v,196,v,16
 tr v,210,134,16896
 v_mfma_f32_16x16x32_bf16 a[148:151], v[192:195], v[4:7], 0
 buffer_load_dwordx4 v[104:107], v128, s[24:27], s50 offen offset:2048 sc1
 mf a,148,v,196,v,20
 v_mfma_f32_16x16x32_bf16 a[152:155], v[192:195], v[8:11], 0
 tr v,212,134,20480
 mf a,152,v,196,v,24
 tr v,214,134,20992
 v_mfma_f32_16x16x32_bf16 a[156:159], v[192:195], v[12:15], 0
 buffer_load_dwordx4 v[108:111], v128, s[24:27], s51 offen offset:2048 sc1
 mf a,156,v,196,v,28
 s_waitcnt lgkmcnt(4)
 v_mfma_f32_16x16x32_bf16 a[160:163], v[200:203], v[0:3], 0
 mf a,160,v,204,v,16
 v_mfma_f32_16x16x32_bf16 a[164:167], v[200:203], v[4:7], 0
 buffer_load_dwordx4 v[112:115], v128, s[24:27], s48 offen offset:3072 sc1
 s_add_u32 s48, s48, 4096
 mf a,164,v,204,v,20
 s_waitcnt lgkmcnt(0)
 s_barrier
 v_mfma_f32_16x16x32_bf16 a[168:171], v[200:203], v[8:11], 0
 tr v,192,135,0
 mf a,168,v,204,v,24
 tr v,194,135,512
 v_mfma_f32_16x16x32_bf16 a[172:175], v[200:203], v[12:15], 0
 tr v,196,135,4096
 mf a,172,v,204,v,28
 tr v,198,135,4608
 v_mfma_f32_16x16x32_bf16 a[176:179], v[208:211], v[0:3], 0
 tr v,200,136,0
 mf a,176,v,212,v,16
 tr v,202,136,512
 v_mfma_f32_16x16x32_bf16 a[180:183], v[208:211], v[4:7], 0
 buffer_load_dwordx4 v[116:119], v128, s[24:27], s49 offen offset:3072 sc1
 s_add_u32 s49, s49, 4096
 mf a,180,v,212,v,20
 v_mfma_f32_16x16x32_bf16 a[184:187], v[208:211], v[8:11], 0
 tr v,204,136,4096
 mf a,184,v,212,v,24
 tr v,206,136,4608
 v_mfma_f32_16x16x32_bf16 a[188:191], v[208:211], v[12:15], 0
 mf a,188,v,212,v,28
 s_waitcnt vmcnt(20) lgkmcnt(4)
f_A1:
 s_mov_b32 s69, f_A4-f_base
 mf a,0,v,192,v,32
 tr v,208,137,0
 v_add_u32 v131, 0xc000, v131
 mf a,0,v,196,v,48
 tr v,210,137,512
 mf a,4,v,192,v,36
 buffer_load_dword v146, v155, s[36:39], s69 offen
 mf a,4,v,196,v,52
 mf a,8,v,192,v,40
 tr v,212,137,4096
 v_add_u32 v132, 0xc000, v132
 mf a,8,v,196,v,56
 tr v,214,137,4608
 mf a,12,v,192,v,44
 buffer_load_dwordx4 v[120:123], v128, s[24:27], s50 offen offset:3072 sc1
 s_add_u32 s50, s50, 4096
 mf a,12,v,196,v,60
 s_waitcnt lgkmcnt(4)
 mf a,16,v,200,v,32
 tr v,192,138,0
 v_add_u32 v133, 0xc000, v133
 mf a,16,v,204,v,48
 tr v,194,138,512
 mf a,20,v,200,v,36
 buffer_load_dwordx4 v[124:127], v128, s[24:27], s51 offen offset:3072 sc1
 s_add_u32 s51, s51, 4096
 mf a,20,v,204,v,52
 s_bitcmp1_b32 s45, 2
 s_cbranch_scc0 f_wA2
 buffer_load_dword v146, v216, s[32:35], 0 offen
 v_add_u32 v216, v218, v216
f_wA2:
 mf a,24,v,200,v,40
 tr v,196,138,4096
 v_add_u32 v134, 0xc000, v134
 mf a,24,v,204,v,56
 tr v,198,138,4608
 mf a,28,v,200,v,44
 buffer_load_dwordx4 v[0:3], v128, s[24:27], s48 offen offset:0 sc1
 mf a,28,v,204,v,60
 s_waitcnt lgkmcnt(4)
 mf a,32,v,208,v,32
 tr v,200,135,8192
 mf a,32,v,212,v,48
 tr v,202,135,8704
 mf a,36,v,208,v,36
 buffer_load_dwordx4 v[4:7], v128, s[24:27], s49 offen offset:0 sc1
 mf a,36,v,212,v,52
 mf a,40,v,208,v,40
 tr v,204,135,12288
 mf a,40,v,212,v,56
 tr v,206,135,12800
 mf a,44,v,208,v,44
 mf a,44,v,212,v,60
 s_waitcnt lgkmcnt(4)
 mf a,48,v,192,v,32
 tr v,208,136,8192
 mf a,48,v,196,v,48
 tr v,210,136,8704
 mf a,52,v,192,v,36
 buffer_load_dwordx4 v[8:11], v128, s[24:27], s50 offen offset:0 sc1
 mf a,52,v,196,v,52
 mf a,56,v,192,v,40
 tr v,212,136,12288
 mf a,56,v,196,v,56
 tr v,214,136,12800
 mf a,60,v,192,v,44
 buffer_load_dwordx4 v[12:15], v128, s[24:27], s51 offen offset:0 sc1
 mf a,60,v,196,v,60
 s_waitcnt lgkmcnt(4)
 mf a,64,v,200,v,32
 tr v,192,137,8192
 mf a,64,v,204,v,48
 tr v,194,137,8704
 mf a,68,v,200,v,36
 buffer_load_dwordx4 v[16:19], v128, s[24:27], s48 offen offset:1024 sc1
 mf a,68,v,204,v,52
 mf a,72,v,200,v,40
 tr v,196,137,12288
 mf a,72,v,204,v,56
 tr v,198,137,12800
 mf a,76,v,200,v,44
 buffer_load_dwordx4 v[20:23], v128, s[24:27], s49 offen offset:1024 sc1
 mf a,76,v,204,v,60
 s_waitcnt lgkmcnt(4)
 mf a,80,v,208,v,32
 tr v,200,138,8192
 mf a,80,v,212,v,48
 tr v,202,138,8704
 mf a,84,v,208,v,36
 buffer_load_dwordx4 v[24:27], v128, s[24:27], s50 offen offset:1024 sc1
 mf a,84,v,212,v,52
 mf a,88,v,208,v,40
 tr v,204,138,12288
 mf a,88,v,212,v,56
 tr v,206,138,12800
 mf a,92,v,208,v,44
 mf a,92,v,212,v,60
 s_waitcnt lgkmcnt(4)
 mf a,96,v,192,v,32
 tr v,208,135,16384
 mf a,96,v,196,v,48
 tr v,210,135,16896
 mf a,100,v,192,v,36
 buffer_load_dwordx4 v[28:31], v128, s[24:27], s51 offen offset:1024 sc1
 mf a,100,v,196,v,52
 mf a,104,v,192,v,40
 tr v,212,135,20480
 mf a,104,v,196,v,56
 tr v,214,135,20992
 mf a,108,v,192,v,44
 mf a,108,v,196,v,60
 s_waitcnt lgkmcnt(4)
 mf a,112,v,200,v,32
 tr v,192,136,16384
 mf a,112,v,204,v,48
 tr v,194,136,16896
 mf a,116,v,200,v,36
 mf a,116,v,204,v,52
 s_bitcmp1_b32 s45, 3
 s_cbranch_scc0 f_wA3
 buffer_load_dword v146, v216, s[32:35], 0 offen
 v_add_u32 v216, v218, v216
f_wA3:
 mf a,120,v,200,v,40
 tr v,196,136,20480
 mf a,120,v,204,v,56
 tr v,198,136,20992
 mf a,124,v,200,v,44
 mf a,124,v,204,v,60
 s_waitcnt lgkmcnt(4)
 mf a,128,v,208,v,32
 tr v,200,137,16384
 mf a,128,v,212,v,48
 tr v,202,137,16896
 mf a,132,v,208,v,36
 mf a,132,v,212,v,52
 mf a,136,v,208,v,40
 tr v,204,137,20480
 mf a,136,v,212,v,56
 tr v,206,137,20992
 mf a,140,v,208,v,44
 mf a,140,v,212,v,60
 s_waitcnt lgkmcnt(4)
 mf a,144,v,192,v,32
 tr v,208,138,16384
 mf a,144,v,196,v,48
 tr v,210,138,16896
 mf a,148,v,192,v,36
 mf a,148,v,196,v,52
 mf a,152,v,192,v,40
 tr v,212,138,20480
 mf a,152,v,196,v,56
 tr v,214,138,20992
 mf a,156,v,192,v,44
 mf a,156,v,196,v,60
 s_waitcnt lgkmcnt(4)
 mf a,160,v,200,v,32
 mf a,160,v,204,v,48
 mf a,164,v,200,v,36
 mf a,164,v,204,v,52
 s_waitcnt vmcnt(25) lgkmcnt(0)
 s_barrier
 mf a,168,v,200,v,40
 tr v,192,131,0
 mf a,168,v,204,v,56
 tr v,194,131,512
 mf a,172,v,200,v,44
 tr v,196,131,4096
 mf a,172,v,204,v,60
 tr v,198,131,4608
 mf a,176,v,208,v,32
 tr v,200,132,0
 mf a,176,v,212,v,48
 tr v,202,132,512
 mf a,180,v,208,v,36
 mf a,180,v,212,v,52
 mf a,184,v,208,v,40
 tr v,204,132,4096
 mf a,184,v,212,v,56
 tr v,206,132,4608
 mf a,188,v,208,v,44
 mf a,188,v,212,v,60
 s_waitcnt vmcnt(17) lgkmcnt(4)
f_A2:
 mf a,0,v,192,v,64
 tr v,208,133,0
 v_add_u32 v135, 0xc000, v135
 mf a,0,v,196,v,80
 tr v,210,133,512
 s_add_u32 m0, s52, 73728
 mf a,4,v,192,v,68
 buffer_load_dwordx4 v130, s[4:7], s46 offen lds
 mf a,4,v,196,v,84
 mf a,8,v,192,v,72
 tr v,212,133,4096
 v_add_u32 v136, 0xc000, v136
 mf a,8,v,196,v,88
 tr v,214,133,4608
 s_add_u32 m0, s52, 81920
 mf a,12,v,192,v,76
 buffer_load_dwordx4 v129, s[8:11], s44 offen lds
 mf a,12,v,196,v,92
 s_waitcnt lgkmcnt(4)
 mf a,16,v,200,v,64
 tr v,192,134,0
 v_add_u32 v137, 0xc000, v137
 mf a,16,v,204,v,80
 tr v,194,134,512
 s_add_u32 m0, s52, 90112
 mf a,20,v,200,v,68
 buffer_load_dwordx4 v129, s[12:15], s44 offen lds
 s_add_u32 s44, s44, 229376
 mf a,20,v,204,v,84
 s_add_u32 s46, s46, 196608
 s_bitcmp1_b32 s45, 4
 s_cbranch_scc0 f_wA4
 buffer_load_dword v146, v216, s[32:35], 0 offen
 v_add_u32 v216, v218, v216
f_wA4:
 mf a,24,v,200,v,72
 tr v,196,134,4096
 v_add_u32 v138, 0xc000, v138
 mf a,24,v,204,v,88
 tr v,198,134,4608
 s_add_u32 m0, s52, 77824
 mf a,28,v,200,v,76
 buffer_load_dwordx4 v130, s[4:7], s46 offen lds
 mf a,28,v,204,v,92
 s_waitcnt lgkmcnt(4)
 mf a,32,v,208,v,64
 tr v,200,131,8192
 mf a,32,v,212,v,80
 tr v,202,131,8704
 s_add_u32 m0, s52, 86016
 mf a,36,v,208,v,68
 buffer_load_dwordx4 v129, s[8:11], s44 offen lds
 mf a,36,v,212,v,84
 mf a,40,v,208,v,72
 tr v,204,131,12288
 mf a,40,v,212,v,88
 tr v,206,131,12800
 mf a,44,v,208,v,76
 mf a,44,v,212,v,92
 s_waitcnt lgkmcnt(4)
 mf a,48,v,192,v,64
 tr v,208,132,8192
 mf a,48,v,196,v,80
 tr v,210,132,8704
 s_add_u32 m0, s52, 94208
 mf a,52,v,192,v,68
 buffer_load_dwordx4 v129, s[12:15], s44 offen lds
 s_add_u32 s44, s44, 229376
 mf a,52,v,196,v,84
 s_add_u32 s46, s46, 196608
 mf a,56,v,192,v,72
 tr v,212,132,12288
 mf a,56,v,196,v,88
 tr v,214,132,12800
 mf a,60,v,192,v,76
 buffer_load_dwordx4 v[32:35], v128, s[24:27], s48 offen offset:2048 sc1
 mf a,60,v,196,v,92
 s_waitcnt lgkmcnt(4)
 mf a,64,v,200,v,64
 tr v,192,133,8192
 mf a,64,v,204,v,80
 tr v,194,133,8704
 mf a,68,v,200,v,68
 buffer_load_dwordx4 v[36:39], v128, s[24:27], s49 offen offset:2048 sc1
 mf a,68,v,204,v,84
 mf a,72,v,200,v,72
 tr v,196,133,12288
 mf a,72,v,204,v,88
 tr v,198,133,12800
 mf a,76,v,200,v,76
 buffer_load_dwordx4 v[40:43], v128, s[24:27], s50 offen offset:2048 sc1
 mf a,76,v,204,v,92
 s_waitcnt lgkmcnt(4)
 mf a,80,v,208,v,64
 tr v,200,134,8192
 mf a,80,v,212,v,80
 tr v,202,134,8704
 mf a,84,v,208,v,68
 buffer_load_dwordx4 v[44:47], v128, s[24:27], s51 offen offset:2048 sc1
 mf a,84,v,212,v,84
 mf a,88,v,208,v,72
 tr v,204,134,12288
 mf a,88,v,212,v,88
 tr v,206,134,12800
 mf a,92,v,208,v,76
 mf a,92,v,212,v,92
 s_waitcnt lgkmcnt(4)
 mf a,96,v,192,v,64
 tr v,208,131,16384
 mf a,96,v,196,v,80
 tr v,210,131,16896
 s_add_u32 m0, s52, 98304
 mf a,100,v,192,v,68
 buffer_load_dwordx4 v130, s[4:7], s46 offen lds
 mf a,100,v,196,v,84
 mf a,104,v,192,v,72
 tr v,212,131,20480
 mf a,104,v,196,v,88
 tr v,214,131,20992
 s_add_u32 m0, s52, 106496
 mf a,108,v,192,v,76
 buffer_load_dwordx4 v129, s[8:11], s44 offen lds
 mf a,108,v,196,v,92
 s_waitcnt lgkmcnt(4)
 mf a,112,v,200,v,64
 tr v,192,132,16384
 mf a,112,v,204,v,80
 tr v,194,132,16896
 s_add_u32 m0, s52, 114688
 mf a,116,v,200,v,68
 buffer_load_dwordx4 v129, s[12:15], s44 offen lds
 s_add_u32 s44, s44, 229376
 mf a,116,v,204,v,84
 s_add_u32 s46, s46, 196608
 s_bitcmp1_b32 s45, 5
 s_cbranch_scc0 f_wA5
 buffer_load_dword v146, v216, s[32:35], 0 offen
 v_add_u32 v216, v218, v216
f_wA5:
 mf a,120,v,200,v,72
 tr v,196,132,20480
 mf a,120,v,204,v,88
 tr v,198,132,20992
 s_add_u32 m0, s52, 102400
 mf a,124,v,200,v,76
 buffer_load_dwordx4 v130, s[4:7], s46 offen lds
 mf a,124,v,204,v,92
 s_waitcnt lgkmcnt(4)
 mf a,128,v,208,v,64
 tr v,200,133,16384
 mf a,128,v,212,v,80
 tr v,202,133,16896
 s_add_u32 m0, s52, 110592
 mf a,132,v,208,v,68
 buffer_load_dwordx4 v129, s[8:11], s44 offen lds
 mf a,132,v,212,v,84
 mf a,136,v,208,v,72
 tr v,204,133,20480
 mf a,136,v,212,v,88
 tr v,206,133,20992
 s_add_u32 m0, s52, 118784
 mf a,140,v,208,v,76
 buffer_load_dwordx4 v129, s[12:15], s44 offen lds
 s_add_u32 s44, s44, 229376
 mf a,140,v,212,v,92
 s_add_u32 s46, s46, 196608
 s_waitcnt lgkmcnt(4)
 mf a,144,v,192,v,64
 tr v,208,134,16384
 mf a,144,v,196,v,80
 tr v,210,134,16896
 mf a,148,v,192,v,68
 buffer_load_dwordx4 v[48:51], v128, s[24:27], s48 offen offset:3072 sc1
 s_add_u32 s48, s48, 4096
 mf a,148,v,196,v,84
 mf a,152,v,192,v,72
 tr v,212,134,20480
 mf a,152,v,196,v,88
 tr v,214,134,20992
 mf a,156,v,192,v,76
 buffer_load_dwordx4 v[52:55], v128, s[24:27], s49 offen offset:3072 sc1
 s_add_u32 s49, s49, 4096
 mf a,156,v,196,v,92
 s_waitcnt lgkmcnt(4)
 mf a,160,v,200,v,64
 mf a,160,v,204,v,80
 mf a,164,v,200,v,68
 buffer_load_dwordx4 v[56:59], v128, s[24:27], s50 offen offset:3072 sc1
 s_add_u32 s50, s50, 4096
 mf a,164,v,204,v,84
 s_waitcnt vmcnt(13) lgkmcnt(0)
 s_barrier
 mf a,168,v,200,v,72
 tr v,192,135,0
 mf a,168,v,204,v,88
 tr v,194,135,512
 mf a,172,v,200,v,76
 tr v,196,135,4096
 mf a,172,v,204,v,92
 tr v,198,135,4608
 mf a,176,v,208,v,64
 tr v,200,136,0
 mf a,176,v,212,v,80
 tr v,202,136,512
 mf a,180,v,208,v,68
 buffer_load_dwordx4 v[60:63], v128, s[24:27], s51 offen offset:3072 sc1
 s_add_u32 s51, s51, 4096
 mf a,180,v,212,v,84
 mf a,184,v,208,v,72
 tr v,204,136,4096
 mf a,184,v,212,v,88
 tr v,206,136,4608
 mf a,188,v,208,v,76
 mf a,188,v,212,v,92
 s_waitcnt lgkmcnt(4)
f_A3:
 mf a,0,v,192,v,96
 tr v,208,137,0
 v_add_u32 v131, 0xc000, v131
 mf a,0,v,196,v,112
 tr v,210,137,512
 s_add_u32 m0, s52, 122880
 mf a,4,v,192,v,100
 buffer_load_dwordx4 v130, s[4:7], s46 offen lds
 mf a,4,v,196,v,116
 mf a,8,v,192,v,104
 tr v,212,137,4096
 v_add_u32 v132, 0xc000, v132
 mf a,8,v,196,v,120
 tr v,214,137,4608
 s_add_u32 m0, s52, 131072
 mf a,12,v,192,v,108
 buffer_load_dwordx4 v129, s[8:11], s44 offen lds
 mf a,12,v,196,v,124
 s_waitcnt lgkmcnt(4)
 mf a,16,v,200,v,96
 tr v,192,138,0
 v_add_u32 v133, 0xc000, v133
 mf a,16,v,204,v,112
 tr v,194,138,512
 s_add_u32 m0, s52, 139264
 mf a,20,v,200,v,100
 buffer_load_dwordx4 v129, s[12:15], s44 offen lds
 s_add_u32 s44, s44, 229376
 mf a,20,v,204,v,116
 s_add_u32 s46, s46, 196608
 s_bitcmp1_b32 s45, 6
 s_cbranch_scc0 f_wA6
 buffer_load_dword v146, v216, s[32:35], 0 offen
 v_add_u32 v216, v218, v216
f_wA6:
 mf a,24,v,200,v,104
 tr v,196,138,4096
 v_add_u32 v134, 0xc000, v134
 mf a,24,v,204,v,120
 tr v,198,138,4608
 s_add_u32 m0, s52, 126976
 mf a,28,v,200,v,108
 buffer_load_dwordx4 v130, s[4:7], s46 offen lds
 mf a,28,v,204,v,124
 s_waitcnt lgkmcnt(4)
 mf a,32,v,208,v,96
 tr v,200,135,8192
 mf a,32,v,212,v,112
 tr v,202,135,8704
 s_add_u32 m0, s52, 135168
 mf a,36,v,208,v,100
 buffer_load_dwordx4 v129, s[8:11], s44 offen lds
 mf a,36,v,212,v,116
 mf a,40,v,208,v,104
 tr v,204,135,12288
 mf a,40,v,212,v,120
 tr v,206,135,12800
 mf a,44,v,208,v,108
 mf a,44,v,212,v,124
 s_waitcnt lgkmcnt(4)
 mf a,48,v,192,v,96
 tr v,208,136,8192
 mf a,48,v,196,v,112
 tr v,210,136,8704
 s_add_u32 m0, s52, 143360
 mf a,52,v,192,v,100
 buffer_load_dwordx4 v129, s[12:15], s44 offen lds
 s_add_u32 s44, s44, 229376
 mf a,52,v,196,v,116
 s_add_u32 s46, s46, 196608
 mf a,56,v,192,v,104
 tr v,212,136,12288
 mf a,56,v,196,v,120
 tr v,214,136,12800
 mf a,60,v,192,v,108
 buffer_load_dwordx4 v[64:67], v128, s[24:27], s48 offen offset:0 sc1
 mf a,60,v,196,v,124
 s_waitcnt lgkmcnt(4)
 mf a,64,v,200,v,96
 tr v,192,137,8192
 mf a,64,v,204,v,112
 tr v,194,137,8704
 mf a,68,v,200,v,100
 buffer_load_dwordx4 v[68:71], v128, s[24:27], s49 offen offset:0 sc1
 mf a,68,v,204,v,116
 mf a,72,v,200,v,104
 tr v,196,137,12288
 mf a,72,v,204,v,120
 tr v,198,137,12800
 mf a,76,v,200,v,108
 buffer_load_dwordx4 v[72:75], v128, s[24:27], s50 offen offset:0 sc1
 mf a,76,v,204,v,124
 s_waitcnt lgkmcnt(4)
 mf a,80,v,208,v,96
 tr v,200,138,8192
 mf a,80,v,212,v,112
 tr v,202,138,8704
 mf a,84,v,208,v,100
 buffer_load_dwordx4 v[76:79], v128, s[24:27], s51 offen offset:0 sc1
 mf a,84,v,212,v,116
 mf a,88,v,208,v,104
 tr v,204,138,12288
 mf a,88,v,212,v,120
 tr v,206,138,12800
 mf a,92,v,208,v,108
 mf a,92,v,212,v,124
 s_waitcnt lgkmcnt(4)
 mf a,96,v,192,v,96
 tr v,208,135,16384
 mf a,96,v,196,v,112
 tr v,210,135,16896
 s_add_u32 m0, s52, 0
 mf a,100,v,192,v,100
 buffer_load_dwordx4 v130, s[4:7], s46 offen lds
 mf a,100,v,196,v,116
 mf a,104,v,192,v,104
 tr v,212,135,20480
 mf a,104,v,196,v,120
 tr v,214,135,20992
 s_add_u32 m0, s52, 8192
 mf a,108,v,192,v,108
 buffer_load_dwordx4 v129, s[8:11], s44 offen lds
 mf a,108,v,196,v,124
 s_waitcnt lgkmcnt(4)
 mf a,112,v,200,v,96
 tr v,192,136,16384
 mf a,112,v,204,v,112
 tr v,194,136,16896
 s_add_u32 m0, s52, 16384
 mf a,116,v,200,v,100
 buffer_load_dwordx4 v129, s[12:15], s44 offen lds
 s_add_u32 s44, s44, 229376
 mf a,116,v,204,v,116
 s_add_u32 s46, s46, 196608
 s_bitcmp1_b32 s45, 7
 s_cbranch_scc0 f_wA7
 buffer_load_dword v146, v216, s[32:35], 0 offen
 v_add_u32 v216, v218, v216
f_wA7:
 mf a,120,v,200,v,104
 tr v,196,136,20480
 mf a,120,v,204,v,120
 tr v,198,136,20992
 s_add_u32 m0, s52, 4096
 mf a,124,v,200,v,108
 buffer_load_dwordx4 v130, s[4:7], s46 offen lds
 mf a,124,v,204,v,124
 s_waitcnt lgkmcnt(4)
 mf a,128,v,208,v,96
 tr v,200,137,16384
 mf a,128,v,212,v,112
 tr v,202,137,16896
 s_add_u32 m0, s52, 12288
 mf a,132,v,208,v,100
 buffer_load_dwordx4 v129, s[8:11], s44 offen lds
 mf a,132,v,212,v,116
 mf a,136,v,208,v,104
 tr v,204,137,20480
 mf a,136,v,212,v,120
 tr v,206,137,20992
 s_add_u32 m0, s52, 20480
 mf a,140,v,208,v,108
 buffer_load_dwordx4 v129, s[12:15], s44 offen lds
 s_add_u32 s44, s44, 229376
 mf a,140,v,212,v,124
 s_add_u32 s46, s46, 196608
 s_waitcnt lgkmcnt(4)
 mf a,144,v,192,v,96
 tr v,208,138,16384
 mf a,144,v,196,v,112
 tr v,210,138,16896
 mf a,148,v,192,v,100
 buffer_load_dwordx4 v[80:83], v128, s[24:27], s48 offen offset:1024 sc1
 mf a,148,v,196,v,116
 mf a,152,v,192,v,104
 tr v,212,138,20480
 mf a,152,v,196,v,120
 tr v,214,138,20992
 mf a,156,v,192,v,108
 buffer_load_dwordx4 v[84:87], v128, s[24:27], s49 offen offset:1024 sc1
 mf a,156,v,196,v,124
 s_waitcnt lgkmcnt(4)
 mf a,160,v,200,v,96
 mf a,160,v,204,v,112
 mf a,164,v,200,v,100
 buffer_load_dwordx4 v[88:91], v128, s[24:27], s50 offen offset:1024 sc1
 mf a,164,v,204,v,116
 s_waitcnt vmcnt(23) lgkmcnt(0)
 s_barrier
 mf a,168,v,200,v,104
 tr v,192,131,0
 mf a,168,v,204,v,120
 tr v,194,131,512
 mf a,172,v,200,v,108
 tr v,196,131,4096
 mf a,172,v,204,v,124
 tr v,198,131,4608
 mf a,176,v,208,v,96
 tr v,200,132,0
 mf a,176,v,212,v,112
 tr v,202,132,512
 mf a,180,v,208,v,100
 buffer_load_dwordx4 v[92:95], v128, s[24:27], s51 offen offset:1024 sc1
 mf a,180,v,212,v,116
 mf a,184,v,208,v,104
 tr v,204,132,4096
 mf a,184,v,212,v,120
 tr v,206,132,4608
 mf a,188,v,208,v,108
 mf a,188,v,212,v,124
 s_waitcnt lgkmcnt(4)
f_A4:
 mf a,0,v,192,v,0
 tr v,208,133,0
 v_add_u32 v135, 0xc000, v135
 mf a,0,v,196,v,16
 tr v,210,133,512
 s_add_u32 m0, s52, 24576
 mf a,4,v,192,v,4
 buffer_load_dwordx4 v130, s[4:7], s46 offen lds
 mf a,4,v,196,v,20
 mf a,8,v,192,v,8
 tr v,212,133,4096
 v_add_u32 v136, 0xc000, v136
 mf a,8,v,196,v,24
 tr v,214,133,4608
 s_add_u32 m0, s52, 32768
 mf a,12,v,192,v,12
 buffer_load_dwordx4 v129, s[8:11], s44 offen lds
 mf a,12,v,196,v,28
 s_waitcnt lgkmcnt(4)
 mf a,16,v,200,v,0
 tr v,192,134,0
 v_add_u32 v137, 0xc000, v137
 mf a,16,v,204,v,16
 tr v,194,134,512
 s_add_u32 m0, s52, 40960
 mf a,20,v,200,v,4
 buffer_load_dwordx4 v129, s[12:15], s44 offen lds
 s_add_u32 s44, s44, 229376
 mf a,20,v,204,v,20
 s_add_u32 s46, s46, 196608
 s_bitcmp1_b32 s45, 8
 s_cbranch_scc0 f_wA8
 buffer_load_dword v146, v216, s[32:35], 0 offen
 v_add_u32 v216, v218, v216
f_wA8:
 mf a,24,v,200,v,8
 tr v,196,134,4096
 v_add_u32 v138, 0xc000, v138
 mf a,24,v,204,v,24
 tr v,198,134,4608
 s_add_u32 m0, s52, 28672
 mf a,28,v,200,v,12
 buffer_load_dwordx4 v130, s[4:7], s46 offen lds
 mf a,28,v,204,v,28
 s_waitcnt lgkmcnt(4)
 mf a,32,v,208,v,0
 tr v,200,131,8192
 mf a,32,v,212,v,16
 tr v,202,131,8704
 s_add_u32 m0, s52, 36864
 mf a,36,v,208,v,4
 buffer_load_dwordx4 v129, s[8:11], s44 offen lds
 mf a,36,v,212,v,20
 mf a,40,v,208,v,8
 tr v,204,131,12288
 mf a,40,v,212,v,24
 tr v,206,131,12800
 mf a,44,v,208,v,12
 mf a,44,v,212,v,28
 s_waitcnt lgkmcnt(4)
 mf a,48,v,192,v,0
 tr v,208,132,8192
 mf a,48,v,196,v,16
 tr v,210,132,8704
 s_add_u32 m0, s52, 45056
 mf a,52,v,192,v,4
 buffer_load_dwordx4 v129, s[12:15], s44 offen lds
 s_add_u32 s44, s44, 229376
 mf a,52,v,196,v,20
 s_add_u32 s46, s46, 196608
 mf a,56,v,192,v,8
 tr v,212,132,12288
 mf a,56,v,196,v,24
 tr v,214,132,12800
 mf a,60,v,192,v,12
 buffer_load_dwordx4 v[96:99], v128, s[24:27], s48 offen offset:2048 sc1
 mf a,60,v,196,v,28
 s_waitcnt lgkmcnt(4)
 mf a,64,v,200,v,0
 tr v,192,133,8192
 mf a,64,v,204,v,16
 tr v,194,133,8704
 mf a,68,v,200,v,4
 buffer_load_dwordx4 v[100:103], v128, s[24:27], s49 offen offset:2048 sc1
 mf a,68,v,204,v,20
 mf a,72,v,200,v,8
 tr v,196,133,12288
 mf a,72,v,204,v,24
 tr v,198,133,12800
 mf a,76,v,200,v,12
 buffer_load_dwordx4 v[104:107], v128, s[24:27], s50 offen offset:2048 sc1
 mf a,76,v,204,v,28
 s_waitcnt lgkmcnt(4)
 mf a,80,v,208,v,0
 tr v,200,134,8192
 mf a,80,v,212,v,16
 tr v,202,134,8704
 mf a,84,v,208,v,4
 buffer_load_dwordx4 v[108:111], v128, s[24:27], s51 offen offset:2048 sc1
 mf a,84,v,212,v,20
 mf a,88,v,208,v,8
 tr v,204,134,12288
 mf a,88,v,212,v,24
 tr v,206,134,12800
 mf a,92,v,208,v,12
 mf a,92,v,212,v,28
 s_waitcnt lgkmcnt(4)
 mf a,96,v,192,v,0
 tr v,208,131,16384
 mf a,96,v,196,v,16
 tr v,210,131,16896
 mf a,100,v,192,v,4
 buffer_load_dwordx4 v[112:115], v128, s[24:27], s48 offen offset:3072 sc1
 s_add_u32 s48, s48, 4096
 mf a,100,v,196,v,20
 mf a,104,v,192,v,8
 tr v,212,131,20480
 mf a,104,v,196,v,24
 tr v,214,131,20992
 mf a,108,v,192,v,12
 buffer_load_dwordx4 v[116:119], v128, s[24:27], s49 offen offset:3072 sc1
 s_add_u32 s49, s49, 4096
 mf a,108,v,196,v,28
 s_waitcnt lgkmcnt(4)
 mf a,112,v,200,v,0
 tr v,192,132,16384
 mf a,112,v,204,v,16
 tr v,194,132,16896
 mf a,116,v,200,v,4
 buffer_load_dwordx4 v[120:123], v128, s[24:27], s50 offen offset:3072 sc1
 s_add_u32 s50, s50, 4096
 mf a,116,v,204,v,20
 s_bitcmp1_b32 s45, 9
 s_cbranch_scc0 f_wA9
 buffer_load_dword v146, v216, s[32:35], 0 offen
 v_add_u32 v216, v218, v216
f_wA9:
 mf a,120,v,200,v,8
 tr v,196,132,20480
 mf a,120,v,204,v,24
 tr v,198,132,20992
 mf a,124,v,200,v,12
 buffer_load_dwordx4 v[124:127], v128, s[24:27], s51 offen offset:3072 sc1
 s_add_u32 s51, s51, 4096
 mf a,124,v,204,v,28
 s_waitcnt lgkmcnt(4)
 mf a,128,v,208,v,0
 tr v,200,133,16384
 mf a,128,v,212,v,16
 tr v,202,133,16896
 s_add_u32 m0, s52, 49152
 mf a,132,v,208,v,4
 buffer_load_dwordx4 v130, s[4:7], s46 offen lds
 mf a,132,v,212,v,20
 mf a,136,v,208,v,8
 tr v,204,133,20480
 mf a,136,v,212,v,24
 tr v,206,133,20992
 s_add_u32 m0, s52, 57344
 mf a,140,v,208,v,12
 buffer_load_dwordx4 v129, s[8:11], s44 offen lds
 mf a,140,v,212,v,28
 s_waitcnt lgkmcnt(4)
 mf a,144,v,192,v,0
 tr v,208,134,16384
 mf a,144,v,196,v,16
 tr v,210,134,16896
 s_add_u32 m0, s52, 65536
 mf a,148,v,192,v,4
 buffer_load_dwordx4 v129, s[12:15], s44 offen lds
 s_add_u32 s44, s44, 229376
 mf a,148,v,196,v,20
 s_add_u32 s46, s46, 196608
 mf a,152,v,192,v,8
 tr v,212,134,20480
 mf a,152,v,196,v,24
 tr v,214,134,20992
 s_add_u32 m0, s52, 53248
 mf a,156,v,192,v,12
 buffer_load_dwordx4 v130, s[4:7], s46 offen lds
 mf a,156,v,196,v,28
 s_waitcnt lgkmcnt(4)
 mf a,160,v,200,v,0
 mf a,160,v,204,v,16
 s_add_u32 m0, s52, 61440
 mf a,164,v,200,v,4
 buffer_load_dwordx4 v129, s[8:11], s44 offen lds
 mf a,164,v,204,v,20
 s_waitcnt vmcnt(33) lgkmcnt(0)
 s_barrier
 mf a,168,v,200,v,8
 tr v,192,135,0
 mf a,168,v,204,v,24
 tr v,194,135,512
 mf a,172,v,200,v,12
 tr v,196,135,4096
 mf a,172,v,204,v,28
 tr v,198,135,4608
 mf a,176,v,208,v,0
 tr v,200,136,0
 mf a,176,v,212,v,16
 tr v,202,136,512
 s_add_u32 m0, s52, 69632
 mf a,180,v,208,v,4
 buffer_load_dwordx4 v129, s[12:15], s44 offen lds
 s_add_u32 s44, s44, 229376
 mf a,180,v,212,v,20
 s_add_u32 s46, s46, 196608
 mf a,184,v,208,v,8
 tr v,204,136,4096
 mf a,184,v,212,v,24
 tr v,206,136,4608
 mf a,188,v,208,v,12
 mf a,188,v,212,v,28
 s_waitcnt lgkmcnt(4)
f_A5:
 s_mov_b32 s69, f_A8-f_base
 mf a,0,v,192,v,32
 tr v,208,137,0
 v_add_u32 v131, 0xfffe8000, v131
 mf a,0,v,196,v,48
 tr v,210,137,512
 mf a,4,v,192,v,36
 buffer_load_dword v146, v155, s[36:39], s69 offen
 mf a,4,v,196,v,52
 mf a,8,v,192,v,40
 tr v,212,137,4096
 v_add_u32 v132, 0xfffe8000, v132
 mf a,8,v,196,v,56
 tr v,214,137,4608
 mf a,12,v,192,v,44
 buffer_load_dwordx4 v[0:3], v128, s[24:27], s48 offen offset:0 sc1
 mf a,12,v,196,v,60
 s_waitcnt lgkmcnt(4)
 mf a,16,v,200,v,32
 tr v,192,138,0
 v_add_u32 v133, 0xfffe8000, v133
 mf a,16,v,204,v,48
 tr v,194,138,512
 mf a,20,v,200,v,36
 buffer_load_dwordx4 v[4:7], v128, s[24:27], s49 offen offset:0 sc1
 mf a,20,v,204,v,52
 s_bitcmp1_b32 s45, 10
 s_cbranch_scc0 f_wA10
 buffer_load_dword v146, v216, s[32:35], 0 offen
 v_add_u32 v216, v218, v216
f_wA10:
 mf a,24,v,200,v,40
 tr v,196,138,4096
 v_add_u32 v134, 0xfffe8000, v134
 mf a,24,v,204,v,56
 tr v,198,138,4608
 mf a,28,v,200,v,44
 buffer_load_dwordx4 v[8:11], v128, s[24:27], s50 offen offset:0 sc1
 mf a,28,v,204,v,60
 s_waitcnt lgkmcnt(4)
 mf a,32,v,208,v,32
 tr v,200,135,8192
 mf a,32,v,212,v,48
 tr v,202,135,8704
 mf a,36,v,208,v,36
 buffer_load_dwordx4 v[12:15], v128, s[24:27], s51 offen offset:0 sc1
 mf a,36,v,212,v,52
 mf a,40,v,208,v,40
 tr v,204,135,12288
 mf a,40,v,212,v,56
 tr v,206,135,12800
 mf a,44,v,208,v,44
 mf a,44,v,212,v,60
 s_waitcnt lgkmcnt(4)
 mf a,48,v,192,v,32
 tr v,208,136,8192
 mf a,48,v,196,v,48
 tr v,210,136,8704
 mf a,52,v,192,v,36
 buffer_load_dwordx4 v[16:19], v128, s[24:27], s48 offen offset:1024 sc1
 mf a,52,v,196,v,52
 mf a,56,v,192,v,40
 tr v,212,136,12288
 mf a,56,v,196,v,56
 tr v,214,136,12800
 mf a,60,v,192,v,44
 buffer_load_dwordx4 v[20:23], v128, s[24:27], s49 offen offset:1024 sc1
 mf a,60,v,196,v,60
 s_waitcnt lgkmcnt(4)
 mf a,64,v,200,v,32
 tr v,192,137,8192
 mf a,64,v,204,v,48
 tr v,194,137,8704
 mf a,68,v,200,v,36
 buffer_load_dwordx4 v[24:27], v128, s[24:27], s50 offen offset:1024 sc1
 mf a,68,v,204,v,52
 mf a,72,v,200,v,40
 tr v,196,137,12288
 mf a,72,v,204,v,56
 tr v,198,137,12800
 mf a,76,v,200,v,44
 buffer_load_dwordx4 v[28:31], v128, s[24:27], s51 offen offset:1024 sc1
 mf a,76,v,204,v,60
 s_waitcnt lgkmcnt(4)
 mf a,80,v,208,v,32
 tr v,200,138,8192
 mf a,80,v,212,v,48
 tr v,202,138,8704
 s_add_u32 m0, s52, 73728
 mf a,84,v,208,v,36
 buffer_load_dwordx4 v130, s[4:7], s46 offen lds
 mf a,84,v,212,v,52
 mf a,88,v,208,v,40
 tr v,204,138,12288
 mf a,88,v,212,v,56
 tr v,206,138,12800
 mf a,92,v,208,v,44
 mf a,92,v,212,v,60
 s_waitcnt lgkmcnt(4)
 mf a,96,v,192,v,32
 tr v,208,135,16384
 mf a,96,v,196,v,48
 tr v,210,135,16896
 s_add_u32 m0, s52, 81920
 mf a,100,v,192,v,36
 buffer_load_dwordx4 v129, s[8:11], s44 offen lds
 mf a,100,v,196,v,52
 mf a,104,v,192,v,40
 tr v,212,135,20480
 mf a,104,v,196,v,56
 tr v,214,135,20992
 s_add_u32 m0, s52, 90112
 mf a,108,v,192,v,44
 buffer_load_dwordx4 v129, s[12:15], s44 offen lds
 s_add_u32 s44, s44, 229376
 mf a,108,v,196,v,60
 s_add_u32 s46, s46, 196608
 s_waitcnt lgkmcnt(4)
 mf a,112,v,200,v,32
 tr v,192,136,16384
 mf a,112,v,204,v,48
 tr v,194,136,16896
 s_add_u32 m0, s52, 77824
 mf a,116,v,200,v,36
 buffer_load_dwordx4 v130, s[4:7], s46 offen lds
 mf a,116,v,204,v,52
 s_bitcmp1_b32 s45, 11
 s_cbranch_scc0 f_wA11
 buffer_load_dword v146, v216, s[32:35], 0 offen
 v_add_u32 v216, v218, v216
f_wA11:
 mf a,120,v,200,v,40
 tr v,196,136,20480
 mf a,120,v,204,v,56
 tr v,198,136,20992
 s_add_u32 m0, s52, 86016
 mf a,124,v,200,v,44
 buffer_load_dwordx4 v129, s[8:11], s44 offen lds
 mf a,124,v,204,v,60
 s_waitcnt lgkmcnt(4)
 mf a,128,v,208,v,32
 tr v,200,137,16384
 mf a,128,v,212,v,48
 tr v,202,137,16896
 s_add_u32 m0, s52, 94208
 mf a,132,v,208,v,36
 buffer_load_dwordx4 v129, s[12:15], s44 offen lds
 s_add_u32 s44, s44, 229376
 mf a,132,v,212,v,52
 s_add_u32 s46, s46, 196608
 mf a,136,v,208,v,40
 tr v,204,137,20480
 mf a,136,v,212,v,56
 tr v,206,137,20992
 s_add_u32 m0, s52, 98304
 mf a,140,v,208,v,44
 buffer_load_dwordx4 v130, s[4:7], s46 offen lds
 mf a,140,v,212,v,60
 s_waitcnt lgkmcnt(4)
 mf a,144,v,192,v,32
 tr v,208,138,16384
 mf a,144,v,196,v,48
 tr v,210,138,16896
 s_add_u32 m0, s52, 106496
 mf a,148,v,192,v,36
 buffer_load_dwordx4 v129, s[8:11], s44 offen lds
 mf a,148,v,196,v,52
 mf a,152,v,192,v,40
 tr v,212,138,20480
 mf a,152,v,196,v,56
 tr v,214,138,20992
 s_add_u32 m0, s52, 114688
 mf a,156,v,192,v,44
 buffer_load_dwordx4 v129, s[12:15], s44 offen lds
 s_add_u32 s44, s44, 229376
 mf a,156,v,196,v,60
 s_add_u32 s46, s46, 196608
 s_waitcnt lgkmcnt(4)
 mf a,160,v,200,v,32
 mf a,160,v,204,v,48
 s_add_u32 m0, s52, 102400
 mf a,164,v,200,v,36
 buffer_load_dwordx4 v130, s[4:7], s46 offen lds
 mf a,164,v,204,v,52
 s_waitcnt vmcnt(43) lgkmcnt(0)
 s_barrier
 mf a,168,v,200,v,40
 tr v,192,131,0
 mf a,168,v,204,v,56
 tr v,194,131,512
 mf a,172,v,200,v,44
 tr v,196,131,4096
 mf a,172,v,204,v,60
 tr v,198,131,4608
 mf a,176,v,208,v,32
 tr v,200,132,0
 mf a,176,v,212,v,48
 tr v,202,132,512
 s_add_u32 m0, s52, 110592
 mf a,180,v,208,v,36
 buffer_load_dwordx4 v129, s[8:11], s44 offen lds
 mf a,180,v,212,v,52
 mf a,184,v,208,v,40
 tr v,204,132,4096
 mf a,184,v,212,v,56
 tr v,206,132,4608
 mf a,188,v,208,v,44
 mf a,188,v,212,v,60
 s_waitcnt vmcnt(40) lgkmcnt(4)
f_A6:
 mf a,0,v,192,v,64
 tr v,208,133,0
 v_add_u32 v135, 0xfffe8000, v135
 mf a,0,v,196,v,80
 tr v,210,133,512
 mf a,4,v,192,v,68
 buffer_load_dwordx4 v[32:35], v128, s[24:27], s48 offen offset:2048 sc1
 mf a,4,v,196,v,84
 mf a,8,v,192,v,72
 tr v,212,133,4096
 v_add_u32 v136, 0xfffe8000, v136
 mf a,8,v,196,v,88
 tr v,214,133,4608
 mf a,12,v,192,v,76
 buffer_load_dwordx4 v[36:39], v128, s[24:27], s49 offen offset:2048 sc1
 mf a,12,v,196,v,92
 s_waitcnt lgkmcnt(4)
 mf a,16,v,200,v,64
 tr v,192,134,0
 v_add_u32 v137, 0xfffe8000, v137
 mf a,16,v,204,v,80
 tr v,194,134,512
 mf a,20,v,200,v,68
 buffer_load_dwordx4 v[40:43], v128, s[24:27], s50 offen offset:2048 sc1
 mf a,20,v,204,v,84
 s_bitcmp1_b32 s45, 12
 s_cbranch_scc0 f_wA12
 buffer_load_dword v146, v216, s[32:35], 0 offen
 v_add_u32 v216, v218, v216
f_wA12:
 mf a,24,v,200,v,72
 tr v,196,134,4096
 v_add_u32 v138, 0xfffe8000, v138
 mf a,24,v,204,v,88
 tr v,198,134,4608
 mf a,28,v,200,v,76
 buffer_load_dwordx4 v[44:47], v128, s[24:27], s51 offen offset:2048 sc1
 mf a,28,v,204,v,92
 s_waitcnt lgkmcnt(4)
 mf a,32,v,208,v,64
 tr v,200,131,8192
 mf a,32,v,212,v,80
 tr v,202,131,8704
 mf a,36,v,208,v,68
 buffer_load_dwordx4 v[48:51], v128, s[24:27], s48 offen offset:3072 sc1
 s_add_u32 s48, s48, 4096
 mf a,36,v,212,v,84
 mf a,40,v,208,v,72
 tr v,204,131,12288
 mf a,40,v,212,v,88
 tr v,206,131,12800
 mf a,44,v,208,v,76
 mf a,44,v,212,v,92
 s_waitcnt lgkmcnt(4)
 mf a,48,v,192,v,64
 tr v,208,132,8192
 mf a,48,v,196,v,80
 tr v,210,132,8704
 mf a,52,v,192,v,68
 buffer_load_dwordx4 v[52:55], v128, s[24:27], s49 offen offset:3072 sc1
 s_add_u32 s49, s49, 4096
 mf a,52,v,196,v,84
 s_bitcmp1_b32 s45, 16
 s_cbranch_scc0 f_wA16
 buffer_load_dword v146, v217, s[28:31], 0 offen
f_wA16:
 mf a,56,v,192,v,72
 tr v,212,132,12288
 mf a,56,v,196,v,88
 tr v,214,132,12800
 mf a,60,v,192,v,76
 buffer_load_dwordx4 v[56:59], v128, s[24:27], s50 offen offset:3072 sc1
 s_add_u32 s50, s50, 4096
 mf a,60,v,196,v,92
 s_waitcnt lgkmcnt(4)
 mf a,64,v,200,v,64
 tr v,192,133,8192
 mf a,64,v,204,v,80
 tr v,194,133,8704
 mf a,68,v,200,v,68
 buffer_load_dwordx4 v[60:63], v128, s[24:27], s51 offen offset:3072 sc1
 s_add_u32 s51, s51, 4096
 mf a,68,v,204,v,84
 mf a,72,v,200,v,72
 tr v,196,133,12288
 mf a,72,v,204,v,88
 tr v,198,133,12800
 s_add_u32 m0, s52, 118784
 mf a,76,v,200,v,76
 buffer_load_dwordx4 v129, s[12:15], s44 offen lds
 s_add_u32 s44, s44, 229376
 mf a,76,v,204,v,92
 s_add_u32 s46, s46, 196608
 s_waitcnt lgkmcnt(4)
 mf a,80,v,208,v,64
 tr v,200,134,8192
 mf a,80,v,212,v,80
 tr v,202,134,8704
 s_add_u32 m0, s52, 122880
 mf a,84,v,208,v,68
 buffer_load_dwordx4 v130, s[4:7], s46 offen lds
 mf a,84,v,212,v,84
 mf a,88,v,208,v,72
 tr v,204,134,12288
 mf a,88,v,212,v,88
 tr v,206,134,12800
 mf a,92,v,208,v,76
 mf a,92,v,212,v,92
 s_waitcnt lgkmcnt(4)
 mf a,96,v,192,v,64
 tr v,208,131,16384
 mf a,96,v,196,v,80
 tr v,210,131,16896
 s_add_u32 m0, s52, 131072
 mf a,100,v,192,v,68
 buffer_load_dwordx4 v129, s[8:11], s44 offen lds
 mf a,100,v,196,v,84
 mf a,104,v,192,v,72
 tr v,212,131,20480
 mf a,104,v,196,v,88
 tr v,214,131,20992
 mf a,108,v,192,v,76
 mf a,108,v,196,v,92
 s_waitcnt lgkmcnt(4)
 mf a,112,v,200,v,64
 tr v,192,132,16384
 mf a,112,v,204,v,80
 tr v,194,132,16896
 s_add_u32 m0, s52, 139264
 mf a,116,v,200,v,68
 buffer_load_dwordx4 v129, s[12:15], s44 offen lds
 s_add_u32 s44, s44, 229376
 mf a,116,v,204,v,84
 s_add_u32 s46, s46, 196608
 s_bitcmp1_b32 s45, 13
 s_cbranch_scc0 f_wA13
 buffer_load_dword v146, v216, s[32:35], 0 offen
 v_add_u32 v216, v218, v216
f_wA13:
 mf a,120,v,200,v,72
 tr v,196,132,20480
 mf a,120,v,204,v,88
 tr v,198,132,20992
 mf a,124,v,200,v,76
 mf a,124,v,204,v,92
 s_waitcnt lgkmcnt(4)
 mf a,128,v,208,v,64
 tr v,200,133,16384
 mf a,128,v,212,v,80
 tr v,202,133,16896
 s_add_u32 m0, s52, 126976
 mf a,132,v,208,v,68
 buffer_load_dwordx4 v130, s[4:7], s46 offen lds
 mf a,132,v,212,v,84
 mf a,136,v,208,v,72
 tr v,204,133,20480
 mf a,136,v,212,v,88
 tr v,206,133,20992
 mf a,140,v,208,v,76
 mf a,140,v,212,v,92
 s_waitcnt lgkmcnt(4)
 mf a,144,v,192,v,64
 tr v,208,134,16384
 mf a,144,v,196,v,80
 tr v,210,134,16896
 s_add_u32 m0, s52, 135168
 mf a,148,v,192,v,68
 buffer_load_dwordx4 v129, s[8:11], s44 offen lds
 mf a,148,v,196,v,84
 mf a,152,v,192,v,72
 tr v,212,134,20480
 mf a,152,v,196,v,88
 tr v,214,134,20992
 mf a,156,v,192,v,76
 mf a,156,v,196,v,92
 s_waitcnt lgkmcnt(4)
 mf a,160,v,200,v,64
 mf a,160,v,204,v,80
 s_add_u32 m0, s52, 143360
 mf a,164,v,200,v,68
 buffer_load_dwordx4 v129, s[12:15], s44 offen lds
 s_add_u32 s44, s44, 229376
 mf a,164,v,204,v,84
 s_waitcnt vmcnt(49) lgkmcnt(0)
 s_barrier
 s_add_u32 s46, s46, 196608
 mf a,168,v,200,v,72
 tr v,192,135,0
 mf a,168,v,204,v,88
 tr v,194,135,512
 mf a,172,v,200,v,76
 tr v,196,135,4096
 mf a,172,v,204,v,92
 tr v,198,135,4608
 mf a,176,v,208,v,64
 tr v,200,136,0
 mf a,176,v,212,v,80
 tr v,202,136,512
 mf a,180,v,208,v,68
 mf a,180,v,212,v,84
 mf a,184,v,208,v,72
 tr v,204,136,4096
 mf a,184,v,212,v,88
 tr v,206,136,4608
 mf a,188,v,208,v,76
 mf a,188,v,212,v,92
 s_waitcnt vmcnt(41) lgkmcnt(4)
f_A7:
 mf a,0,v,192,v,96
 tr v,208,137,0
 v_add_u32 v131, 0xc000, v131
 mf a,0,v,196,v,112
 tr v,210,137,512
 mf a,4,v,192,v,100
 buffer_load_dwordx4 v[64:67], v128, s[24:27], s48 offen offset:0 sc1
 mf a,4,v,196,v,116
 mf a,8,v,192,v,104
 tr v,212,137,4096
 v_add_u32 v132, 0xc000, v132
 mf a,8,v,196,v,120
 tr v,214,137,4608
 mf a,12,v,192,v,108
 buffer_load_dwordx4 v[68:71], v128, s[24:27], s49 offen offset:0 sc1
 mf a,12,v,196,v,124
 s_waitcnt lgkmcnt(4)
 mf a,16,v,200,v,96
 tr v,192,138,0
 v_add_u32 v133, 0xc000, v133
 mf a,16,v,204,v,112
 tr v,194,138,512
 mf a,20,v,200,v,100
 buffer_load_dwordx4 v[72:75], v128, s[24:27], s50 offen offset:0 sc1
 mf a,20,v,204,v,116
 mf a,24,v,200,v,104
 tr v,196,138,4096
 v_add_u32 v134, 0xc000, v134
 mf a,24,v,204,v,120
 tr v,198,138,4608
 mf a,28,v,200,v,108
 buffer_load_dwordx4 v[76:79], v128, s[24:27], s51 offen offset:0 sc1
 mf a,28,v,204,v,124
 s_waitcnt lgkmcnt(4)
 mf a,32,v,208,v,96
 tr v,200,135,8192
 mf a,32,v,212,v,112
 tr v,202,135,8704
 mf a,36,v,208,v,100
 buffer_load_dwordx4 v[80:83], v128, s[24:27], s48 offen offset:1024 sc1
 mf a,36,v,212,v,116
 mf a,40,v,208,v,104
 tr v,204,135,12288
 mf a,40,v,212,v,120
 tr v,206,135,12800
 mf a,44,v,208,v,108
 mf a,44,v,212,v,124
 s_waitcnt lgkmcnt(4)
 mf a,48,v,192,v,96
 tr v,208,136,8192
 mf a,48,v,196,v,112
 tr v,210,136,8704
 mf a,52,v,192,v,100
 buffer_load_dwordx4 v[84:87], v128, s[24:27], s49 offen offset:1024 sc1
 mf a,52,v,196,v,116
 s_bitcmp1_b32 s45, 17
 s_cbranch_scc0 f_wA17
 buffer_load_dword v146, v217, s[28:31], 0 offen
f_wA17:
 mf a,56,v,192,v,104
 tr v,212,136,12288
 mf a,56,v,196,v,120
 tr v,214,136,12800
 mf a,60,v,192,v,108
 buffer_load_dwordx4 v[88:91], v128, s[24:27], s50 offen offset:1024 sc1
 mf a,60,v,196,v,124
 s_waitcnt lgkmcnt(4)
 mf a,64,v,200,v,96
 tr v,192,137,8192
 mf a,64,v,204,v,112
 tr v,194,137,8704
 mf a,68,v,200,v,100
 buffer_load_dwordx4 v[92:95], v128, s[24:27], s51 offen offset:1024 sc1
 mf a,68,v,204,v,116
 mf a,72,v,200,v,104
 tr v,196,137,12288
 mf a,72,v,204,v,120
 tr v,198,137,12800
 s_add_u32 m0, s52, 0
 mf a,76,v,200,v,108
 buffer_load_dwordx4 v130, s[4:7], s46 offen lds
 mf a,76,v,204,v,124
 s_waitcnt lgkmcnt(4)
 mf a,80,v,208,v,96
 tr v,200,138,8192
 mf a,80,v,212,v,112
 tr v,202,138,8704
 s_add_u32 m0, s52, 8192
 mf a,84,v,208,v,100
 buffer_load_dwordx4 v129, s[8:11], s44 offen lds
 mf a,84,v,212,v,116
 mf a,88,v,208,v,104
 tr v,204,138,12288
 mf a,88,v,212,v,120
 tr v,206,138,12800
 mf a,92,v,208,v,108
 mf a,92,v,212,v,124
 s_waitcnt lgkmcnt(4)
 mf a,96,v,192,v,96
 tr v,208,135,16384
 mf a,96,v,196,v,112
 tr v,210,135,16896
 s_add_u32 m0, s52, 16384
 mf a,100,v,192,v,100
 buffer_load_dwordx4 v129, s[12:15], s44 offen lds
 s_add_u32 s44, s44, 229376
 mf a,100,v,196,v,116
 s_add_u32 s46, s46, 196608
 mf a,104,v,192,v,104
 tr v,212,135,20480
 mf a,104,v,196,v,120
 tr v,214,135,20992
 mf a,108,v,192,v,108
 mf a,108,v,196,v,124
 s_waitcnt lgkmcnt(4)
 mf a,112,v,200,v,96
 tr v,192,136,16384
 mf a,112,v,204,v,112
 tr v,194,136,16896
 s_add_u32 m0, s52, 4096
 mf a,116,v,200,v,100
 buffer_load_dwordx4 v130, s[4:7], s46 offen lds
 mf a,116,v,204,v,116
 mf a,120,v,200,v,104
 tr v,196,136,20480
 mf a,120,v,204,v,120
 tr v,198,136,20992
 mf a,124,v,200,v,108
 mf a,124,v,204,v,124
 s_waitcnt lgkmcnt(4)
 mf a,128,v,208,v,96
 tr v,200,137,16384
 mf a,128,v,212,v,112
 tr v,202,137,16896
 mf a,132,v,208,v,100
 mf a,132,v,212,v,116
 mf a,136,v,208,v,104
 tr v,204,137,20480
 mf a,136,v,212,v,120
 tr v,206,137,20992
 s_add_u32 m0, s52, 12288
 mf a,140,v,208,v,108
 buffer_load_dwordx4 v129, s[8:11], s44 offen lds
 mf a,140,v,212,v,124
 s_waitcnt lgkmcnt(4)
 mf a,144,v,192,v,96
 tr v,208,138,16384
 mf a,144,v,196,v,112
 tr v,210,138,16896
 mf a,148,v,192,v,100
 mf a,148,v,196,v,116
 mf a,152,v,192,v,104
 tr v,212,138,20480
 mf a,152,v,196,v,120
 tr v,214,138,20992
 mf a,156,v,192,v,108
 mf a,156,v,196,v,124
 s_waitcnt lgkmcnt(4)
 mf a,160,v,200,v,96
 mf a,160,v,204,v,112
 s_add_u32 m0, s52, 20480
 mf a,164,v,200,v,100
 buffer_load_dwordx4 v129, s[12:15], s44 offen lds
 s_add_u32 s44, s44, 229376
 mf a,164,v,204,v,116
 s_waitcnt vmcnt(49) lgkmcnt(0)
 s_barrier
 s_add_u32 s46, s46, 196608
 mf a,168,v,200,v,104
 tr v,192,131,0
 mf a,168,v,204,v,120
 tr v,194,131,512
 mf a,172,v,200,v,108
 tr v,196,131,4096
 mf a,172,v,204,v,124
 tr v,198,131,4608
 mf a,176,v,208,v,96
 tr v,200,132,0
 mf a,176,v,212,v,112
 tr v,202,132,512
 mf a,180,v,208,v,100
 mf a,180,v,212,v,116
 mf a,184,v,208,v,104
 tr v,204,132,4096
 mf a,184,v,212,v,120
 tr v,206,132,4608
 mf a,188,v,208,v,108
 mf a,188,v,212,v,124
 s_waitcnt vmcnt(40) lgkmcnt(4)
f_A8:
 mf a,0,v,192,v,0
 tr v,208,133,0
 v_add_u32 v135, 0xc000, v135
 mf a,0,v,196,v,16
 tr v,210,133,512
 mf a,4,v,192,v,4
 buffer_load_dwordx4 v[96:99], v128, s[24:27], s48 offen offset:2048 sc1
 mf a,4,v,196,v,20
 mf a,8,v,192,v,8
 tr v,212,133,4096
 v_add_u32 v136, 0xc000, v136
 mf a,8,v,196,v,24
 tr v,214,133,4608
 mf a,12,v,192,v,12
 buffer_load_dwordx4 v[100:103], v128, s[24:27], s49 offen offset:2048 sc1
 mf a,12,v,196,v,28
 s_waitcnt lgkmcnt(4)
 mf a,16,v,200,v,0
 tr v,192,134,0
 v_add_u32 v137, 0xc000, v137
 mf a,16,v,204,v,16
 tr v,194,134,512
 mf a,20,v,200,v,4
 buffer_load_dwordx4 v[104:107], v128, s[24:27], s50 offen offset:2048 sc1
 mf a,20,v,204,v,20
 mf a,24,v,200,v,8
 tr v,196,134,4096
 v_add_u32 v138, 0xc000, v138
 mf a,24,v,204,v,24
 tr v,198,134,4608
 mf a,28,v,200,v,12
 buffer_load_dwordx4 v[108:111], v128, s[24:27], s51 offen offset:2048 sc1
 mf a,28,v,204,v,28
 s_waitcnt lgkmcnt(4)
 mf a,32,v,208,v,0
 tr v,200,131,8192
 mf a,32,v,212,v,16
 tr v,202,131,8704
 mf a,36,v,208,v,4
 buffer_load_dwordx4 v[112:115], v128, s[24:27], s48 offen offset:3072 sc1
 s_add_u32 s48, s48, 4096
 mf a,36,v,212,v,20
 mf a,40,v,208,v,8
 tr v,204,131,12288
 mf a,40,v,212,v,24
 tr v,206,131,12800
 mf a,44,v,208,v,12
 mf a,44,v,212,v,28
 s_waitcnt lgkmcnt(4)
 mf a,48,v,192,v,0
 tr v,208,132,8192
 mf a,48,v,196,v,16
 tr v,210,132,8704
 mf a,52,v,192,v,4
 buffer_load_dwordx4 v[116:119], v128, s[24:27], s49 offen offset:3072 sc1
 s_add_u32 s49, s49, 4096
 mf a,52,v,196,v,20
 s_bitcmp1_b32 s45, 18
 s_cbranch_scc0 f_wA18
 buffer_load_dword v146, v217, s[28:31], 0 offen
f_wA18:
 mf a,56,v,192,v,8
 tr v,212,132,12288
 mf a,56,v,196,v,24
 tr v,214,132,12800
 mf a,60,v,192,v,12
 buffer_load_dwordx4 v[120:123], v128, s[24:27], s50 offen offset:3072 sc1
 s_add_u32 s50, s50, 4096
 mf a,60,v,196,v,28
 s_waitcnt lgkmcnt(4)
 mf a,64,v,200,v,0
 tr v,192,133,8192
 mf a,64,v,204,v,16
 tr v,194,133,8704
 mf a,68,v,200,v,4
 buffer_load_dwordx4 v[124:127], v128, s[24:27], s51 offen offset:3072 sc1
 s_add_u32 s51, s51, 4096
 mf a,68,v,204,v,20
 mf a,72,v,200,v,8
 tr v,196,133,12288
 mf a,72,v,204,v,24
 tr v,198,133,12800
 s_add_u32 m0, s52, 24576
 mf a,76,v,200,v,12
 buffer_load_dwordx4 v130, s[4:7], s46 offen lds
 mf a,76,v,204,v,28
 s_waitcnt lgkmcnt(4)
 mf a,80,v,208,v,0
 tr v,200,134,8192
 mf a,80,v,212,v,16
 tr v,202,134,8704
 s_add_u32 m0, s52, 32768
 mf a,84,v,208,v,4
 buffer_load_dwordx4 v129, s[8:11], s44 offen lds
 mf a,84,v,212,v,20
 mf a,88,v,208,v,8
 tr v,204,134,12288
 mf a,88,v,212,v,24
 tr v,206,134,12800
 mf a,92,v,208,v,12
 mf a,92,v,212,v,28
 s_waitcnt lgkmcnt(4)
 mf a,96,v,192,v,0
 tr v,208,131,16384
 mf a,96,v,196,v,16
 tr v,210,131,16896
 s_add_u32 m0, s52, 40960
 mf a,100,v,192,v,4
 buffer_load_dwordx4 v129, s[12:15], s44 offen lds
 s_add_u32 s44, s44, 229376
 mf a,100,v,196,v,20
 s_add_u32 s46, s46, 196608
 mf a,104,v,192,v,8
 tr v,212,131,20480
 mf a,104,v,196,v,24
 tr v,214,131,20992
 mf a,108,v,192,v,12
 mf a,108,v,196,v,28
 s_waitcnt lgkmcnt(4)
 mf a,112,v,200,v,0
 tr v,192,132,16384
 mf a,112,v,204,v,16
 tr v,194,132,16896
 s_add_u32 m0, s52, 28672
 mf a,116,v,200,v,4
 buffer_load_dwordx4 v130, s[4:7], s46 offen lds
 mf a,116,v,204,v,20
 mf a,120,v,200,v,8
 tr v,196,132,20480
 mf a,120,v,204,v,24
 tr v,198,132,20992
 mf a,124,v,200,v,12
 mf a,124,v,204,v,28
 s_waitcnt lgkmcnt(4)
 mf a,128,v,208,v,0
 tr v,200,133,16384
 mf a,128,v,212,v,16
 tr v,202,133,16896
 mf a,132,v,208,v,4
 mf a,132,v,212,v,20
 mf a,136,v,208,v,8
 tr v,204,133,20480
 mf a,136,v,212,v,24
 tr v,206,133,20992
 s_add_u32 m0, s52, 36864
 mf a,140,v,208,v,12
 buffer_load_dwordx4 v129, s[8:11], s44 offen lds
 mf a,140,v,212,v,28
 s_waitcnt lgkmcnt(4)
 mf a,144,v,192,v,0
 tr v,208,134,16384
 mf a,144,v,196,v,16
 tr v,210,134,16896
 mf a,148,v,192,v,4
 mf a,148,v,196,v,20
 mf a,152,v,192,v,8
 tr v,212,134,20480
 mf a,152,v,196,v,24
 tr v,214,134,20992
 mf a,156,v,192,v,12
 mf a,156,v,196,v,28
 s_waitcnt lgkmcnt(4)
 mf a,160,v,200,v,0
 mf a,160,v,204,v,16
 s_add_u32 m0, s52, 45056
 mf a,164,v,200,v,4
 buffer_load_dwordx4 v129, s[12:15], s44 offen lds
 s_add_u32 s44, s44, 229376
 mf a,164,v,204,v,20
 s_waitcnt vmcnt(48) lgkmcnt(0)
 s_barrier
 s_add_u32 s46, s46, 196608
 mf a,168,v,200,v,8
 tr v,192,135,0
 mf a,168,v,204,v,24
 tr v,194,135,512
 mf a,172,v,200,v,12
 tr v,196,135,4096
 mf a,172,v,204,v,28
 tr v,198,135,4608
 mf a,176,v,208,v,0
 tr v,200,136,0
 mf a,176,v,212,v,16
 tr v,202,136,512
 mf a,180,v,208,v,4
 mf a,180,v,212,v,20
 mf a,184,v,208,v,8
 tr v,204,136,4096
 mf a,184,v,212,v,24
 tr v,206,136,4608
 mf a,188,v,208,v,12
 mf a,188,v,212,v,28
 s_waitcnt vmcnt(35) lgkmcnt(4)
f_A9:
 s_mov_b32 s69, f_A12-f_base
 mf a,0,v,192,v,32
 tr v,208,137,0
 v_add_u32 v131, 0xc000, v131
 mf a,0,v,196,v,48
 tr v,210,137,512
 mf a,4,v,192,v,36
 buffer_load_dword v146, v155, s[36:39], s69 offen
 mf a,4,v,196,v,52
 mf a,8,v,192,v,40
 tr v,212,137,4096
 v_add_u32 v132, 0xc000, v132
 mf a,8,v,196,v,56
 tr v,214,137,4608
 mf a,12,v,192,v,44
 buffer_load_dwordx4 v[0:3], v128, s[24:27], s48 offen offset:0 sc1
 mf a,12,v,196,v,60
 s_waitcnt lgkmcnt(4)
 mf a,16,v,200,v,32
 tr v,192,138,0
 v_add_u32 v133, 0xc000, v133
 mf a,16,v,204,v,48
 tr v,194,138,512
 mf a,20,v,200,v,36
 buffer_load_dwordx4 v[4:7], v128, s[24:27], s49 offen offset:0 sc1
 mf a,20,v,204,v,52
 mf a,24,v,200,v,40
 tr v,196,138,4096
 v_add_u32 v134, 0xc000, v134
 mf a,24,v,204,v,56
 tr v,198,138,4608
 mf a,28,v,200,v,44
 buffer_load_dwordx4 v[8:11], v128, s[24:27], s50 offen offset:0 sc1
 mf a,28,v,204,v,60
 s_waitcnt lgkmcnt(4)
 mf a,32,v,208,v,32
 tr v,200,135,8192
 mf a,32,v,212,v,48
 tr v,202,135,8704
 mf a,36,v,208,v,36
 buffer_load_dwordx4 v[12:15], v128, s[24:27], s51 offen offset:0 sc1
 mf a,36,v,212,v,52
 mf a,40,v,208,v,40
 tr v,204,135,12288
 mf a,40,v,212,v,56
 tr v,206,135,12800
 mf a,44,v,208,v,44
 mf a,44,v,212,v,60
 s_waitcnt lgkmcnt(4)
 mf a,48,v,192,v,32
 tr v,208,136,8192
 mf a,48,v,196,v,48
 tr v,210,136,8704
 mf a,52,v,192,v,36
 buffer_load_dwordx4 a[192:195], v128, s[24:27], s48 offen offset:1024 sc1
 mf a,52,v,196,v,52
 s_bitcmp1_b32 s45, 19
 s_cbranch_scc0 f_wA19
 buffer_load_dword v146, v217, s[28:31], 0 offen
f_wA19:
 mf a,56,v,192,v,40
 tr v,212,136,12288
 mf a,56,v,196,v,56
 tr v,214,136,12800
 mf a,60,v,192,v,44
 buffer_load_dwordx4 a[196:199], v128, s[24:27], s49 offen offset:1024 sc1
 mf a,60,v,196,v,60
 s_waitcnt lgkmcnt(4)
 mf a,64,v,200,v,32
 tr v,192,137,8192
 mf a,64,v,204,v,48
 tr v,194,137,8704
 mf a,68,v,200,v,36
 buffer_load_dwordx4 a[200:203], v128, s[24:27], s50 offen offset:1024 sc1
 mf a,68,v,204,v,52
 mf a,72,v,200,v,40
 tr v,196,137,12288
 mf a,72,v,204,v,56
 tr v,198,137,12800
 mf a,76,v,200,v,44
 buffer_load_dwordx4 a[204:207], v128, s[24:27], s51 offen offset:1024 sc1
 mf a,76,v,204,v,60
 s_waitcnt lgkmcnt(4)
 mf a,80,v,208,v,32
 tr v,200,138,8192
 mf a,80,v,212,v,48
 tr v,202,138,8704
 s_add_u32 m0, s52, 49152
 mf a,84,v,208,v,36
 buffer_load_dwordx4 v130, s[4:7], s46 offen lds
 mf a,84,v,212,v,52
 mf a,88,v,208,v,40
 tr v,204,138,12288
 mf a,88,v,212,v,56
 tr v,206,138,12800
 mf a,92,v,208,v,44
 mf a,92,v,212,v,60
 s_waitcnt lgkmcnt(4)
 mf a,96,v,192,v,32
 tr v,208,135,16384
 mf a,96,v,196,v,48
 tr v,210,135,16896
 s_add_u32 m0, s52, 57344
 mf a,100,v,192,v,36
 buffer_load_dwordx4 v129, s[8:11], s44 offen lds
 mf a,100,v,196,v,52
 mf a,104,v,192,v,40
 tr v,212,135,20480
 mf a,104,v,196,v,56
 tr v,214,135,20992
 mf a,108,v,192,v,44
 mf a,108,v,196,v,60
 s_waitcnt lgkmcnt(4)
 mf a,112,v,200,v,32
 tr v,192,136,16384
 mf a,112,v,204,v,48
 tr v,194,136,16896
 s_add_u32 m0, s52, 65536
 mf a,116,v,200,v,36
 buffer_load_dwordx4 v129, s[12:15], s44 offen lds
 s_add_u32 s44, s44, 229376
 mf a,116,v,204,v,52
 s_add_u32 s46, s46, 196608
 mf a,120,v,200,v,40
 tr v,196,136,20480
 mf a,120,v,204,v,56
 tr v,198,136,20992
 mf a,124,v,200,v,44
 mf a,124,v,204,v,60
 s_waitcnt lgkmcnt(4)
 mf a,128,v,208,v,32
 tr v,200,137,16384
 mf a,128,v,212,v,48
 tr v,202,137,16896
 s_add_u32 m0, s52, 53248
 mf a,132,v,208,v,36
 buffer_load_dwordx4 v130, s[4:7], s46 offen lds
 mf a,132,v,212,v,52
 mf a,136,v,208,v,40
 tr v,204,137,20480
 mf a,136,v,212,v,56
 tr v,206,137,20992
 mf a,140,v,208,v,44
 mf a,140,v,212,v,60
 s_waitcnt lgkmcnt(4)
 mf a,144,v,192,v,32
 tr v,208,138,16384
 mf a,144,v,196,v,48
 tr v,210,138,16896
 s_add_u32 m0, s52, 61440
 mf a,148,v,192,v,36
 buffer_load_dwordx4 v129, s[8:11], s44 offen lds
 mf a,148,v,196,v,52
 mf a,152,v,192,v,40
 tr v,212,138,20480
 mf a,152,v,196,v,56
 tr v,214,138,20992
 mf a,156,v,192,v,44
 mf a,156,v,196,v,60
 s_waitcnt lgkmcnt(4)
 mf a,160,v,200,v,32
 mf a,160,v,204,v,48
 s_add_u32 m0, s52, 69632
 mf a,164,v,200,v,36
 buffer_load_dwordx4 v129, s[12:15], s44 offen lds
 s_add_u32 s44, s44, 229376
 mf a,164,v,204,v,52
 s_waitcnt vmcnt(49) lgkmcnt(0)
 s_barrier
 s_add_u32 s46, s46, 196608
 mf a,168,v,200,v,40
 tr v,192,131,0
 mf a,168,v,204,v,56
 tr v,194,131,512
 mf a,172,v,200,v,44
 tr v,196,131,4096
 mf a,172,v,204,v,60
 tr v,198,131,4608
 mf a,176,v,208,v,32
 tr v,200,132,0
 mf a,176,v,212,v,48
 tr v,202,132,512
 mf a,180,v,208,v,36
 mf a,180,v,212,v,52
 mf a,184,v,208,v,40
 tr v,204,132,4096
 mf a,184,v,212,v,56
 tr v,206,132,4608
 mf a,188,v,208,v,44
 mf a,188,v,212,v,60
 s_waitcnt vmcnt(35) lgkmcnt(4)
f_A10:
 mf a,0,v,192,v,64
 tr v,208,133,0
 v_add_u32 v135, 0xc000, v135
 mf a,0,v,196,v,80
 tr v,210,133,512
 mf a,4,v,192,v,68
 buffer_load_dwordx4 a[208:211], v128, s[24:27], s48 offen offset:2048 sc1
 mf a,4,v,196,v,84
 mf a,8,v,192,v,72
 tr v,212,133,4096
 v_add_u32 v136, 0xc000, v136
 mf a,8,v,196,v,88
 tr v,214,133,4608
 mf a,12,v,192,v,76
 buffer_load_dwordx4 a[212:215], v128, s[24:27], s49 offen offset:2048 sc1
 mf a,12,v,196,v,92
 s_waitcnt lgkmcnt(4)
 mf a,16,v,200,v,64
 tr v,192,134,0
 v_add_u32 v137, 0xc000, v137
 mf a,16,v,204,v,80
 tr v,194,134,512
 mf a,20,v,200,v,68
 buffer_load_dwordx4 a[216:219], v128, s[24:27], s50 offen offset:2048 sc1
 mf a,20,v,204,v,84
 mf a,24,v,200,v,72
 tr v,196,134,4096
 v_add_u32 v138, 0xc000, v138
 mf a,24,v,204,v,88
 tr v,198,134,4608
 mf a,28,v,200,v,76
 buffer_load_dwordx4 a[220:223], v128, s[24:27], s51 offen offset:2048 sc1
 mf a,28,v,204,v,92
 s_waitcnt lgkmcnt(4)
 mf a,32,v,208,v,64
 tr v,200,131,8192
 mf a,32,v,212,v,80
 tr v,202,131,8704
 mf a,36,v,208,v,68
 buffer_load_dwordx4 a[224:227], v128, s[24:27], s48 offen offset:3072 sc1
 s_add_u32 s48, s48, 4096
 mf a,36,v,212,v,84
 mf a,40,v,208,v,72
 tr v,204,131,12288
 mf a,40,v,212,v,88
 tr v,206,131,12800
 mf a,44,v,208,v,76
 mf a,44,v,212,v,92
 s_waitcnt lgkmcnt(4)
 mf a,48,v,192,v,64
 tr v,208,132,8192
 mf a,48,v,196,v,80
 tr v,210,132,8704
 mf a,52,v,192,v,68
 buffer_load_dwordx4 a[228:231], v128, s[24:27], s49 offen offset:3072 sc1
 s_add_u32 s49, s49, 4096
 mf a,52,v,196,v,84
 s_bitcmp1_b32 s45, 20
 s_cbranch_scc0 f_wA20
 buffer_load_dword v146, v217, s[28:31], 0 offen
f_wA20:
 mf a,56,v,192,v,72
 tr v,212,132,12288
 mf a,56,v,196,v,88
 tr v,214,132,12800
 mf a,60,v,192,v,76
 buffer_load_dwordx4 a[232:235], v128, s[24:27], s50 offen offset:3072 sc1
 s_add_u32 s50, s50, 4096
 mf a,60,v,196,v,92
 s_waitcnt lgkmcnt(4)
 mf a,64,v,200,v,64
 tr v,192,133,8192
 mf a,64,v,204,v,80
 tr v,194,133,8704
 mf a,68,v,200,v,68
 buffer_load_dwordx4 a[236:239], v128, s[24:27], s51 offen offset:3072 sc1
 s_add_u32 s51, s51, 4096
 mf a,68,v,204,v,84
 mf a,72,v,200,v,72
 tr v,196,133,12288
 mf a,72,v,204,v,88
 tr v,198,133,12800
 s_add_u32 m0, s52, 73728
 mf a,76,v,200,v,76
 buffer_load_dwordx4 v130, s[4:7], s46 offen lds
 mf a,76,v,204,v,92
 s_waitcnt lgkmcnt(4)
 mf a,80,v,208,v,64
 tr v,200,134,8192
 mf a,80,v,212,v,80
 tr v,202,134,8704
 s_add_u32 m0, s52, 81920
 mf a,84,v,208,v,68
 buffer_load_dwordx4 v129, s[8:11], s44 offen lds
 mf a,84,v,212,v,84
 mf a,88,v,208,v,72
 tr v,204,134,12288
 mf a,88,v,212,v,88
 tr v,206,134,12800
 mf a,92,v,208,v,76
 mf a,92,v,212,v,92
 s_waitcnt lgkmcnt(4)
 mf a,96,v,192,v,64
 tr v,208,131,16384
 mf a,96,v,196,v,80
 tr v,210,131,16896
 s_add_u32 m0, s52, 90112
 mf a,100,v,192,v,68
 buffer_load_dwordx4 v129, s[12:15], s44 offen lds
 s_add_u32 s44, s44, 229376
 mf a,100,v,196,v,84
 s_add_u32 s46, s46, 196608
 mf a,104,v,192,v,72
 tr v,212,131,20480
 mf a,104,v,196,v,88
 tr v,214,131,20992
 mf a,108,v,192,v,76
 mf a,108,v,196,v,92
 s_waitcnt lgkmcnt(4)
 mf a,112,v,200,v,64
 tr v,192,132,16384
 mf a,112,v,204,v,80
 tr v,194,132,16896
 s_add_u32 m0, s52, 77824
 mf a,116,v,200,v,68
 buffer_load_dwordx4 v130, s[4:7], s46 offen lds
 mf a,116,v,204,v,84
 mf a,120,v,200,v,72
 tr v,196,132,20480
 mf a,120,v,204,v,88
 tr v,198,132,20992
 mf a,124,v,200,v,76
 mf a,124,v,204,v,92
 s_waitcnt lgkmcnt(4)
 mf a,128,v,208,v,64
 tr v,200,133,16384
 mf a,128,v,212,v,80
 tr v,202,133,16896
 mf a,132,v,208,v,68
 mf a,132,v,212,v,84
 mf a,136,v,208,v,72
 tr v,204,133,20480
 mf a,136,v,212,v,88
 tr v,206,133,20992
 s_add_u32 m0, s52, 86016
 mf a,140,v,208,v,76
 buffer_load_dwordx4 v129, s[8:11], s44 offen lds
 mf a,140,v,212,v,92
 s_waitcnt lgkmcnt(4)
 mf a,144,v,192,v,64
 tr v,208,134,16384
 mf a,144,v,196,v,80
 tr v,210,134,16896
 mf a,148,v,192,v,68
 mf a,148,v,196,v,84
 mf a,152,v,192,v,72
 tr v,212,134,20480
 mf a,152,v,196,v,88
 tr v,214,134,20992
 mf a,156,v,192,v,76
 mf a,156,v,196,v,92
 s_waitcnt lgkmcnt(4)
 mf a,160,v,200,v,64
 mf a,160,v,204,v,80
 s_add_u32 m0, s52, 94208
 mf a,164,v,200,v,68
 buffer_load_dwordx4 v129, s[12:15], s44 offen lds
 s_mov_b32 s44, 7110656
 mf a,164,v,204,v,84
 s_waitcnt lgkmcnt(0)
 s_barrier
 mf a,168,v,200,v,72
 tr v,192,135,0
 mf a,168,v,204,v,88
 tr v,194,135,512
 mf a,172,v,200,v,76
 tr v,196,135,4096
 mf a,172,v,204,v,92
 tr v,198,135,4608
 mf a,176,v,208,v,64
 tr v,200,136,0
 mf a,176,v,212,v,80
 tr v,202,136,512
 mf a,180,v,208,v,68
 mf a,180,v,212,v,84
 mf a,184,v,208,v,72
 tr v,204,136,4096
 mf a,184,v,212,v,88
 tr v,206,136,4608
 mf a,188,v,208,v,76
 mf a,188,v,212,v,92
 s_waitcnt vmcnt(35) lgkmcnt(4)
f_A11:
 mf a,0,v,192,v,96
 tr v,208,137,0
 v_add_u32 v131, 0xfffe8000, v131
 mf a,0,v,196,v,112
 tr v,210,137,512
 mf a,4,v,192,v,100
 buffer_load_dwordx4 a[240:243], v128, s[24:27], s48 offen offset:0 sc1
 mf a,4,v,196,v,116
 mf a,8,v,192,v,104
 tr v,212,137,4096
 v_add_u32 v132, 0xfffe8000, v132
 mf a,8,v,196,v,120
 tr v,214,137,4608
 mf a,12,v,192,v,108
 buffer_load_dwordx4 a[244:247], v128, s[24:27], s49 offen offset:0 sc1
 mf a,12,v,196,v,124
 s_waitcnt lgkmcnt(4)
 mf a,16,v,200,v,96
 tr v,192,138,0
 v_add_u32 v133, 0xfffe8000, v133
 mf a,16,v,204,v,112
 tr v,194,138,512
 mf a,20,v,200,v,100
 buffer_load_dwordx4 a[248:251], v128, s[24:27], s50 offen offset:0 sc1
 mf a,20,v,204,v,116
 mf a,24,v,200,v,104
 tr v,196,138,4096
 v_add_u32 v134, 0xfffe8000, v134
 mf a,24,v,204,v,120
 tr v,198,138,4608
 mf a,28,v,200,v,108
 buffer_load_dwordx4 a[252:255], v128, s[24:27], s51 offen offset:0 sc1
 mf a,28,v,204,v,124
 s_waitcnt lgkmcnt(4)
 mf a,32,v,208,v,96
 tr v,200,135,8192
 mf a,32,v,212,v,112
 tr v,202,135,8704
 mf a,36,v,208,v,100
 buffer_load_dwordx4 v[160:163], v128, s[24:27], s48 offen offset:1024 sc1
 mf a,36,v,212,v,116
 mf a,40,v,208,v,104
 tr v,204,135,12288
 mf a,40,v,212,v,120
 tr v,206,135,12800
 mf a,44,v,208,v,108
 mf a,44,v,212,v,124
 s_waitcnt lgkmcnt(4)
 mf a,48,v,192,v,96
 tr v,208,136,8192
 mf a,48,v,196,v,112
 tr v,210,136,8704
 mf a,52,v,192,v,100
 buffer_load_dwordx4 v[164:167], v128, s[24:27], s49 offen offset:1024 sc1
 mf a,52,v,196,v,116
 s_bitcmp1_b32 s45, 21
 s_cbranch_scc0 f_wA21
 buffer_load_dword v146, v217, s[28:31], 0 offen
f_wA21:
 mf a,56,v,192,v,104
 tr v,212,136,12288
 mf a,56,v,196,v,120
 tr v,214,136,12800
 mf a,60,v,192,v,108
 buffer_load_dwordx4 v[168:171], v128, s[24:27], s50 offen offset:1024 sc1
 mf a,60,v,196,v,124
 s_waitcnt lgkmcnt(4)
 mf a,64,v,200,v,96
 tr v,192,137,8192
 mf a,64,v,204,v,112
 tr v,194,137,8704
 mf a,68,v,200,v,100
 buffer_load_dwordx4 v[172:175], v128, s[24:27], s51 offen offset:1024 sc1
 mf a,68,v,204,v,116
 mf a,72,v,200,v,104
 tr v,196,137,12288
 mf a,72,v,204,v,120
 tr v,198,137,12800
 s_add_u32 m0, s52, 98304
 mf a,76,v,200,v,108
 buffer_load_dwordx4 v129, s[16:19], s44 offen lds
 mf a,76,v,204,v,124
 s_waitcnt lgkmcnt(4)
 mf a,80,v,208,v,96
 tr v,200,138,8192
 mf a,80,v,212,v,112
 tr v,202,138,8704
 s_add_u32 m0, s52, 106496
 mf a,84,v,208,v,100
 buffer_load_dwordx4 v129, s[20:23], s44 offen lds
 s_sub_u32 s44, s44, 229376
 mf a,84,v,212,v,116
 mf a,88,v,208,v,104
 tr v,204,138,12288
 mf a,88,v,212,v,120
 tr v,206,138,12800
 mf a,92,v,208,v,108
 mf a,92,v,212,v,124
 s_waitcnt lgkmcnt(4)
 mf a,96,v,192,v,96
 tr v,208,135,16384
 mf a,96,v,196,v,112
 tr v,210,135,16896
 s_add_u32 m0, s52, 102400
 mf a,100,v,192,v,100
 buffer_load_dwordx4 v129, s[16:19], s44 offen lds
 mf a,100,v,196,v,116
 mf a,104,v,192,v,104
 tr v,212,135,20480
 mf a,104,v,196,v,120
 tr v,214,135,20992
 mf a,108,v,192,v,108
 mf a,108,v,196,v,124
 s_waitcnt lgkmcnt(4)
 mf a,112,v,200,v,96
 tr v,192,136,16384
 mf a,112,v,204,v,112
 tr v,194,136,16896
 mf a,116,v,200,v,100
 mf a,116,v,204,v,116
 mf a,120,v,200,v,104
 tr v,196,136,20480
 mf a,120,v,204,v,120
 tr v,198,136,20992
 mf a,124,v,200,v,108
 mf a,124,v,204,v,124
 s_waitcnt lgkmcnt(4)
 mf a,128,v,208,v,96
 tr v,200,137,16384
 mf a,128,v,212,v,112
 tr v,202,137,16896
 mf a,132,v,208,v,100
 mf a,132,v,212,v,116
 mf a,136,v,208,v,104
 tr v,204,137,20480
 mf a,136,v,212,v,120
 tr v,206,137,20992
 s_add_u32 m0, s52, 110592
 mf a,140,v,208,v,108
 buffer_load_dwordx4 v129, s[20:23], s44 offen lds
 s_sub_u32 s44, s44, 229376
 mf a,140,v,212,v,124
 s_waitcnt lgkmcnt(4)
 mf a,144,v,192,v,96
 tr v,208,138,16384
 mf a,144,v,196,v,112
 tr v,210,138,16896
 mf a,148,v,192,v,100
 mf a,148,v,196,v,116
 mf a,152,v,192,v,104
 tr v,212,138,20480
 mf a,152,v,196,v,120
 tr v,214,138,20992
 mf a,156,v,192,v,108
 mf a,156,v,196,v,124
 s_waitcnt lgkmcnt(4)
 mf a,160,v,200,v,96
 mf a,160,v,204,v,112
 mf a,164,v,200,v,100
 mf a,164,v,204,v,116
 s_waitcnt lgkmcnt(0)
 s_barrier
 mf a,168,v,200,v,104
 tr v,192,131,0
 mf a,168,v,204,v,120
 tr v,194,131,512
 mf a,172,v,200,v,108
 tr v,196,131,4096
 mf a,172,v,204,v,124
 tr v,198,131,4608
 mf a,176,v,208,v,96
 tr v,200,132,0
 mf a,176,v,212,v,112
 tr v,202,132,512
 mf a,180,v,208,v,100
 mf a,180,v,212,v,116
 mf a,184,v,208,v,104
 tr v,204,132,4096
 mf a,184,v,212,v,120
 tr v,206,132,4608
 mf a,188,v,208,v,108
 mf a,188,v,212,v,124
 s_waitcnt vmcnt(32) lgkmcnt(4)
f_A12:
 mf a,0,v,192,v,0
 tr v,208,133,0
 v_add_u32 v135, 0xfffe8000, v135
 mf a,0,v,196,a,192
 tr v,210,133,512
 mf a,4,v,192,v,4
 buffer_load_dwordx4 v[176:179], v128, s[24:27], s48 offen offset:2048 sc1
 mf a,4,v,196,a,196
 mf a,8,v,192,v,8
 tr v,212,133,4096
 v_add_u32 v136, 0xfffe8000, v136
 mf a,8,v,196,a,200
 tr v,214,133,4608
 mf a,12,v,192,v,12
 buffer_load_dwordx4 v[180:183], v128, s[24:27], s49 offen offset:2048 sc1
 mf a,12,v,196,a,204
 s_waitcnt lgkmcnt(4)
 mf a,16,v,200,v,0
 tr v,192,134,0
 v_add_u32 v137, 0xfffe8000, v137
 mf a,16,v,204,a,192
 tr v,194,134,512
 mf a,20,v,200,v,4
 buffer_load_dwordx4 v[184:187], v128, s[24:27], s50 offen offset:2048 sc1
 mf a,20,v,204,a,196
 mf a,24,v,200,v,8
 tr v,196,134,4096
 v_add_u32 v138, 0xfffe8000, v138
 mf a,24,v,204,a,200
 tr v,198,134,4608
 mf a,28,v,200,v,12
 buffer_load_dwordx4 v[188:191], v128, s[24:27], s51 offen offset:2048 sc1
 mf a,28,v,204,a,204
 s_waitcnt lgkmcnt(4)
 mf a,32,v,208,v,0
 tr v,200,131,8192
 mf a,32,v,212,a,192
 tr v,202,131,8704
 mf a,36,v,208,v,4
 buffer_load_dwordx4 v[240:243], v128, s[24:27], s48 offen offset:3072 sc1
 s_sub_u32 s48, s48, 4096
 mf a,36,v,212,a,196
 mf a,40,v,208,v,8
 tr v,204,131,12288
 mf a,40,v,212,a,200
 tr v,206,131,12800
 mf a,44,v,208,v,12
 mf a,44,v,212,a,204
 s_waitcnt lgkmcnt(4)
 mf a,48,v,192,v,0
 tr v,208,132,8192
 mf a,48,v,196,a,192
 tr v,210,132,8704
 mf a,52,v,192,v,4
 buffer_load_dwordx4 v[244:247], v128, s[24:27], s49 offen offset:3072 sc1
 s_sub_u32 s49, s49, 4096
 mf a,52,v,196,a,196
 s_bitcmp1_b32 s45, 22
 s_cbranch_scc0 f_wA22
 buffer_load_dword v146, v217, s[28:31], 0 offen
f_wA22:
 mf a,56,v,192,v,8
 tr v,212,132,12288
 mf a,56,v,196,a,200
 tr v,214,132,12800
 mf a,60,v,192,v,12
 buffer_load_dwordx4 v[248:251], v128, s[24:27], s50 offen offset:3072 sc1
 s_sub_u32 s50, s50, 4096
 mf a,60,v,196,a,204
 s_waitcnt lgkmcnt(4)
 mf a,64,v,200,v,0
 tr v,192,133,8192
 mf a,64,v,204,a,192
 tr v,194,133,8704
 mf a,68,v,200,v,4
 buffer_load_dwordx4 v[252:255], v128, s[24:27], s51 offen offset:3072 sc1
 s_sub_u32 s51, s51, 4096
 mf a,68,v,204,a,196
 mf a,72,v,200,v,8
 tr v,196,133,12288
 mf a,72,v,204,a,200
 tr v,198,133,12800
 s_add_u32 m0, s52, 122880
 mf a,76,v,200,v,12
 buffer_load_dwordx4 v129, s[16:19], s44 offen lds
 mf a,76,v,204,a,204
 s_waitcnt lgkmcnt(4)
 mf a,80,v,208,v,0
 tr v,200,134,8192
 mf a,80,v,212,a,192
 tr v,202,134,8704
 s_add_u32 m0, s52, 131072
 mf a,84,v,208,v,4
 buffer_load_dwordx4 v129, s[20:23], s44 offen lds
 s_sub_u32 s44, s44, 229376
 mf a,84,v,212,a,196
 mf a,88,v,208,v,8
 tr v,204,134,12288
 mf a,88,v,212,a,200
 tr v,206,134,12800
 mf a,92,v,208,v,12
 mf a,92,v,212,a,204
 s_waitcnt lgkmcnt(4)
 mf a,96,v,192,v,0
 tr v,208,131,16384
 mf a,96,v,196,a,192
 tr v,210,131,16896
 s_add_u32 m0, s52, 126976
 mf a,100,v,192,v,4
 buffer_load_dwordx4 v129, s[16:19], s44 offen lds
 mf a,100,v,196,a,196
 mf a,104,v,192,v,8
 tr v,212,131,20480
 mf a,104,v,196,a,200
 tr v,214,131,20992
 mf a,108,v,192,v,12
 mf a,108,v,196,a,204
 s_waitcnt lgkmcnt(4)
 mf a,112,v,200,v,0
 tr v,192,132,16384
 mf a,112,v,204,a,192
 tr v,194,132,16896
 mf a,116,v,200,v,4
 mf a,116,v,204,a,196
 mf a,120,v,200,v,8
 tr v,196,132,20480
 mf a,120,v,204,a,200
 tr v,198,132,20992
 mf a,124,v,200,v,12
 mf a,124,v,204,a,204
 s_waitcnt lgkmcnt(4)
 mf a,128,v,208,v,0
 tr v,200,133,16384
 mf a,128,v,212,a,192
 tr v,202,133,16896
 mf a,132,v,208,v,4
 mf a,132,v,212,a,196
 mf a,136,v,208,v,8
 tr v,204,133,20480
 mf a,136,v,212,a,200
 tr v,206,133,20992
 s_add_u32 m0, s52, 135168
 mf a,140,v,208,v,12
 buffer_load_dwordx4 v129, s[20:23], s44 offen lds
 s_sub_u32 s44, s44, 229376
 mf a,140,v,212,a,204
 s_waitcnt lgkmcnt(4)
 mf a,144,v,192,v,0
 tr v,208,134,16384
 mf a,144,v,196,a,192
 tr v,210,134,16896
 mf a,148,v,192,v,4
 mf a,148,v,196,a,196
 mf a,152,v,192,v,8
 tr v,212,134,20480
 mf a,152,v,196,a,200
 tr v,214,134,20992
 mf a,156,v,192,v,12
 mf a,156,v,196,a,204
 s_waitcnt lgkmcnt(4)
 mf a,160,v,200,v,0
 mf a,160,v,204,a,192
 mf a,164,v,200,v,4
 mf a,164,v,204,a,196
 s_waitcnt lgkmcnt(0)
 s_barrier
 mf a,168,v,200,v,8
 tr v,192,135,0
 mf a,168,v,204,a,200
 tr v,194,135,512
 mf a,172,v,200,v,12
 tr v,196,135,4096
 mf a,172,v,204,a,204
 tr v,198,135,4608
 mf a,176,v,208,v,0
 tr v,200,136,0
 mf a,176,v,212,a,192
 tr v,202,136,512
 mf a,180,v,208,v,4
 mf a,180,v,212,a,196
 mf a,184,v,208,v,8
 tr v,204,136,4096
 mf a,184,v,212,a,200
 tr v,206,136,4608
 mf a,188,v,208,v,12
 mf a,188,v,212,a,204
 s_waitcnt vmcnt(30) lgkmcnt(4)
f_A13:
 s_mov_b32 s69, f_A16-f_base
 mf a,0,v,192,a,208
 tr v,208,137,0
 v_add_u32 v131, 0xc000, v131
 mf a,0,v,196,a,224
 tr v,210,137,512
 mf a,4,v,192,a,212
 buffer_load_dword v146, v155, s[36:39], s69 offen
 mf a,4,v,196,a,228
 mf a,8,v,192,a,216
 tr v,212,137,4096
 v_add_u32 v132, 0xc000, v132
 mf a,8,v,196,a,232
 tr v,214,137,4608
 mf a,12,v,192,a,220
 mf a,12,v,196,a,236
 s_waitcnt lgkmcnt(4)
 mf a,16,v,200,a,208
 tr v,192,138,0
 v_add_u32 v133, 0xc000, v133
 mf a,16,v,204,a,224
 tr v,194,138,512
 s_add_u32 m0, s52, 0
 mf a,20,v,200,a,212
 buffer_load_dwordx4 v129, s[16:19], s44 offen lds
 mf a,20,v,204,a,228
 mf a,24,v,200,a,216
 tr v,196,138,4096
 v_add_u32 v134, 0xc000, v134
 mf a,24,v,204,a,232
 tr v,198,138,4608
 mf a,28,v,200,a,220
 mf a,28,v,204,a,236
 s_waitcnt lgkmcnt(4)
 mf a,32,v,208,a,208
 tr v,200,135,8192
 mf a,32,v,212,a,224
 tr v,202,135,8704
 s_add_u32 m0, s52, 8192
 mf a,36,v,208,a,212
 buffer_load_dwordx4 v129, s[20:23], s44 offen lds
 s_sub_u32 s44, s44, 229376
 mf a,36,v,212,a,228
 mf a,40,v,208,a,216
 tr v,204,135,12288
 mf a,40,v,212,a,232
 tr v,206,135,12800
 mf a,44,v,208,a,220
 mf a,44,v,212,a,236
 s_waitcnt lgkmcnt(4)
 mf a,48,v,192,a,208
 tr v,208,136,8192
 mf a,48,v,196,a,224
 tr v,210,136,8704
 mf a,52,v,192,a,212
 mf a,52,v,196,a,228
 s_bitcmp1_b32 s45, 23
 s_cbranch_scc0 f_wA23
 buffer_load_dword v146, v217, s[28:31], 0 offen
f_wA23:
 mf a,56,v,192,a,216
 tr v,212,136,12288
 mf a,56,v,196,a,232
 tr v,214,136,12800
 s_add_u32 m0, s52, 4096
 mf a,60,v,192,a,220
 buffer_load_dwordx4 v129, s[16:19], s44 offen lds
 mf a,60,v,196,a,236
 s_waitcnt lgkmcnt(4)
 mf a,64,v,200,a,208
 tr v,192,137,8192
 mf a,64,v,204,a,224
 tr v,194,137,8704
 mf a,68,v,200,a,212
 mf a,68,v,204,a,228
 mf a,72,v,200,a,216
 tr v,196,137,12288
 mf a,72,v,204,a,232
 tr v,198,137,12800
 s_add_u32 m0, s52, 12288
 mf a,76,v,200,a,220
 buffer_load_dwordx4 v129, s[20:23], s44 offen lds
 s_sub_u32 s44, s44, 229376
 mf a,76,v,204,a,236
 s_waitcnt lgkmcnt(4)
 mf a,80,v,208,a,208
 tr v,200,138,8192
 mf a,80,v,212,a,224
 tr v,202,138,8704
 mf a,84,v,208,a,212
 mf a,84,v,212,a,228
 mf a,88,v,208,a,216
 tr v,204,138,12288
 mf a,88,v,212,a,232
 tr v,206,138,12800
 mf a,92,v,208,a,220
 mf a,92,v,212,a,236
 s_waitcnt lgkmcnt(4)
 mf a,96,v,192,a,208
 tr v,208,135,16384
 mf a,96,v,196,a,224
 tr v,210,135,16896
 mf a,100,v,192,a,212
 mf a,100,v,196,a,228
 mf a,104,v,192,a,216
 tr v,212,135,20480
 mf a,104,v,196,a,232
 tr v,214,135,20992
 mf a,108,v,192,a,220
 mf a,108,v,196,a,236
 s_waitcnt lgkmcnt(4)
 mf a,112,v,200,a,208
 tr v,192,136,16384
 mf a,112,v,204,a,224
 tr v,194,136,16896
 mf a,116,v,200,a,212
 mf a,116,v,204,a,228
 mf a,120,v,200,a,216
 tr v,196,136,20480
 mf a,120,v,204,a,232
 tr v,198,136,20992
 mf a,124,v,200,a,220
 mf a,124,v,204,a,236
 s_waitcnt lgkmcnt(4)
 mf a,128,v,208,a,208
 tr v,200,137,16384
 mf a,128,v,212,a,224
 tr v,202,137,16896
 mf a,132,v,208,a,212
 mf a,132,v,212,a,228
 mf a,136,v,208,a,216
 tr v,204,137,20480
 mf a,136,v,212,a,232
 tr v,206,137,20992
 mf a,140,v,208,a,220
 mf a,140,v,212,a,236
 s_waitcnt lgkmcnt(4)
 mf a,144,v,192,a,208
 tr v,208,138,16384
 mf a,144,v,196,a,224
 tr v,210,138,16896
 mf a,148,v,192,a,212
 mf a,148,v,196,a,228
 mf a,152,v,192,a,216
 tr v,212,138,20480
 mf a,152,v,196,a,232
 tr v,214,138,20992
 mf a,156,v,192,a,220
 mf a,156,v,196,a,236
 s_waitcnt lgkmcnt(4)
 mf a,160,v,200,a,208
 mf a,160,v,204,a,224
 mf a,164,v,200,a,212
 mf a,164,v,204,a,228
 s_waitcnt lgkmcnt(0)
 s_barrier
 mf a,168,v,200,a,216
 tr v,192,131,0
 mf a,168,v,204,a,232
 tr v,194,131,512
 mf a,172,v,200,a,220
 tr v,196,131,4096
 mf a,172,v,204,a,236
 tr v,198,131,4608
 mf a,176,v,208,a,208
 tr v,200,132,0
 mf a,176,v,212,a,224
 tr v,202,132,512
 mf a,180,v,208,a,212
 mf a,180,v,212,a,228
 mf a,184,v,208,a,216
 tr v,204,132,4096
 mf a,184,v,212,a,232
 tr v,206,132,4608
 mf a,188,v,208,a,220
 mf a,188,v,212,a,236
 s_waitcnt vmcnt(21) lgkmcnt(4)
f_A14:
 mf a,0,v,192,a,240
 tr v,208,133,0
 v_add_u32 v135, 0xc000, v135
 mf a,0,v,196,v,160
 tr v,210,133,512
 s_add_u32 m0, s52, 24576
 mf a,4,v,192,a,244
 buffer_load_dwordx4 v129, s[16:19], s44 offen lds
 s_lshl_b32 s4, s57, 1
 mf a,4,v,196,v,164
 s_add_u32 s4, s4, s55
 s_mul_i32 s4, s4, 589824
 s_lshl_b32 s69, s54, 10
 mf a,8,v,192,a,248
 tr v,212,133,4096
 v_add_u32 v136, 0xc000, v136
 mf a,8,v,196,v,168
 tr v,214,133,4608
 s_add_u32 s4, s4, s69
 mf a,12,v,192,a,252
 s_add_u32 s4, s4, 4308992
 s_add_u32 s5, s4, 294912
 s_lshr_b32 s10, s60, 1
 mf a,12,v,196,v,172
 s_waitcnt lgkmcnt(4)
 s_lshl_b32 s10, s10, 2
 s_lshr_b32 s11, s61, 3
 mf a,16,v,200,a,240
 tr v,192,134,0
 v_add_u32 v137, 0xc000, v137
 mf a,16,v,204,v,160
 tr v,194,134,512
 s_add_u32 s10, s10, s11
 mf a,20,v,200,a,244
 s_lshl_b32 s76, s10, 12
 s_add_u32 s76, s76, 42008576
 s_and_b32 s11, s61, 7
 mf a,20,v,204,v,164
 s_lshl_b32 s11, s11, 8
 s_and_b32 s13, s60, 1
 s_lshl_b32 s12, s10, 2
 mf a,24,v,200,a,248
 tr v,196,134,4096
 v_add_u32 v138, 0xc000, v138
 mf a,24,v,204,v,168
 tr v,198,134,4608
 s_add_u32 m0, s52, 32768
 mf a,28,v,200,a,252
 buffer_load_dwordx4 v129, s[20:23], s44 offen lds
 s_sub_u32 s44, s44, 229376
 mf a,28,v,204,v,172
 s_waitcnt lgkmcnt(4)
 s_add_u32 s12, s12, s3
 s_lshl_b32 s12, s12, 16
 mf a,32,v,208,a,240
 tr v,200,131,8192
 s_add_u32 s12, s12, s11
 mf a,32,v,212,v,160
 tr v,202,131,8704
 s_lshl_b32 s14, s13, 7
 mf a,36,v,208,a,244
 s_add_u32 s6, s12, s14
 s_add_u32 s7, s6, 32768
 s_lshl_b32 s14, s55, 7
 mf a,36,v,212,v,164
 s_add_u32 s11, s11, s14
 s_mul_i32 s14, s13, 52
 s_mul_i32 s15, s56, 56
 mf a,40,v,208,a,248
 tr v,204,131,12288
 s_add_u32 s14, s14, s15
 mf a,40,v,212,v,168
 tr v,206,131,12800
 s_lshl1_add_u32 s13, s13, s56
 mf a,44,v,208,a,252
 s_lshl_b32 s62, s14, 16
 s_add_u32 s62, s62, s11
 s_lshl_b32 s8, s13, 19
 mf a,44,v,212,v,172
 s_waitcnt lgkmcnt(4)
 s_add_u32 s8, s8, s11
 s_lshl3_add_u32 s9, s13, 112
 mf a,48,v,192,a,240
 tr v,208,132,8192
 s_sub_u32 s9, s9, s14
 mf a,48,v,196,v,160
 tr v,210,132,8704
 s_add_u32 m0, s52, 28672
 mf a,52,v,192,a,244
 buffer_load_dwordx4 v129, s[16:19], s44 offen lds
 s_lshl_b32 s9, s9, 10
 mf a,52,v,196,v,164
 s_lshl1_add_u32 s10, s10, s55
 s_mul_i32 s10, s10, 589824
 s_lshl_b32 s11, s14, 10
 mf a,56,v,192,a,248
 tr v,212,132,12288
 s_add_u32 s10, s10, s11
 mf a,56,v,196,v,168
 tr v,214,132,12800
 s_add_u32 s10, s10, 4194304
 mf a,60,v,192,a,252
 s_mul_i32 s11, s56, 294912
 s_sub_u32 s12, 294912, s11
 s_add_u32 s54, s10, s11
 mf a,60,v,196,v,172
 s_waitcnt lgkmcnt(4)
 s_add_u32 s55, s54, 147456
 s_add_u32 s56, s10, s12
 mf a,64,v,200,a,240
 tr v,192,133,8192
 s_add_u32 s57, s56, 147456
 mf a,64,v,204,v,160
 tr v,194,133,8704
 s_lshl2_add_u32 s10, s2, s3
 mf a,68,v,200,a,244
 s_lshl_b32 s11, s10, 13
 s_add_u32 s58, s11, 50331648
 s_add_u32 s59, s58, 4096
 mf a,68,v,204,v,164
 s_xor_b32 s60, s58, 32768
 s_add_u32 s61, s60, 4096
 mf a,72,v,200,a,248
 tr v,196,133,12288
 mf a,72,v,204,v,168
 tr v,198,133,12800
 s_add_u32 m0, s52, 36864
 mf a,76,v,200,a,252
 buffer_load_dwordx4 v129, s[20:23], s44 offen lds
 s_sub_u32 s44, s44, 229376
 mf a,76,v,204,v,172
 s_waitcnt lgkmcnt(4)
 mf a,80,v,208,a,240
 tr v,200,134,8192
 mf a,80,v,212,v,160
 tr v,202,134,8704
 mf a,84,v,208,a,244
 mf a,84,v,212,v,164
 mf a,88,v,208,a,248
 tr v,204,134,12288
 mf a,88,v,212,v,168
 tr v,206,134,12800
 mf a,92,v,208,a,252
 mf a,92,v,212,v,172
 s_waitcnt lgkmcnt(4)
 mf a,96,v,192,a,240
 tr v,208,131,16384
 mf a,96,v,196,v,160
 tr v,210,131,16896
 mf a,100,v,192,a,244
 mf a,100,v,196,v,164
 mf a,104,v,192,a,248
 tr v,212,131,20480
 mf a,104,v,196,v,168
 tr v,214,131,20992
 mf a,108,v,192,a,252
 mf a,108,v,196,v,172
 s_waitcnt lgkmcnt(4)
 mf a,112,v,200,a,240
 tr v,192,132,16384
 mf a,112,v,204,v,160
 tr v,194,132,16896
 mf a,116,v,200,a,244
 mf a,116,v,204,v,164
 mf a,120,v,200,a,248
 tr v,196,132,20480
 mf a,120,v,204,v,168
 tr v,198,132,20992
 mf a,124,v,200,a,252
 mf a,124,v,204,v,172
 s_waitcnt lgkmcnt(4)
 mf a,128,v,208,a,240
 tr v,200,133,16384
 mf a,128,v,212,v,160
 tr v,202,133,16896
 mf a,132,v,208,a,244
 mf a,132,v,212,v,164
 mf a,136,v,208,a,248
 tr v,204,133,20480
 mf a,136,v,212,v,168
 tr v,206,133,20992
 mf a,140,v,208,a,252
 mf a,140,v,212,v,172
 s_waitcnt lgkmcnt(4)
 mf a,144,v,192,a,240
 tr v,208,134,16384
 mf a,144,v,196,v,160
 tr v,210,134,16896
 mf a,148,v,192,a,244
 mf a,148,v,196,v,164
 mf a,152,v,192,a,248
 tr v,212,134,20480
 mf a,152,v,196,v,168
 tr v,214,134,20992
 mf a,156,v,192,a,252
 mf a,156,v,196,v,172
 s_waitcnt lgkmcnt(4)
 mf a,160,v,200,a,240
 mf a,160,v,204,v,160
 mf a,164,v,200,a,244
 mf a,164,v,204,v,164
 s_waitcnt lgkmcnt(0)
 s_barrier
 mf a,168,v,200,a,248
 tr v,192,135,0
 mf a,168,v,204,v,168
 tr v,194,135,512
 mf a,172,v,200,a,252
 tr v,196,135,4096
 mf a,172,v,204,v,172
 tr v,198,135,4608
 mf a,176,v,208,a,240
 tr v,200,136,0
 mf a,176,v,212,v,160
 tr v,202,136,512
 mf a,180,v,208,a,244
 mf a,180,v,212,v,164
 mf a,184,v,208,a,248
 tr v,204,136,4096
 mf a,184,v,212,v,168
 tr v,206,136,4608
 mf a,188,v,208,a,252
 mf a,188,v,212,v,172
 s_waitcnt vmcnt(13) lgkmcnt(4)
f_A15:
 mf a,0,v,192,v,176
 tr v,208,137,0
 v_add_u32 v131, 0xc000, v131
 mf a,0,v,196,v,240
 tr v,210,137,512
 s_add_u32 m0, s52, 49152
 mf a,4,v,192,v,180
 buffer_load_dwordx4 v129, s[16:19], s44 offen lds
 mf a,4,v,196,v,244
 mf a,8,v,192,v,184
 tr v,212,137,4096
 v_add_u32 v132, 0xc000, v132
 mf a,8,v,196,v,248
 tr v,214,137,4608
 mf a,12,v,192,v,188
 mf a,12,v,196,v,252
 s_waitcnt lgkmcnt(4)
 mf a,16,v,200,v,176
 tr v,192,138,0
 v_add_u32 v133, 0xc000, v133
 mf a,16,v,204,v,240
 tr v,194,138,512
 mf a,20,v,200,v,180
 mf a,20,v,204,v,244
 mf a,24,v,200,v,184
 tr v,196,138,4096
 v_add_u32 v134, 0xc000, v134
 mf a,24,v,204,v,248
 tr v,198,138,4608
 s_add_u32 m0, s52, 57344
 mf a,28,v,200,v,188
 buffer_load_dwordx4 v129, s[20:23], s44 offen lds
 s_sub_u32 s44, s44, 229376
 mf a,28,v,204,v,252
 s_waitcnt lgkmcnt(4)
 mf a,32,v,208,v,176
 tr v,200,135,8192
 mf a,32,v,212,v,240
 tr v,202,135,8704
 mf a,36,v,208,v,180
 mf a,36,v,212,v,244
 mf a,40,v,208,v,184
 tr v,204,135,12288
 mf a,40,v,212,v,248
 tr v,206,135,12800
 mf a,44,v,208,v,188
 mf a,44,v,212,v,252
 s_waitcnt lgkmcnt(4)
 mf a,48,v,192,v,176
 tr v,208,136,8192
 mf a,48,v,196,v,240
 tr v,210,136,8704
 s_add_u32 m0, s52, 53248
 mf a,52,v,192,v,180
 buffer_load_dwordx4 v129, s[16:19], s44 offen lds
 mf a,52,v,196,v,244
 mf a,56,v,192,v,184
 tr v,212,136,12288
 mf a,56,v,196,v,248
 tr v,214,136,12800
 mf a,60,v,192,v,188
 mf a,60,v,196,v,252
 s_waitcnt lgkmcnt(4)
 mf a,64,v,200,v,176
 tr v,192,137,8192
 mf a,64,v,204,v,240
 tr v,194,137,8704
 mf a,68,v,200,v,180
 mf a,68,v,204,v,244
 mf a,72,v,200,v,184
 tr v,196,137,12288
 mf a,72,v,204,v,248
 tr v,198,137,12800
 s_add_u32 m0, s52, 61440
 mf a,76,v,200,v,188
 buffer_load_dwordx4 v129, s[20:23], s44 offen lds
 s_sub_u32 s44, s44, 229376
 mf a,76,v,204,v,252
 s_waitcnt lgkmcnt(4)
 mf a,80,v,208,v,176
 tr v,200,138,8192
 mf a,80,v,212,v,240
 tr v,202,138,8704
 mf a,84,v,208,v,180
 mf a,84,v,212,v,244
 mf a,88,v,208,v,184
 tr v,204,138,12288
 mf a,88,v,212,v,248
 tr v,206,138,12800
 mf a,92,v,208,v,188
 mf a,92,v,212,v,252
 s_waitcnt lgkmcnt(4)
 mf a,96,v,192,v,176
 tr v,208,135,16384
 mf a,96,v,196,v,240
 tr v,210,135,16896
 mf a,100,v,192,v,180
 mf a,100,v,196,v,244
 mf a,104,v,192,v,184
 tr v,212,135,20480
 mf a,104,v,196,v,248
 tr v,214,135,20992
 mf a,108,v,192,v,188
 mf a,108,v,196,v,252
 s_waitcnt lgkmcnt(4)
 mf a,112,v,200,v,176
 tr v,192,136,16384
 mf a,112,v,204,v,240
 tr v,194,136,16896
 mf a,116,v,200,v,180
 mf a,116,v,204,v,244
 mf a,120,v,200,v,184
 tr v,196,136,20480
 mf a,120,v,204,v,248
 tr v,198,136,20992
 mf a,124,v,200,v,188
 mf a,124,v,204,v,252
 s_waitcnt lgkmcnt(4)
 mf a,128,v,208,v,176
 tr v,200,137,16384
 mf a,128,v,212,v,240
 tr v,202,137,16896
 mf a,132,v,208,v,180
 mf a,132,v,212,v,244
 mf a,136,v,208,v,184
 tr v,204,137,20480
 mf a,136,v,212,v,248
 tr v,206,137,20992
 mf a,140,v,208,v,188
 mf a,140,v,212,v,252
 s_waitcnt lgkmcnt(4)
 mf a,144,v,192,v,176
 tr v,208,138,16384
 mf a,144,v,196,v,240
 tr v,210,138,16896
 mf a,148,v,192,v,180
 mf a,148,v,196,v,244
 mf a,152,v,192,v,184
 tr v,212,138,20480
 mf a,152,v,196,v,248
 tr v,214,138,20992
 mf a,156,v,192,v,188
 mf a,156,v,196,v,252
 s_waitcnt lgkmcnt(4)
 mf a,160,v,200,v,176
 mf a,160,v,204,v,240
 mf a,164,v,200,v,180
 mf a,164,v,204,v,244
 s_waitcnt lgkmcnt(0)
 s_barrier
 mf a,168,v,200,v,184
 tr v,192,131,0
 mf a,168,v,204,v,248
 tr v,194,131,512
 mf a,172,v,200,v,188
 tr v,196,132,0
 mf a,172,v,204,v,252
 tr v,198,132,512
 mf a,176,v,208,v,176
 tr v,200,131,8192
 mf a,176,v,212,v,240
 tr v,202,131,8704
 mf a,180,v,208,v,180
 mf a,180,v,212,v,244
 mf a,184,v,208,v,184
 tr v,204,132,8192
 mf a,184,v,212,v,248
 tr v,206,132,8704
 mf a,188,v,208,v,188
 mf a,188,v,212,v,252
 s_waitcnt lgkmcnt(4)
f_A16:
 v_mfma_f32_16x16x32_bf16 v[0:3], v[192:195], v[240:243], 0
 tr v,208,133,0
 v_add_u32 v135, 0xc000, v135
 v_mfma_f32_16x16x32_bf16 v[4:7], v[192:195], v[244:247], 0
 tr v,210,133,512
 s_add_u32 m0, s52, 73728
 v_mfma_f32_16x16x32_bf16 v[8:11], v[192:195], v[248:251], 0
 buffer_load_dwordx4 v129, s[16:19], s44 offen lds
 v_mfma_f32_16x16x32_bf16 v[12:15], v[192:195], v[252:255], 0
 v_accvgpr_read_b32 v216, a0
 v_accvgpr_read_b32 v217, a1
 v_mfma_f32_16x16x32_bf16 v[16:19], v[196:199], v[240:243], 0
 tr v,212,134,0
 v_add_u32 v136, 0xc000, v136
 v_mfma_f32_16x16x32_bf16 v[20:23], v[196:199], v[244:247], 0
 tr v,214,134,512
 v_accvgpr_read_b32 v218, a2
 v_mfma_f32_16x16x32_bf16 v[24:27], v[196:199], v[248:251], 0
 v_accvgpr_read_b32 v219, a3
 v_accvgpr_read_b32 v220, a16
 v_mfma_f32_16x16x32_bf16 v[28:31], v[196:199], v[252:255], 0
 s_waitcnt lgkmcnt(4)
 v_accvgpr_read_b32 v221, a17
 v_accvgpr_read_b32 v222, a18
 v_mfma_f32_16x16x32_bf16 v[64:67], v[200:203], v[240:243], 0
 tr v,192,133,8192
 v_add_u32 v137, 0xc000, v137
 v_mfma_f32_16x16x32_bf16 v[68:71], v[200:203], v[244:247], 0
 tr v,194,133,8704
 s_add_u32 m0, s52, 81920
 v_mfma_f32_16x16x32_bf16 v[72:75], v[200:203], v[248:251], 0
 buffer_load_dwordx4 v129, s[20:23], s44 offen lds
 s_sub_u32 s44, s44, 229376
 v_mfma_f32_16x16x32_bf16 v[76:79], v[200:203], v[252:255], 0
 v_accvgpr_read_b32 v223, a19
 v_mul_f32 v216, s70, v216
 v_mfma_f32_16x16x32_bf16 v[80:83], v[204:207], v[240:243], 0
 tr v,196,134,8192
 v_add_u32 v138, 0xc000, v138
 v_mfma_f32_16x16x32_bf16 v[84:87], v[204:207], v[244:247], 0
 tr v,198,134,8704
 v_mul_f32 v217, s70, v217
 v_mfma_f32_16x16x32_bf16 v[88:91], v[204:207], v[248:251], 0
 v_mul_f32 v218, s70, v218
 v_mul_f32 v219, s70, v219
 v_mfma_f32_16x16x32_bf16 v[92:95], v[204:207], v[252:255], 0
 s_waitcnt lgkmcnt(4)
 v_mul_f32 v220, s70, v220
 v_mul_f32 v221, s70, v221
 v_mfma_f32_16x16x32_bf16 v[32:35], v[208:211], v[240:243], 0
 tr v,200,131,4096
 v_mul_f32 v222, s70, v222
 v_mfma_f32_16x16x32_bf16 v[36:39], v[208:211], v[244:247], 0
 tr v,202,131,4608
 s_add_u32 m0, s52, 77824
 v_mfma_f32_16x16x32_bf16 v[40:43], v[208:211], v[248:251], 0
 buffer_load_dwordx4 v129, s[16:19], s44 offen lds
 v_mul_f32 v223, s70, v223
 v_mfma_f32_16x16x32_bf16 v[44:47], v[208:211], v[252:255], 0
 v_cvt_pk_bf16_f32 v236, v216, v217
 v_cvt_pk_bf16_f32 v237, v218, v219
 v_mfma_f32_16x16x32_bf16 v[48:51], v[212:215], v[240:243], 0
 tr v,204,132,4096
 v_cvt_pk_bf16_f32 v238, v220, v221
 v_mfma_f32_16x16x32_bf16 v[52:55], v[212:215], v[244:247], 0
 tr v,206,132,4608
 v_cvt_pk_bf16_f32 v239, v222, v223
 v_mfma_f32_16x16x32_bf16 v[56:59], v[212:215], v[248:251], 0
 buffer_store_dwordx4 v[236:239], v139, s[24:27], s68 offen offset:0 sc1
 v_mfma_f32_16x16x32_bf16 v[60:63], v[212:215], v[252:255], 0
 s_waitcnt lgkmcnt(4)
 v_mfma_f32_16x16x32_bf16 v[96:99], v[192:195], v[240:243], 0
 tr v,208,131,12288
 v_mfma_f32_16x16x32_bf16 v[100:103], v[192:195], v[244:247], 0
 tr v,210,131,12800
 s_add_u32 m0, s52, 86016
 v_mfma_f32_16x16x32_bf16 v[104:107], v[192:195], v[248:251], 0
 buffer_load_dwordx4 v129, s[20:23], s44 offen lds
 s_sub_u32 s44, s44, 229376
 v_mfma_f32_16x16x32_bf16 v[108:111], v[192:195], v[252:255], 0
 v_mfma_f32_16x16x32_bf16 v[112:115], v[196:199], v[240:243], 0
 tr v,212,132,12288
 v_mfma_f32_16x16x32_bf16 v[116:119], v[196:199], v[244:247], 0
 tr v,214,132,12800
 v_mfma_f32_16x16x32_bf16 v[120:123], v[196:199], v[248:251], 0
 v_mfma_f32_16x16x32_bf16 v[124:127], v[196:199], v[252:255], 0
 s_waitcnt lgkmcnt(4)
 mf v,0,v,200,v,176
 tr v,192,133,4096
 mf v,4,v,200,v,180
 tr v,194,133,4608
 mf v,8,v,200,v,184
 buffer_load_dwordx4 v[240:243], v128, s[24:27], s48 offen offset:0 sc1
 s_sub_u32 s48, s48, 4096
 mf v,12,v,200,v,188
 mf v,16,v,204,v,176
 tr v,196,134,4096
 mf v,20,v,204,v,180
 tr v,198,134,4608
 mf v,24,v,204,v,184
 buffer_load_dwordx4 v[244:247], v128, s[24:27], s49 offen offset:0 sc1
 s_sub_u32 s49, s49, 4096
 mf v,28,v,204,v,188
 s_waitcnt lgkmcnt(4)
 mf v,64,v,208,v,176
 tr v,200,133,12288
 mf v,68,v,208,v,180
 tr v,202,133,12800
 mf v,72,v,208,v,184
 mf v,76,v,208,v,188
 mf v,80,v,212,v,176
 tr v,204,134,12288
 mf v,84,v,212,v,180
 tr v,206,134,12800
 mf v,88,v,212,v,184
 buffer_load_dwordx4 v[248:251], v128, s[24:27], s50 offen offset:0 sc1
 s_sub_u32 s50, s50, 4096
 mf v,92,v,212,v,188
 s_waitcnt lgkmcnt(4)
 mf v,32,v,192,v,176
 mf v,36,v,192,v,180
 mf v,40,v,192,v,184
 mf v,44,v,192,v,188
 s_waitcnt vmcnt(21) lgkmcnt(0)
 s_barrier
 mf v,48,v,196,v,176
 tr v,208,135,0
 mf v,52,v,196,v,180
 tr v,210,135,512
 mf v,56,v,196,v,184
 tr v,212,136,0
 mf v,60,v,196,v,188
 tr v,214,136,512
 mf v,96,v,200,v,176
 tr v,192,135,8192
 mf v,100,v,200,v,180
 tr v,194,135,8704
 mf v,104,v,200,v,184
 buffer_load_dwordx4 v[252:255], v128, s[24:27], s51 offen offset:0 sc1
 s_sub_u32 s51, s51, 4096
 mf v,108,v,200,v,188
 mf v,112,v,204,v,176
 tr v,196,136,8192
 mf v,116,v,204,v,180
 tr v,198,136,8704
 mf v,120,v,204,v,184
 mf v,124,v,204,v,188
 s_waitcnt lgkmcnt(4)
f_A17:
 s_mov_b32 s69, f_A20-f_base
 mf v,0,v,208,v,160
 tr v,200,137,0
 v_add_u32 v131, 0xfffe8000, v131
 mf v,4,v,208,v,164
 tr v,202,137,512
 v_accvgpr_read_b32 v216, a4
 mf v,8,v,208,v,168
 buffer_load_dword v146, v155, s[36:39], s69 offen
 v_accvgpr_read_b32 v217, a5
 mf v,12,v,208,v,172
 v_accvgpr_read_b32 v218, a6
 v_accvgpr_read_b32 v219, a7
 mf v,16,v,212,v,160
 tr v,204,138,0
 v_add_u32 v132, 0xfffe8000, v132
 mf v,20,v,212,v,164
 tr v,206,138,512
 v_accvgpr_read_b32 v220, a20
 mf v,24,v,212,v,168
 buffer_load_dwordx4 v[176:179], v128, s[24:27], s48 offen offset:3072 sc1
 v_accvgpr_read_b32 v221, a21
 mf v,28,v,212,v,172
 s_waitcnt lgkmcnt(4)
 v_accvgpr_read_b32 v222, a22
 v_accvgpr_read_b32 v223, a23
 mf v,64,v,192,v,160
 tr v,208,137,8192
 v_add_u32 v133, 0xfffe8000, v133
 mf v,68,v,192,v,164
 tr v,210,137,8704
 v_mul_f32 v216, s70, v216
 mf v,72,v,192,v,168
 buffer_load_dwordx4 v[180:183], v128, s[24:27], s49 offen offset:3072 sc1
 v_mul_f32 v217, s70, v217
 mf v,76,v,192,v,172
 v_mul_f32 v218, s70, v218
 v_mul_f32 v219, s70, v219
 mf v,80,v,196,v,160
 tr v,212,138,8192
 v_add_u32 v134, 0xfffe8000, v134
 mf v,84,v,196,v,164
 tr v,214,138,8704
 v_mul_f32 v220, s70, v220
 mf v,88,v,196,v,168
 buffer_load_dwordx4 v[184:187], v128, s[24:27], s50 offen offset:3072 sc1
 v_mul_f32 v221, s70, v221
 mf v,92,v,196,v,172
 s_waitcnt lgkmcnt(4)
 v_mul_f32 v222, s70, v222
 v_mul_f32 v223, s70, v223
 mf v,32,v,200,v,160
 tr v,192,135,4096
 v_cvt_pk_bf16_f32 v232, v216, v217
 mf v,36,v,200,v,164
 tr v,194,135,4608
 v_cvt_pk_bf16_f32 v233, v218, v219
 mf v,40,v,200,v,168
 buffer_load_dwordx4 v[188:191], v128, s[24:27], s51 offen offset:3072 sc1
 v_cvt_pk_bf16_f32 v234, v220, v221
 mf v,44,v,200,v,172
 v_cvt_pk_bf16_f32 v235, v222, v223
 mf v,48,v,204,v,160
 tr v,196,136,4096
 mf v,52,v,204,v,164
 tr v,198,136,4608
 s_add_u32 m0, s52, 98304
 mf v,56,v,204,v,168
 buffer_load_dwordx4 v129, s[16:19], s44 offen lds
 mf v,60,v,204,v,172
 s_waitcnt lgkmcnt(4)
 buffer_store_dwordx4 v[232:235], v140, s[24:27], s68 offen offset:0 sc1
 mf v,96,v,208,v,160
 tr v,200,135,12288
 mf v,100,v,208,v,164
 tr v,202,135,12800
 s_add_u32 m0, s52, 106496
 mf v,104,v,208,v,168
 buffer_load_dwordx4 v129, s[20:23], s44 offen lds
 s_sub_u32 s44, s44, 229376
 mf v,108,v,208,v,172
 mf v,112,v,212,v,160
 tr v,204,136,12288
 mf v,116,v,212,v,164
 tr v,206,136,12800
 mf v,120,v,212,v,168
 mf v,124,v,212,v,172
 s_waitcnt lgkmcnt(4)
 mf v,0,v,192,a,240
 tr v,208,137,4096
 mf v,4,v,192,a,244
 tr v,210,137,4608
 mf v,8,v,192,a,248
 buffer_load_dwordx4 v[160:163], v128, s[24:27], s48 offen offset:2048 sc1
 mf v,12,v,192,a,252
 mf v,16,v,196,a,240
 tr v,212,138,4096
 mf v,20,v,196,a,244
 tr v,214,138,4608
 mf v,24,v,196,a,248
 buffer_load_dwordx4 v[164:167], v128, s[24:27], s49 offen offset:2048 sc1
 mf v,28,v,196,a,252
 s_waitcnt lgkmcnt(4)
 mf v,64,v,200,a,240
 tr v,192,137,12288
 mf v,68,v,200,a,244
 tr v,194,137,12800
 mf v,72,v,200,a,248
 buffer_load_dwordx4 v[168:171], v128, s[24:27], s50 offen offset:2048 sc1
 mf v,76,v,200,a,252
 mf v,80,v,204,a,240
 tr v,196,138,12288
 mf v,84,v,204,a,244
 tr v,198,138,12800
 mf v,88,v,204,a,248
 buffer_load_dwordx4 v[172:175], v128, s[24:27], s51 offen offset:2048 sc1
 mf v,92,v,204,a,252
 s_waitcnt lgkmcnt(4)
 mf v,32,v,208,a,240
 mf v,36,v,208,a,244
 s_add_u32 m0, s52, 102400
 mf v,40,v,208,a,248
 buffer_load_dwordx4 v129, s[16:19], s44 offen lds
 mf v,44,v,208,a,252
 s_waitcnt vmcnt(30) lgkmcnt(0)
 s_barrier
 mf v,48,v,212,a,240
 tr v,200,131,0
 mf v,52,v,212,a,244
 tr v,202,131,512
 mf v,56,v,212,a,248
 tr v,204,132,0
 mf v,60,v,212,a,252
 tr v,206,132,512
 mf v,96,v,192,a,240
 tr v,208,131,8192
 mf v,100,v,192,a,244
 tr v,210,131,8704
 s_add_u32 m0, s52, 110592
 mf v,104,v,192,a,248
 buffer_load_dwordx4 v129, s[20:23], s44 offen lds
 s_sub_u32 s44, s44, 229376
 mf v,108,v,192,a,252
 mf v,112,v,196,a,240
 tr v,212,132,8192
 mf v,116,v,196,a,244
 tr v,214,132,8704
 mf v,120,v,196,a,248
 mf v,124,v,196,a,252
 s_waitcnt lgkmcnt(4)
f_A18:
 mf v,0,v,200,a,224
 tr v,192,133,0
 v_add_u32 v135, 0xfffe8000, v135
 mf v,4,v,200,a,228
 tr v,194,133,512
 v_accvgpr_read_b32 v216, a8
 mf v,8,v,200,a,232
 buffer_load_dwordx4 a[240:243], v128, s[24:27], s48 offen offset:1024 sc1
 v_accvgpr_read_b32 v217, a9
 mf v,12,v,200,a,236
 v_accvgpr_read_b32 v218, a10
 v_accvgpr_read_b32 v219, a11
 mf v,16,v,204,a,224
 tr v,196,134,0
 v_add_u32 v136, 0xfffe8000, v136
 mf v,20,v,204,a,228
 tr v,198,134,512
 v_accvgpr_read_b32 v220, a24
 mf v,24,v,204,a,232
 buffer_load_dwordx4 a[244:247], v128, s[24:27], s49 offen offset:1024 sc1
 v_accvgpr_read_b32 v221, a25
 mf v,28,v,204,a,236
 s_waitcnt lgkmcnt(4)
 v_accvgpr_read_b32 v222, a26
 v_accvgpr_read_b32 v223, a27
 mf v,64,v,208,a,224
 tr v,200,133,8192
 v_add_u32 v137, 0xfffe8000, v137
 mf v,68,v,208,a,228
 tr v,202,133,8704
 v_mul_f32 v216, s70, v216
 mf v,72,v,208,a,232
 buffer_load_dwordx4 a[248:251], v128, s[24:27], s50 offen offset:1024 sc1
 v_mul_f32 v217, s70, v217
 mf v,76,v,208,a,236
 v_mul_f32 v218, s70, v218
 v_mul_f32 v219, s70, v219
 mf v,80,v,212,a,224
 tr v,204,134,8192
 v_add_u32 v138, 0xfffe8000, v138
 mf v,84,v,212,a,228
 tr v,206,134,8704
 v_mul_f32 v220, s70, v220
 mf v,88,v,212,a,232
 buffer_load_dwordx4 a[252:255], v128, s[24:27], s51 offen offset:1024 sc1
 v_mul_f32 v221, s70, v221
 mf v,92,v,212,a,236
 s_waitcnt lgkmcnt(4)
 v_mul_f32 v222, s70, v222
 v_mul_f32 v223, s70, v223
 mf v,32,v,192,a,224
 tr v,208,131,4096
 v_cvt_pk_bf16_f32 v236, v216, v217
 mf v,36,v,192,a,228
 tr v,210,131,4608
 s_add_u32 m0, s52, 122880
 mf v,40,v,192,a,232
 buffer_load_dwordx4 v129, s[16:19], s44 offen lds
 v_cvt_pk_bf16_f32 v237, v218, v219
 mf v,44,v,192,a,236
 v_cvt_pk_bf16_f32 v238, v220, v221
 v_cvt_pk_bf16_f32 v239, v222, v223
 mf v,48,v,196,a,224
 tr v,212,132,4096
 mf v,52,v,196,a,228
 tr v,214,132,4608
 s_add_u32 m0, s52, 131072
 mf v,56,v,196,a,232
 buffer_load_dwordx4 v129, s[20:23], s44 offen lds
 s_sub_u32 s44, s44, 229376
 mf v,60,v,196,a,236
 s_waitcnt lgkmcnt(4)
 buffer_store_dwordx4 v[236:239], v139, s[24:27], s68 offen offset:2048 sc1
 mf v,96,v,200,a,224
 tr v,192,131,12288
 v_accvgpr_read_b32 v216, a12
 mf v,100,v,200,a,228
 tr v,194,131,12800
 s_add_u32 m0, s52, 126976
 mf v,104,v,200,a,232
 buffer_load_dwordx4 v129, s[16:19], s44 offen lds
 v_accvgpr_read_b32 v217, a13
 mf v,108,v,200,a,236
 v_accvgpr_read_b32 v218, a14
 v_accvgpr_read_b32 v219, a15
 mf v,112,v,204,a,224
 tr v,196,132,12288
 v_accvgpr_read_b32 v220, a28
 mf v,116,v,204,a,228
 tr v,198,132,12800
 v_accvgpr_read_b32 v221, a29
 mf v,120,v,204,a,232
 v_accvgpr_read_b32 v222, a30
 v_accvgpr_read_b32 v223, a31
 mf v,124,v,204,a,236
 s_waitcnt lgkmcnt(4)
 v_mul_f32 v216, s70, v216
 v_mul_f32 v217, s70, v217
 mf v,0,v,208,a,208
 tr v,200,133,4096
 v_mul_f32 v218, s70, v218
 mf v,4,v,208,a,212
 tr v,202,133,4608
 v_mul_f32 v219, s70, v219
 mf v,8,v,208,a,216
 buffer_load_dwordx4 a[224:227], v128, s[24:27], s48 offen offset:0 sc1
 s_sub_u32 s48, s48, 4096
 mf v,12,v,208,a,220
 v_mul_f32 v220, s70, v220
 v_mul_f32 v221, s70, v221
 mf v,16,v,212,a,208
 tr v,204,134,4096
 v_mul_f32 v222, s70, v222
 mf v,20,v,212,a,212
 tr v,206,134,4608
 v_mul_f32 v223, s70, v223
 mf v,24,v,212,a,216
 buffer_load_dwordx4 a[228:231], v128, s[24:27], s49 offen offset:0 sc1
 s_sub_u32 s49, s49, 4096
 mf v,28,v,212,a,220
 s_waitcnt lgkmcnt(4)
 v_cvt_pk_bf16_f32 v232, v216, v217
 v_cvt_pk_bf16_f32 v233, v218, v219
 mf v,64,v,192,a,208
 tr v,208,133,12288
 v_cvt_pk_bf16_f32 v234, v220, v221
 mf v,68,v,192,a,212
 tr v,210,133,12800
 v_cvt_pk_bf16_f32 v235, v222, v223
 mf v,72,v,192,a,216
 buffer_load_dwordx4 a[232:235], v128, s[24:27], s50 offen offset:0 sc1
 s_sub_u32 s50, s50, 4096
 mf v,76,v,192,a,220
 buffer_store_dwordx4 v[232:235], v140, s[24:27], s68 offen offset:2048 sc1
 s_add_u32 s68, s68, 131072
 mf v,80,v,196,a,208
 tr v,212,134,12288
 mf v,84,v,196,a,212
 tr v,214,134,12800
 mf v,88,v,196,a,216
 mf v,92,v,196,a,220
 s_waitcnt lgkmcnt(4)
 mf v,32,v,200,a,208
 mf v,36,v,200,a,212
 mf v,40,v,200,a,216
 buffer_load_dwordx4 a[236:239], v128, s[24:27], s51 offen offset:0 sc1
 s_sub_u32 s51, s51, 4096
 mf v,44,v,200,a,220
 s_waitcnt vmcnt(40) lgkmcnt(0)
 s_barrier
 mf v,48,v,204,a,208
 tr v,192,135,0
 mf v,52,v,204,a,212
 tr v,194,135,512
 mf v,56,v,204,a,216
 tr v,196,136,0
 mf v,60,v,204,a,220
 tr v,198,136,512
 mf v,96,v,208,a,208
 tr v,200,135,8192
 mf v,100,v,208,a,212
 tr v,202,135,8704
 s_add_u32 m0, s52, 135168
 mf v,104,v,208,a,216
 buffer_load_dwordx4 v129, s[20:23], s44 offen lds
 s_sub_u32 s44, s44, 229376
 mf v,108,v,208,a,220
 mf v,112,v,212,a,208
 tr v,204,136,8192
 mf v,116,v,212,a,212
 tr v,206,136,8704
 mf v,120,v,212,a,216
 mf v,124,v,212,a,220
 s_waitcnt lgkmcnt(4)
f_A19:
 mf v,0,v,192,a,192
 tr v,208,137,0
 v_add_u32 v131, 0xc000, v131
 mf v,4,v,192,a,196
 tr v,210,137,512
 v_accvgpr_read_b32 v216, a32
 mf v,8,v,192,a,200
 buffer_load_dwordx4 a[208:211], v128, s[24:27], s48 offen offset:3072 sc1
 v_accvgpr_read_b32 v217, a33
 mf v,12,v,192,a,204
 v_accvgpr_read_b32 v218, a34
 v_accvgpr_read_b32 v219, a35
 mf v,16,v,196,a,192
 tr v,212,138,0
 v_add_u32 v132, 0xc000, v132
 mf v,20,v,196,a,196
 tr v,214,138,512
 v_accvgpr_read_b32 v220, a48
 mf v,24,v,196,a,200
 buffer_load_dwordx4 a[212:215], v128, s[24:27], s49 offen offset:3072 sc1
 v_accvgpr_read_b32 v221, a49
 mf v,28,v,196,a,204
 s_waitcnt lgkmcnt(4)
 v_accvgpr_read_b32 v222, a50
 v_accvgpr_read_b32 v223, a51
 mf v,64,v,200,a,192
 tr v,192,137,8192
 v_add_u32 v133, 0xc000, v133
 mf v,68,v,200,a,196
 tr v,194,137,8704
 v_mul_f32 v216, s70, v216
 mf v,72,v,200,a,200
 buffer_load_dwordx4 a[216:219], v128, s[24:27], s50 offen offset:3072 sc1
 v_mul_f32 v217, s70, v217
 mf v,76,v,200,a,204
 v_mul_f32 v218, s70, v218
 v_mul_f32 v219, s70, v219
 mf v,80,v,204,a,192
 tr v,196,138,8192
 v_add_u32 v134, 0xc000, v134
 mf v,84,v,204,a,196
 tr v,198,138,8704
 v_mul_f32 v220, s70, v220
 mf v,88,v,204,a,200
 buffer_load_dwordx4 a[220:223], v128, s[24:27], s51 offen offset:3072 sc1
 v_mul_f32 v221, s70, v221
 mf v,92,v,204,a,204
 s_waitcnt lgkmcnt(4)
 v_mul_f32 v222, s70, v222
 v_mul_f32 v223, s70, v223
 mf v,32,v,208,a,192
 tr v,200,135,4096
 v_cvt_pk_bf16_f32 v236, v216, v217
 mf v,36,v,208,a,196
 tr v,202,135,4608
 s_add_u32 m0, s52, 0
 mf v,40,v,208,a,200
 buffer_load_dwordx4 v129, s[16:19], s44 offen lds
 v_cvt_pk_bf16_f32 v237, v218, v219
 mf v,44,v,208,a,204
 v_cvt_pk_bf16_f32 v238, v220, v221
 v_cvt_pk_bf16_f32 v239, v222, v223
 mf v,48,v,212,a,192
 tr v,204,136,4096
 mf v,52,v,212,a,196
 tr v,206,136,4608
 s_add_u32 m0, s52, 8192
 mf v,56,v,212,a,200
 buffer_load_dwordx4 v129, s[20:23], s44 offen lds
 s_sub_u32 s44, s44, 229376
 mf v,60,v,212,a,204
 s_waitcnt lgkmcnt(4)
 buffer_store_dwordx4 v[236:239], v139, s[24:27], s68 offen offset:0 sc1
 mf v,96,v,192,a,192
 tr v,208,135,12288
 mf v,100,v,192,a,196
 tr v,210,135,12800
 s_add_u32 m0, s52, 4096
 mf v,104,v,192,a,200
 buffer_load_dwordx4 v129, s[16:19], s44 offen lds
 mf v,108,v,192,a,204
 mf v,112,v,196,a,192
 tr v,212,136,12288
 mf v,116,v,196,a,196
 tr v,214,136,12800
 mf v,120,v,196,a,200
 mf v,124,v,196,a,204
 s_waitcnt vmcnt(36) lgkmcnt(4)
 mf v,0,v,200,v,240
 tr v,192,137,4096
 mf v,4,v,200,v,244
 tr v,194,137,4608
 mf v,8,v,200,v,248
 buffer_load_dwordx4 a[192:195], v128, s[24:27], s48 offen offset:2048 sc1
 mf v,12,v,200,v,252
 mf v,16,v,204,v,240
 tr v,196,138,4096
 mf v,20,v,204,v,244
 tr v,198,138,4608
 mf v,24,v,204,v,248
 buffer_load_dwordx4 a[196:199], v128, s[24:27], s49 offen offset:2048 sc1
 mf v,28,v,204,v,252
 s_waitcnt lgkmcnt(4)
 mf v,64,v,208,v,240
 tr v,200,137,12288
 mf v,68,v,208,v,244
 tr v,202,137,12800
 mf v,72,v,208,v,248
 buffer_load_dwordx4 a[200:203], v128, s[24:27], s50 offen offset:2048 sc1
 mf v,76,v,208,v,252
 mf v,80,v,212,v,240
 tr v,204,138,12288
 mf v,84,v,212,v,244
 tr v,206,138,12800
 mf v,88,v,212,v,248
 mf v,92,v,212,v,252
 s_waitcnt lgkmcnt(4)
 mf v,32,v,192,v,240
 mf v,36,v,192,v,244
 mf v,40,v,192,v,248
 buffer_load_dwordx4 a[204:207], v128, s[24:27], s51 offen offset:2048 sc1
 mf v,44,v,192,v,252
 s_waitcnt lgkmcnt(0)
 s_barrier
 mf v,48,v,196,v,240
 tr v,208,131,0
 mf v,52,v,196,v,244
 tr v,210,131,512
 mf v,56,v,196,v,248
 tr v,212,132,0
 mf v,60,v,196,v,252
 tr v,214,132,512
 mf v,96,v,200,v,240
 tr v,192,131,8192
 mf v,100,v,200,v,244
 tr v,194,131,8704
 s_add_u32 m0, s52, 12288
 mf v,104,v,200,v,248
 buffer_load_dwordx4 v129, s[20:23], s44 offen lds
 s_sub_u32 s44, s44, 229376
 mf v,108,v,200,v,252
 mf v,112,v,204,v,240
 tr v,196,132,8192
 mf v,116,v,204,v,244
 tr v,198,132,8704
 mf v,120,v,204,v,248
 mf v,124,v,204,v,252
 s_waitcnt vmcnt(36) lgkmcnt(4)
f_A20:
 mf v,0,v,208,v,176
 tr v,200,133,0
 v_add_u32 v135, 0xc000, v135
 mf v,4,v,208,v,180
 tr v,202,133,512
 v_accvgpr_read_b32 v216, a36
 mf v,8,v,208,v,184
 buffer_load_dwordx4 v[240:243], v128, s[24:27], s48 offen offset:1024 sc1
 v_accvgpr_read_b32 v217, a37
 mf v,12,v,208,v,188
 v_accvgpr_read_b32 v218, a38
 v_accvgpr_read_b32 v219, a39
 mf v,16,v,212,v,176
 tr v,204,134,0
 v_add_u32 v136, 0xc000, v136
 mf v,20,v,212,v,180
 tr v,206,134,512
 v_accvgpr_read_b32 v220, a52
 mf v,24,v,212,v,184
 buffer_load_dwordx4 v[244:247], v128, s[24:27], s49 offen offset:1024 sc1
 v_accvgpr_read_b32 v221, a53
 mf v,28,v,212,v,188
 s_waitcnt lgkmcnt(4)
 v_accvgpr_read_b32 v222, a54
 v_accvgpr_read_b32 v223, a55
 mf v,64,v,192,v,176
 tr v,208,133,8192
 v_add_u32 v137, 0xc000, v137
 mf v,68,v,192,v,180
 tr v,210,133,8704
 v_mul_f32 v216, s70, v216
 mf v,72,v,192,v,184
 buffer_load_dwordx4 v[248:251], v128, s[24:27], s50 offen offset:1024 sc1
 v_mul_f32 v217, s70, v217
 mf v,76,v,192,v,188
 v_mul_f32 v218, s70, v218
 v_mul_f32 v219, s70, v219
 mf v,80,v,196,v,176
 tr v,212,134,8192
 v_add_u32 v138, 0xc000, v138
 mf v,84,v,196,v,180
 tr v,214,134,8704
 v_mul_f32 v220, s70, v220
 mf v,88,v,196,v,184
 buffer_load_dwordx4 v[252:255], v128, s[24:27], s51 offen offset:1024 sc1
 v_mul_f32 v221, s70, v221
 mf v,92,v,196,v,188
 s_waitcnt lgkmcnt(4)
 v_mul_f32 v222, s70, v222
 v_mul_f32 v223, s70, v223
 mf v,32,v,200,v,176
 tr v,192,131,4096
 v_cvt_pk_bf16_f32 v232, v216, v217
 mf v,36,v,200,v,180
 tr v,194,131,4608
 s_add_u32 m0, s52, 24576
 mf v,40,v,200,v,184
 buffer_load_dwordx4 v129, s[16:19], s44 offen lds
 v_cvt_pk_bf16_f32 v233, v218, v219
 mf v,44,v,200,v,188
 v_cvt_pk_bf16_f32 v234, v220, v221
 v_cvt_pk_bf16_f32 v235, v222, v223
 mf v,48,v,204,v,176
 tr v,196,132,4096
 mf v,52,v,204,v,180
 tr v,198,132,4608
 s_add_u32 m0, s52, 32768
 mf v,56,v,204,v,184
 buffer_load_dwordx4 v129, s[20:23], s44 offen lds
 s_sub_u32 s44, s44, 229376
 mf v,60,v,204,v,188
 s_waitcnt lgkmcnt(4)
 buffer_store_dwordx4 v[232:235], v140, s[24:27], s68 offen offset:0 sc1
 mf v,96,v,208,v,176
 tr v,200,131,12288
 mf v,100,v,208,v,180
 tr v,202,131,12800
 s_add_u32 m0, s52, 28672
 mf v,104,v,208,v,184
 buffer_load_dwordx4 v129, s[16:19], s44 offen lds
 mf v,108,v,208,v,188
 mf v,112,v,212,v,176
 tr v,204,132,12288
 mf v,116,v,212,v,180
 tr v,206,132,12800
 mf v,120,v,212,v,184
 mf v,124,v,212,v,188
 s_waitcnt vmcnt(37) lgkmcnt(4)
 mf v,0,v,192,v,160
 tr v,208,133,4096
 mf v,4,v,192,v,164
 tr v,210,133,4608
 mf v,8,v,192,v,168
 buffer_load_dwordx4 v[176:179], v128, s[24:27], s48 offen offset:0 sc1
 s_sub_u32 s48, s48, 4096
 mf v,12,v,192,v,172
 mf v,16,v,196,v,160
 tr v,212,134,4096
 mf v,20,v,196,v,164
 tr v,214,134,4608
 mf v,24,v,196,v,168
 buffer_load_dwordx4 v[180:183], v128, s[24:27], s49 offen offset:0 sc1
 s_sub_u32 s49, s49, 4096
 mf v,28,v,196,v,172
 s_waitcnt lgkmcnt(4)
 mf v,64,v,200,v,160
 tr v,192,133,12288
 mf v,68,v,200,v,164
 tr v,194,133,12800
 mf v,72,v,200,v,168
 buffer_load_dwordx4 v[184:187], v128, s[24:27], s50 offen offset:0 sc1
 s_sub_u32 s50, s50, 4096
 mf v,76,v,200,v,172
 mf v,80,v,204,v,160
 tr v,196,134,12288
 mf v,84,v,204,v,164
 tr v,198,134,12800
 mf v,88,v,204,v,168
 mf v,92,v,204,v,172
 s_waitcnt lgkmcnt(4)
 mf v,32,v,208,v,160
 mf v,36,v,208,v,164
 mf v,40,v,208,v,168
 buffer_load_dwordx4 v[188:191], v128, s[24:27], s51 offen offset:0 sc1
 s_sub_u32 s51, s51, 4096
 mf v,44,v,208,v,172
 s_waitcnt lgkmcnt(0)
 s_barrier
 mf v,48,v,212,v,160
 tr v,200,135,0
 mf v,52,v,212,v,164
 tr v,202,135,512
 mf v,56,v,212,v,168
 tr v,204,136,0
 mf v,60,v,212,v,172
 tr v,206,136,512
 mf v,96,v,192,v,160
 tr v,208,135,8192
 mf v,100,v,192,v,164
 tr v,210,135,8704
 s_add_u32 m0, s52, 36864
 mf v,104,v,192,v,168
 buffer_load_dwordx4 v129, s[20:23], s44 offen lds
 s_sub_u32 s44, s44, 229376
 mf v,108,v,192,v,172
 mf v,112,v,196,v,160
 tr v,212,136,8192
 mf v,116,v,196,v,164
 tr v,214,136,8704
 mf v,120,v,196,v,168
 mf v,124,v,196,v,172
 s_waitcnt vmcnt(36) lgkmcnt(4)
f_A21:
 s_mov_b32 s69, f_A24-f_base
 mf v,0,v,200,a,240
 tr v,192,137,0
 v_add_u32 v131, 0xc000, v131
 mf v,4,v,200,a,244
 tr v,194,137,512
 v_accvgpr_read_b32 v216, a40
 mf v,8,v,200,a,248
 buffer_load_dword v146, v155, s[36:39], s69 offen
 v_accvgpr_read_b32 v217, a41
 mf v,12,v,200,a,252
 v_accvgpr_read_b32 v218, a42
 v_accvgpr_read_b32 v219, a43
 mf v,16,v,204,a,240
 tr v,196,138,0
 v_add_u32 v132, 0xc000, v132
 mf v,20,v,204,a,244
 tr v,198,138,512
 v_accvgpr_read_b32 v220, a56
 mf v,24,v,204,a,248
 buffer_load_dwordx4 v[160:163], v128, s[24:27], s48 offen offset:3072 sc1
 v_accvgpr_read_b32 v221, a57
 mf v,28,v,204,a,252
 s_waitcnt lgkmcnt(4)
 v_accvgpr_read_b32 v222, a58
 v_accvgpr_read_b32 v223, a59
 mf v,64,v,208,a,240
 tr v,200,137,8192
 v_add_u32 v133, 0xc000, v133
 mf v,68,v,208,a,244
 tr v,202,137,8704
 v_mul_f32 v216, s70, v216
 mf v,72,v,208,a,248
 buffer_load_dwordx4 v[164:167], v128, s[24:27], s49 offen offset:3072 sc1
 v_mul_f32 v217, s70, v217
 mf v,76,v,208,a,252
 v_mul_f32 v218, s70, v218
 v_mul_f32 v219, s70, v219
 mf v,80,v,212,a,240
 tr v,204,138,8192
 v_add_u32 v134, 0xc000, v134
 mf v,84,v,212,a,244
 tr v,206,138,8704
 v_mul_f32 v220, s70, v220
 mf v,88,v,212,a,248
 buffer_load_dwordx4 v[168:171], v128, s[24:27], s50 offen offset:3072 sc1
 v_mul_f32 v221, s70, v221
 mf v,92,v,212,a,252
 s_waitcnt lgkmcnt(4)
 v_mul_f32 v222, s70, v222
 v_mul_f32 v223, s70, v223
 mf v,32,v,192,a,240
 tr v,208,135,4096
 v_cvt_pk_bf16_f32 v236, v216, v217
 mf v,36,v,192,a,244
 tr v,210,135,4608
 v_cvt_pk_bf16_f32 v237, v218, v219
 mf v,40,v,192,a,248
 buffer_load_dwordx4 v[172:175], v128, s[24:27], s51 offen offset:3072 sc1
 v_cvt_pk_bf16_f32 v238, v220, v221
 mf v,44,v,192,a,252
 v_cvt_pk_bf16_f32 v239, v222, v223
 mf v,48,v,196,a,240
 tr v,212,136,4096
 mf v,52,v,196,a,244
 tr v,214,136,4608
 s_add_u32 m0, s52, 49152
 mf v,56,v,196,a,248
 buffer_load_dwordx4 v129, s[16:19], s44 offen lds
 mf v,60,v,196,a,252
 s_waitcnt lgkmcnt(4)
 buffer_store_dwordx4 v[236:239], v139, s[24:27], s68 offen offset:2048 sc1
 mf v,96,v,200,a,240
 tr v,192,135,12288
 v_accvgpr_read_b32 v216, a44
 mf v,100,v,200,a,244
 tr v,194,135,12800
 s_add_u32 m0, s52, 57344
 mf v,104,v,200,a,248
 buffer_load_dwordx4 v129, s[20:23], s44 offen lds
 s_sub_u32 s44, s44, 229376
 mf v,108,v,200,a,252
 v_accvgpr_read_b32 v217, a45
 v_accvgpr_read_b32 v218, a46
 mf v,112,v,204,a,240
 tr v,196,136,12288
 v_accvgpr_read_b32 v219, a47
 mf v,116,v,204,a,244
 tr v,198,136,12800
 v_accvgpr_read_b32 v220, a60
 mf v,120,v,204,a,248
 v_accvgpr_read_b32 v221, a61
 v_accvgpr_read_b32 v222, a62
 mf v,124,v,204,a,252
 s_waitcnt vmcnt(35) lgkmcnt(4)
 v_accvgpr_read_b32 v223, a63
 v_mul_f32 v216, s70, v216
 mf v,0,v,208,a,224
 tr v,200,137,4096
 v_mul_f32 v217, s70, v217
 mf v,4,v,208,a,228
 tr v,202,137,4608
 v_mul_f32 v218, s70, v218
 mf v,8,v,208,a,232
 buffer_load_dwordx4 a[240:243], v128, s[24:27], s48 offen offset:2048 sc1
 v_mul_f32 v219, s70, v219
 mf v,12,v,208,a,236
 v_mul_f32 v220, s70, v220
 v_mul_f32 v221, s70, v221
 mf v,16,v,212,a,224
 tr v,204,138,4096
 v_mul_f32 v222, s70, v222
 mf v,20,v,212,a,228
 tr v,206,138,4608
 v_mul_f32 v223, s70, v223
 mf v,24,v,212,a,232
 buffer_load_dwordx4 a[244:247], v128, s[24:27], s49 offen offset:2048 sc1
 v_cvt_pk_bf16_f32 v232, v216, v217
 mf v,28,v,212,a,236
 s_waitcnt lgkmcnt(4)
 v_cvt_pk_bf16_f32 v233, v218, v219
 v_cvt_pk_bf16_f32 v234, v220, v221
 mf v,64,v,192,a,224
 tr v,208,137,12288
 v_cvt_pk_bf16_f32 v235, v222, v223
 mf v,68,v,192,a,228
 tr v,210,137,12800
 mf v,72,v,192,a,232
 buffer_load_dwordx4 a[248:251], v128, s[24:27], s50 offen offset:2048 sc1
 mf v,76,v,192,a,236
 buffer_store_dwordx4 v[232:235], v140, s[24:27], s68 offen offset:2048 sc1
 mf v,80,v,196,a,224
 tr v,212,138,12288
 mf v,84,v,196,a,228
 tr v,214,138,12800
 mf v,88,v,196,a,232
 buffer_load_dwordx4 a[252:255], v128, s[24:27], s51 offen offset:2048 sc1
 mf v,92,v,196,a,236
 s_waitcnt lgkmcnt(4)
 mf v,32,v,200,a,224
 mf v,36,v,200,a,228
 s_add_u32 m0, s52, 53248
 mf v,40,v,200,a,232
 buffer_load_dwordx4 v129, s[16:19], s44 offen lds
 mf v,44,v,200,a,236
 s_waitcnt lgkmcnt(0)
 s_barrier
 mf v,48,v,204,a,224
 tr v,192,131,0
 mf v,52,v,204,a,228
 tr v,194,131,512
 mf v,56,v,204,a,232
 tr v,196,132,0
 mf v,60,v,204,a,236
 tr v,198,132,512
 mf v,96,v,208,a,224
 tr v,200,131,8192
 mf v,100,v,208,a,228
 tr v,202,131,8704
 s_add_u32 m0, s52, 61440
 mf v,104,v,208,a,232
 buffer_load_dwordx4 v129, s[20:23], s44 offen lds
 s_sub_u32 s44, s44, 229376
 mf v,108,v,208,a,236
 mf v,112,v,212,a,224
 tr v,204,132,8192
 mf v,116,v,212,a,228
 tr v,206,132,8704
 mf v,120,v,212,a,232
 mf v,124,v,212,a,236
 s_waitcnt vmcnt(37) lgkmcnt(4)
f_A22:
 mf v,0,v,192,a,208
 tr v,208,133,0
 v_add_u32 v135, 0xc000, v135
 mf v,4,v,192,a,212
 tr v,210,133,512
 v_accvgpr_read_b32 v216, a64
 mf v,8,v,192,a,216
 buffer_load_dwordx4 a[224:227], v128, s[24:27], s48 offen offset:1024 sc1
 v_accvgpr_read_b32 v217, a65
 mf v,12,v,192,a,220
 v_accvgpr_read_b32 v218, a66
 v_accvgpr_read_b32 v219, a67
 mf v,16,v,196,a,208
 tr v,212,134,0
 v_add_u32 v136, 0xc000, v136
 mf v,20,v,196,a,212
 tr v,214,134,512
 v_accvgpr_read_b32 v220, a80
 mf v,24,v,196,a,216
 buffer_load_dwordx4 a[228:231], v128, s[24:27], s49 offen offset:1024 sc1
 v_accvgpr_read_b32 v221, a81
 mf v,28,v,196,a,220
 s_waitcnt lgkmcnt(4)
 v_accvgpr_read_b32 v222, a82
 v_accvgpr_read_b32 v223, a83
 mf v,64,v,200,a,208
 tr v,192,133,8192
 v_add_u32 v137, 0xc000, v137
 mf v,68,v,200,a,212
 tr v,194,133,8704
 v_accvgpr_read_b32 v224, a128
 mf v,72,v,200,a,216
 buffer_load_dwordx4 a[232:235], v128, s[24:27], s50 offen offset:1024 sc1
 v_accvgpr_read_b32 v225, a129
 mf v,76,v,200,a,220
 v_accvgpr_read_b32 v226, a130
 v_accvgpr_read_b32 v227, a131
 mf v,80,v,204,a,208
 tr v,196,134,8192
 v_add_u32 v138, 0xc000, v138
 mf v,84,v,204,a,212
 tr v,198,134,8704
 v_accvgpr_read_b32 v228, a144
 mf v,88,v,204,a,216
 buffer_load_dwordx4 a[236:239], v128, s[24:27], s51 offen offset:1024 sc1
 v_accvgpr_read_b32 v229, a145
 mf v,92,v,204,a,220
 s_waitcnt lgkmcnt(4)
 v_accvgpr_read_b32 v230, a146
 v_accvgpr_read_b32 v231, a147
 mf v,32,v,208,a,208
 tr v,200,131,4096
 v_mul_f32 v216, v216, v224
 mf v,36,v,208,a,212
 tr v,202,131,4608
 s_add_u32 m0, s52, 73728
 mf v,40,v,208,a,216
 buffer_load_dwordx4 v129, s[16:19], s44 offen lds
 v_mul_f32 v217, v217, v225
 mf v,44,v,208,a,220
 v_mul_f32 v218, v218, v226
 v_mul_f32 v219, v219, v227
 mf v,48,v,212,a,208
 tr v,204,132,4096
 v_mul_f32 v220, v220, v228
 mf v,52,v,212,a,212
 tr v,206,132,4608
 s_add_u32 m0, s52, 81920
 mf v,56,v,212,a,216
 buffer_load_dwordx4 v129, s[20:23], s44 offen lds
 s_sub_u32 s44, s44, 229376
 mf v,60,v,212,a,220
 s_waitcnt lgkmcnt(4)
 v_mul_f32 v221, v221, v229
 v_mul_f32 v222, v222, v230
 mf v,96,v,192,a,208
 tr v,208,131,12288
 v_mul_f32 v223, v223, v231
 mf v,100,v,192,a,212
 tr v,210,131,12800
 s_add_u32 m0, s52, 77824
 mf v,104,v,192,a,216
 buffer_load_dwordx4 v129, s[16:19], s44 offen lds
 v_cvt_pk_bf16_f32 v236, v216, v217
 mf v,108,v,192,a,220
 v_cvt_pk_bf16_f32 v237, v218, v219
 v_cvt_pk_bf16_f32 v238, v220, v221
 mf v,112,v,196,a,208
 tr v,212,132,12288
 v_cvt_pk_bf16_f32 v239, v222, v223
 mf v,116,v,196,a,212
 tr v,214,132,12800
 mf v,120,v,196,a,216
 buffer_store_dwordx4 v[236:239], v128, s[24:27], s67 offen offset:0 sc1
 mf v,124,v,196,a,220
 s_waitcnt vmcnt(37) lgkmcnt(4)
 mf v,0,v,200,a,192
 tr v,192,133,4096
 mf v,4,v,200,a,196
 tr v,194,133,4608
 mf v,8,v,200,a,200
 buffer_load_dwordx4 a[208:211], v128, s[24:27], s48 offen offset:0 sc1
 s_sub_u32 s48, s48, 4096
 mf v,12,v,200,a,204
 mf v,16,v,204,a,192
 tr v,196,134,4096
 mf v,20,v,204,a,196
 tr v,198,134,4608
 mf v,24,v,204,a,200
 buffer_load_dwordx4 a[212:215], v128, s[24:27], s49 offen offset:0 sc1
 s_sub_u32 s49, s49, 4096
 mf v,28,v,204,a,204
 s_waitcnt lgkmcnt(4)
 mf v,64,v,208,a,192
 tr v,200,133,12288
 mf v,68,v,208,a,196
 tr v,202,133,12800
 mf v,72,v,208,a,200
 buffer_load_dwordx4 a[216:219], v128, s[24:27], s50 offen offset:0 sc1
 s_sub_u32 s50, s50, 4096
 mf v,76,v,208,a,204
 mf v,80,v,212,a,192
 tr v,204,134,12288
 mf v,84,v,212,a,196
 tr v,206,134,12800
 mf v,88,v,212,a,200
 mf v,92,v,212,a,204
 s_waitcnt lgkmcnt(4)
 mf v,32,v,192,a,192
 mf v,36,v,192,a,196
 mf v,40,v,192,a,200
 buffer_load_dwordx4 a[220:223], v128, s[24:27], s51 offen offset:0 sc1
 s_sub_u32 s51, s51, 4096
 mf v,44,v,192,a,204
 s_waitcnt lgkmcnt(0)
 s_barrier
 mf v,48,v,196,a,192
 tr v,208,135,0
 mf v,52,v,196,a,196
 tr v,210,135,512
 mf v,56,v,196,a,200
 tr v,212,136,0
 mf v,60,v,196,a,204
 tr v,214,136,512
 mf v,96,v,200,a,192
 tr v,192,135,8192
 mf v,100,v,200,a,196
 tr v,194,135,8704
 s_add_u32 m0, s52, 86016
 mf v,104,v,200,a,200
 buffer_load_dwordx4 v129, s[20:23], s44 offen lds
 s_sub_u32 s44, s44, 229376
 mf v,108,v,200,a,204
 mf v,112,v,204,a,192
 tr v,196,136,8192
 mf v,116,v,204,a,196
 tr v,198,136,8704
 mf v,120,v,204,a,200
 mf v,124,v,204,a,204
 s_waitcnt vmcnt(37) lgkmcnt(4)
f_A23:
 mf v,0,v,208,v,240
 tr v,200,137,0
 v_add_u32 v131, 0xfffe8000, v131
 mf v,4,v,208,v,244
 tr v,202,137,512
 v_accvgpr_read_b32 v216, a96
 mf v,8,v,208,v,248
 buffer_load_dwordx4 a[192:195], v128, s[24:27], s48 offen offset:3072 sc1
 v_accvgpr_read_b32 v217, a97
 mf v,12,v,208,v,252
 v_accvgpr_read_b32 v218, a98
 v_accvgpr_read_b32 v219, a99
 mf v,16,v,212,v,240
 tr v,204,138,0
 v_add_u32 v132, 0xfffe8000, v132
 mf v,20,v,212,v,244
 tr v,206,138,512
 v_accvgpr_read_b32 v220, a112
 mf v,24,v,212,v,248
 buffer_load_dwordx4 a[196:199], v128, s[24:27], s49 offen offset:3072 sc1
 v_accvgpr_read_b32 v221, a113
 mf v,28,v,212,v,252
 s_waitcnt lgkmcnt(4)
 v_accvgpr_read_b32 v222, a114
 v_accvgpr_read_b32 v223, a115
 mf v,64,v,192,v,240
 tr v,208,137,8192
 v_add_u32 v133, 0xfffe8000, v133
 mf v,68,v,192,v,244
 tr v,210,137,8704
 v_accvgpr_read_b32 v224, a160
 mf v,72,v,192,v,248
 buffer_load_dwordx4 a[200:203], v128, s[24:27], s50 offen offset:3072 sc1
 v_accvgpr_read_b32 v225, a161
 mf v,76,v,192,v,252
 v_accvgpr_read_b32 v226, a162
 v_accvgpr_read_b32 v227, a163
 mf v,80,v,196,v,240
 tr v,212,138,8192
 v_add_u32 v134, 0xfffe8000, v134
 mf v,84,v,196,v,244
 tr v,214,138,8704
 v_accvgpr_read_b32 v228, a176
 mf v,88,v,196,v,248
 buffer_load_dwordx4 a[204:207], v128, s[24:27], s51 offen offset:3072 sc1
 v_accvgpr_read_b32 v229, a177
 mf v,92,v,196,v,252
 s_waitcnt lgkmcnt(4)
 v_accvgpr_read_b32 v230, a178
 v_accvgpr_read_b32 v231, a179
 mf v,32,v,200,v,240
 tr v,192,135,4096
 v_mul_f32 v216, v216, v224
 mf v,36,v,200,v,244
 tr v,194,135,4608
 s_add_u32 m0, s52, 98304
 mf v,40,v,200,v,248
 buffer_load_dwordx4 v129, s[16:19], s44 offen lds
 v_mul_f32 v217, v217, v225
 mf v,44,v,200,v,252
 v_mul_f32 v218, v218, v226
 v_mul_f32 v219, v219, v227
 mf v,48,v,204,v,240
 tr v,196,136,4096
 v_mul_f32 v220, v220, v228
 mf v,52,v,204,v,244
 tr v,198,136,4608
 s_add_u32 m0, s52, 106496
 mf v,56,v,204,v,248
 buffer_load_dwordx4 v129, s[20:23], s44 offen lds
 s_sub_u32 s44, s44, 229376
 mf v,60,v,204,v,252
 s_waitcnt lgkmcnt(4)
 v_mul_f32 v221, v221, v229
 v_mul_f32 v222, v222, v230
 mf v,96,v,208,v,240
 tr v,200,135,12288
 v_mul_f32 v223, v223, v231
 mf v,100,v,208,v,244
 tr v,202,135,12800
 s_add_u32 m0, s52, 102400
 mf v,104,v,208,v,248
 buffer_load_dwordx4 v129, s[16:19], s44 offen lds
 v_cvt_pk_bf16_f32 v232, v216, v217
 mf v,108,v,208,v,252
 v_cvt_pk_bf16_f32 v233, v218, v219
 v_cvt_pk_bf16_f32 v234, v220, v221
 mf v,112,v,212,v,240
 tr v,204,136,12288
 v_cvt_pk_bf16_f32 v235, v222, v223
 mf v,116,v,212,v,244
 tr v,206,136,12800
 mf v,120,v,212,v,248
 buffer_store_dwordx4 v[232:235], v128, s[24:27], s67 offen offset:1024 sc1
 s_add_u32 s67, s67, 147456
 mf v,124,v,212,v,252
 s_waitcnt vmcnt(37) lgkmcnt(4)
 mf v,0,v,192,v,176
 tr v,208,137,4096
 mf v,4,v,192,v,180
 tr v,210,137,4608
 mf v,8,v,192,v,184
 buffer_load_dwordx4 v[240:243], v128, s[24:27], s48 offen offset:2048 sc1
 mf v,12,v,192,v,188
 mf v,16,v,196,v,176
 tr v,212,138,4096
 mf v,20,v,196,v,180
 tr v,214,138,4608
 mf v,24,v,196,v,184
 buffer_load_dwordx4 v[244:247], v128, s[24:27], s49 offen offset:2048 sc1
 mf v,28,v,196,v,188
 s_waitcnt lgkmcnt(4)
 mf v,64,v,200,v,176
 tr v,192,137,12288
 mf v,68,v,200,v,180
 tr v,194,137,12800
 mf v,72,v,200,v,184
 buffer_load_dwordx4 v[248:251], v128, s[24:27], s50 offen offset:2048 sc1
 mf v,76,v,200,v,188
 mf v,80,v,204,v,176
 tr v,196,138,12288
 mf v,84,v,204,v,180
 tr v,198,138,12800
 mf v,88,v,204,v,184
 buffer_load_dwordx4 v[252:255], v128, s[24:27], s51 offen offset:2048 sc1
 mf v,92,v,204,v,188
 s_waitcnt lgkmcnt(4)
 mf v,32,v,208,v,176
 mf v,36,v,208,v,180
 s_add_u32 m0, s52, 110592
 mf v,40,v,208,v,184
 buffer_load_dwordx4 v129, s[20:23], s44 offen lds
 s_sub_u32 s44, s44, 229376
 mf v,44,v,208,v,188
 s_waitcnt vmcnt(29) lgkmcnt(0)
 s_barrier
 mf v,48,v,212,v,176
 tr v,200,131,0
 mf v,52,v,212,v,180
 tr v,202,131,512
 mf v,56,v,212,v,184
 tr v,204,132,0
 mf v,60,v,212,v,188
 tr v,206,132,512
 mf v,96,v,192,v,176
 tr v,208,131,8192
 mf v,100,v,192,v,180
 tr v,210,131,8704
 mf v,104,v,192,v,184
 buffer_store_dword v144, v143, s[24:27], s72 offen sc1
 mf v,108,v,192,v,188
 mf v,112,v,196,v,176
 tr v,212,132,8192
 mf v,116,v,196,v,180
 tr v,214,132,8704
 mf v,120,v,196,v,184
 mf v,124,v,196,v,188
 s_waitcnt lgkmcnt(4)
f_A24:
 mf v,0,v,200,v,160
 tr v,192,133,0
 v_add_u32 v135, 0xfffe8000, v135
 mf v,4,v,200,v,164
 tr v,194,133,512
 v_accvgpr_read_b32 v216, a68
 mf v,8,v,200,v,168
 buffer_load_dwordx4 v[176:179], v128, s[24:27], s48 offen offset:1024 sc1
 v_accvgpr_read_b32 v217, a69
 mf v,12,v,200,v,172
 v_accvgpr_read_b32 v218, a70
 v_accvgpr_read_b32 v219, a71
 mf v,16,v,204,v,160
 tr v,196,134,0
 v_add_u32 v136, 0xfffe8000, v136
 mf v,20,v,204,v,164
 tr v,198,134,512
 v_accvgpr_read_b32 v220, a84
 mf v,24,v,204,v,168
 buffer_load_dwordx4 v[180:183], v128, s[24:27], s49 offen offset:1024 sc1
 v_accvgpr_read_b32 v221, a85
 mf v,28,v,204,v,172
 s_waitcnt lgkmcnt(4)
 v_accvgpr_read_b32 v222, a86
 v_accvgpr_read_b32 v223, a87
 mf v,64,v,208,v,160
 tr v,200,133,8192
 v_add_u32 v137, 0xfffe8000, v137
 mf v,68,v,208,v,164
 tr v,202,133,8704
 v_accvgpr_read_b32 v224, a132
 mf v,72,v,208,v,168
 buffer_load_dwordx4 v[184:187], v128, s[24:27], s50 offen offset:1024 sc1
 v_accvgpr_read_b32 v225, a133
 mf v,76,v,208,v,172
 v_accvgpr_read_b32 v226, a134
 v_accvgpr_read_b32 v227, a135
 mf v,80,v,212,v,160
 tr v,204,134,8192
 v_add_u32 v138, 0xfffe8000, v138
 mf v,84,v,212,v,164
 tr v,206,134,8704
 v_accvgpr_read_b32 v228, a148
 mf v,88,v,212,v,168
 buffer_load_dwordx4 v[188:191], v128, s[24:27], s51 offen offset:1024 sc1
 v_accvgpr_read_b32 v229, a149
 mf v,92,v,212,v,172
 s_waitcnt lgkmcnt(4)
 v_accvgpr_read_b32 v230, a150
 v_accvgpr_read_b32 v231, a151
 mf v,32,v,192,v,160
 tr v,208,131,4096
 v_mul_f32 v216, v216, v224
 mf v,36,v,192,v,164
 tr v,210,131,4608
 s_add_u32 m0, s52, 122880
 mf v,40,v,192,v,168
 buffer_load_dwordx4 v129, s[16:19], s44 offen lds
 v_mul_f32 v217, v217, v225
 mf v,44,v,192,v,172
 v_mul_f32 v218, v218, v226
 v_mul_f32 v219, v219, v227
 mf v,48,v,196,v,160
 tr v,212,132,4096
 v_mul_f32 v220, v220, v228
 mf v,52,v,196,v,164
 tr v,214,132,4608
 s_add_u32 m0, s52, 131072
 mf v,56,v,196,v,168
 buffer_load_dwordx4 v129, s[20:23], s44 offen lds
 s_sub_u32 s44, s44, 229376
 mf v,60,v,196,v,172
 s_waitcnt lgkmcnt(4)
 v_mul_f32 v221, v221, v229
 v_mul_f32 v222, v222, v230
 mf v,96,v,200,v,160
 tr v,192,131,12288
 v_mul_f32 v223, v223, v231
 mf v,100,v,200,v,164
 tr v,194,131,12800
 s_add_u32 m0, s52, 126976
 mf v,104,v,200,v,168
 buffer_load_dwordx4 v129, s[16:19], s44 offen lds
 v_cvt_pk_bf16_f32 v236, v216, v217
 mf v,108,v,200,v,172
 v_cvt_pk_bf16_f32 v237, v218, v219
 v_cvt_pk_bf16_f32 v238, v220, v221
 mf v,112,v,204,v,160
 tr v,196,132,12288
 v_cvt_pk_bf16_f32 v239, v222, v223
 mf v,116,v,204,v,164
 tr v,198,132,12800
 mf v,120,v,204,v,168
 buffer_store_dwordx4 v[236:239], v128, s[24:27], s67 offen offset:0 sc1
 mf v,124,v,204,v,172
 s_waitcnt vmcnt(37) lgkmcnt(4)
 mf v,0,v,208,a,240
 tr v,200,133,4096
 mf v,4,v,208,a,244
 tr v,202,133,4608
 mf v,8,v,208,a,248
 buffer_load_dwordx4 v[160:163], v128, s[24:27], s48 offen offset:0 sc1
 s_sub_u32 s48, s48, 4096
 mf v,12,v,208,a,252
 mf v,16,v,212,a,240
 tr v,204,134,4096
 mf v,20,v,212,a,244
 tr v,206,134,4608
 mf v,24,v,212,a,248
 buffer_load_dwordx4 v[164:167], v128, s[24:27], s49 offen offset:0 sc1
 s_sub_u32 s49, s49, 4096
 mf v,28,v,212,a,252
 s_waitcnt lgkmcnt(4)
 mf v,64,v,192,a,240
 tr v,208,133,12288
 mf v,68,v,192,a,244
 tr v,210,133,12800
 mf v,72,v,192,a,248
 buffer_load_dwordx4 v[168:171], v128, s[24:27], s50 offen offset:0 sc1
 s_sub_u32 s50, s50, 4096
 mf v,76,v,192,a,252
 mf v,80,v,196,a,240
 tr v,212,134,12288
 mf v,84,v,196,a,244
 tr v,214,134,12800
 mf v,88,v,196,a,248
 mf v,92,v,196,a,252
 s_waitcnt lgkmcnt(4)
 mf v,32,v,200,a,240
 mf v,36,v,200,a,244
 mf v,40,v,200,a,248
 buffer_load_dwordx4 v[172:175], v128, s[24:27], s51 offen offset:0 sc1
 s_sub_u32 s51, s51, 4096
 mf v,44,v,200,a,252
 s_waitcnt lgkmcnt(0)
 s_barrier
 mf v,48,v,204,a,240
 tr v,192,135,0
 mf v,52,v,204,a,244
 tr v,194,135,512
 mf v,56,v,204,a,248
 tr v,196,136,0
 mf v,60,v,204,a,252
 tr v,198,136,512
 mf v,96,v,208,a,240
 tr v,200,135,8192
 mf v,100,v,208,a,244
 tr v,202,135,8704
 s_add_u32 m0, s52, 135168
 mf v,104,v,208,a,248
 buffer_load_dwordx4 v129, s[20:23], s44 offen lds
 s_sub_u32 s44, s44, 229376
 mf v,108,v,208,a,252
 mf v,112,v,212,a,240
 tr v,204,136,8192
 mf v,116,v,212,a,244
 tr v,206,136,8704
 mf v,120,v,212,a,248
 mf v,124,v,212,a,252
 s_waitcnt vmcnt(36) lgkmcnt(4)
f_A25:
 s_mov_b32 s69, f_A28-f_base
 mf v,0,v,192,a,224
 tr v,208,137,0
 v_add_u32 v131, 0xc000, v131
 mf v,4,v,192,a,228
 tr v,210,137,512
 v_accvgpr_read_b32 v216, a100
 mf v,8,v,192,a,232
 buffer_load_dword v146, v155, s[36:39], s69 offen
 v_accvgpr_read_b32 v217, a101
 mf v,12,v,192,a,236
 v_accvgpr_read_b32 v218, a102
 v_accvgpr_read_b32 v219, a103
 mf v,16,v,196,a,224
 tr v,212,138,0
 v_add_u32 v132, 0xc000, v132
 mf v,20,v,196,a,228
 tr v,214,138,512
 v_accvgpr_read_b32 v220, a116
 mf v,24,v,196,a,232
 buffer_load_dwordx4 a[240:243], v128, s[24:27], s48 offen offset:3072 sc1
 v_accvgpr_read_b32 v221, a117
 mf v,28,v,196,a,236
 s_waitcnt lgkmcnt(4)
 v_accvgpr_read_b32 v222, a118
 v_accvgpr_read_b32 v223, a119
 mf v,64,v,200,a,224
 tr v,192,137,8192
 v_add_u32 v133, 0xc000, v133
 mf v,68,v,200,a,228
 tr v,194,137,8704
 v_accvgpr_read_b32 v224, a164
 mf v,72,v,200,a,232
 buffer_load_dwordx4 a[244:247], v128, s[24:27], s49 offen offset:3072 sc1
 v_accvgpr_read_b32 v225, a165
 mf v,76,v,200,a,236
 v_accvgpr_read_b32 v226, a166
 v_accvgpr_read_b32 v227, a167
 mf v,80,v,204,a,224
 tr v,196,138,8192
 v_add_u32 v134, 0xc000, v134
 mf v,84,v,204,a,228
 tr v,198,138,8704
 v_accvgpr_read_b32 v228, a180
 mf v,88,v,204,a,232
 buffer_load_dwordx4 a[248:251], v128, s[24:27], s50 offen offset:3072 sc1
 v_accvgpr_read_b32 v229, a181
 mf v,92,v,204,a,236
 s_waitcnt lgkmcnt(4)
 v_accvgpr_read_b32 v230, a182
 v_accvgpr_read_b32 v231, a183
 mf v,32,v,208,a,224
 tr v,200,135,4096
 v_mul_f32 v216, v216, v224
 mf v,36,v,208,a,228
 tr v,202,135,4608
 v_mul_f32 v217, v217, v225
 mf v,40,v,208,a,232
 buffer_load_dwordx4 a[252:255], v128, s[24:27], s51 offen offset:3072 sc1
 v_mul_f32 v218, v218, v226
 mf v,44,v,208,a,236
 v_mul_f32 v219, v219, v227
 v_mul_f32 v220, v220, v228
 mf v,48,v,212,a,224
 tr v,204,136,4096
 v_mul_f32 v221, v221, v229
 mf v,52,v,212,a,228
 tr v,206,136,4608
 s_add_u32 m0, s52, 0
 mf v,56,v,212,a,232
 buffer_load_dwordx4 v129, s[16:19], s44 offen lds
 v_mul_f32 v222, v222, v230
 mf v,60,v,212,a,236
 s_waitcnt lgkmcnt(4)
 v_mul_f32 v223, v223, v231
 v_cvt_pk_bf16_f32 v232, v216, v217
 mf v,96,v,192,a,224
 tr v,208,135,12288
 v_cvt_pk_bf16_f32 v233, v218, v219
 mf v,100,v,192,a,228
 tr v,210,135,12800
 s_add_u32 m0, s52, 8192
 mf v,104,v,192,a,232
 buffer_load_dwordx4 v129, s[20:23], s44 offen lds
 s_sub_u32 s44, s44, 229376
 mf v,108,v,192,a,236
 v_cvt_pk_bf16_f32 v234, v220, v221
 v_cvt_pk_bf16_f32 v235, v222, v223
 mf v,112,v,196,a,224
 tr v,212,136,12288
 mf v,116,v,196,a,228
 tr v,214,136,12800
 mf v,120,v,196,a,232
 buffer_store_dwordx4 v[232:235], v128, s[24:27], s67 offen offset:1024 sc1
 s_add_u32 s67, s67, 147456
 mf v,124,v,196,a,236
 s_waitcnt vmcnt(36) lgkmcnt(4)
 mf v,0,v,200,a,208
 tr v,192,137,4096
 mf v,4,v,200,a,212
 tr v,194,137,4608
 mf v,8,v,200,a,216
 buffer_load_dwordx4 a[224:227], v128, s[24:27], s48 offen offset:2048 sc1
 mf v,12,v,200,a,220
 mf v,16,v,204,a,208
 tr v,196,138,4096
 mf v,20,v,204,a,212
 tr v,198,138,4608
 mf v,24,v,204,a,216
 buffer_load_dwordx4 a[228:231], v128, s[24:27], s49 offen offset:2048 sc1
 mf v,28,v,204,a,220
 s_waitcnt lgkmcnt(4)
 mf v,64,v,208,a,208
 tr v,200,137,12288
 mf v,68,v,208,a,212
 tr v,202,137,12800
 mf v,72,v,208,a,216
 buffer_load_dwordx4 a[232:235], v128, s[24:27], s50 offen offset:2048 sc1
 mf v,76,v,208,a,220
 mf v,80,v,212,a,208
 tr v,204,138,12288
 mf v,84,v,212,a,212
 tr v,206,138,12800
 mf v,88,v,212,a,216
 buffer_load_dwordx4 a[236:239], v128, s[24:27], s51 offen offset:2048 sc1
 mf v,92,v,212,a,220
 s_waitcnt lgkmcnt(4)
 mf v,32,v,192,a,208
 mf v,36,v,192,a,212
 s_add_u32 m0, s52, 4096
 mf v,40,v,192,a,216
 buffer_load_dwordx4 v129, s[16:19], s44 offen lds
 mf v,44,v,192,a,220
 s_waitcnt lgkmcnt(0)
 s_barrier
 mf v,48,v,196,a,208
 tr v,208,131,0
 mf v,52,v,196,a,212
 tr v,210,131,512
 mf v,56,v,196,a,216
 tr v,212,132,0
 mf v,60,v,196,a,220
 tr v,214,132,512
 mf v,96,v,200,a,208
 tr v,192,131,8192
 mf v,100,v,200,a,212
 tr v,194,131,8704
 s_add_u32 m0, s52, 12288
 mf v,104,v,200,a,216
 buffer_load_dwordx4 v129, s[20:23], s44 offen lds
 s_sub_u32 s44, s44, 229376
 mf v,108,v,200,a,220
 mf v,112,v,204,a,208
 tr v,196,132,8192
 mf v,116,v,204,a,212
 tr v,198,132,8704
 mf v,120,v,204,a,216
 mf v,124,v,204,a,220
 s_waitcnt vmcnt(37) lgkmcnt(4)
f_A26:
 mf v,0,v,208,a,192
 tr v,200,133,0
 v_add_u32 v135, 0xc000, v135
 mf v,4,v,208,a,196
 tr v,202,133,512
 v_accvgpr_read_b32 v216, a72
 mf v,8,v,208,a,200
 buffer_load_dwordx4 a[208:211], v128, s[24:27], s48 offen offset:1024 sc1
 v_accvgpr_read_b32 v217, a73
 mf v,12,v,208,a,204
 v_accvgpr_read_b32 v218, a74
 v_accvgpr_read_b32 v219, a75
 mf v,16,v,212,a,192
 tr v,204,134,0
 v_add_u32 v136, 0xc000, v136
 mf v,20,v,212,a,196
 tr v,206,134,512
 v_accvgpr_read_b32 v220, a88
 mf v,24,v,212,a,200
 buffer_load_dwordx4 a[212:215], v128, s[24:27], s49 offen offset:1024 sc1
 v_accvgpr_read_b32 v221, a89
 mf v,28,v,212,a,204
 s_waitcnt lgkmcnt(4)
 v_accvgpr_read_b32 v222, a90
 v_accvgpr_read_b32 v223, a91
 mf v,64,v,192,a,192
 tr v,208,133,8192
 v_add_u32 v137, 0xc000, v137
 mf v,68,v,192,a,196
 tr v,210,133,8704
 v_accvgpr_read_b32 v224, a136
 mf v,72,v,192,a,200
 buffer_load_dwordx4 a[216:219], v128, s[24:27], s50 offen offset:1024 sc1
 v_accvgpr_read_b32 v225, a137
 mf v,76,v,192,a,204
 v_accvgpr_read_b32 v226, a138
 v_accvgpr_read_b32 v227, a139
 mf v,80,v,196,a,192
 tr v,212,134,8192
 v_add_u32 v138, 0xc000, v138
 mf v,84,v,196,a,196
 tr v,214,134,8704
 v_accvgpr_read_b32 v228, a152
 mf v,88,v,196,a,200
 buffer_load_dwordx4 a[220:223], v128, s[24:27], s51 offen offset:1024 sc1
 v_accvgpr_read_b32 v229, a153
 mf v,92,v,196,a,204
 s_waitcnt lgkmcnt(4)
 v_accvgpr_read_b32 v230, a154
 v_accvgpr_read_b32 v231, a155
 mf v,32,v,200,a,192
 tr v,192,131,4096
 v_mul_f32 v216, v216, v224
 mf v,36,v,200,a,196
 tr v,194,131,4608
 s_add_u32 m0, s52, 24576
 mf v,40,v,200,a,200
 buffer_load_dwordx4 v129, s[16:19], s44 offen lds
 v_mul_f32 v217, v217, v225
 mf v,44,v,200,a,204
 v_mul_f32 v218, v218, v226
 v_mul_f32 v219, v219, v227
 mf v,48,v,204,a,192
 tr v,196,132,4096
 v_mul_f32 v220, v220, v228
 mf v,52,v,204,a,196
 tr v,198,132,4608
 s_add_u32 m0, s52, 32768
 mf v,56,v,204,a,200
 buffer_load_dwordx4 v129, s[20:23], s44 offen lds
 s_sub_u32 s44, s44, 229376
 mf v,60,v,204,a,204
 s_waitcnt lgkmcnt(4)
 v_mul_f32 v221, v221, v229
 v_mul_f32 v222, v222, v230
 mf v,96,v,208,a,192
 tr v,200,131,12288
 v_mul_f32 v223, v223, v231
 mf v,100,v,208,a,196
 tr v,202,131,12800
 s_add_u32 m0, s52, 28672
 mf v,104,v,208,a,200
 buffer_load_dwordx4 v129, s[16:19], s44 offen lds
 v_cvt_pk_bf16_f32 v236, v216, v217
 mf v,108,v,208,a,204
 v_cvt_pk_bf16_f32 v237, v218, v219
 v_cvt_pk_bf16_f32 v238, v220, v221
 mf v,112,v,212,a,192
 tr v,204,132,12288
 v_cvt_pk_bf16_f32 v239, v222, v223
 mf v,116,v,212,a,196
 tr v,206,132,12800
 mf v,120,v,212,a,200
 buffer_store_dwordx4 v[236:239], v128, s[24:27], s67 offen offset:0 sc1
 mf v,124,v,212,a,204
 s_waitcnt vmcnt(37) lgkmcnt(4)
 mf v,0,v,192,v,240
 tr v,208,133,4096
 mf v,4,v,192,v,244
 tr v,210,133,4608
 mf v,8,v,192,v,248
 buffer_load_dwordx4 a[192:195], v128, s[24:27], s48 offen offset:0 sc1
 s_sub_u32 s48, s48, 4096
 mf v,12,v,192,v,252
 mf v,16,v,196,v,240
 tr v,212,134,4096
 mf v,20,v,196,v,244
 tr v,214,134,4608
 mf v,24,v,196,v,248
 buffer_load_dwordx4 a[196:199], v128, s[24:27], s49 offen offset:0 sc1
 s_sub_u32 s49, s49, 4096
 mf v,28,v,196,v,252
 s_waitcnt lgkmcnt(4)
 mf v,64,v,200,v,240
 tr v,192,133,12288
 mf v,68,v,200,v,244
 tr v,194,133,12800
 mf v,72,v,200,v,248
 buffer_load_dwordx4 a[200:203], v128, s[24:27], s50 offen offset:0 sc1
 s_sub_u32 s50, s50, 4096
 mf v,76,v,200,v,252
 mf v,80,v,204,v,240
 tr v,196,134,12288
 mf v,84,v,204,v,244
 tr v,198,134,12800
 mf v,88,v,204,v,248
 mf v,92,v,204,v,252
 s_waitcnt lgkmcnt(4)
 mf v,32,v,208,v,240
 mf v,36,v,208,v,244
 mf v,40,v,208,v,248
 buffer_load_dwordx4 a[204:207], v128, s[24:27], s51 offen offset:0 sc1
 s_sub_u32 s51, s51, 4096
 mf v,44,v,208,v,252
 s_waitcnt lgkmcnt(0)
 s_barrier
 mf v,48,v,212,v,240
 tr v,200,135,0
 mf v,52,v,212,v,244
 tr v,202,135,512
 mf v,56,v,212,v,248
 tr v,204,136,0
 mf v,60,v,212,v,252
 tr v,206,136,512
 mf v,96,v,192,v,240
 tr v,208,135,8192
 mf v,100,v,192,v,244
 tr v,210,135,8704
 s_add_u32 m0, s52, 36864
 mf v,104,v,192,v,248
 buffer_load_dwordx4 v129, s[20:23], s44 offen lds
 s_sub_u32 s44, s44, 229376
 mf v,108,v,192,v,252
 mf v,112,v,196,v,240
 tr v,212,136,8192
 mf v,116,v,196,v,244
 tr v,214,136,8704
 mf v,120,v,196,v,248
 mf v,124,v,196,v,252
 s_waitcnt vmcnt(36) lgkmcnt(4)
f_A27:
 mf v,0,v,200,v,176
 tr v,192,137,0
 v_add_u32 v131, 0xc000, v131
 mf v,4,v,200,v,180
 tr v,194,137,512
 v_accvgpr_read_b32 v216, a104
 mf v,8,v,200,v,184
 buffer_load_dwordx4 v[240:243], v128, s[24:27], s48 offen offset:3072 sc1
 v_accvgpr_read_b32 v217, a105
 mf v,12,v,200,v,188
 v_accvgpr_read_b32 v218, a106
 v_accvgpr_read_b32 v219, a107
 mf v,16,v,204,v,176
 tr v,196,138,0
 v_add_u32 v132, 0xc000, v132
 mf v,20,v,204,v,180
 tr v,198,138,512
 v_accvgpr_read_b32 v220, a120
 mf v,24,v,204,v,184
 v_accvgpr_read_b32 v221, a121
 v_accvgpr_read_b32 v222, a122
 mf v,28,v,204,v,188
 s_waitcnt lgkmcnt(4)
 v_accvgpr_read_b32 v223, a123
 v_accvgpr_read_b32 v224, a168
 mf v,64,v,208,v,176
 tr v,200,137,8192
 v_add_u32 v133, 0xc000, v133
 mf v,68,v,208,v,180
 tr v,202,137,8704
 v_accvgpr_read_b32 v225, a169
 mf v,72,v,208,v,184
 buffer_load_dwordx4 v[244:247], v128, s[24:27], s49 offen offset:3072 sc1
 v_accvgpr_read_b32 v226, a170
 mf v,76,v,208,v,188
 v_accvgpr_read_b32 v227, a171
 v_accvgpr_read_b32 v228, a184
 mf v,80,v,212,v,176
 tr v,204,138,8192
 v_add_u32 v134, 0xc000, v134
 mf v,84,v,212,v,180
 tr v,206,138,8704
 v_accvgpr_read_b32 v229, a185
 mf v,88,v,212,v,184
 v_accvgpr_read_b32 v230, a186
 v_accvgpr_read_b32 v231, a187
 mf v,92,v,212,v,188
 s_waitcnt lgkmcnt(4)
 v_mul_f32 v216, v216, v224
 v_mul_f32 v217, v217, v225
 mf v,32,v,192,v,176
 tr v,208,135,4096
 v_mul_f32 v218, v218, v226
 mf v,36,v,192,v,180
 tr v,210,135,4608
 v_mul_f32 v219, v219, v227
 mf v,40,v,192,v,184
 buffer_load_dwordx4 v[248:251], v128, s[24:27], s50 offen offset:3072 sc1
 v_mul_f32 v220, v220, v228
 mf v,44,v,192,v,188
 v_mul_f32 v221, v221, v229
 v_mul_f32 v222, v222, v230
 mf v,48,v,196,v,176
 tr v,212,136,4096
 v_mul_f32 v223, v223, v231
 mf v,52,v,196,v,180
 tr v,214,136,4608
 v_cvt_pk_bf16_f32 v232, v216, v217
 mf v,56,v,196,v,184
 v_cvt_pk_bf16_f32 v233, v218, v219
 v_cvt_pk_bf16_f32 v234, v220, v221
 mf v,60,v,196,v,188
 s_waitcnt lgkmcnt(4)
 v_cvt_pk_bf16_f32 v235, v222, v223
 mf v,96,v,200,v,176
 tr v,192,135,12288
 mf v,100,v,200,v,180
 tr v,194,135,12800
 mf v,104,v,200,v,184
 buffer_load_dwordx4 v[252:255], v128, s[24:27], s51 offen offset:3072 sc1
 mf v,108,v,200,v,188
 buffer_store_dwordx4 v[232:235], v128, s[24:27], s67 offen offset:1024 sc1
 s_add_u32 s67, s67, 147456
 mf v,112,v,204,v,176
 tr v,196,136,12288
 mf v,116,v,204,v,180
 tr v,198,136,12800
 mf v,120,v,204,v,184
 mf v,124,v,204,v,188
 s_waitcnt vmcnt(33) lgkmcnt(4)
 mf v,0,v,208,v,160
 tr v,200,137,4096
 mf v,4,v,208,v,164
 tr v,202,137,4608
 mf v,8,v,208,v,168
 buffer_load_dwordx4 v[176:179], v128, s[24:27], s48 offen offset:2048 sc1
 mf v,12,v,208,v,172
 mf v,16,v,212,v,160
 tr v,204,138,4096
 mf v,20,v,212,v,164
 tr v,206,138,4608
 mf v,24,v,212,v,168
 buffer_load_dwordx4 v[180:183], v128, s[24:27], s49 offen offset:2048 sc1
 mf v,28,v,212,v,172
 s_waitcnt lgkmcnt(4)
 mf v,64,v,192,v,160
 tr v,208,137,12288
 mf v,68,v,192,v,164
 tr v,210,137,12800
 mf v,72,v,192,v,168
 mf v,76,v,192,v,172
 mf v,80,v,196,v,160
 tr v,212,138,12288
 mf v,84,v,196,v,164
 tr v,214,138,12800
 mf v,88,v,196,v,168
 buffer_load_dwordx4 v[184:187], v128, s[24:27], s50 offen offset:2048 sc1
 mf v,92,v,196,v,172
 s_waitcnt lgkmcnt(4)
 mf v,32,v,200,v,160
 mf v,36,v,200,v,164
 mf v,40,v,200,v,168
 mf v,44,v,200,v,172
 s_waitcnt lgkmcnt(0)
 s_barrier
 mf v,48,v,204,v,160
 tr v,192,131,0
 mf v,52,v,204,v,164
 tr v,194,131,512
 mf v,56,v,204,v,168
 tr v,196,132,0
 mf v,60,v,204,v,172
 tr v,198,132,512
 mf v,96,v,208,v,160
 tr v,200,131,8192
 mf v,100,v,208,v,164
 tr v,202,131,8704
 mf v,104,v,208,v,168
 buffer_load_dwordx4 v[188:191], v128, s[24:27], s51 offen offset:2048 sc1
 mf v,108,v,208,v,172
 mf v,112,v,212,v,160
 tr v,204,132,8192
 mf v,116,v,212,v,164
 tr v,206,132,8704
 mf v,120,v,212,v,168
 mf v,124,v,212,v,172
 s_waitcnt vmcnt(31) lgkmcnt(4)
f_A28:
 mf v,0,v,192,a,240
 tr v,208,133,0
 v_add_u32 v135, 0xc000, v135
 mf v,4,v,192,a,244
 tr v,210,133,512
 v_accvgpr_read_b32 v216, a76
 mf v,8,v,192,a,248
 buffer_load_dword v154, v145, s[24:27], s73 offen offset:0 sc1
 v_accvgpr_read_b32 v217, a77
 mf v,12,v,192,a,252
 v_accvgpr_read_b32 v218, a78
 v_accvgpr_read_b32 v219, a79
 mf v,16,v,196,a,240
 tr v,212,134,0
 v_add_u32 v136, 0xc000, v136
 mf v,20,v,196,a,244
 tr v,214,134,512
 v_accvgpr_read_b32 v220, a92
 mf v,24,v,196,a,248
 buffer_load_dwordx4 v[160:163], v128, s[24:27], s48 offen offset:1024 sc1
 v_accvgpr_read_b32 v221, a93
 mf v,28,v,196,a,252
 s_waitcnt lgkmcnt(4)
 v_accvgpr_read_b32 v222, a94
 v_accvgpr_read_b32 v223, a95
 mf v,64,v,200,a,240
 tr v,192,133,8192
 v_add_u32 v137, 0xc000, v137
 mf v,68,v,200,a,244
 tr v,194,133,8704
 v_accvgpr_read_b32 v224, a140
 mf v,72,v,200,a,248
 v_accvgpr_read_b32 v225, a141
 v_accvgpr_read_b32 v226, a142
 mf v,76,v,200,a,252
 v_accvgpr_read_b32 v227, a143
 v_accvgpr_read_b32 v228, a156
 mf v,80,v,204,a,240
 tr v,196,134,8192
 v_add_u32 v138, 0xc000, v138
 mf v,84,v,204,a,244
 tr v,198,134,8704
 v_accvgpr_read_b32 v229, a157
 mf v,88,v,204,a,248
 buffer_load_dwordx4 v[164:167], v128, s[24:27], s49 offen offset:1024 sc1
 v_accvgpr_read_b32 v230, a158
 mf v,92,v,204,a,252
 s_waitcnt lgkmcnt(4)
 v_accvgpr_read_b32 v231, a159
 v_mul_f32 v216, v216, v224
 mf v,32,v,208,a,240
 tr v,200,131,4096
 v_mul_f32 v217, v217, v225
 mf v,36,v,208,a,244
 tr v,202,131,4608
 v_mul_f32 v218, v218, v226
 mf v,40,v,208,a,248
 buffer_load_dwordx4 v[168:171], v128, s[24:27], s50 offen offset:1024 sc1
 v_mul_f32 v219, v219, v227
 mf v,44,v,208,a,252
 v_mul_f32 v220, v220, v228
 v_mul_f32 v221, v221, v229
 mf v,48,v,212,a,240
 tr v,204,132,4096
 v_mul_f32 v222, v222, v230
 mf v,52,v,212,a,244
 tr v,206,132,4608
 v_mul_f32 v223, v223, v231
 mf v,56,v,212,a,248
 v_cvt_pk_bf16_f32 v236, v216, v217
 v_cvt_pk_bf16_f32 v237, v218, v219
 mf v,60,v,212,a,252
 s_waitcnt lgkmcnt(4)
 v_cvt_pk_bf16_f32 v238, v220, v221
 v_cvt_pk_bf16_f32 v239, v222, v223
 mf v,96,v,192,a,240
 tr v,208,131,12288
 mf v,100,v,192,a,244
 tr v,210,131,12800
 mf v,104,v,192,a,248
 buffer_load_dwordx4 v[172:175], v128, s[24:27], s51 offen offset:1024 sc1
 mf v,108,v,192,a,252
 buffer_store_dwordx4 v[236:239], v128, s[24:27], s67 offen offset:0 sc1
 v_accvgpr_read_b32 v216, a108
 mf v,112,v,196,a,240
 tr v,212,132,12288
 v_accvgpr_read_b32 v217, a109
 mf v,116,v,196,a,244
 tr v,214,132,12800
 v_accvgpr_read_b32 v218, a110
 mf v,120,v,196,a,248
 v_accvgpr_read_b32 v219, a111
 v_accvgpr_read_b32 v220, a124
 mf v,124,v,196,a,252
 s_waitcnt vmcnt(30) lgkmcnt(4)
 v_accvgpr_read_b32 v221, a125
 v_accvgpr_read_b32 v222, a126
 mf v,0,v,200,a,224
 tr v,192,133,4096
 v_accvgpr_read_b32 v223, a127
 mf v,4,v,200,a,228
 tr v,194,133,4608
 v_accvgpr_read_b32 v224, a172
 mf v,8,v,200,a,232
 buffer_load_dwordx4 a[240:243], v128, s[24:27], s48 offen offset:0 sc1
 v_accvgpr_read_b32 v225, a173
 mf v,12,v,200,a,236
 v_accvgpr_read_b32 v226, a174
 v_accvgpr_read_b32 v227, a175
 mf v,16,v,204,a,224
 tr v,196,134,4096
 v_accvgpr_read_b32 v228, a188
 mf v,20,v,204,a,228
 tr v,198,134,4608
 v_accvgpr_read_b32 v229, a189
 mf v,24,v,204,a,232
 buffer_load_dwordx4 a[244:247], v128, s[24:27], s49 offen offset:0 sc1
 v_accvgpr_read_b32 v230, a190
 mf v,28,v,204,a,236
 s_waitcnt lgkmcnt(4)
 v_accvgpr_read_b32 v231, a191
 v_mul_f32 v216, v216, v224
 mf v,64,v,208,a,224
 tr v,200,133,12288
 v_mul_f32 v217, v217, v225
 mf v,68,v,208,a,228
 tr v,202,133,12800
 v_mul_f32 v218, v218, v226
 mf v,72,v,208,a,232
 v_mul_f32 v219, v219, v227
 v_mul_f32 v220, v220, v228
 mf v,76,v,208,a,236
 v_mul_f32 v221, v221, v229
 v_mul_f32 v222, v222, v230
 mf v,80,v,212,a,224
 tr v,204,134,12288
 v_mul_f32 v223, v223, v231
 mf v,84,v,212,a,228
 tr v,206,134,12800
 v_cvt_pk_bf16_f32 v232, v216, v217
 mf v,88,v,212,a,232
 buffer_load_dwordx4 a[248:251], v128, s[24:27], s50 offen offset:0 sc1
 v_cvt_pk_bf16_f32 v233, v218, v219
 mf v,92,v,212,a,236
 s_waitcnt lgkmcnt(4)
 v_cvt_pk_bf16_f32 v234, v220, v221
 v_cvt_pk_bf16_f32 v235, v222, v223
 mf v,32,v,192,a,224
 buffer_store_dwordx4 v[232:235], v128, s[24:27], s67 offen offset:1024 sc1
 s_sub_u32 s67, s67, 440320
 mf v,36,v,192,a,228
 mf v,40,v,192,a,232
 mf v,44,v,192,a,236
 s_waitcnt lgkmcnt(0)
 s_barrier
 mf v,48,v,196,a,224
 tr v,208,135,0
 mf v,52,v,196,a,228
 tr v,210,135,512
 mf v,56,v,196,a,232
 tr v,212,136,0
 mf v,60,v,196,a,236
 tr v,214,136,512
 mf v,96,v,200,a,224
 tr v,192,135,8192
 mf v,100,v,200,a,228
 tr v,194,135,8704
 mf v,104,v,200,a,232
 buffer_load_dwordx4 a[252:255], v128, s[24:27], s51 offen offset:0 sc1
 mf v,108,v,200,a,236
 mf v,112,v,204,a,224
 tr v,196,136,8192
 mf v,116,v,204,a,228
 tr v,198,136,8704
 mf v,120,v,204,a,232
 mf v,124,v,204,a,236
 s_waitcnt vmcnt(29) lgkmcnt(4)
f_A29:
 s_mov_b32 s69, f_att-f_base
 mf v,0,v,208,a,208
 tr v,200,137,0
 v_add_u32 v131, 0xfffe8000, v131
 mf v,4,v,208,a,212
 tr v,202,137,512
 mf v,8,v,208,a,216
 buffer_load_dword v146, v155, s[36:39], s69 offen
 mf v,12,v,208,a,220
 mf v,16,v,212,a,208
 tr v,204,138,0
 v_add_u32 v132, 0xfffe8000, v132
 mf v,20,v,212,a,212
 tr v,206,138,512
 mf v,24,v,212,a,216
 mf v,28,v,212,a,220
 s_waitcnt lgkmcnt(4)
 mf v,64,v,192,a,208
 tr v,208,137,8192
 v_add_u32 v133, 0xfffe8000, v133
 mf v,68,v,192,a,212
 tr v,210,137,8704
 mf v,72,v,192,a,216
 mf v,76,v,192,a,220
 mf v,80,v,196,a,208
 tr v,212,138,8192
 v_add_u32 v134, 0xfffe8000, v134
 mf v,84,v,196,a,212
 tr v,214,138,8704
 mf v,88,v,196,a,216
 mf v,92,v,196,a,220
 s_waitcnt lgkmcnt(4)
 mf v,32,v,200,a,208
 tr v,192,135,4096
 mf v,36,v,200,a,212
 tr v,194,135,4608
 mf v,40,v,200,a,216
 mf v,44,v,200,a,220
 mf v,48,v,204,a,208
 tr v,196,136,4096
 mf v,52,v,204,a,212
 tr v,198,136,4608
 mf v,56,v,204,a,216
 mf v,60,v,204,a,220
 s_waitcnt lgkmcnt(4)
 mf v,96,v,208,a,208
 tr v,200,135,12288
 mf v,100,v,208,a,212
 tr v,202,135,12800
 mf v,104,v,208,a,216
 mf v,108,v,208,a,220
 mf v,112,v,212,a,208
 tr v,204,136,12288
 mf v,116,v,212,a,212
 tr v,206,136,12800
 mf v,120,v,212,a,216
 mf v,124,v,212,a,220
 s_waitcnt vmcnt(22) lgkmcnt(4)
 mf v,0,v,192,a,192
 tr v,208,137,4096
 mf v,4,v,192,a,196
 tr v,210,137,4608
 mf v,8,v,192,a,200
 mf v,12,v,192,a,204
 mf v,16,v,196,a,192
 tr v,212,138,4096
 mf v,20,v,196,a,196
 tr v,214,138,4608
 mf v,24,v,196,a,200
 mf v,28,v,196,a,204
 s_waitcnt lgkmcnt(4)
 mf v,64,v,200,a,192
 tr v,192,137,12288
 mf v,68,v,200,a,196
 tr v,194,137,12800
 mf v,72,v,200,a,200
 mf v,76,v,200,a,204
 mf v,80,v,204,a,192
 tr v,196,138,12288
 mf v,84,v,204,a,196
 tr v,198,138,12800
 mf v,88,v,204,a,200
 mf v,92,v,204,a,204
 s_waitcnt lgkmcnt(4)
 mf v,32,v,208,a,192
 mf v,36,v,208,a,196
 mf v,40,v,208,a,200
 mf v,44,v,208,a,204
 s_waitcnt lgkmcnt(0)
 s_barrier
 mf v,48,v,212,a,192
 tr v,200,131,0
 mf v,52,v,212,a,196
 tr v,202,131,512
 mf v,56,v,212,a,200
 tr v,204,132,0
 mf v,60,v,212,a,204
 tr v,206,132,512
 mf v,96,v,192,a,192
 tr v,208,131,8192
 mf v,100,v,192,a,196
 tr v,210,131,8704
 mf v,104,v,192,a,200
 mf v,108,v,192,a,204
 mf v,112,v,196,a,192
 tr v,212,132,8192
 mf v,116,v,196,a,196
 tr v,214,132,8704
 mf v,120,v,196,a,200
 mf v,124,v,196,a,204
 s_waitcnt vmcnt(17) lgkmcnt(4)
f_A30:
 s_waitcnt vmcnt(11)
 v_cmp_ne_u32 vcc, v144, v154
 s_cbranch_vccnz f_pqA
f_pqA_back:
 mf v,0,v,200,v,240
 tr v,192,133,0
 v_add_u32 v135, 0xfffe8000, v135
 mf v,4,v,200,v,244
 tr v,194,133,512
 mf v,8,v,200,v,248
 buffer_load_dwordx4 a[32:35], v128, s[24:27], s63 offen offset:0 sc1
 mf v,12,v,200,v,252
 mf v,16,v,204,v,240
 tr v,196,134,0
 v_add_u32 v136, 0xfffe8000, v136
 mf v,20,v,204,v,244
 tr v,198,134,512
 mf v,24,v,204,v,248
 buffer_load_dwordx4 a[36:39], v128, s[24:27], s63 offen offset:1024 sc1
 mf v,28,v,204,v,252
 s_waitcnt lgkmcnt(4)
 mf v,64,v,208,v,240
 tr v,200,133,8192
 v_add_u32 v137, 0xfffe8000, v137
 mf v,68,v,208,v,244
 tr v,202,133,8704
 mf v,72,v,208,v,248
 buffer_load_dwordx4 a[0:3], v128, s[24:27], s65 offen offset:0 sc1
 mf v,76,v,208,v,252
 mf v,80,v,212,v,240
 tr v,204,134,8192
 v_add_u32 v138, 0xfffe8000, v138
 mf v,84,v,212,v,244
 tr v,206,134,8704
 mf v,88,v,212,v,248
 buffer_load_dwordx4 a[4:7], v128, s[24:27], s65 offen offset:1024 sc1
 mf v,92,v,212,v,252
 s_waitcnt lgkmcnt(4)
 mf v,32,v,192,v,240
 tr v,208,131,4096
 mf v,36,v,192,v,244
 tr v,210,131,4608
 mf v,40,v,192,v,248
 buffer_load_dwordx4 a[8:11], v128, s[24:27], s65 offen offset:2048 sc1
 mf v,44,v,192,v,252
 mf v,48,v,196,v,240
 tr v,212,132,4096
 mf v,52,v,196,v,244
 tr v,214,132,4608
 mf v,56,v,196,v,248
 buffer_load_dwordx4 a[12:15], v128, s[24:27], s65 offen offset:3072 sc1
 mf v,60,v,196,v,252
 s_waitcnt lgkmcnt(4)
 mf v,96,v,200,v,240
 tr v,192,131,12288
 mf v,100,v,200,v,244
 tr v,194,131,12800
 mf v,104,v,200,v,248
 buffer_load_dwordx4 a[16:19], v128, s[24:27], s66 offen offset:0 sc1
 mf v,108,v,200,v,252
 mf v,112,v,204,v,240
 tr v,196,132,12288
 mf v,116,v,204,v,244
 tr v,198,132,12800
 mf v,120,v,204,v,248
 buffer_load_dwordx4 a[20:23], v128, s[24:27], s66 offen offset:1024 sc1
 mf v,124,v,204,v,252
 s_waitcnt lgkmcnt(4)
 mf v,0,v,208,v,176
 tr v,200,133,4096
 mf v,4,v,208,v,180
 tr v,202,133,4608
 mf v,8,v,208,v,184
 buffer_load_dwordx4 a[64:67], v128, s[24:27], s64 offen offset:0 sc1
 mf v,12,v,208,v,188
 mf v,16,v,212,v,176
 tr v,204,134,4096
 mf v,20,v,212,v,180
 tr v,206,134,4608
 mf v,24,v,212,v,184
 buffer_load_dwordx4 a[68:71], v128, s[24:27], s64 offen offset:1024 sc1
 mf v,28,v,212,v,188
 s_waitcnt lgkmcnt(4)
 mf v,64,v,192,v,176
 tr v,208,133,12288
 mf v,68,v,192,v,180
 tr v,210,133,12800
 mf v,72,v,192,v,184
 buffer_load_dwordx4 a[24:27], v128, s[24:27], s66 offen offset:2048 sc1
 mf v,76,v,192,v,188
 mf v,80,v,196,v,176
 tr v,212,134,12288
 mf v,84,v,196,v,180
 tr v,214,134,12800
 mf v,88,v,196,v,184
 buffer_load_dwordx4 a[28:31], v128, s[24:27], s66 offen offset:3072 sc1
 mf v,92,v,196,v,188
 s_waitcnt lgkmcnt(4)
 mf v,32,v,200,v,176
 mf v,36,v,200,v,180
 mf v,40,v,200,v,184
 buffer_load_dwordx4 a[40:43], v128, s[24:27], s63 offen offset:2048 sc1
 mf v,44,v,200,v,188
 s_waitcnt lgkmcnt(0)
 s_barrier
 mf v,48,v,204,v,176
 tr v,192,135,0
 mf v,52,v,204,v,180
 tr v,194,135,512
 mf v,56,v,204,v,184
 tr v,196,135,4096
 mf v,60,v,204,v,188
 tr v,198,135,4608
 mf v,96,v,208,v,176
 tr v,200,136,0
 mf v,100,v,208,v,180
 tr v,202,136,512
 mf v,104,v,208,v,184
 buffer_load_dwordx4 a[44:47], v128, s[24:27], s63 offen offset:3072 sc1
 mf v,108,v,208,v,188
 mf v,112,v,212,v,176
 tr v,204,136,4096
 mf v,116,v,212,v,180
 tr v,206,136,4608
 mf v,120,v,212,v,184
 mf v,124,v,212,v,188
 s_waitcnt vmcnt(15) lgkmcnt(4)
f_A31:
 s_add_u32 s63, s63, 4096
 mf v,0,v,192,v,160
 tr v,208,135,8192
 mf v,0,v,196,a,240
 tr v,210,135,8704
 mf v,4,v,192,v,164
 buffer_load_dwordx4 a[72:75], v128, s[24:27], s64 offen offset:2048 sc1
 mf v,4,v,196,a,244
 mf v,8,v,192,v,168
 tr v,212,135,12288
 mf v,8,v,196,a,248
 tr v,214,135,12800
 mf v,12,v,192,v,172
 buffer_load_dwordx4 a[76:79], v128, s[24:27], s64 offen offset:3072 sc1
 s_add_u32 s64, s64, 4096
 mf v,12,v,196,a,252
 s_waitcnt lgkmcnt(4)
 mf v,16,v,200,v,160
 tr v,192,136,8192
 mf v,16,v,204,a,240
 tr v,194,136,8704
 mf v,20,v,200,v,164
 buffer_load_dwordx4 a[48:51], v128, s[24:27], s63 offen offset:0 sc1
 mf v,20,v,204,a,244
 mf v,24,v,200,v,168
 tr v,196,136,12288
 mf v,24,v,204,a,248
 tr v,198,136,12800
 mf v,28,v,200,v,172
 mf v,28,v,204,a,252
 s_waitcnt lgkmcnt(4)
 mf v,64,v,208,v,160
 tr v,200,137,0
 mf v,64,v,212,a,240
 tr v,202,137,512
 mf v,68,v,208,v,164
 buffer_load_dwordx4 a[52:55], v128, s[24:27], s63 offen offset:1024 sc1
 mf v,68,v,212,a,244
 mf v,72,v,208,v,168
 tr v,204,137,4096
 mf v,72,v,212,a,248
 tr v,206,137,4608
 mf v,76,v,208,v,172
 buffer_load_dwordx4 a[80:83], v128, s[24:27], s64 offen offset:0 sc1
 mf v,76,v,212,a,252
 s_waitcnt lgkmcnt(4)
 mf v,80,v,192,v,160
 tr v,208,138,0
 mf v,80,v,196,a,240
 tr v,210,138,512
 mf v,84,v,192,v,164
 buffer_load_dwordx4 a[84:87], v128, s[24:27], s64 offen offset:1024 sc1
 mf v,84,v,196,a,244
 mf v,88,v,192,v,168
 tr v,212,138,4096
 mf v,88,v,196,a,248
 tr v,214,138,4608
 mf v,92,v,192,v,172
 mf v,92,v,196,a,252
 s_waitcnt lgkmcnt(4)
 mf v,32,v,200,v,160
 tr v,192,137,8192
 mf v,32,v,204,a,240
 tr v,194,137,8704
 mf v,36,v,200,v,164
 mf v,36,v,204,a,244
 v_mul_f32 v216, v0, v64
 v_mul_f32 v217, v1, v65
 mf v,40,v,200,v,168
 tr v,196,137,12288
 v_mul_f32 v218, v2, v66
 mf v,40,v,204,a,248
 tr v,198,137,12800
 v_mul_f32 v219, v3, v67
 mf v,44,v,200,v,172
 v_mul_f32 v220, v16, v80
 v_mul_f32 v221, v17, v81
 mf v,44,v,204,a,252
 s_waitcnt lgkmcnt(4)
 v_mul_f32 v222, v18, v82
 v_mul_f32 v223, v19, v83
 mf v,48,v,208,v,160
 tr v,200,138,8192
 v_cvt_pk_bf16_f32 v236, v216, v217
 mf v,48,v,212,a,240
 tr v,202,138,8704
 v_cvt_pk_bf16_f32 v237, v218, v219
 mf v,52,v,208,v,164
 v_cvt_pk_bf16_f32 v238, v220, v221
 v_cvt_pk_bf16_f32 v239, v222, v223
 mf v,52,v,212,a,244
 buffer_store_dwordx4 v[236:239], v128, s[24:27], s67 offen offset:0 sc1
 s_add_u32 s67, s67, 147456
 mf v,56,v,208,v,168
 tr v,204,138,12288
 v_mul_f32 v216, v4, v68
 mf v,56,v,212,a,248
 tr v,206,138,12800
 v_mul_f32 v217, v5, v69
 mf v,60,v,208,v,172
 v_mul_f32 v218, v6, v70
 v_mul_f32 v219, v7, v71
 mf v,60,v,212,a,252
 s_waitcnt lgkmcnt(4)
 v_mul_f32 v220, v20, v84
 v_mul_f32 v221, v21, v85
 mf v,96,v,192,v,160
 v_mul_f32 v222, v22, v86
 v_mul_f32 v223, v23, v87
 mf v,96,v,196,a,240
 v_cvt_pk_bf16_f32 v232, v216, v217
 v_cvt_pk_bf16_f32 v233, v218, v219
 mf v,100,v,192,v,164
 v_cvt_pk_bf16_f32 v234, v220, v221
 v_cvt_pk_bf16_f32 v235, v222, v223
 mf v,100,v,196,a,244
 buffer_store_dwordx4 v[232:235], v128, s[24:27], s67 offen offset:0 sc1
 s_add_u32 s67, s67, 147456
 mf v,104,v,192,v,168
 v_mul_f32 v216, v8, v72
 v_mul_f32 v217, v9, v73
 mf v,104,v,196,a,248
 v_mul_f32 v218, v10, v74
 v_mul_f32 v219, v11, v75
 mf v,108,v,192,v,172
 v_mul_f32 v220, v24, v88
 v_mul_f32 v221, v25, v89
 mf v,108,v,196,a,252
 s_waitcnt lgkmcnt(0)
 v_mul_f32 v222, v26, v90
 v_mul_f32 v223, v27, v91
 mf v,112,v,200,v,160
 v_cvt_pk_bf16_f32 v236, v216, v217
 v_cvt_pk_bf16_f32 v237, v218, v219
 mf v,112,v,204,a,240
 v_cvt_pk_bf16_f32 v238, v220, v221
 v_cvt_pk_bf16_f32 v239, v222, v223
 mf v,116,v,200,v,164
 buffer_store_dwordx4 v[236:239], v128, s[24:27], s67 offen offset:0 sc1
 s_add_u32 s67, s67, 147456
 mf v,116,v,204,a,244
 v_mul_f32 v216, v12, v76
 v_mul_f32 v217, v13, v77
 mf v,120,v,200,v,168
 v_mul_f32 v218, v14, v78
 v_mul_f32 v219, v15, v79
 mf v,120,v,204,a,248
 v_mul_f32 v220, v28, v92
 v_mul_f32 v221, v29, v93
 mf v,124,v,200,v,172
 v_mul_f32 v222, v30, v94
 v_mul_f32 v223, v31, v95
 mf v,124,v,204,a,252
 v_cvt_pk_bf16_f32 v232, v216, v217
 v_cvt_pk_bf16_f32 v233, v218, v219
 v_cvt_pk_bf16_f32 v234, v220, v221
 v_cvt_pk_bf16_f32 v235, v222, v223
 buffer_store_dwordx4 v[232:235], v128, s[24:27], s67 offen offset:0 sc1
 s_branch f_att
f_pqA:
 s_mov_b32 s69, 0
f_pqA_1:
 s_sleep 1
 buffer_load_dword v154, v145, s[24:27], s73 offen offset:0 sc1
 s_add_u32 s69, s69, 1
 s_waitcnt vmcnt(0)
 v_cmp_ne_u32 vcc, v144, v154
 s_cmp_lt_u32 s69, 0x8000
 s_cbranch_scc0 f_pqA_back
 s_cbranch_vccnz f_pqA_1
 s_branch f_pqA_back
f_pqC:
 s_mov_b32 s69, 0
f_pqC_1:
 s_sleep 1
 buffer_load_dword v154, v145, s[24:27], s73 offen offset:0 sc1
 s_add_u32 s69, s69, 1
 s_waitcnt vmcnt(0)
 v_cmp_ne_u32 vcc, v144, v154
 s_cmp_lt_u32 s69, 0x8000
 s_cbranch_scc0 f_pqC_back
 s_cbranch_vccnz f_pqC_1
 s_branch f_pqC_back
f_lbC:
 s_add_u32 m0, s52, 0
 s_nop 0
 buffer_load_dwordx4 v130, s[4:7], s46 offen lds
 s_add_u32 m0, s52, 8192
 s_nop 0
 buffer_load_dwordx4 v130, s[8:11], s46 offen lds
 s_add_u32 m0, s52, 16384
 s_nop 0
 buffer_load_dwordx4 v130, s[12:15], s46 offen lds
 s_add_u32 s46, s46, 196608
 s_add_u32 m0, s52, 4096
 s_nop 0
 buffer_load_dwordx4 v130, s[4:7], s46 offen lds
 s_add_u32 m0, s52, 12288
 s_nop 0
 buffer_load_dwordx4 v130, s[8:11], s46 offen lds
 s_add_u32 m0, s52, 20480
 s_nop 0
 buffer_load_dwordx4 v130, s[12:15], s46 offen lds
 s_add_u32 s46, s46, 196608
 s_add_u32 m0, s52, 24576
 s_nop 0
 buffer_load_dwordx4 v130, s[4:7], s46 offen lds
 s_add_u32 m0, s52, 32768
 s_nop 0
 buffer_load_dwordx4 v130, s[8:11], s46 offen lds
 s_add_u32 m0, s52, 40960
 s_nop 0
 buffer_load_dwordx4 v130, s[12:15], s46 offen lds
 s_add_u32 s46, s46, 196608
 s_add_u32 m0, s52, 28672
 s_nop 0
 buffer_load_dwordx4 v130, s[4:7], s46 offen lds
 s_add_u32 m0, s52, 36864
 s_nop 0
 buffer_load_dwordx4 v130, s[8:11], s46 offen lds
 s_add_u32 m0, s52, 45056
 s_nop 0
 buffer_load_dwordx4 v130, s[12:15], s46 offen lds
 s_add_u32 s46, s46, 196608
 s_lshr_b32 s71, s61, 2
 s_cmp_eq_u32 s3, 3
 s_cselect_b32 s45, 0, 0x101
 s_lshl_b32 s45, s45, s71
 s_lshr_b32 s45, s45, 2
 s_add_u32 s71, s71, 16
 s_bitset1_b32 s45, s71
 s_and_b32 s71, s61, 3
 s_lshl_b32 s71, s71, 15
 s_add_u32 s71, s71, s48
 s_branch f_pmC
f_plC:
 s_sleep 2
f_pmC:
 buffer_load_dword v154, v119, s[24:27], s47 offen sc1
 s_add_u32 s69, s69, 1
 s_cmp_lt_u32 s69, 0x8000
 s_waitcnt vmcnt(0)
 v_cmp_ne_u32 vcc, v144, v154
 s_cbranch_scc0 f_pkC
 s_cbranch_vccnz f_plC
f_pkC:
 buffer_load_dwordx4 v[0:3], v128, s[24:27], s48 offen offset:0 sc1
 buffer_load_dwordx4 v[4:7], v128, s[24:27], s49 offen offset:0 sc1
 buffer_load_dwordx4 v[8:11], v128, s[24:27], s50 offen offset:0 sc1
 buffer_load_dwordx4 v[12:15], v128, s[24:27], s51 offen offset:0 sc1
 buffer_load_dwordx4 v[16:19], v128, s[24:27], s48 offen offset:1024 sc1
 buffer_load_dwordx4 v[20:23], v128, s[24:27], s49 offen offset:1024 sc1
 buffer_load_dwordx4 v[24:27], v128, s[24:27], s50 offen offset:1024 sc1
 buffer_load_dwordx4 v[28:31], v128, s[24:27], s51 offen offset:1024 sc1
 s_barrier
 tr v,192,131,0
 tr v,194,131,512
 tr v,196,131,4096
 tr v,198,131,4608
 tr v,200,132,0
 tr v,202,132,512
 tr v,204,132,4096
 tr v,206,132,4608
 buffer_load_dwordx4 v[32:35], v128, s[24:27], s48 offen offset:2048 sc1
 buffer_load_dwordx4 v[36:39], v128, s[24:27], s49 offen offset:2048 sc1
 buffer_load_dwordx4 v[40:43], v128, s[24:27], s50 offen offset:2048 sc1
 buffer_load_dwordx4 v[44:47], v128, s[24:27], s51 offen offset:2048 sc1
 buffer_load_dwordx4 v[48:51], v128, s[24:27], s48 offen offset:3072 sc1
 s_add_u32 s48, s48, 4096
 buffer_load_dwordx4 v[52:55], v128, s[24:27], s49 offen offset:3072 sc1
 s_add_u32 s49, s49, 4096
 buffer_load_dwordx4 v[56:59], v128, s[24:27], s50 offen offset:3072 sc1
 s_add_u32 s50, s50, 4096
 buffer_load_dwordx4 v[60:63], v128, s[24:27], s51 offen offset:3072 sc1
 s_add_u32 s51, s51, 4096
 s_waitcnt vmcnt(8) lgkmcnt(4)
f_C0:
 v_mfma_f32_16x16x32_bf16 a[0:3], v[0:3], v[192:195], 0
 tr v,208,133,0
 mf a,0,v,16,v,196
 tr v,210,133,512
 s_add_u32 m0, s52, 49152
 v_mfma_f32_16x16x32_bf16 a[4:7], v[4:7], v[192:195], 0
 buffer_load_dwordx4 v130, s[4:7], s46 offen lds
 mf a,4,v,20,v,196
 v_mfma_f32_16x16x32_bf16 a[8:11], v[8:11], v[192:195], 0
 tr v,212,133,4096
 mf a,8,v,24,v,196
 tr v,214,133,4608
 s_add_u32 m0, s52, 57344
 v_mfma_f32_16x16x32_bf16 a[12:15], v[12:15], v[192:195], 0
 buffer_load_dwordx4 v130, s[8:11], s46 offen lds
 mf a,12,v,28,v,196
 s_waitcnt lgkmcnt(4)
 v_mfma_f32_16x16x32_bf16 a[16:19], v[0:3], v[200:203], 0
 tr v,192,134,0
 mf a,16,v,16,v,204
 tr v,194,134,512
 s_add_u32 m0, s52, 65536
 v_mfma_f32_16x16x32_bf16 a[20:23], v[4:7], v[200:203], 0
 buffer_load_dwordx4 v130, s[12:15], s46 offen lds
 s_add_u32 s46, s46, 196608
 mf a,20,v,20,v,204
 s_bitcmp1_b32 s45, 0
 s_cbranch_scc0 f_wC0
 buffer_load_dword v146, v216, s[32:35], 0 offen
 v_add_u32 v216, v218, v216
f_wC0:
 v_mfma_f32_16x16x32_bf16 a[24:27], v[8:11], v[200:203], 0
 tr v,196,134,4096
 mf a,24,v,24,v,204
 tr v,198,134,4608
 s_add_u32 m0, s52, 53248
 v_mfma_f32_16x16x32_bf16 a[28:31], v[12:15], v[200:203], 0
 buffer_load_dwordx4 v130, s[4:7], s46 offen lds
 mf a,28,v,28,v,204
 s_waitcnt lgkmcnt(4)
 v_mfma_f32_16x16x32_bf16 a[32:35], v[0:3], v[208:211], 0
 tr v,200,131,8192
 mf a,32,v,16,v,212
 tr v,202,131,8704
 s_add_u32 m0, s52, 61440
 v_mfma_f32_16x16x32_bf16 a[36:39], v[4:7], v[208:211], 0
 buffer_load_dwordx4 v130, s[8:11], s46 offen lds
 mf a,36,v,20,v,212
 v_mfma_f32_16x16x32_bf16 a[40:43], v[8:11], v[208:211], 0
 tr v,204,131,12288
 mf a,40,v,24,v,212
 tr v,206,131,12800
 v_mfma_f32_16x16x32_bf16 a[44:47], v[12:15], v[208:211], 0
 mf a,44,v,28,v,212
 s_waitcnt lgkmcnt(4)
 v_mfma_f32_16x16x32_bf16 a[48:51], v[0:3], v[192:195], 0
 tr v,208,132,8192
 mf a,48,v,16,v,196
 tr v,210,132,8704
 s_add_u32 m0, s52, 69632
 v_mfma_f32_16x16x32_bf16 a[52:55], v[4:7], v[192:195], 0
 buffer_load_dwordx4 v130, s[12:15], s46 offen lds
 s_add_u32 s46, s46, 196608
 mf a,52,v,20,v,196
 v_mfma_f32_16x16x32_bf16 a[56:59], v[8:11], v[192:195], 0
 tr v,212,132,12288
 mf a,56,v,24,v,196
 tr v,214,132,12800
 v_mfma_f32_16x16x32_bf16 a[60:63], v[12:15], v[192:195], 0
 buffer_load_dwordx4 v[64:67], v128, s[24:27], s48 offen offset:0 sc1
 mf a,60,v,28,v,196
 s_waitcnt lgkmcnt(4)
 v_mfma_f32_16x16x32_bf16 a[64:67], v[0:3], v[200:203], 0
 tr v,192,133,8192
 mf a,64,v,16,v,204
 tr v,194,133,8704
 v_mfma_f32_16x16x32_bf16 a[68:71], v[4:7], v[200:203], 0
 buffer_load_dwordx4 v[68:71], v128, s[24:27], s49 offen offset:0 sc1
 mf a,68,v,20,v,204
 v_mfma_f32_16x16x32_bf16 a[72:75], v[8:11], v[200:203], 0
 tr v,196,133,12288
 mf a,72,v,24,v,204
 tr v,198,133,12800
 v_mfma_f32_16x16x32_bf16 a[76:79], v[12:15], v[200:203], 0
 buffer_load_dwordx4 v[72:75], v128, s[24:27], s50 offen offset:0 sc1
 mf a,76,v,28,v,204
 s_waitcnt lgkmcnt(4)
 v_mfma_f32_16x16x32_bf16 a[80:83], v[0:3], v[208:211], 0
 tr v,200,134,8192
 mf a,80,v,16,v,212
 tr v,202,134,8704
 v_mfma_f32_16x16x32_bf16 a[84:87], v[4:7], v[208:211], 0
 buffer_load_dwordx4 v[76:79], v128, s[24:27], s51 offen offset:0 sc1
 mf a,84,v,20,v,212
 v_mfma_f32_16x16x32_bf16 a[88:91], v[8:11], v[208:211], 0
 tr v,204,134,12288
 mf a,88,v,24,v,212
 tr v,206,134,12800
 v_mfma_f32_16x16x32_bf16 a[92:95], v[12:15], v[208:211], 0
 mf a,92,v,28,v,212
 s_waitcnt lgkmcnt(4)
 v_mfma_f32_16x16x32_bf16 a[96:99], v[0:3], v[192:195], 0
 tr v,208,131,16384
 mf a,96,v,16,v,196
 tr v,210,131,16896
 v_mfma_f32_16x16x32_bf16 a[100:103], v[4:7], v[192:195], 0
 buffer_load_dwordx4 v[80:83], v128, s[24:27], s48 offen offset:1024 sc1
 mf a,100,v,20,v,196
 v_mfma_f32_16x16x32_bf16 a[104:107], v[8:11], v[192:195], 0
 tr v,212,131,20480
 mf a,104,v,24,v,196
 tr v,214,131,20992
 v_mfma_f32_16x16x32_bf16 a[108:111], v[12:15], v[192:195], 0
 buffer_load_dwordx4 v[84:87], v128, s[24:27], s49 offen offset:1024 sc1
 mf a,108,v,28,v,196
 s_waitcnt lgkmcnt(4)
 v_mfma_f32_16x16x32_bf16 a[112:115], v[0:3], v[200:203], 0
 tr v,192,132,16384
 mf a,112,v,16,v,204
 tr v,194,132,16896
 v_mfma_f32_16x16x32_bf16 a[116:119], v[4:7], v[200:203], 0
 buffer_load_dwordx4 v[88:91], v128, s[24:27], s50 offen offset:1024 sc1
 mf a,116,v,20,v,204
 s_bitcmp1_b32 s45, 1
 s_cbranch_scc0 f_wC1
 buffer_load_dword v146, v216, s[32:35], 0 offen
 v_add_u32 v216, v218, v216
f_wC1:
 v_mfma_f32_16x16x32_bf16 a[120:123], v[8:11], v[200:203], 0
 tr v,196,132,20480
 mf a,120,v,24,v,204
 tr v,198,132,20992
 v_mfma_f32_16x16x32_bf16 a[124:127], v[12:15], v[200:203], 0
 buffer_load_dwordx4 v[92:95], v128, s[24:27], s51 offen offset:1024 sc1
 mf a,124,v,28,v,204
 s_waitcnt lgkmcnt(4)
 v_mfma_f32_16x16x32_bf16 a[128:131], v[208:211], v[0:3], 0
 tr v,200,133,16384
 mf a,128,v,212,v,16
 tr v,202,133,16896
 v_mfma_f32_16x16x32_bf16 a[132:135], v[208:211], v[4:7], 0
 buffer_load_dwordx4 v[96:99], v128, s[24:27], s48 offen offset:2048 sc1
 mf a,132,v,212,v,20
 v_mfma_f32_16x16x32_bf16 a[136:139], v[208:211], v[8:11], 0
 tr v,204,133,20480
 mf a,136,v,212,v,24
 tr v,206,133,20992
 v_mfma_f32_16x16x32_bf16 a[140:143], v[208:211], v[12:15], 0
 buffer_load_dwordx4 v[100:103], v128, s[24:27], s49 offen offset:2048 sc1
 mf a,140,v,212,v,28
 s_waitcnt lgkmcnt(4)
 v_mfma_f32_16x16x32_bf16 a[144:147], v[192:195], v[0:3], 0
 tr v,208,134,16384
 mf a,144,v,196,v,16
 tr v,210,134,16896
 v_mfma_f32_16x16x32_bf16 a[148:151], v[192:195], v[4:7], 0
 buffer_load_dwordx4 v[104:107], v128, s[24:27], s50 offen offset:2048 sc1
 mf a,148,v,196,v,20
 v_mfma_f32_16x16x32_bf16 a[152:155], v[192:195], v[8:11], 0
 tr v,212,134,20480
 mf a,152,v,196,v,24
 tr v,214,134,20992
 v_mfma_f32_16x16x32_bf16 a[156:159], v[192:195], v[12:15], 0
 buffer_load_dwordx4 v[108:111], v128, s[24:27], s51 offen offset:2048 sc1
 mf a,156,v,196,v,28
 s_waitcnt lgkmcnt(4)
 v_mfma_f32_16x16x32_bf16 a[160:163], v[200:203], v[0:3], 0
 mf a,160,v,204,v,16
 v_mfma_f32_16x16x32_bf16 a[164:167], v[200:203], v[4:7], 0
 buffer_load_dwordx4 v[112:115], v128, s[24:27], s48 offen offset:3072 sc1
 s_add_u32 s48, s48, 4096
 mf a,164,v,204,v,20
 s_waitcnt lgkmcnt(0)
 s_barrier
 v_mfma_f32_16x16x32_bf16 a[168:171], v[200:203], v[8:11], 0
 tr v,192,135,0
 mf a,168,v,204,v,24
 tr v,194,135,512
 v_mfma_f32_16x16x32_bf16 a[172:175], v[200:203], v[12:15], 0
 tr v,196,135,4096
 mf a,172,v,204,v,28
 tr v,198,135,4608
 v_mfma_f32_16x16x32_bf16 a[176:179], v[208:211], v[0:3], 0
 tr v,200,136,0
 mf a,176,v,212,v,16
 tr v,202,136,512
 v_mfma_f32_16x16x32_bf16 a[180:183], v[208:211], v[4:7], 0
 buffer_load_dwordx4 v[116:119], v128, s[24:27], s49 offen offset:3072 sc1
 s_add_u32 s49, s49, 4096
 mf a,180,v,212,v,20
 v_mfma_f32_16x16x32_bf16 a[184:187], v[208:211], v[8:11], 0
 tr v,204,136,4096
 mf a,184,v,212,v,24
 tr v,206,136,4608
 v_mfma_f32_16x16x32_bf16 a[188:191], v[208:211], v[12:15], 0
 mf a,188,v,212,v,28
 s_waitcnt vmcnt(20) lgkmcnt(4)
f_C1:
 s_mov_b32 s69, f_C4-f_base
 mf a,0,v,32,v,192
 tr v,208,137,0
 v_add_u32 v131, 0xc000, v131
 mf a,0,v,48,v,196
 tr v,210,137,512
 mf a,4,v,36,v,192
 buffer_load_dword v146, v155, s[36:39], s69 offen
 mf a,4,v,52,v,196
 mf a,8,v,40,v,192
 tr v,212,137,4096
 v_add_u32 v132, 0xc000, v132
 mf a,8,v,56,v,196
 tr v,214,137,4608
 mf a,12,v,44,v,192
 buffer_load_dwordx4 v[120:123], v128, s[24:27], s50 offen offset:3072 sc1
 s_add_u32 s50, s50, 4096
 mf a,12,v,60,v,196
 s_waitcnt lgkmcnt(4)
 mf a,16,v,32,v,200
 tr v,192,138,0
 v_add_u32 v133, 0xc000, v133
 mf a,16,v,48,v,204
 tr v,194,138,512
 mf a,20,v,36,v,200
 buffer_load_dwordx4 v[124:127], v128, s[24:27], s51 offen offset:3072 sc1
 s_add_u32 s51, s51, 4096
 mf a,20,v,52,v,204
 s_bitcmp1_b32 s45, 2
 s_cbranch_scc0 f_wC2
 buffer_load_dword v146, v216, s[32:35], 0 offen
 v_add_u32 v216, v218, v216
f_wC2:
 mf a,24,v,40,v,200
 tr v,196,138,4096
 v_add_u32 v134, 0xc000, v134
 mf a,24,v,56,v,204
 tr v,198,138,4608
 mf a,28,v,44,v,200
 buffer_load_dwordx4 v[0:3], v128, s[24:27], s48 offen offset:0 sc1
 mf a,28,v,60,v,204
 s_waitcnt lgkmcnt(4)
 mf a,32,v,32,v,208
 tr v,200,135,8192
 mf a,32,v,48,v,212
 tr v,202,135,8704
 mf a,36,v,36,v,208
 buffer_load_dwordx4 v[4:7], v128, s[24:27], s49 offen offset:0 sc1
 mf a,36,v,52,v,212
 mf a,40,v,40,v,208
 tr v,204,135,12288
 mf a,40,v,56,v,212
 tr v,206,135,12800
 mf a,44,v,44,v,208
 mf a,44,v,60,v,212
 s_waitcnt lgkmcnt(4)
 mf a,48,v,32,v,192
 tr v,208,136,8192
 mf a,48,v,48,v,196
 tr v,210,136,8704
 mf a,52,v,36,v,192
 buffer_load_dwordx4 v[8:11], v128, s[24:27], s50 offen offset:0 sc1
 mf a,52,v,52,v,196
 mf a,56,v,40,v,192
 tr v,212,136,12288
 mf a,56,v,56,v,196
 tr v,214,136,12800
 mf a,60,v,44,v,192
 buffer_load_dwordx4 v[12:15], v128, s[24:27], s51 offen offset:0 sc1
 mf a,60,v,60,v,196
 s_waitcnt lgkmcnt(4)
 mf a,64,v,32,v,200
 tr v,192,137,8192
 mf a,64,v,48,v,204
 tr v,194,137,8704
 mf a,68,v,36,v,200
 buffer_load_dwordx4 v[16:19], v128, s[24:27], s48 offen offset:1024 sc1
 mf a,68,v,52,v,204
 mf a,72,v,40,v,200
 tr v,196,137,12288
 mf a,72,v,56,v,204
 tr v,198,137,12800
 mf a,76,v,44,v,200
 buffer_load_dwordx4 v[20:23], v128, s[24:27], s49 offen offset:1024 sc1
 mf a,76,v,60,v,204
 s_waitcnt lgkmcnt(4)
 mf a,80,v,32,v,208
 tr v,200,138,8192
 mf a,80,v,48,v,212
 tr v,202,138,8704
 mf a,84,v,36,v,208
 buffer_load_dwordx4 v[24:27], v128, s[24:27], s50 offen offset:1024 sc1
 mf a,84,v,52,v,212
 mf a,88,v,40,v,208
 tr v,204,138,12288
 mf a,88,v,56,v,212
 tr v,206,138,12800
 mf a,92,v,44,v,208
 mf a,92,v,60,v,212
 s_waitcnt lgkmcnt(4)
 mf a,96,v,32,v,192
 tr v,208,135,16384
 mf a,96,v,48,v,196
 tr v,210,135,16896
 mf a,100,v,36,v,192
 buffer_load_dwordx4 v[28:31], v128, s[24:27], s51 offen offset:1024 sc1
 mf a,100,v,52,v,196
 mf a,104,v,40,v,192
 tr v,212,135,20480
 mf a,104,v,56,v,196
 tr v,214,135,20992
 mf a,108,v,44,v,192
 mf a,108,v,60,v,196
 s_waitcnt lgkmcnt(4)
 mf a,112,v,32,v,200
 tr v,192,136,16384
 mf a,112,v,48,v,204
 tr v,194,136,16896
 mf a,116,v,36,v,200
 mf a,116,v,52,v,204
 s_bitcmp1_b32 s45, 3
 s_cbranch_scc0 f_wC3
 buffer_load_dword v146, v216, s[32:35], 0 offen
 v_add_u32 v216, v218, v216
f_wC3:
 mf a,120,v,40,v,200
 tr v,196,136,20480
 mf a,120,v,56,v,204
 tr v,198,136,20992
 mf a,124,v,44,v,200
 mf a,124,v,60,v,204
 s_waitcnt lgkmcnt(4)
 mf a,128,v,208,v,32
 tr v,200,137,16384
 mf a,128,v,212,v,48
 tr v,202,137,16896
 mf a,132,v,208,v,36
 mf a,132,v,212,v,52
 mf a,136,v,208,v,40
 tr v,204,137,20480
 mf a,136,v,212,v,56
 tr v,206,137,20992
 mf a,140,v,208,v,44
 mf a,140,v,212,v,60
 s_waitcnt lgkmcnt(4)
 mf a,144,v,192,v,32
 tr v,208,138,16384
 mf a,144,v,196,v,48
 tr v,210,138,16896
 mf a,148,v,192,v,36
 mf a,148,v,196,v,52
 mf a,152,v,192,v,40
 tr v,212,138,20480
 mf a,152,v,196,v,56
 tr v,214,138,20992
 mf a,156,v,192,v,44
 mf a,156,v,196,v,60
 s_waitcnt lgkmcnt(4)
 mf a,160,v,200,v,32
 mf a,160,v,204,v,48
 mf a,164,v,200,v,36
 mf a,164,v,204,v,52
 s_waitcnt vmcnt(25) lgkmcnt(0)
 s_barrier
 mf a,168,v,200,v,40
 tr v,192,131,0
 mf a,168,v,204,v,56
 tr v,194,131,512
 mf a,172,v,200,v,44
 tr v,196,131,4096
 mf a,172,v,204,v,60
 tr v,198,131,4608
 mf a,176,v,208,v,32
 tr v,200,132,0
 mf a,176,v,212,v,48
 tr v,202,132,512
 mf a,180,v,208,v,36
 mf a,180,v,212,v,52
 mf a,184,v,208,v,40
 tr v,204,132,4096
 mf a,184,v,212,v,56
 tr v,206,132,4608
 mf a,188,v,208,v,44
 mf a,188,v,212,v,60
 s_waitcnt vmcnt(17) lgkmcnt(4)
f_C2:
 mf a,0,v,64,v,192
 tr v,208,133,0
 v_add_u32 v135, 0xc000, v135
 mf a,0,v,80,v,196
 tr v,210,133,512
 s_add_u32 m0, s52, 73728
 mf a,4,v,68,v,192
 buffer_load_dwordx4 v130, s[4:7], s46 offen lds
 mf a,4,v,84,v,196
 mf a,8,v,72,v,192
 tr v,212,133,4096
 v_add_u32 v136, 0xc000, v136
 mf a,8,v,88,v,196
 tr v,214,133,4608
 s_add_u32 m0, s52, 81920
 mf a,12,v,76,v,192
 buffer_load_dwordx4 v130, s[8:11], s46 offen lds
 mf a,12,v,92,v,196
 s_waitcnt lgkmcnt(4)
 mf a,16,v,64,v,200
 tr v,192,134,0
 v_add_u32 v137, 0xc000, v137
 mf a,16,v,80,v,204
 tr v,194,134,512
 s_add_u32 m0, s52, 90112
 mf a,20,v,68,v,200
 buffer_load_dwordx4 v130, s[12:15], s46 offen lds
 s_add_u32 s46, s46, 196608
 mf a,20,v,84,v,204
 s_bitcmp1_b32 s45, 4
 s_cbranch_scc0 f_wC4
 buffer_load_dword v146, v216, s[32:35], 0 offen
 v_add_u32 v216, v218, v216
f_wC4:
 mf a,24,v,72,v,200
 tr v,196,134,4096
 v_add_u32 v138, 0xc000, v138
 mf a,24,v,88,v,204
 tr v,198,134,4608
 s_add_u32 m0, s52, 77824
 mf a,28,v,76,v,200
 buffer_load_dwordx4 v130, s[4:7], s46 offen lds
 mf a,28,v,92,v,204
 s_waitcnt lgkmcnt(4)
 mf a,32,v,64,v,208
 tr v,200,131,8192
 mf a,32,v,80,v,212
 tr v,202,131,8704
 s_add_u32 m0, s52, 86016
 mf a,36,v,68,v,208
 buffer_load_dwordx4 v130, s[8:11], s46 offen lds
 mf a,36,v,84,v,212
 mf a,40,v,72,v,208
 tr v,204,131,12288
 mf a,40,v,88,v,212
 tr v,206,131,12800
 mf a,44,v,76,v,208
 mf a,44,v,92,v,212
 s_waitcnt lgkmcnt(4)
 mf a,48,v,64,v,192
 tr v,208,132,8192
 mf a,48,v,80,v,196
 tr v,210,132,8704
 s_add_u32 m0, s52, 94208
 mf a,52,v,68,v,192
 buffer_load_dwordx4 v130, s[12:15], s46 offen lds
 s_add_u32 s46, s46, 196608
 mf a,52,v,84,v,196
 mf a,56,v,72,v,192
 tr v,212,132,12288
 mf a,56,v,88,v,196
 tr v,214,132,12800
 mf a,60,v,76,v,192
 buffer_load_dwordx4 v[32:35], v128, s[24:27], s48 offen offset:2048 sc1
 mf a,60,v,92,v,196
 s_waitcnt lgkmcnt(4)
 mf a,64,v,64,v,200
 tr v,192,133,8192
 mf a,64,v,80,v,204
 tr v,194,133,8704
 mf a,68,v,68,v,200
 buffer_load_dwordx4 v[36:39], v128, s[24:27], s49 offen offset:2048 sc1
 mf a,68,v,84,v,204
 mf a,72,v,72,v,200
 tr v,196,133,12288
 mf a,72,v,88,v,204
 tr v,198,133,12800
 mf a,76,v,76,v,200
 buffer_load_dwordx4 v[40:43], v128, s[24:27], s50 offen offset:2048 sc1
 mf a,76,v,92,v,204
 s_waitcnt lgkmcnt(4)
 mf a,80,v,64,v,208
 tr v,200,134,8192
 mf a,80,v,80,v,212
 tr v,202,134,8704
 mf a,84,v,68,v,208
 buffer_load_dwordx4 v[44:47], v128, s[24:27], s51 offen offset:2048 sc1
 mf a,84,v,84,v,212
 mf a,88,v,72,v,208
 tr v,204,134,12288
 mf a,88,v,88,v,212
 tr v,206,134,12800
 mf a,92,v,76,v,208
 mf a,92,v,92,v,212
 s_waitcnt lgkmcnt(4)
 mf a,96,v,64,v,192
 tr v,208,131,16384
 mf a,96,v,80,v,196
 tr v,210,131,16896
 s_add_u32 m0, s52, 98304
 mf a,100,v,68,v,192
 buffer_load_dwordx4 v130, s[4:7], s46 offen lds
 mf a,100,v,84,v,196
 mf a,104,v,72,v,192
 tr v,212,131,20480
 mf a,104,v,88,v,196
 tr v,214,131,20992
 s_add_u32 m0, s52, 106496
 mf a,108,v,76,v,192
 buffer_load_dwordx4 v130, s[8:11], s46 offen lds
 mf a,108,v,92,v,196
 s_waitcnt lgkmcnt(4)
 mf a,112,v,64,v,200
 tr v,192,132,16384
 mf a,112,v,80,v,204
 tr v,194,132,16896
 s_add_u32 m0, s52, 114688
 mf a,116,v,68,v,200
 buffer_load_dwordx4 v130, s[12:15], s46 offen lds
 s_add_u32 s46, s46, 196608
 mf a,116,v,84,v,204
 s_bitcmp1_b32 s45, 5
 s_cbranch_scc0 f_wC5
 buffer_load_dword v146, v216, s[32:35], 0 offen
 v_add_u32 v216, v218, v216
f_wC5:
 mf a,120,v,72,v,200
 tr v,196,132,20480
 mf a,120,v,88,v,204
 tr v,198,132,20992
 s_add_u32 m0, s52, 102400
 mf a,124,v,76,v,200
 buffer_load_dwordx4 v130, s[4:7], s46 offen lds
 mf a,124,v,92,v,204
 s_waitcnt lgkmcnt(4)
 mf a,128,v,208,v,64
 tr v,200,133,16384
 mf a,128,v,212,v,80
 tr v,202,133,16896
 s_add_u32 m0, s52, 110592
 mf a,132,v,208,v,68
 buffer_load_dwordx4 v130, s[8:11], s46 offen lds
 mf a,132,v,212,v,84
 mf a,136,v,208,v,72
 tr v,204,133,20480
 mf a,136,v,212,v,88
 tr v,206,133,20992
 s_add_u32 m0, s52, 118784
 mf a,140,v,208,v,76
 buffer_load_dwordx4 v130, s[12:15], s46 offen lds
 s_add_u32 s46, s46, 196608
 mf a,140,v,212,v,92
 s_waitcnt lgkmcnt(4)
 mf a,144,v,192,v,64
 tr v,208,134,16384
 mf a,144,v,196,v,80
 tr v,210,134,16896
 mf a,148,v,192,v,68
 buffer_load_dwordx4 v[48:51], v128, s[24:27], s48 offen offset:3072 sc1
 s_add_u32 s48, s48, 4096
 mf a,148,v,196,v,84
 mf a,152,v,192,v,72
 tr v,212,134,20480
 mf a,152,v,196,v,88
 tr v,214,134,20992
 mf a,156,v,192,v,76
 buffer_load_dwordx4 v[52:55], v128, s[24:27], s49 offen offset:3072 sc1
 s_add_u32 s49, s49, 4096
 mf a,156,v,196,v,92
 s_waitcnt lgkmcnt(4)
 mf a,160,v,200,v,64
 mf a,160,v,204,v,80
 mf a,164,v,200,v,68
 buffer_load_dwordx4 v[56:59], v128, s[24:27], s50 offen offset:3072 sc1
 s_add_u32 s50, s50, 4096
 mf a,164,v,204,v,84
 s_waitcnt vmcnt(13) lgkmcnt(0)
 s_barrier
 mf a,168,v,200,v,72
 tr v,192,135,0
 mf a,168,v,204,v,88
 tr v,194,135,512
 mf a,172,v,200,v,76
 tr v,196,135,4096
 mf a,172,v,204,v,92
 tr v,198,135,4608
 mf a,176,v,208,v,64
 tr v,200,136,0
 mf a,176,v,212,v,80
 tr v,202,136,512
 mf a,180,v,208,v,68
 buffer_load_dwordx4 v[60:63], v128, s[24:27], s51 offen offset:3072 sc1
 s_add_u32 s51, s51, 4096
 mf a,180,v,212,v,84
 mf a,184,v,208,v,72
 tr v,204,136,4096
 mf a,184,v,212,v,88
 tr v,206,136,4608
 mf a,188,v,208,v,76
 mf a,188,v,212,v,92
 s_waitcnt lgkmcnt(4)
f_C3:
 mf a,0,v,96,v,192
 tr v,208,137,0
 v_add_u32 v131, 0xc000, v131
 mf a,0,v,112,v,196
 tr v,210,137,512
 s_add_u32 m0, s52, 122880
 mf a,4,v,100,v,192
 buffer_load_dwordx4 v130, s[4:7], s46 offen lds
 mf a,4,v,116,v,196
 mf a,8,v,104,v,192
 tr v,212,137,4096
 v_add_u32 v132, 0xc000, v132
 mf a,8,v,120,v,196
 tr v,214,137,4608
 s_add_u32 m0, s52, 131072
 mf a,12,v,108,v,192
 buffer_load_dwordx4 v130, s[8:11], s46 offen lds
 mf a,12,v,124,v,196
 s_waitcnt lgkmcnt(4)
 mf a,16,v,96,v,200
 tr v,192,138,0
 v_add_u32 v133, 0xc000, v133
 mf a,16,v,112,v,204
 tr v,194,138,512
 s_add_u32 m0, s52, 139264
 mf a,20,v,100,v,200
 buffer_load_dwordx4 v130, s[12:15], s46 offen lds
 s_add_u32 s46, s46, 196608
 mf a,20,v,116,v,204
 s_bitcmp1_b32 s45, 6
 s_cbranch_scc0 f_wC6
 buffer_load_dword v146, v216, s[32:35], 0 offen
 v_add_u32 v216, v218, v216
f_wC6:
 mf a,24,v,104,v,200
 tr v,196,138,4096
 v_add_u32 v134, 0xc000, v134
 mf a,24,v,120,v,204
 tr v,198,138,4608
 s_add_u32 m0, s52, 126976
 mf a,28,v,108,v,200
 buffer_load_dwordx4 v130, s[4:7], s46 offen lds
 mf a,28,v,124,v,204
 s_waitcnt lgkmcnt(4)
 mf a,32,v,96,v,208
 tr v,200,135,8192
 mf a,32,v,112,v,212
 tr v,202,135,8704
 s_add_u32 m0, s52, 135168
 mf a,36,v,100,v,208
 buffer_load_dwordx4 v130, s[8:11], s46 offen lds
 mf a,36,v,116,v,212
 mf a,40,v,104,v,208
 tr v,204,135,12288
 mf a,40,v,120,v,212
 tr v,206,135,12800
 mf a,44,v,108,v,208
 mf a,44,v,124,v,212
 s_waitcnt lgkmcnt(4)
 mf a,48,v,96,v,192
 tr v,208,136,8192
 mf a,48,v,112,v,196
 tr v,210,136,8704
 s_add_u32 m0, s52, 143360
 mf a,52,v,100,v,192
 buffer_load_dwordx4 v130, s[12:15], s46 offen lds
 s_add_u32 s46, s46, 196608
 mf a,52,v,116,v,196
 mf a,56,v,104,v,192
 tr v,212,136,12288
 mf a,56,v,120,v,196
 tr v,214,136,12800
 mf a,60,v,108,v,192
 buffer_load_dwordx4 v[64:67], v128, s[24:27], s48 offen offset:0 sc1
 mf a,60,v,124,v,196
 s_waitcnt lgkmcnt(4)
 mf a,64,v,96,v,200
 tr v,192,137,8192
 mf a,64,v,112,v,204
 tr v,194,137,8704
 mf a,68,v,100,v,200
 buffer_load_dwordx4 v[68:71], v128, s[24:27], s49 offen offset:0 sc1
 mf a,68,v,116,v,204
 mf a,72,v,104,v,200
 tr v,196,137,12288
 mf a,72,v,120,v,204
 tr v,198,137,12800
 mf a,76,v,108,v,200
 buffer_load_dwordx4 v[72:75], v128, s[24:27], s50 offen offset:0 sc1
 mf a,76,v,124,v,204
 s_waitcnt lgkmcnt(4)
 mf a,80,v,96,v,208
 tr v,200,138,8192
 mf a,80,v,112,v,212
 tr v,202,138,8704
 mf a,84,v,100,v,208
 buffer_load_dwordx4 v[76:79], v128, s[24:27], s51 offen offset:0 sc1
 mf a,84,v,116,v,212
 mf a,88,v,104,v,208
 tr v,204,138,12288
 mf a,88,v,120,v,212
 tr v,206,138,12800
 mf a,92,v,108,v,208
 mf a,92,v,124,v,212
 s_waitcnt lgkmcnt(4)
 mf a,96,v,96,v,192
 tr v,208,135,16384
 mf a,96,v,112,v,196
 tr v,210,135,16896
 s_add_u32 m0, s52, 0
 mf a,100,v,100,v,192
 buffer_load_dwordx4 v130, s[4:7], s46 offen lds
 mf a,100,v,116,v,196
 mf a,104,v,104,v,192
 tr v,212,135,20480
 mf a,104,v,120,v,196
 tr v,214,135,20992
 s_add_u32 m0, s52, 8192
 mf a,108,v,108,v,192
 buffer_load_dwordx4 v130, s[8:11], s46 offen lds
 mf a,108,v,124,v,196
 s_waitcnt lgkmcnt(4)
 mf a,112,v,96,v,200
 tr v,192,136,16384
 mf a,112,v,112,v,204
 tr v,194,136,16896
 s_add_u32 m0, s52, 16384
 mf a,116,v,100,v,200
 buffer_load_dwordx4 v130, s[12:15], s46 offen lds
 s_add_u32 s46, s46, 196608
 mf a,116,v,116,v,204
 s_bitcmp1_b32 s45, 7
 s_cbranch_scc0 f_wC7
 buffer_load_dword v146, v216, s[32:35], 0 offen
 v_add_u32 v216, v218, v216
f_wC7:
 mf a,120,v,104,v,200
 tr v,196,136,20480
 mf a,120,v,120,v,204
 tr v,198,136,20992
 s_add_u32 m0, s52, 4096
 mf a,124,v,108,v,200
 buffer_load_dwordx4 v130, s[4:7], s46 offen lds
 mf a,124,v,124,v,204
 s_waitcnt lgkmcnt(4)
 mf a,128,v,208,v,96
 tr v,200,137,16384
 mf a,128,v,212,v,112
 tr v,202,137,16896
 s_add_u32 m0, s52, 12288
 mf a,132,v,208,v,100
 buffer_load_dwordx4 v130, s[8:11], s46 offen lds
 mf a,132,v,212,v,116
 mf a,136,v,208,v,104
 tr v,204,137,20480
 mf a,136,v,212,v,120
 tr v,206,137,20992
 s_add_u32 m0, s52, 20480
 mf a,140,v,208,v,108
 buffer_load_dwordx4 v130, s[12:15], s46 offen lds
 s_add_u32 s46, s46, 196608
 mf a,140,v,212,v,124
 s_waitcnt lgkmcnt(4)
 mf a,144,v,192,v,96
 tr v,208,138,16384
 mf a,144,v,196,v,112
 tr v,210,138,16896
 mf a,148,v,192,v,100
 buffer_load_dwordx4 v[80:83], v128, s[24:27], s48 offen offset:1024 sc1
 mf a,148,v,196,v,116
 mf a,152,v,192,v,104
 tr v,212,138,20480
 mf a,152,v,196,v,120
 tr v,214,138,20992
 mf a,156,v,192,v,108
 buffer_load_dwordx4 v[84:87], v128, s[24:27], s49 offen offset:1024 sc1
 mf a,156,v,196,v,124
 s_waitcnt lgkmcnt(4)
 mf a,160,v,200,v,96
 mf a,160,v,204,v,112
 mf a,164,v,200,v,100
 buffer_load_dwordx4 v[88:91], v128, s[24:27], s50 offen offset:1024 sc1
 mf a,164,v,204,v,116
 s_waitcnt vmcnt(23) lgkmcnt(0)
 s_barrier
 mf a,168,v,200,v,104
 tr v,192,131,0
 mf a,168,v,204,v,120
 tr v,194,131,512
 mf a,172,v,200,v,108
 tr v,196,131,4096
 mf a,172,v,204,v,124
 tr v,198,131,4608
 mf a,176,v,208,v,96
 tr v,200,132,0
 mf a,176,v,212,v,112
 tr v,202,132,512
 mf a,180,v,208,v,100
 buffer_load_dwordx4 v[92:95], v128, s[24:27], s51 offen offset:1024 sc1
 mf a,180,v,212,v,116
 mf a,184,v,208,v,104
 tr v,204,132,4096
 mf a,184,v,212,v,120
 tr v,206,132,4608
 mf a,188,v,208,v,108
 mf a,188,v,212,v,124
 s_waitcnt lgkmcnt(4)
f_C4:
 mf a,0,v,0,v,192
 tr v,208,133,0
 v_add_u32 v135, 0xc000, v135
 mf a,0,v,16,v,196
 tr v,210,133,512
 s_add_u32 m0, s52, 24576
 mf a,4,v,4,v,192
 buffer_load_dwordx4 v130, s[4:7], s46 offen lds
 mf a,4,v,20,v,196
 mf a,8,v,8,v,192
 tr v,212,133,4096
 v_add_u32 v136, 0xc000, v136
 mf a,8,v,24,v,196
 tr v,214,133,4608
 s_add_u32 m0, s52, 32768
 mf a,12,v,12,v,192
 buffer_load_dwordx4 v130, s[8:11], s46 offen lds
 mf a,12,v,28,v,196
 s_waitcnt lgkmcnt(4)
 mf a,16,v,0,v,200
 tr v,192,134,0
 v_add_u32 v137, 0xc000, v137
 mf a,16,v,16,v,204
 tr v,194,134,512
 s_add_u32 m0, s52, 40960
 mf a,20,v,4,v,200
 buffer_load_dwordx4 v130, s[12:15], s46 offen lds
 s_add_u32 s46, s46, 196608
 mf a,20,v,20,v,204
 s_bitcmp1_b32 s45, 8
 s_cbranch_scc0 f_wC8
 buffer_load_dword v146, v216, s[32:35], 0 offen
 v_add_u32 v216, v218, v216
f_wC8:
 mf a,24,v,8,v,200
 tr v,196,134,4096
 v_add_u32 v138, 0xc000, v138
 mf a,24,v,24,v,204
 tr v,198,134,4608
 s_add_u32 m0, s52, 28672
 mf a,28,v,12,v,200
 buffer_load_dwordx4 v130, s[4:7], s46 offen lds
 mf a,28,v,28,v,204
 s_waitcnt lgkmcnt(4)
 mf a,32,v,0,v,208
 tr v,200,131,8192
 mf a,32,v,16,v,212
 tr v,202,131,8704
 s_add_u32 m0, s52, 36864
 mf a,36,v,4,v,208
 buffer_load_dwordx4 v130, s[8:11], s46 offen lds
 mf a,36,v,20,v,212
 mf a,40,v,8,v,208
 tr v,204,131,12288
 mf a,40,v,24,v,212
 tr v,206,131,12800
 mf a,44,v,12,v,208
 mf a,44,v,28,v,212
 s_waitcnt lgkmcnt(4)
 mf a,48,v,0,v,192
 tr v,208,132,8192
 mf a,48,v,16,v,196
 tr v,210,132,8704
 s_add_u32 m0, s52, 45056
 mf a,52,v,4,v,192
 buffer_load_dwordx4 v130, s[12:15], s46 offen lds
 s_add_u32 s46, s46, 196608
 mf a,52,v,20,v,196
 mf a,56,v,8,v,192
 tr v,212,132,12288
 mf a,56,v,24,v,196
 tr v,214,132,12800
 mf a,60,v,12,v,192
 buffer_load_dwordx4 v[96:99], v128, s[24:27], s48 offen offset:2048 sc1
 mf a,60,v,28,v,196
 s_waitcnt lgkmcnt(4)
 mf a,64,v,0,v,200
 tr v,192,133,8192
 mf a,64,v,16,v,204
 tr v,194,133,8704
 mf a,68,v,4,v,200
 buffer_load_dwordx4 v[100:103], v128, s[24:27], s49 offen offset:2048 sc1
 mf a,68,v,20,v,204
 mf a,72,v,8,v,200
 tr v,196,133,12288
 mf a,72,v,24,v,204
 tr v,198,133,12800
 mf a,76,v,12,v,200
 buffer_load_dwordx4 v[104:107], v128, s[24:27], s50 offen offset:2048 sc1
 mf a,76,v,28,v,204
 s_waitcnt lgkmcnt(4)
 mf a,80,v,0,v,208
 tr v,200,134,8192
 mf a,80,v,16,v,212
 tr v,202,134,8704
 mf a,84,v,4,v,208
 buffer_load_dwordx4 v[108:111], v128, s[24:27], s51 offen offset:2048 sc1
 mf a,84,v,20,v,212
 mf a,88,v,8,v,208
 tr v,204,134,12288
 mf a,88,v,24,v,212
 tr v,206,134,12800
 mf a,92,v,12,v,208
 mf a,92,v,28,v,212
 s_waitcnt lgkmcnt(4)
 mf a,96,v,0,v,192
 tr v,208,131,16384
 mf a,96,v,16,v,196
 tr v,210,131,16896
 mf a,100,v,4,v,192
 buffer_load_dwordx4 v[112:115], v128, s[24:27], s48 offen offset:3072 sc1
 s_add_u32 s48, s48, 4096
 mf a,100,v,20,v,196
 mf a,104,v,8,v,192
 tr v,212,131,20480
 mf a,104,v,24,v,196
 tr v,214,131,20992
 mf a,108,v,12,v,192
 buffer_load_dwordx4 v[116:119], v128, s[24:27], s49 offen offset:3072 sc1
 s_add_u32 s49, s49, 4096
 mf a,108,v,28,v,196
 s_waitcnt lgkmcnt(4)
 mf a,112,v,0,v,200
 tr v,192,132,16384
 mf a,112,v,16,v,204
 tr v,194,132,16896
 mf a,116,v,4,v,200
 buffer_load_dwordx4 v[120:123], v128, s[24:27], s50 offen offset:3072 sc1
 s_add_u32 s50, s50, 4096
 mf a,116,v,20,v,204
 s_bitcmp1_b32 s45, 9
 s_cbranch_scc0 f_wC9
 buffer_load_dword v146, v216, s[32:35], 0 offen
 v_add_u32 v216, v218, v216
f_wC9:
 mf a,120,v,8,v,200
 tr v,196,132,20480
 mf a,120,v,24,v,204
 tr v,198,132,20992
 mf a,124,v,12,v,200
 buffer_load_dwordx4 v[124:127], v128, s[24:27], s51 offen offset:3072 sc1
 s_add_u32 s51, s51, 4096
 mf a,124,v,28,v,204
 s_waitcnt lgkmcnt(4)
 mf a,128,v,208,v,0
 tr v,200,133,16384
 mf a,128,v,212,v,16
 tr v,202,133,16896
 s_add_u32 m0, s52, 49152
 mf a,132,v,208,v,4
 buffer_load_dwordx4 v130, s[4:7], s46 offen lds
 mf a,132,v,212,v,20
 mf a,136,v,208,v,8
 tr v,204,133,20480
 mf a,136,v,212,v,24
 tr v,206,133,20992
 s_add_u32 m0, s52, 57344
 mf a,140,v,208,v,12
 buffer_load_dwordx4 v130, s[8:11], s46 offen lds
 mf a,140,v,212,v,28
 s_waitcnt lgkmcnt(4)
 mf a,144,v,192,v,0
 tr v,208,134,16384
 mf a,144,v,196,v,16
 tr v,210,134,16896
 s_add_u32 m0, s52, 65536
 mf a,148,v,192,v,4
 buffer_load_dwordx4 v130, s[12:15], s46 offen lds
 s_add_u32 s46, s46, 196608
 mf a,148,v,196,v,20
 mf a,152,v,192,v,8
 tr v,212,134,20480
 mf a,152,v,196,v,24
 tr v,214,134,20992
 s_add_u32 m0, s52, 53248
 mf a,156,v,192,v,12
 buffer_load_dwordx4 v130, s[4:7], s46 offen lds
 mf a,156,v,196,v,28
 s_waitcnt lgkmcnt(4)
 mf a,160,v,200,v,0
 mf a,160,v,204,v,16
 s_add_u32 m0, s52, 61440
 mf a,164,v,200,v,4
 buffer_load_dwordx4 v130, s[8:11], s46 offen lds
 mf a,164,v,204,v,20
 s_waitcnt vmcnt(33) lgkmcnt(0)
 s_barrier
 mf a,168,v,200,v,8
 tr v,192,135,0
 mf a,168,v,204,v,24
 tr v,194,135,512
 mf a,172,v,200,v,12
 tr v,196,135,4096
 mf a,172,v,204,v,28
 tr v,198,135,4608
 mf a,176,v,208,v,0
 tr v,200,136,0
 mf a,176,v,212,v,16
 tr v,202,136,512
 s_add_u32 m0, s52, 69632
 mf a,180,v,208,v,4
 buffer_load_dwordx4 v130, s[12:15], s46 offen lds
 s_add_u32 s46, s46, 196608
 mf a,180,v,212,v,20
 mf a,184,v,208,v,8
 tr v,204,136,4096
 mf a,184,v,212,v,24
 tr v,206,136,4608
 mf a,188,v,208,v,12
 mf a,188,v,212,v,28
 s_waitcnt lgkmcnt(4)
f_C5:
 s_mov_b32 s69, f_C8-f_base
 mf a,0,v,32,v,192
 tr v,208,137,0
 v_add_u32 v131, 0xfffe8000, v131
 mf a,0,v,48,v,196
 tr v,210,137,512
 mf a,4,v,36,v,192
 buffer_load_dword v146, v155, s[36:39], s69 offen
 mf a,4,v,52,v,196
 mf a,8,v,40,v,192
 tr v,212,137,4096
 v_add_u32 v132, 0xfffe8000, v132
 mf a,8,v,56,v,196
 tr v,214,137,4608
 mf a,12,v,44,v,192
 buffer_load_dwordx4 v[0:3], v128, s[24:27], s48 offen offset:0 sc1
 mf a,12,v,60,v,196
 s_waitcnt lgkmcnt(4)
 mf a,16,v,32,v,200
 tr v,192,138,0
 v_add_u32 v133, 0xfffe8000, v133
 mf a,16,v,48,v,204
 tr v,194,138,512
 mf a,20,v,36,v,200
 buffer_load_dwordx4 v[4:7], v128, s[24:27], s49 offen offset:0 sc1
 mf a,20,v,52,v,204
 s_bitcmp1_b32 s45, 10
 s_cbranch_scc0 f_wC10
 buffer_load_dword v146, v216, s[32:35], 0 offen
 v_add_u32 v216, v218, v216
f_wC10:
 mf a,24,v,40,v,200
 tr v,196,138,4096
 v_add_u32 v134, 0xfffe8000, v134
 mf a,24,v,56,v,204
 tr v,198,138,4608
 mf a,28,v,44,v,200
 buffer_load_dwordx4 v[8:11], v128, s[24:27], s50 offen offset:0 sc1
 mf a,28,v,60,v,204
 s_waitcnt lgkmcnt(4)
 mf a,32,v,32,v,208
 tr v,200,135,8192
 mf a,32,v,48,v,212
 tr v,202,135,8704
 mf a,36,v,36,v,208
 buffer_load_dwordx4 v[12:15], v128, s[24:27], s51 offen offset:0 sc1
 mf a,36,v,52,v,212
 mf a,40,v,40,v,208
 tr v,204,135,12288
 mf a,40,v,56,v,212
 tr v,206,135,12800
 mf a,44,v,44,v,208
 mf a,44,v,60,v,212
 s_waitcnt lgkmcnt(4)
 mf a,48,v,32,v,192
 tr v,208,136,8192
 mf a,48,v,48,v,196
 tr v,210,136,8704
 mf a,52,v,36,v,192
 buffer_load_dwordx4 v[16:19], v128, s[24:27], s48 offen offset:1024 sc1
 mf a,52,v,52,v,196
 mf a,56,v,40,v,192
 tr v,212,136,12288
 mf a,56,v,56,v,196
 tr v,214,136,12800
 mf a,60,v,44,v,192
 buffer_load_dwordx4 v[20:23], v128, s[24:27], s49 offen offset:1024 sc1
 mf a,60,v,60,v,196
 s_waitcnt lgkmcnt(4)
 mf a,64,v,32,v,200
 tr v,192,137,8192
 mf a,64,v,48,v,204
 tr v,194,137,8704
 mf a,68,v,36,v,200
 buffer_load_dwordx4 v[24:27], v128, s[24:27], s50 offen offset:1024 sc1
 mf a,68,v,52,v,204
 mf a,72,v,40,v,200
 tr v,196,137,12288
 mf a,72,v,56,v,204
 tr v,198,137,12800
 mf a,76,v,44,v,200
 buffer_load_dwordx4 v[28:31], v128, s[24:27], s51 offen offset:1024 sc1
 mf a,76,v,60,v,204
 s_waitcnt lgkmcnt(4)
 mf a,80,v,32,v,208
 tr v,200,138,8192
 mf a,80,v,48,v,212
 tr v,202,138,8704
 s_add_u32 m0, s52, 73728
 mf a,84,v,36,v,208
 buffer_load_dwordx4 v130, s[4:7], s46 offen lds
 mf a,84,v,52,v,212
 mf a,88,v,40,v,208
 tr v,204,138,12288
 mf a,88,v,56,v,212
 tr v,206,138,12800
 mf a,92,v,44,v,208
 mf a,92,v,60,v,212
 s_waitcnt lgkmcnt(4)
 mf a,96,v,32,v,192
 tr v,208,135,16384
 mf a,96,v,48,v,196
 tr v,210,135,16896
 s_add_u32 m0, s52, 81920
 mf a,100,v,36,v,192
 buffer_load_dwordx4 v130, s[8:11], s46 offen lds
 mf a,100,v,52,v,196
 mf a,104,v,40,v,192
 tr v,212,135,20480
 mf a,104,v,56,v,196
 tr v,214,135,20992
 s_add_u32 m0, s52, 90112
 mf a,108,v,44,v,192
 buffer_load_dwordx4 v130, s[12:15], s46 offen lds
 s_add_u32 s46, s46, 196608
 mf a,108,v,60,v,196
 s_waitcnt lgkmcnt(4)
 mf a,112,v,32,v,200
 tr v,192,136,16384
 mf a,112,v,48,v,204
 tr v,194,136,16896
 s_add_u32 m0, s52, 77824
 mf a,116,v,36,v,200
 buffer_load_dwordx4 v130, s[4:7], s46 offen lds
 mf a,116,v,52,v,204
 s_bitcmp1_b32 s45, 11
 s_cbranch_scc0 f_wC11
 buffer_load_dword v146, v216, s[32:35], 0 offen
 v_add_u32 v216, v218, v216
f_wC11:
 mf a,120,v,40,v,200
 tr v,196,136,20480
 mf a,120,v,56,v,204
 tr v,198,136,20992
 s_add_u32 m0, s52, 86016
 mf a,124,v,44,v,200
 buffer_load_dwordx4 v130, s[8:11], s46 offen lds
 mf a,124,v,60,v,204
 s_waitcnt lgkmcnt(4)
 mf a,128,v,208,v,32
 tr v,200,137,16384
 mf a,128,v,212,v,48
 tr v,202,137,16896
 s_add_u32 m0, s52, 94208
 mf a,132,v,208,v,36
 buffer_load_dwordx4 v130, s[12:15], s46 offen lds
 s_add_u32 s46, s46, 196608
 mf a,132,v,212,v,52
 mf a,136,v,208,v,40
 tr v,204,137,20480
 mf a,136,v,212,v,56
 tr v,206,137,20992
 s_add_u32 m0, s52, 98304
 mf a,140,v,208,v,44
 buffer_load_dwordx4 v130, s[4:7], s46 offen lds
 mf a,140,v,212,v,60
 s_waitcnt lgkmcnt(4)
 mf a,144,v,192,v,32
 tr v,208,138,16384
 mf a,144,v,196,v,48
 tr v,210,138,16896
 s_add_u32 m0, s52, 106496
 mf a,148,v,192,v,36
 buffer_load_dwordx4 v130, s[8:11], s46 offen lds
 mf a,148,v,196,v,52
 mf a,152,v,192,v,40
 tr v,212,138,20480
 mf a,152,v,196,v,56
 tr v,214,138,20992
 s_add_u32 m0, s52, 114688
 mf a,156,v,192,v,44
 buffer_load_dwordx4 v130, s[12:15], s46 offen lds
 s_add_u32 s46, s46, 196608
 mf a,156,v,196,v,60
 s_waitcnt lgkmcnt(4)
 mf a,160,v,200,v,32
 mf a,160,v,204,v,48
 s_add_u32 m0, s52, 102400
 mf a,164,v,200,v,36
 buffer_load_dwordx4 v130, s[4:7], s46 offen lds
 mf a,164,v,204,v,52
 s_waitcnt vmcnt(43) lgkmcnt(0)
 s_barrier
 mf a,168,v,200,v,40
 tr v,192,131,0
 mf a,168,v,204,v,56
 tr v,194,131,512
 mf a,172,v,200,v,44
 tr v,196,131,4096
 mf a,172,v,204,v,60
 tr v,198,131,4608
 mf a,176,v,208,v,32
 tr v,200,132,0
 mf a,176,v,212,v,48
 tr v,202,132,512
 s_add_u32 m0, s52, 110592
 mf a,180,v,208,v,36
 buffer_load_dwordx4 v130, s[8:11], s46 offen lds
 mf a,180,v,212,v,52
 mf a,184,v,208,v,40
 tr v,204,132,4096
 mf a,184,v,212,v,56
 tr v,206,132,4608
 mf a,188,v,208,v,44
 mf a,188,v,212,v,60
 s_waitcnt vmcnt(40) lgkmcnt(4)
f_C6:
 mf a,0,v,64,v,192
 tr v,208,133,0
 v_add_u32 v135, 0xfffe8000, v135
 mf a,0,v,80,v,196
 tr v,210,133,512
 mf a,4,v,68,v,192
 buffer_load_dwordx4 v[32:35], v128, s[24:27], s48 offen offset:2048 sc1
 mf a,4,v,84,v,196
 mf a,8,v,72,v,192
 tr v,212,133,4096
 v_add_u32 v136, 0xfffe8000, v136
 mf a,8,v,88,v,196
 tr v,214,133,4608
 mf a,12,v,76,v,192
 buffer_load_dwordx4 v[36:39], v128, s[24:27], s49 offen offset:2048 sc1
 mf a,12,v,92,v,196
 s_waitcnt lgkmcnt(4)
 mf a,16,v,64,v,200
 tr v,192,134,0
 v_add_u32 v137, 0xfffe8000, v137
 mf a,16,v,80,v,204
 tr v,194,134,512
 mf a,20,v,68,v,200
 buffer_load_dwordx4 v[40:43], v128, s[24:27], s50 offen offset:2048 sc1
 mf a,20,v,84,v,204
 s_bitcmp1_b32 s45, 12
 s_cbranch_scc0 f_wC12
 buffer_load_dword v146, v216, s[32:35], 0 offen
 v_add_u32 v216, v218, v216
f_wC12:
 mf a,24,v,72,v,200
 tr v,196,134,4096
 v_add_u32 v138, 0xfffe8000, v138
 mf a,24,v,88,v,204
 tr v,198,134,4608
 mf a,28,v,76,v,200
 buffer_load_dwordx4 v[44:47], v128, s[24:27], s51 offen offset:2048 sc1
 mf a,28,v,92,v,204
 s_waitcnt lgkmcnt(4)
 mf a,32,v,64,v,208
 tr v,200,131,8192
 mf a,32,v,80,v,212
 tr v,202,131,8704
 mf a,36,v,68,v,208
 buffer_load_dwordx4 v[48:51], v128, s[24:27], s48 offen offset:3072 sc1
 s_add_u32 s48, s48, 4096
 mf a,36,v,84,v,212
 mf a,40,v,72,v,208
 tr v,204,131,12288
 mf a,40,v,88,v,212
 tr v,206,131,12800
 mf a,44,v,76,v,208
 mf a,44,v,92,v,212
 s_waitcnt lgkmcnt(4)
 mf a,48,v,64,v,192
 tr v,208,132,8192
 mf a,48,v,80,v,196
 tr v,210,132,8704
 mf a,52,v,68,v,192
 buffer_load_dwordx4 v[52:55], v128, s[24:27], s49 offen offset:3072 sc1
 s_add_u32 s49, s49, 4096
 mf a,52,v,84,v,196
 s_bitcmp1_b32 s45, 16
 s_cbranch_scc0 f_wC16
 buffer_load_dword v146, v217, s[28:31], 0 offen
f_wC16:
 mf a,56,v,72,v,192
 tr v,212,132,12288
 mf a,56,v,88,v,196
 tr v,214,132,12800
 mf a,60,v,76,v,192
 buffer_load_dwordx4 v[56:59], v128, s[24:27], s50 offen offset:3072 sc1
 s_add_u32 s50, s50, 4096
 mf a,60,v,92,v,196
 s_waitcnt lgkmcnt(4)
 mf a,64,v,64,v,200
 tr v,192,133,8192
 mf a,64,v,80,v,204
 tr v,194,133,8704
 mf a,68,v,68,v,200
 buffer_load_dwordx4 v[60:63], v128, s[24:27], s51 offen offset:3072 sc1
 s_add_u32 s51, s51, 4096
 mf a,68,v,84,v,204
 mf a,72,v,72,v,200
 tr v,196,133,12288
 mf a,72,v,88,v,204
 tr v,198,133,12800
 s_add_u32 m0, s52, 118784
 mf a,76,v,76,v,200
 buffer_load_dwordx4 v130, s[12:15], s46 offen lds
 s_add_u32 s46, s46, 196608
 mf a,76,v,92,v,204
 s_waitcnt lgkmcnt(4)
 mf a,80,v,64,v,208
 tr v,200,134,8192
 mf a,80,v,80,v,212
 tr v,202,134,8704
 s_add_u32 m0, s52, 122880
 mf a,84,v,68,v,208
 buffer_load_dwordx4 v130, s[4:7], s46 offen lds
 mf a,84,v,84,v,212
 mf a,88,v,72,v,208
 tr v,204,134,12288
 mf a,88,v,88,v,212
 tr v,206,134,12800
 mf a,92,v,76,v,208
 mf a,92,v,92,v,212
 s_waitcnt lgkmcnt(4)
 mf a,96,v,64,v,192
 tr v,208,131,16384
 mf a,96,v,80,v,196
 tr v,210,131,16896
 s_add_u32 m0, s52, 131072
 mf a,100,v,68,v,192
 buffer_load_dwordx4 v130, s[8:11], s46 offen lds
 mf a,100,v,84,v,196
 mf a,104,v,72,v,192
 tr v,212,131,20480
 mf a,104,v,88,v,196
 tr v,214,131,20992
 mf a,108,v,76,v,192
 mf a,108,v,92,v,196
 s_waitcnt lgkmcnt(4)
 mf a,112,v,64,v,200
 tr v,192,132,16384
 mf a,112,v,80,v,204
 tr v,194,132,16896
 s_add_u32 m0, s52, 139264
 mf a,116,v,68,v,200
 buffer_load_dwordx4 v130, s[12:15], s46 offen lds
 s_add_u32 s46, s46, 196608
 mf a,116,v,84,v,204
 s_bitcmp1_b32 s45, 13
 s_cbranch_scc0 f_wC13
 buffer_load_dword v146, v216, s[32:35], 0 offen
 v_add_u32 v216, v218, v216
f_wC13:
 mf a,120,v,72,v,200
 tr v,196,132,20480
 mf a,120,v,88,v,204
 tr v,198,132,20992
 mf a,124,v,76,v,200
 mf a,124,v,92,v,204
 s_waitcnt lgkmcnt(4)
 mf a,128,v,208,v,64
 tr v,200,133,16384
 mf a,128,v,212,v,80
 tr v,202,133,16896
 s_add_u32 m0, s52, 126976
 mf a,132,v,208,v,68
 buffer_load_dwordx4 v130, s[4:7], s46 offen lds
 mf a,132,v,212,v,84
 mf a,136,v,208,v,72
 tr v,204,133,20480
 mf a,136,v,212,v,88
 tr v,206,133,20992
 mf a,140,v,208,v,76
 mf a,140,v,212,v,92
 s_waitcnt lgkmcnt(4)
 mf a,144,v,192,v,64
 tr v,208,134,16384
 mf a,144,v,196,v,80
 tr v,210,134,16896
 s_add_u32 m0, s52, 135168
 mf a,148,v,192,v,68
 buffer_load_dwordx4 v130, s[8:11], s46 offen lds
 mf a,148,v,196,v,84
 mf a,152,v,192,v,72
 tr v,212,134,20480
 mf a,152,v,196,v,88
 tr v,214,134,20992
 mf a,156,v,192,v,76
 mf a,156,v,196,v,92
 s_waitcnt lgkmcnt(4)
 mf a,160,v,200,v,64
 mf a,160,v,204,v,80
 s_add_u32 m0, s52, 143360
 mf a,164,v,200,v,68
 buffer_load_dwordx4 v130, s[12:15], s46 offen lds
 s_add_u32 s46, s46, 196608
 mf a,164,v,204,v,84
 s_waitcnt vmcnt(49) lgkmcnt(0)
 s_barrier
 mf a,168,v,200,v,72
 tr v,192,135,0
 mf a,168,v,204,v,88
 tr v,194,135,512
 mf a,172,v,200,v,76
 tr v,196,135,4096
 mf a,172,v,204,v,92
 tr v,198,135,4608
 mf a,176,v,208,v,64
 tr v,200,136,0
 mf a,176,v,212,v,80
 tr v,202,136,512
 mf a,180,v,208,v,68
 mf a,180,v,212,v,84
 mf a,184,v,208,v,72
 tr v,204,136,4096
 mf a,184,v,212,v,88
 tr v,206,136,4608
 mf a,188,v,208,v,76
 mf a,188,v,212,v,92
 s_waitcnt vmcnt(41) lgkmcnt(4)
f_C7:
 mf a,0,v,96,v,192
 tr v,208,137,0
 v_add_u32 v131, 0xc000, v131
 mf a,0,v,112,v,196
 tr v,210,137,512
 mf a,4,v,100,v,192
 buffer_load_dwordx4 v[64:67], v128, s[24:27], s48 offen offset:0 sc1
 mf a,4,v,116,v,196
 mf a,8,v,104,v,192
 tr v,212,137,4096
 v_add_u32 v132, 0xc000, v132
 mf a,8,v,120,v,196
 tr v,214,137,4608
 mf a,12,v,108,v,192
 buffer_load_dwordx4 v[68:71], v128, s[24:27], s49 offen offset:0 sc1
 mf a,12,v,124,v,196
 s_waitcnt lgkmcnt(4)
 mf a,16,v,96,v,200
 tr v,192,138,0
 v_add_u32 v133, 0xc000, v133
 mf a,16,v,112,v,204
 tr v,194,138,512
 mf a,20,v,100,v,200
 buffer_load_dwordx4 v[72:75], v128, s[24:27], s50 offen offset:0 sc1
 mf a,20,v,116,v,204
 mf a,24,v,104,v,200
 tr v,196,138,4096
 v_add_u32 v134, 0xc000, v134
 mf a,24,v,120,v,204
 tr v,198,138,4608
 mf a,28,v,108,v,200
 buffer_load_dwordx4 v[76:79], v128, s[24:27], s51 offen offset:0 sc1
 mf a,28,v,124,v,204
 s_waitcnt lgkmcnt(4)
 mf a,32,v,96,v,208
 tr v,200,135,8192
 mf a,32,v,112,v,212
 tr v,202,135,8704
 mf a,36,v,100,v,208
 buffer_load_dwordx4 v[80:83], v128, s[24:27], s48 offen offset:1024 sc1
 mf a,36,v,116,v,212
 mf a,40,v,104,v,208
 tr v,204,135,12288
 mf a,40,v,120,v,212
 tr v,206,135,12800
 mf a,44,v,108,v,208
 mf a,44,v,124,v,212
 s_waitcnt lgkmcnt(4)
 mf a,48,v,96,v,192
 tr v,208,136,8192
 mf a,48,v,112,v,196
 tr v,210,136,8704
 mf a,52,v,100,v,192
 buffer_load_dwordx4 v[84:87], v128, s[24:27], s49 offen offset:1024 sc1
 mf a,52,v,116,v,196
 s_bitcmp1_b32 s45, 17
 s_cbranch_scc0 f_wC17
 buffer_load_dword v146, v217, s[28:31], 0 offen
f_wC17:
 mf a,56,v,104,v,192
 tr v,212,136,12288
 mf a,56,v,120,v,196
 tr v,214,136,12800
 mf a,60,v,108,v,192
 buffer_load_dwordx4 v[88:91], v128, s[24:27], s50 offen offset:1024 sc1
 mf a,60,v,124,v,196
 s_waitcnt lgkmcnt(4)
 mf a,64,v,96,v,200
 tr v,192,137,8192
 mf a,64,v,112,v,204
 tr v,194,137,8704
 mf a,68,v,100,v,200
 buffer_load_dwordx4 v[92:95], v128, s[24:27], s51 offen offset:1024 sc1
 mf a,68,v,116,v,204
 mf a,72,v,104,v,200
 tr v,196,137,12288
 mf a,72,v,120,v,204
 tr v,198,137,12800
 s_add_u32 m0, s52, 0
 mf a,76,v,108,v,200
 buffer_load_dwordx4 v130, s[4:7], s46 offen lds
 mf a,76,v,124,v,204
 s_waitcnt lgkmcnt(4)
 mf a,80,v,96,v,208
 tr v,200,138,8192
 mf a,80,v,112,v,212
 tr v,202,138,8704
 s_add_u32 m0, s52, 8192
 mf a,84,v,100,v,208
 buffer_load_dwordx4 v130, s[8:11], s46 offen lds
 mf a,84,v,116,v,212
 mf a,88,v,104,v,208
 tr v,204,138,12288
 mf a,88,v,120,v,212
 tr v,206,138,12800
 mf a,92,v,108,v,208
 mf a,92,v,124,v,212
 s_waitcnt lgkmcnt(4)
 mf a,96,v,96,v,192
 tr v,208,135,16384
 mf a,96,v,112,v,196
 tr v,210,135,16896
 s_add_u32 m0, s52, 16384
 mf a,100,v,100,v,192
 buffer_load_dwordx4 v130, s[12:15], s46 offen lds
 s_add_u32 s46, s46, 196608
 mf a,100,v,116,v,196
 mf a,104,v,104,v,192
 tr v,212,135,20480
 mf a,104,v,120,v,196
 tr v,214,135,20992
 mf a,108,v,108,v,192
 mf a,108,v,124,v,196
 s_waitcnt lgkmcnt(4)
 mf a,112,v,96,v,200
 tr v,192,136,16384
 mf a,112,v,112,v,204
 tr v,194,136,16896
 s_add_u32 m0, s52, 4096
 mf a,116,v,100,v,200
 buffer_load_dwordx4 v130, s[4:7], s46 offen lds
 mf a,116,v,116,v,204
 mf a,120,v,104,v,200
 tr v,196,136,20480
 mf a,120,v,120,v,204
 tr v,198,136,20992
 mf a,124,v,108,v,200
 mf a,124,v,124,v,204
 s_waitcnt lgkmcnt(4)
 mf a,128,v,208,v,96
 tr v,200,137,16384
 mf a,128,v,212,v,112
 tr v,202,137,16896
 mf a,132,v,208,v,100
 mf a,132,v,212,v,116
 mf a,136,v,208,v,104
 tr v,204,137,20480
 mf a,136,v,212,v,120
 tr v,206,137,20992
 s_add_u32 m0, s52, 12288
 mf a,140,v,208,v,108
 buffer_load_dwordx4 v130, s[8:11], s46 offen lds
 mf a,140,v,212,v,124
 s_waitcnt lgkmcnt(4)
 mf a,144,v,192,v,96
 tr v,208,138,16384
 mf a,144,v,196,v,112
 tr v,210,138,16896
 mf a,148,v,192,v,100
 mf a,148,v,196,v,116
 mf a,152,v,192,v,104
 tr v,212,138,20480
 mf a,152,v,196,v,120
 tr v,214,138,20992
 mf a,156,v,192,v,108
 mf a,156,v,196,v,124
 s_waitcnt lgkmcnt(4)
 mf a,160,v,200,v,96
 mf a,160,v,204,v,112
 s_add_u32 m0, s52, 20480
 mf a,164,v,200,v,100
 buffer_load_dwordx4 v130, s[12:15], s46 offen lds
 s_add_u32 s46, s46, 196608
 mf a,164,v,204,v,116
 s_waitcnt vmcnt(49) lgkmcnt(0)
 s_barrier
 mf a,168,v,200,v,104
 tr v,192,131,0
 mf a,168,v,204,v,120
 tr v,194,131,512
 mf a,172,v,200,v,108
 tr v,196,131,4096
 mf a,172,v,204,v,124
 tr v,198,131,4608
 mf a,176,v,208,v,96
 tr v,200,132,0
 mf a,176,v,212,v,112
 tr v,202,132,512
 mf a,180,v,208,v,100
 mf a,180,v,212,v,116
 mf a,184,v,208,v,104
 tr v,204,132,4096
 mf a,184,v,212,v,120
 tr v,206,132,4608
 mf a,188,v,208,v,108
 mf a,188,v,212,v,124
 s_waitcnt vmcnt(40) lgkmcnt(4)
f_C8:
 mf a,0,v,0,v,192
 tr v,208,133,0
 v_add_u32 v135, 0xc000, v135
 mf a,0,v,16,v,196
 tr v,210,133,512
 mf a,4,v,4,v,192
 buffer_load_dwordx4 v[96:99], v128, s[24:27], s48 offen offset:2048 sc1
 mf a,4,v,20,v,196
 mf a,8,v,8,v,192
 tr v,212,133,4096
 v_add_u32 v136, 0xc000, v136
 mf a,8,v,24,v,196
 tr v,214,133,4608
 mf a,12,v,12,v,192
 buffer_load_dwordx4 v[100:103], v128, s[24:27], s49 offen offset:2048 sc1
 mf a,12,v,28,v,196
 s_waitcnt lgkmcnt(4)
 mf a,16,v,0,v,200
 tr v,192,134,0
 v_add_u32 v137, 0xc000, v137
 mf a,16,v,16,v,204
 tr v,194,134,512
 mf a,20,v,4,v,200
 buffer_load_dwordx4 v[104:107], v128, s[24:27], s50 offen offset:2048 sc1
 mf a,20,v,20,v,204
 mf a,24,v,8,v,200
 tr v,196,134,4096
 v_add_u32 v138, 0xc000, v138
 mf a,24,v,24,v,204
 tr v,198,134,4608
 mf a,28,v,12,v,200
 buffer_load_dwordx4 v[108:111], v128, s[24:27], s51 offen offset:2048 sc1
 mf a,28,v,28,v,204
 s_waitcnt lgkmcnt(4)
 mf a,32,v,0,v,208
 tr v,200,131,8192
 mf a,32,v,16,v,212
 tr v,202,131,8704
 mf a,36,v,4,v,208
 buffer_load_dwordx4 v[112:115], v128, s[24:27], s48 offen offset:3072 sc1
 s_add_u32 s48, s48, 4096
 mf a,36,v,20,v,212
 mf a,40,v,8,v,208
 tr v,204,131,12288
 mf a,40,v,24,v,212
 tr v,206,131,12800
 mf a,44,v,12,v,208
 mf a,44,v,28,v,212
 s_waitcnt lgkmcnt(4)
 mf a,48,v,0,v,192
 tr v,208,132,8192
 mf a,48,v,16,v,196
 tr v,210,132,8704
 mf a,52,v,4,v,192
 buffer_load_dwordx4 v[116:119], v128, s[24:27], s49 offen offset:3072 sc1
 s_add_u32 s49, s49, 4096
 mf a,52,v,20,v,196
 s_bitcmp1_b32 s45, 18
 s_cbranch_scc0 f_wC18
 buffer_load_dword v146, v217, s[28:31], 0 offen
f_wC18:
 mf a,56,v,8,v,192
 tr v,212,132,12288
 mf a,56,v,24,v,196
 tr v,214,132,12800
 mf a,60,v,12,v,192
 buffer_load_dwordx4 v[120:123], v128, s[24:27], s50 offen offset:3072 sc1
 s_add_u32 s50, s50, 4096
 mf a,60,v,28,v,196
 s_waitcnt lgkmcnt(4)
 mf a,64,v,0,v,200
 tr v,192,133,8192
 mf a,64,v,16,v,204
 tr v,194,133,8704
 mf a,68,v,4,v,200
 buffer_load_dwordx4 v[124:127], v128, s[24:27], s51 offen offset:3072 sc1
 s_add_u32 s51, s51, 4096
 mf a,68,v,20,v,204
 mf a,72,v,8,v,200
 tr v,196,133,12288
 mf a,72,v,24,v,204
 tr v,198,133,12800
 s_add_u32 m0, s52, 24576
 mf a,76,v,12,v,200
 buffer_load_dwordx4 v130, s[4:7], s46 offen lds
 mf a,76,v,28,v,204
 s_waitcnt lgkmcnt(4)
 mf a,80,v,0,v,208
 tr v,200,134,8192
 mf a,80,v,16,v,212
 tr v,202,134,8704
 s_add_u32 m0, s52, 32768
 mf a,84,v,4,v,208
 buffer_load_dwordx4 v130, s[8:11], s46 offen lds
 mf a,84,v,20,v,212
 mf a,88,v,8,v,208
 tr v,204,134,12288
 mf a,88,v,24,v,212
 tr v,206,134,12800
 mf a,92,v,12,v,208
 mf a,92,v,28,v,212
 s_waitcnt lgkmcnt(4)
 mf a,96,v,0,v,192
 tr v,208,131,16384
 mf a,96,v,16,v,196
 tr v,210,131,16896
 s_add_u32 m0, s52, 40960
 mf a,100,v,4,v,192
 buffer_load_dwordx4 v130, s[12:15], s46 offen lds
 s_add_u32 s46, s46, 196608
 mf a,100,v,20,v,196
 mf a,104,v,8,v,192
 tr v,212,131,20480
 mf a,104,v,24,v,196
 tr v,214,131,20992
 mf a,108,v,12,v,192
 mf a,108,v,28,v,196
 s_waitcnt lgkmcnt(4)
 mf a,112,v,0,v,200
 tr v,192,132,16384
 mf a,112,v,16,v,204
 tr v,194,132,16896
 s_add_u32 m0, s52, 28672
 mf a,116,v,4,v,200
 buffer_load_dwordx4 v130, s[4:7], s46 offen lds
 mf a,116,v,20,v,204
 mf a,120,v,8,v,200
 tr v,196,132,20480
 mf a,120,v,24,v,204
 tr v,198,132,20992
 mf a,124,v,12,v,200
 mf a,124,v,28,v,204
 s_waitcnt lgkmcnt(4)
 mf a,128,v,208,v,0
 tr v,200,133,16384
 mf a,128,v,212,v,16
 tr v,202,133,16896
 mf a,132,v,208,v,4
 mf a,132,v,212,v,20
 mf a,136,v,208,v,8
 tr v,204,133,20480
 mf a,136,v,212,v,24
 tr v,206,133,20992
 s_add_u32 m0, s52, 36864
 mf a,140,v,208,v,12
 buffer_load_dwordx4 v130, s[8:11], s46 offen lds
 mf a,140,v,212,v,28
 s_waitcnt lgkmcnt(4)
 mf a,144,v,192,v,0
 tr v,208,134,16384
 mf a,144,v,196,v,16
 tr v,210,134,16896
 mf a,148,v,192,v,4
 mf a,148,v,196,v,20
 mf a,152,v,192,v,8
 tr v,212,134,20480
 mf a,152,v,196,v,24
 tr v,214,134,20992
 mf a,156,v,192,v,12
 mf a,156,v,196,v,28
 s_waitcnt lgkmcnt(4)
 mf a,160,v,200,v,0
 mf a,160,v,204,v,16
 s_add_u32 m0, s52, 45056
 mf a,164,v,200,v,4
 buffer_load_dwordx4 v130, s[12:15], s46 offen lds
 s_add_u32 s46, s46, 196608
 mf a,164,v,204,v,20
 s_waitcnt vmcnt(48) lgkmcnt(0)
 s_barrier
 mf a,168,v,200,v,8
 tr v,192,135,0
 mf a,168,v,204,v,24
 tr v,194,135,512
 mf a,172,v,200,v,12
 tr v,196,135,4096
 mf a,172,v,204,v,28
 tr v,198,135,4608
 mf a,176,v,208,v,0
 tr v,200,136,0
 mf a,176,v,212,v,16
 tr v,202,136,512
 mf a,180,v,208,v,4
 mf a,180,v,212,v,20
 mf a,184,v,208,v,8
 tr v,204,136,4096
 mf a,184,v,212,v,24
 tr v,206,136,4608
 mf a,188,v,208,v,12
 mf a,188,v,212,v,28
 s_waitcnt vmcnt(35) lgkmcnt(4)
f_C9:
 s_mov_b32 s69, f_C12-f_base
 mf a,0,v,32,v,192
 tr v,208,137,0
 v_add_u32 v131, 0xc000, v131
 mf a,0,v,48,v,196
 tr v,210,137,512
 mf a,4,v,36,v,192
 buffer_load_dword v146, v155, s[36:39], s69 offen
 mf a,4,v,52,v,196
 mf a,8,v,40,v,192
 tr v,212,137,4096
 v_add_u32 v132, 0xc000, v132
 mf a,8,v,56,v,196
 tr v,214,137,4608
 mf a,12,v,44,v,192
 buffer_load_dwordx4 v[0:3], v128, s[24:27], s48 offen offset:0 sc1
 mf a,12,v,60,v,196
 s_waitcnt lgkmcnt(4)
 mf a,16,v,32,v,200
 tr v,192,138,0
 v_add_u32 v133, 0xc000, v133
 mf a,16,v,48,v,204
 tr v,194,138,512
 mf a,20,v,36,v,200
 buffer_load_dwordx4 v[4:7], v128, s[24:27], s49 offen offset:0 sc1
 mf a,20,v,52,v,204
 mf a,24,v,40,v,200
 tr v,196,138,4096
 v_add_u32 v134, 0xc000, v134
 mf a,24,v,56,v,204
 tr v,198,138,4608
 mf a,28,v,44,v,200
 buffer_load_dwordx4 v[8:11], v128, s[24:27], s50 offen offset:0 sc1
 mf a,28,v,60,v,204
 s_waitcnt lgkmcnt(4)
 mf a,32,v,32,v,208
 tr v,200,135,8192
 mf a,32,v,48,v,212
 tr v,202,135,8704
 mf a,36,v,36,v,208
 buffer_load_dwordx4 v[12:15], v128, s[24:27], s51 offen offset:0 sc1
 mf a,36,v,52,v,212
 mf a,40,v,40,v,208
 tr v,204,135,12288
 mf a,40,v,56,v,212
 tr v,206,135,12800
 mf a,44,v,44,v,208
 mf a,44,v,60,v,212
 s_waitcnt lgkmcnt(4)
 mf a,48,v,32,v,192
 tr v,208,136,8192
 mf a,48,v,48,v,196
 tr v,210,136,8704
 mf a,52,v,36,v,192
 buffer_load_dwordx4 a[192:195], v128, s[24:27], s48 offen offset:1024 sc1
 mf a,52,v,52,v,196
 s_bitcmp1_b32 s45, 19
 s_cbranch_scc0 f_wC19
 buffer_load_dword v146, v217, s[28:31], 0 offen
f_wC19:
 mf a,56,v,40,v,192
 tr v,212,136,12288
 mf a,56,v,56,v,196
 tr v,214,136,12800
 mf a,60,v,44,v,192
 buffer_load_dwordx4 a[196:199], v128, s[24:27], s49 offen offset:1024 sc1
 mf a,60,v,60,v,196
 s_waitcnt lgkmcnt(4)
 mf a,64,v,32,v,200
 tr v,192,137,8192
 mf a,64,v,48,v,204
 tr v,194,137,8704
 mf a,68,v,36,v,200
 buffer_load_dwordx4 a[200:203], v128, s[24:27], s50 offen offset:1024 sc1
 mf a,68,v,52,v,204
 mf a,72,v,40,v,200
 tr v,196,137,12288
 mf a,72,v,56,v,204
 tr v,198,137,12800
 mf a,76,v,44,v,200
 buffer_load_dwordx4 a[204:207], v128, s[24:27], s51 offen offset:1024 sc1
 mf a,76,v,60,v,204
 s_waitcnt lgkmcnt(4)
 mf a,80,v,32,v,208
 tr v,200,138,8192
 mf a,80,v,48,v,212
 tr v,202,138,8704
 s_add_u32 m0, s52, 49152
 mf a,84,v,36,v,208
 buffer_load_dwordx4 v130, s[4:7], s46 offen lds
 mf a,84,v,52,v,212
 mf a,88,v,40,v,208
 tr v,204,138,12288
 mf a,88,v,56,v,212
 tr v,206,138,12800
 mf a,92,v,44,v,208
 mf a,92,v,60,v,212
 s_waitcnt lgkmcnt(4)
 mf a,96,v,32,v,192
 tr v,208,135,16384
 mf a,96,v,48,v,196
 tr v,210,135,16896
 s_add_u32 m0, s52, 57344
 mf a,100,v,36,v,192
 buffer_load_dwordx4 v130, s[8:11], s46 offen lds
 mf a,100,v,52,v,196
 mf a,104,v,40,v,192
 tr v,212,135,20480
 mf a,104,v,56,v,196
 tr v,214,135,20992
 mf a,108,v,44,v,192
 mf a,108,v,60,v,196
 s_waitcnt lgkmcnt(4)
 mf a,112,v,32,v,200
 tr v,192,136,16384
 mf a,112,v,48,v,204
 tr v,194,136,16896
 s_add_u32 m0, s52, 65536
 mf a,116,v,36,v,200
 buffer_load_dwordx4 v130, s[12:15], s46 offen lds
 s_add_u32 s46, s46, 196608
 mf a,116,v,52,v,204
 mf a,120,v,40,v,200
 tr v,196,136,20480
 mf a,120,v,56,v,204
 tr v,198,136,20992
 mf a,124,v,44,v,200
 mf a,124,v,60,v,204
 s_waitcnt lgkmcnt(4)
 mf a,128,v,208,v,32
 tr v,200,137,16384
 mf a,128,v,212,v,48
 tr v,202,137,16896
 s_add_u32 m0, s52, 53248
 mf a,132,v,208,v,36
 buffer_load_dwordx4 v130, s[4:7], s46 offen lds
 mf a,132,v,212,v,52
 mf a,136,v,208,v,40
 tr v,204,137,20480
 mf a,136,v,212,v,56
 tr v,206,137,20992
 mf a,140,v,208,v,44
 mf a,140,v,212,v,60
 s_waitcnt lgkmcnt(4)
 mf a,144,v,192,v,32
 tr v,208,138,16384
 mf a,144,v,196,v,48
 tr v,210,138,16896
 s_add_u32 m0, s52, 61440
 mf a,148,v,192,v,36
 buffer_load_dwordx4 v130, s[8:11], s46 offen lds
 mf a,148,v,196,v,52
 mf a,152,v,192,v,40
 tr v,212,138,20480
 mf a,152,v,196,v,56
 tr v,214,138,20992
 mf a,156,v,192,v,44
 mf a,156,v,196,v,60
 s_waitcnt lgkmcnt(4)
 mf a,160,v,200,v,32
 mf a,160,v,204,v,48
 s_add_u32 m0, s52, 69632
 mf a,164,v,200,v,36
 buffer_load_dwordx4 v130, s[12:15], s46 offen lds
 s_add_u32 s46, s46, 196608
 mf a,164,v,204,v,52
 s_waitcnt vmcnt(49) lgkmcnt(0)
 s_barrier
 mf a,168,v,200,v,40
 tr v,192,131,0
 mf a,168,v,204,v,56
 tr v,194,131,512
 mf a,172,v,200,v,44
 tr v,196,131,4096
 mf a,172,v,204,v,60
 tr v,198,131,4608
 mf a,176,v,208,v,32
 tr v,200,132,0
 mf a,176,v,212,v,48
 tr v,202,132,512
 mf a,180,v,208,v,36
 mf a,180,v,212,v,52
 mf a,184,v,208,v,40
 tr v,204,132,4096
 mf a,184,v,212,v,56
 tr v,206,132,4608
 mf a,188,v,208,v,44
 mf a,188,v,212,v,60
 s_waitcnt vmcnt(35) lgkmcnt(4)
f_C10:
 mf a,0,v,64,v,192
 tr v,208,133,0
 v_add_u32 v135, 0xc000, v135
 mf a,0,v,80,v,196
 tr v,210,133,512
 mf a,4,v,68,v,192
 buffer_load_dwordx4 a[208:211], v128, s[24:27], s48 offen offset:2048 sc1
 mf a,4,v,84,v,196
 mf a,8,v,72,v,192
 tr v,212,133,4096
 v_add_u32 v136, 0xc000, v136
 mf a,8,v,88,v,196
 tr v,214,133,4608
 mf a,12,v,76,v,192
 buffer_load_dwordx4 a[212:215], v128, s[24:27], s49 offen offset:2048 sc1
 mf a,12,v,92,v,196
 s_waitcnt lgkmcnt(4)
 mf a,16,v,64,v,200
 tr v,192,134,0
 v_add_u32 v137, 0xc000, v137
 mf a,16,v,80,v,204
 tr v,194,134,512
 mf a,20,v,68,v,200
 buffer_load_dwordx4 a[216:219], v128, s[24:27], s50 offen offset:2048 sc1
 mf a,20,v,84,v,204
 mf a,24,v,72,v,200
 tr v,196,134,4096
 v_add_u32 v138, 0xc000, v138
 mf a,24,v,88,v,204
 tr v,198,134,4608
 mf a,28,v,76,v,200
 buffer_load_dwordx4 a[220:223], v128, s[24:27], s51 offen offset:2048 sc1
 mf a,28,v,92,v,204
 s_waitcnt lgkmcnt(4)
 mf a,32,v,64,v,208
 tr v,200,131,8192
 mf a,32,v,80,v,212
 tr v,202,131,8704
 mf a,36,v,68,v,208
 buffer_load_dwordx4 a[224:227], v128, s[24:27], s48 offen offset:3072 sc1
 s_add_u32 s48, s48, 4096
 mf a,36,v,84,v,212
 mf a,40,v,72,v,208
 tr v,204,131,12288
 mf a,40,v,88,v,212
 tr v,206,131,12800
 mf a,44,v,76,v,208
 mf a,44,v,92,v,212
 s_waitcnt lgkmcnt(4)
 mf a,48,v,64,v,192
 tr v,208,132,8192
 mf a,48,v,80,v,196
 tr v,210,132,8704
 mf a,52,v,68,v,192
 buffer_load_dwordx4 a[228:231], v128, s[24:27], s49 offen offset:3072 sc1
 s_add_u32 s49, s49, 4096
 mf a,52,v,84,v,196
 s_bitcmp1_b32 s45, 20
 s_cbranch_scc0 f_wC20
 buffer_load_dword v146, v217, s[28:31], 0 offen
f_wC20:
 mf a,56,v,72,v,192
 tr v,212,132,12288
 mf a,56,v,88,v,196
 tr v,214,132,12800
 mf a,60,v,76,v,192
 buffer_load_dwordx4 a[232:235], v128, s[24:27], s50 offen offset:3072 sc1
 s_add_u32 s50, s50, 4096
 mf a,60,v,92,v,196
 s_waitcnt lgkmcnt(4)
 mf a,64,v,64,v,200
 tr v,192,133,8192
 mf a,64,v,80,v,204
 tr v,194,133,8704
 mf a,68,v,68,v,200
 buffer_load_dwordx4 a[236:239], v128, s[24:27], s51 offen offset:3072 sc1
 s_add_u32 s51, s51, 4096
 mf a,68,v,84,v,204
 mf a,72,v,72,v,200
 tr v,196,133,12288
 mf a,72,v,88,v,204
 tr v,198,133,12800
 s_add_u32 m0, s52, 73728
 mf a,76,v,76,v,200
 buffer_load_dwordx4 v130, s[4:7], s46 offen lds
 mf a,76,v,92,v,204
 s_waitcnt lgkmcnt(4)
 mf a,80,v,64,v,208
 tr v,200,134,8192
 mf a,80,v,80,v,212
 tr v,202,134,8704
 s_add_u32 m0, s52, 81920
 mf a,84,v,68,v,208
 buffer_load_dwordx4 v130, s[8:11], s46 offen lds
 mf a,84,v,84,v,212
 mf a,88,v,72,v,208
 tr v,204,134,12288
 mf a,88,v,88,v,212
 tr v,206,134,12800
 mf a,92,v,76,v,208
 mf a,92,v,92,v,212
 s_waitcnt lgkmcnt(4)
 mf a,96,v,64,v,192
 tr v,208,131,16384
 mf a,96,v,80,v,196
 tr v,210,131,16896
 s_add_u32 m0, s52, 90112
 mf a,100,v,68,v,192
 buffer_load_dwordx4 v130, s[12:15], s46 offen lds
 s_add_u32 s46, s46, 196608
 mf a,100,v,84,v,196
 mf a,104,v,72,v,192
 tr v,212,131,20480
 mf a,104,v,88,v,196
 tr v,214,131,20992
 mf a,108,v,76,v,192
 mf a,108,v,92,v,196
 s_waitcnt lgkmcnt(4)
 mf a,112,v,64,v,200
 tr v,192,132,16384
 mf a,112,v,80,v,204
 tr v,194,132,16896
 s_add_u32 m0, s52, 77824
 mf a,116,v,68,v,200
 buffer_load_dwordx4 v130, s[4:7], s46 offen lds
 mf a,116,v,84,v,204
 mf a,120,v,72,v,200
 tr v,196,132,20480
 mf a,120,v,88,v,204
 tr v,198,132,20992
 mf a,124,v,76,v,200
 mf a,124,v,92,v,204
 s_waitcnt lgkmcnt(4)
 mf a,128,v,208,v,64
 tr v,200,133,16384
 mf a,128,v,212,v,80
 tr v,202,133,16896
 mf a,132,v,208,v,68
 mf a,132,v,212,v,84
 mf a,136,v,208,v,72
 tr v,204,133,20480
 mf a,136,v,212,v,88
 tr v,206,133,20992
 s_add_u32 m0, s52, 86016
 mf a,140,v,208,v,76
 buffer_load_dwordx4 v130, s[8:11], s46 offen lds
 mf a,140,v,212,v,92
 s_waitcnt lgkmcnt(4)
 mf a,144,v,192,v,64
 tr v,208,134,16384
 mf a,144,v,196,v,80
 tr v,210,134,16896
 mf a,148,v,192,v,68
 mf a,148,v,196,v,84
 mf a,152,v,192,v,72
 tr v,212,134,20480
 mf a,152,v,196,v,88
 tr v,214,134,20992
 mf a,156,v,192,v,76
 mf a,156,v,196,v,92
 s_waitcnt lgkmcnt(4)
 mf a,160,v,200,v,64
 mf a,160,v,204,v,80
 s_add_u32 m0, s52, 94208
 mf a,164,v,200,v,68
 buffer_load_dwordx4 v130, s[12:15], s46 offen lds
 s_mov_b32 s44, 7110656
 mf a,164,v,204,v,84
 s_waitcnt lgkmcnt(0)
 s_barrier
 mf a,168,v,200,v,72
 tr v,192,135,0
 mf a,168,v,204,v,88
 tr v,194,135,512
 mf a,172,v,200,v,76
 tr v,196,135,4096
 mf a,172,v,204,v,92
 tr v,198,135,4608
 mf a,176,v,208,v,64
 tr v,200,136,0
 mf a,176,v,212,v,80
 tr v,202,136,512
 mf a,180,v,208,v,68
 mf a,180,v,212,v,84
 mf a,184,v,208,v,72
 tr v,204,136,4096
 mf a,184,v,212,v,88
 tr v,206,136,4608
 mf a,188,v,208,v,76
 mf a,188,v,212,v,92
 s_waitcnt vmcnt(35) lgkmcnt(4)
f_C11:
 mf a,0,v,96,v,192
 tr v,208,137,0
 v_add_u32 v131, 0xfffe8000, v131
 mf a,0,v,112,v,196
 tr v,210,137,512
 mf a,4,v,100,v,192
 buffer_load_dwordx4 a[240:243], v128, s[24:27], s48 offen offset:0 sc1
 mf a,4,v,116,v,196
 mf a,8,v,104,v,192
 tr v,212,137,4096
 v_add_u32 v132, 0xfffe8000, v132
 mf a,8,v,120,v,196
 tr v,214,137,4608
 mf a,12,v,108,v,192
 buffer_load_dwordx4 a[244:247], v128, s[24:27], s49 offen offset:0 sc1
 mf a,12,v,124,v,196
 s_waitcnt lgkmcnt(4)
 mf a,16,v,96,v,200
 tr v,192,138,0
 v_add_u32 v133, 0xfffe8000, v133
 mf a,16,v,112,v,204
 tr v,194,138,512
 mf a,20,v,100,v,200
 buffer_load_dwordx4 a[248:251], v128, s[24:27], s50 offen offset:0 sc1
 mf a,20,v,116,v,204
 mf a,24,v,104,v,200
 tr v,196,138,4096
 v_add_u32 v134, 0xfffe8000, v134
 mf a,24,v,120,v,204
 tr v,198,138,4608
 mf a,28,v,108,v,200
 buffer_load_dwordx4 a[252:255], v128, s[24:27], s51 offen offset:0 sc1
 mf a,28,v,124,v,204
 s_waitcnt lgkmcnt(4)
 mf a,32,v,96,v,208
 tr v,200,135,8192
 mf a,32,v,112,v,212
 tr v,202,135,8704
 mf a,36,v,100,v,208
 buffer_load_dwordx4 v[160:163], v128, s[24:27], s48 offen offset:1024 sc1
 mf a,36,v,116,v,212
 mf a,40,v,104,v,208
 tr v,204,135,12288
 mf a,40,v,120,v,212
 tr v,206,135,12800
 mf a,44,v,108,v,208
 mf a,44,v,124,v,212
 s_waitcnt lgkmcnt(4)
 mf a,48,v,96,v,192
 tr v,208,136,8192
 mf a,48,v,112,v,196
 tr v,210,136,8704
 mf a,52,v,100,v,192
 buffer_load_dwordx4 v[164:167], v128, s[24:27], s49 offen offset:1024 sc1
 mf a,52,v,116,v,196
 s_bitcmp1_b32 s45, 21
 s_cbranch_scc0 f_wC21
 buffer_load_dword v146, v217, s[28:31], 0 offen
f_wC21:
 mf a,56,v,104,v,192
 tr v,212,136,12288
 mf a,56,v,120,v,196
 tr v,214,136,12800
 mf a,60,v,108,v,192
 buffer_load_dwordx4 v[168:171], v128, s[24:27], s50 offen offset:1024 sc1
 mf a,60,v,124,v,196
 s_waitcnt lgkmcnt(4)
 mf a,64,v,96,v,200
 tr v,192,137,8192
 mf a,64,v,112,v,204
 tr v,194,137,8704
 mf a,68,v,100,v,200
 buffer_load_dwordx4 v[172:175], v128, s[24:27], s51 offen offset:1024 sc1
 mf a,68,v,116,v,204
 mf a,72,v,104,v,200
 tr v,196,137,12288
 mf a,72,v,120,v,204
 tr v,198,137,12800
 s_add_u32 m0, s52, 98304
 mf a,76,v,108,v,200
 buffer_load_dwordx4 v129, s[16:19], s44 offen lds
 mf a,76,v,124,v,204
 s_waitcnt lgkmcnt(4)
 mf a,80,v,96,v,208
 tr v,200,138,8192
 mf a,80,v,112,v,212
 tr v,202,138,8704
 s_add_u32 m0, s52, 106496
 mf a,84,v,100,v,208
 buffer_load_dwordx4 v129, s[20:23], s44 offen lds
 s_sub_u32 s44, s44, 229376
 mf a,84,v,116,v,212
 mf a,88,v,104,v,208
 tr v,204,138,12288
 mf a,88,v,120,v,212
 tr v,206,138,12800
 mf a,92,v,108,v,208
 mf a,92,v,124,v,212
 s_waitcnt lgkmcnt(4)
 mf a,96,v,96,v,192
 tr v,208,135,16384
 mf a,96,v,112,v,196
 tr v,210,135,16896
 s_add_u32 m0, s52, 102400
 mf a,100,v,100,v,192
 buffer_load_dwordx4 v129, s[16:19], s44 offen lds
 mf a,100,v,116,v,196
 mf a,104,v,104,v,192
 tr v,212,135,20480
 mf a,104,v,120,v,196
 tr v,214,135,20992
 mf a,108,v,108,v,192
 mf a,108,v,124,v,196
 s_waitcnt lgkmcnt(4)
 mf a,112,v,96,v,200
 tr v,192,136,16384
 mf a,112,v,112,v,204
 tr v,194,136,16896
 mf a,116,v,100,v,200
 mf a,116,v,116,v,204
 mf a,120,v,104,v,200
 tr v,196,136,20480
 mf a,120,v,120,v,204
 tr v,198,136,20992
 mf a,124,v,108,v,200
 mf a,124,v,124,v,204
 s_waitcnt lgkmcnt(4)
 mf a,128,v,208,v,96
 tr v,200,137,16384
 mf a,128,v,212,v,112
 tr v,202,137,16896
 mf a,132,v,208,v,100
 mf a,132,v,212,v,116
 mf a,136,v,208,v,104
 tr v,204,137,20480
 mf a,136,v,212,v,120
 tr v,206,137,20992
 s_add_u32 m0, s52, 110592
 mf a,140,v,208,v,108
 buffer_load_dwordx4 v129, s[20:23], s44 offen lds
 s_sub_u32 s44, s44, 229376
 mf a,140,v,212,v,124
 s_waitcnt lgkmcnt(4)
 mf a,144,v,192,v,96
 tr v,208,138,16384
 mf a,144,v,196,v,112
 tr v,210,138,16896
 mf a,148,v,192,v,100
 mf a,148,v,196,v,116
 mf a,152,v,192,v,104
 tr v,212,138,20480
 mf a,152,v,196,v,120
 tr v,214,138,20992
 mf a,156,v,192,v,108
 mf a,156,v,196,v,124
 s_waitcnt lgkmcnt(4)
 mf a,160,v,200,v,96
 mf a,160,v,204,v,112
 mf a,164,v,200,v,100
 mf a,164,v,204,v,116
 s_waitcnt lgkmcnt(0)
 s_barrier
 mf a,168,v,200,v,104
 tr v,192,131,0
 mf a,168,v,204,v,120
 tr v,194,131,512
 mf a,172,v,200,v,108
 tr v,196,131,4096
 mf a,172,v,204,v,124
 tr v,198,131,4608
 mf a,176,v,208,v,96
 tr v,200,132,0
 mf a,176,v,212,v,112
 tr v,202,132,512
 mf a,180,v,208,v,100
 mf a,180,v,212,v,116
 mf a,184,v,208,v,104
 tr v,204,132,4096
 mf a,184,v,212,v,120
 tr v,206,132,4608
 mf a,188,v,208,v,108
 mf a,188,v,212,v,124
 s_waitcnt vmcnt(32) lgkmcnt(4)
f_C12:
 mf a,0,v,0,v,192
 tr v,208,133,0
 v_add_u32 v135, 0xfffe8000, v135
 mf a,0,a,192,v,196
 tr v,210,133,512
 mf a,4,v,4,v,192
 buffer_load_dwordx4 v[176:179], v128, s[24:27], s48 offen offset:2048 sc1
 mf a,4,a,196,v,196
 mf a,8,v,8,v,192
 tr v,212,133,4096
 v_add_u32 v136, 0xfffe8000, v136
 mf a,8,a,200,v,196
 tr v,214,133,4608
 mf a,12,v,12,v,192
 buffer_load_dwordx4 v[180:183], v128, s[24:27], s49 offen offset:2048 sc1
 mf a,12,a,204,v,196
 s_waitcnt lgkmcnt(4)
 mf a,16,v,0,v,200
 tr v,192,134,0
 v_add_u32 v137, 0xfffe8000, v137
 mf a,16,a,192,v,204
 tr v,194,134,512
 mf a,20,v,4,v,200
 buffer_load_dwordx4 v[184:187], v128, s[24:27], s50 offen offset:2048 sc1
 mf a,20,a,196,v,204
 mf a,24,v,8,v,200
 tr v,196,134,4096
 v_add_u32 v138, 0xfffe8000, v138
 mf a,24,a,200,v,204
 tr v,198,134,4608
 mf a,28,v,12,v,200
 buffer_load_dwordx4 v[188:191], v128, s[24:27], s51 offen offset:2048 sc1
 mf a,28,a,204,v,204
 s_waitcnt lgkmcnt(4)
 mf a,32,v,0,v,208
 tr v,200,131,8192
 mf a,32,a,192,v,212
 tr v,202,131,8704
 mf a,36,v,4,v,208
 buffer_load_dwordx4 v[240:243], v128, s[24:27], s48 offen offset:3072 sc1
 s_sub_u32 s48, s48, 4096
 mf a,36,a,196,v,212
 mf a,40,v,8,v,208
 tr v,204,131,12288
 mf a,40,a,200,v,212
 tr v,206,131,12800
 mf a,44,v,12,v,208
 mf a,44,a,204,v,212
 s_waitcnt lgkmcnt(4)
 mf a,48,v,0,v,192
 tr v,208,132,8192
 mf a,48,a,192,v,196
 tr v,210,132,8704
 mf a,52,v,4,v,192
 buffer_load_dwordx4 v[244:247], v128, s[24:27], s49 offen offset:3072 sc1
 s_sub_u32 s49, s49, 4096
 mf a,52,a,196,v,196
 s_bitcmp1_b32 s45, 22
 s_cbranch_scc0 f_wC22
 buffer_load_dword v146, v217, s[28:31], 0 offen
f_wC22:
 mf a,56,v,8,v,192
 tr v,212,132,12288
 mf a,56,a,200,v,196
 tr v,214,132,12800
 mf a,60,v,12,v,192
 buffer_load_dwordx4 v[248:251], v128, s[24:27], s50 offen offset:3072 sc1
 s_sub_u32 s50, s50, 4096
 mf a,60,a,204,v,196
 s_waitcnt lgkmcnt(4)
 mf a,64,v,0,v,200
 tr v,192,133,8192
 mf a,64,a,192,v,204
 tr v,194,133,8704
 mf a,68,v,4,v,200
 buffer_load_dwordx4 v[252:255], v128, s[24:27], s51 offen offset:3072 sc1
 s_sub_u32 s51, s51, 4096
 mf a,68,a,196,v,204
 mf a,72,v,8,v,200
 tr v,196,133,12288
 mf a,72,a,200,v,204
 tr v,198,133,12800
 s_add_u32 m0, s52, 122880
 mf a,76,v,12,v,200
 buffer_load_dwordx4 v129, s[16:19], s44 offen lds
 mf a,76,a,204,v,204
 s_waitcnt lgkmcnt(4)
 mf a,80,v,0,v,208
 tr v,200,134,8192
 mf a,80,a,192,v,212
 tr v,202,134,8704
 s_add_u32 m0, s52, 131072
 mf a,84,v,4,v,208
 buffer_load_dwordx4 v129, s[20:23], s44 offen lds
 s_sub_u32 s44, s44, 229376
 mf a,84,a,196,v,212
 mf a,88,v,8,v,208
 tr v,204,134,12288
 mf a,88,a,200,v,212
 tr v,206,134,12800
 mf a,92,v,12,v,208
 mf a,92,a,204,v,212
 s_waitcnt lgkmcnt(4)
 mf a,96,v,0,v,192
 tr v,208,131,16384
 mf a,96,a,192,v,196
 tr v,210,131,16896
 s_add_u32 m0, s52, 126976
 mf a,100,v,4,v,192
 buffer_load_dwordx4 v129, s[16:19], s44 offen lds
 mf a,100,a,196,v,196
 mf a,104,v,8,v,192
 tr v,212,131,20480
 mf a,104,a,200,v,196
 tr v,214,131,20992
 mf a,108,v,12,v,192
 mf a,108,a,204,v,196
 s_waitcnt lgkmcnt(4)
 mf a,112,v,0,v,200
 tr v,192,132,16384
 mf a,112,a,192,v,204
 tr v,194,132,16896
 mf a,116,v,4,v,200
 mf a,116,a,196,v,204
 mf a,120,v,8,v,200
 tr v,196,132,20480
 mf a,120,a,200,v,204
 tr v,198,132,20992
 mf a,124,v,12,v,200
 mf a,124,a,204,v,204
 s_waitcnt lgkmcnt(4)
 mf a,128,v,208,v,0
 tr v,200,133,16384
 mf a,128,v,212,a,192
 tr v,202,133,16896
 mf a,132,v,208,v,4
 mf a,132,v,212,a,196
 mf a,136,v,208,v,8
 tr v,204,133,20480
 mf a,136,v,212,a,200
 tr v,206,133,20992
 s_add_u32 m0, s52, 135168
 mf a,140,v,208,v,12
 buffer_load_dwordx4 v129, s[20:23], s44 offen lds
 s_sub_u32 s44, s44, 229376
 mf a,140,v,212,a,204
 s_waitcnt lgkmcnt(4)
 mf a,144,v,192,v,0
 tr v,208,134,16384
 mf a,144,v,196,a,192
 tr v,210,134,16896
 mf a,148,v,192,v,4
 mf a,148,v,196,a,196
 mf a,152,v,192,v,8
 tr v,212,134,20480
 mf a,152,v,196,a,200
 tr v,214,134,20992
 mf a,156,v,192,v,12
 mf a,156,v,196,a,204
 s_waitcnt lgkmcnt(4)
 mf a,160,v,200,v,0
 mf a,160,v,204,a,192
 mf a,164,v,200,v,4
 mf a,164,v,204,a,196
 s_waitcnt lgkmcnt(0)
 s_barrier
 mf a,168,v,200,v,8
 tr v,192,135,0
 mf a,168,v,204,a,200
 tr v,194,135,512
 mf a,172,v,200,v,12
 tr v,196,135,4096
 mf a,172,v,204,a,204
 tr v,198,135,4608
 mf a,176,v,208,v,0
 tr v,200,136,0
 mf a,176,v,212,a,192
 tr v,202,136,512
 mf a,180,v,208,v,4
 mf a,180,v,212,a,196
 mf a,184,v,208,v,8
 tr v,204,136,4096
 mf a,184,v,212,a,200
 tr v,206,136,4608
 mf a,188,v,208,v,12
 mf a,188,v,212,a,204
 s_waitcnt vmcnt(30) lgkmcnt(4)
f_C13:
 s_mov_b32 s69, f_C16-f_base
 mf a,0,a,208,v,192
 tr v,208,137,0
 v_add_u32 v131, 0xc000, v131
 mf a,0,a,224,v,196
 tr v,210,137,512
 mf a,4,a,212,v,192
 buffer_load_dword v146, v155, s[36:39], s69 offen
 mf a,4,a,228,v,196
 mf a,8,a,216,v,192
 tr v,212,137,4096
 v_add_u32 v132, 0xc000, v132
 mf a,8,a,232,v,196
 tr v,214,137,4608
 mf a,12,a,220,v,192
 mf a,12,a,236,v,196
 s_waitcnt lgkmcnt(4)
 mf a,16,a,208,v,200
 tr v,192,138,0
 v_add_u32 v133, 0xc000, v133
 mf a,16,a,224,v,204
 tr v,194,138,512
 s_add_u32 m0, s52, 0
 mf a,20,a,212,v,200
 buffer_load_dwordx4 v129, s[16:19], s44 offen lds
 mf a,20,a,228,v,204
 mf a,24,a,216,v,200
 tr v,196,138,4096
 v_add_u32 v134, 0xc000, v134
 mf a,24,a,232,v,204
 tr v,198,138,4608
 mf a,28,a,220,v,200
 mf a,28,a,236,v,204
 s_waitcnt lgkmcnt(4)
 mf a,32,a,208,v,208
 tr v,200,135,8192
 mf a,32,a,224,v,212
 tr v,202,135,8704
 s_add_u32 m0, s52, 8192
 mf a,36,a,212,v,208
 buffer_load_dwordx4 v129, s[20:23], s44 offen lds
 s_sub_u32 s44, s44, 229376
 mf a,36,a,228,v,212
 mf a,40,a,216,v,208
 tr v,204,135,12288
 mf a,40,a,232,v,212
 tr v,206,135,12800
 mf a,44,a,220,v,208
 mf a,44,a,236,v,212
 s_waitcnt lgkmcnt(4)
 mf a,48,a,208,v,192
 tr v,208,136,8192
 mf a,48,a,224,v,196
 tr v,210,136,8704
 mf a,52,a,212,v,192
 mf a,52,a,228,v,196
 s_bitcmp1_b32 s45, 23
 s_cbranch_scc0 f_wC23
 buffer_load_dword v146, v217, s[28:31], 0 offen
f_wC23:
 mf a,56,a,216,v,192
 tr v,212,136,12288
 mf a,56,a,232,v,196
 tr v,214,136,12800
 s_add_u32 m0, s52, 4096
 mf a,60,a,220,v,192
 buffer_load_dwordx4 v129, s[16:19], s44 offen lds
 mf a,60,a,236,v,196
 s_waitcnt lgkmcnt(4)
 mf a,64,a,208,v,200
 tr v,192,137,8192
 mf a,64,a,224,v,204
 tr v,194,137,8704
 mf a,68,a,212,v,200
 mf a,68,a,228,v,204
 mf a,72,a,216,v,200
 tr v,196,137,12288
 mf a,72,a,232,v,204
 tr v,198,137,12800
 s_add_u32 m0, s52, 12288
 mf a,76,a,220,v,200
 buffer_load_dwordx4 v129, s[20:23], s44 offen lds
 s_sub_u32 s44, s44, 229376
 mf a,76,a,236,v,204
 s_waitcnt lgkmcnt(4)
 mf a,80,a,208,v,208
 tr v,200,138,8192
 mf a,80,a,224,v,212
 tr v,202,138,8704
 mf a,84,a,212,v,208
 mf a,84,a,228,v,212
 mf a,88,a,216,v,208
 tr v,204,138,12288
 mf a,88,a,232,v,212
 tr v,206,138,12800
 mf a,92,a,220,v,208
 mf a,92,a,236,v,212
 s_waitcnt lgkmcnt(4)
 mf a,96,a,208,v,192
 tr v,208,135,16384
 mf a,96,a,224,v,196
 tr v,210,135,16896
 mf a,100,a,212,v,192
 mf a,100,a,228,v,196
 mf a,104,a,216,v,192
 tr v,212,135,20480
 mf a,104,a,232,v,196
 tr v,214,135,20992
 mf a,108,a,220,v,192
 mf a,108,a,236,v,196
 s_waitcnt lgkmcnt(4)
 mf a,112,a,208,v,200
 tr v,192,136,16384
 mf a,112,a,224,v,204
 tr v,194,136,16896
 mf a,116,a,212,v,200
 mf a,116,a,228,v,204
 mf a,120,a,216,v,200
 tr v,196,136,20480
 mf a,120,a,232,v,204
 tr v,198,136,20992
 mf a,124,a,220,v,200
 mf a,124,a,236,v,204
 s_waitcnt lgkmcnt(4)
 mf a,128,v,208,a,208
 tr v,200,137,16384
 mf a,128,v,212,a,224
 tr v,202,137,16896
 mf a,132,v,208,a,212
 mf a,132,v,212,a,228
 mf a,136,v,208,a,216
 tr v,204,137,20480
 mf a,136,v,212,a,232
 tr v,206,137,20992
 mf a,140,v,208,a,220
 mf a,140,v,212,a,236
 s_waitcnt lgkmcnt(4)
 mf a,144,v,192,a,208
 tr v,208,138,16384
 mf a,144,v,196,a,224
 tr v,210,138,16896
 mf a,148,v,192,a,212
 mf a,148,v,196,a,228
 mf a,152,v,192,a,216
 tr v,212,138,20480
 mf a,152,v,196,a,232
 tr v,214,138,20992
 mf a,156,v,192,a,220
 mf a,156,v,196,a,236
 s_waitcnt lgkmcnt(4)
 mf a,160,v,200,a,208
 mf a,160,v,204,a,224
 mf a,164,v,200,a,212
 mf a,164,v,204,a,228
 s_waitcnt lgkmcnt(0)
 s_barrier
 mf a,168,v,200,a,216
 tr v,192,131,0
 mf a,168,v,204,a,232
 tr v,194,131,512
 mf a,172,v,200,a,220
 tr v,196,131,4096
 mf a,172,v,204,a,236
 tr v,198,131,4608
 mf a,176,v,208,a,208
 tr v,200,132,0
 mf a,176,v,212,a,224
 tr v,202,132,512
 mf a,180,v,208,a,212
 mf a,180,v,212,a,228
 mf a,184,v,208,a,216
 tr v,204,132,4096
 mf a,184,v,212,a,232
 tr v,206,132,4608
 mf a,188,v,208,a,220
 mf a,188,v,212,a,236
 s_waitcnt vmcnt(21) lgkmcnt(4)
f_C14:
 mf a,0,a,240,v,192
 tr v,208,133,0
 v_add_u32 v135, 0xc000, v135
 mf a,0,v,160,v,196
 tr v,210,133,512
 s_add_u32 m0, s52, 24576
 mf a,4,a,244,v,192
 buffer_load_dwordx4 v129, s[16:19], s44 offen lds
 s_lshl_b32 s4, s57, 1
 mf a,4,v,164,v,196
 s_add_u32 s4, s4, s55
 s_mul_i32 s4, s4, 589824
 s_lshl_b32 s69, s54, 10
 mf a,8,a,248,v,192
 tr v,212,133,4096
 v_add_u32 v136, 0xc000, v136
 mf a,8,v,168,v,196
 tr v,214,133,4608
 s_add_u32 s4, s4, s69
 mf a,12,a,252,v,192
 s_add_u32 s4, s4, 4308992
 s_add_u32 s5, s4, 294912
 s_lshr_b32 s10, s60, 1
 mf a,12,v,172,v,196
 s_waitcnt lgkmcnt(4)
 s_lshl_b32 s10, s10, 2
 s_lshr_b32 s11, s61, 3
 mf a,16,a,240,v,200
 tr v,192,134,0
 v_add_u32 v137, 0xc000, v137
 mf a,16,v,160,v,204
 tr v,194,134,512
 s_add_u32 s10, s10, s11
 mf a,20,a,244,v,200
 s_lshl_b32 s76, s10, 12
 s_add_u32 s76, s76, 42008576
 s_and_b32 s11, s61, 7
 mf a,20,v,164,v,204
 s_lshl_b32 s11, s11, 8
 s_and_b32 s13, s60, 1
 s_lshl_b32 s12, s10, 2
 mf a,24,a,248,v,200
 tr v,196,134,4096
 v_add_u32 v138, 0xc000, v138
 mf a,24,v,168,v,204
 tr v,198,134,4608
 s_add_u32 m0, s52, 32768
 mf a,28,a,252,v,200
 buffer_load_dwordx4 v129, s[20:23], s44 offen lds
 s_sub_u32 s44, s44, 229376
 mf a,28,v,172,v,204
 s_waitcnt lgkmcnt(4)
 s_add_u32 s12, s12, s3
 s_lshl_b32 s12, s12, 16
 mf a,32,a,240,v,208
 tr v,200,131,8192
 s_add_u32 s12, s12, s11
 mf a,32,v,160,v,212
 tr v,202,131,8704
 s_lshl_b32 s14, s13, 7
 mf a,36,a,244,v,208
 s_add_u32 s6, s12, s14
 s_add_u32 s7, s6, 32768
 s_lshl_b32 s14, s55, 7
 mf a,36,v,164,v,212
 s_add_u32 s11, s11, s14
 s_mul_i32 s14, s13, 52
 s_mul_i32 s15, s56, 56
 mf a,40,a,248,v,208
 tr v,204,131,12288
 s_add_u32 s14, s14, s15
 mf a,40,v,168,v,212
 tr v,206,131,12800
 s_lshl1_add_u32 s13, s13, s56
 mf a,44,a,252,v,208
 s_lshl_b32 s62, s14, 16
 s_add_u32 s62, s62, s11
 s_lshl_b32 s8, s13, 19
 mf a,44,v,172,v,212
 s_waitcnt lgkmcnt(4)
 s_add_u32 s8, s8, s11
 s_lshl3_add_u32 s9, s13, 112
 mf a,48,a,240,v,192
 tr v,208,132,8192
 s_sub_u32 s9, s9, s14
 mf a,48,v,160,v,196
 tr v,210,132,8704
 s_add_u32 m0, s52, 28672
 mf a,52,a,244,v,192
 buffer_load_dwordx4 v129, s[16:19], s44 offen lds
 s_lshl_b32 s9, s9, 10
 mf a,52,v,164,v,196
 s_lshl1_add_u32 s10, s10, s55
 s_mul_i32 s10, s10, 589824
 s_lshl_b32 s11, s14, 10
 mf a,56,a,248,v,192
 tr v,212,132,12288
 s_add_u32 s10, s10, s11
 mf a,56,v,168,v,196
 tr v,214,132,12800
 s_add_u32 s10, s10, 4194304
 mf a,60,a,252,v,192
 s_mul_i32 s11, s56, 294912
 s_sub_u32 s12, 294912, s11
 s_add_u32 s54, s10, s11
 mf a,60,v,172,v,196
 s_waitcnt lgkmcnt(4)
 s_add_u32 s55, s54, 147456
 s_add_u32 s56, s10, s12
 mf a,64,a,240,v,200
 tr v,192,133,8192
 s_add_u32 s57, s56, 147456
 mf a,64,v,160,v,204
 tr v,194,133,8704
 s_lshl2_add_u32 s10, s2, s3
 mf a,68,a,244,v,200
 s_lshl_b32 s11, s10, 13
 s_add_u32 s58, s11, 50331648
 s_add_u32 s59, s58, 4096
 mf a,68,v,164,v,204
 s_xor_b32 s60, s58, 32768
 s_add_u32 s61, s60, 4096
 mf a,72,a,248,v,200
 tr v,196,133,12288
 mf a,72,v,168,v,204
 tr v,198,133,12800
 s_add_u32 m0, s52, 36864
 mf a,76,a,252,v,200
 buffer_load_dwordx4 v129, s[20:23], s44 offen lds
 s_sub_u32 s44, s44, 229376
 mf a,76,v,172,v,204
 s_waitcnt lgkmcnt(4)
 mf a,80,a,240,v,208
 tr v,200,134,8192
 mf a,80,v,160,v,212
 tr v,202,134,8704
 mf a,84,a,244,v,208
 mf a,84,v,164,v,212
 mf a,88,a,248,v,208
 tr v,204,134,12288
 mf a,88,v,168,v,212
 tr v,206,134,12800
 mf a,92,a,252,v,208
 mf a,92,v,172,v,212
 s_waitcnt lgkmcnt(4)
 mf a,96,a,240,v,192
 tr v,208,131,16384
 mf a,96,v,160,v,196
 tr v,210,131,16896
 mf a,100,a,244,v,192
 mf a,100,v,164,v,196
 mf a,104,a,248,v,192
 tr v,212,131,20480
 mf a,104,v,168,v,196
 tr v,214,131,20992
 mf a,108,a,252,v,192
 mf a,108,v,172,v,196
 s_waitcnt lgkmcnt(4)
 mf a,112,a,240,v,200
 tr v,192,132,16384
 mf a,112,v,160,v,204
 tr v,194,132,16896
 mf a,116,a,244,v,200
 mf a,116,v,164,v,204
 mf a,120,a,248,v,200
 tr v,196,132,20480
 mf a,120,v,168,v,204
 tr v,198,132,20992
 mf a,124,a,252,v,200
 mf a,124,v,172,v,204
 s_waitcnt lgkmcnt(4)
 mf a,128,v,208,a,240
 tr v,200,133,16384
 mf a,128,v,212,v,160
 tr v,202,133,16896
 mf a,132,v,208,a,244
 mf a,132,v,212,v,164
 mf a,136,v,208,a,248
 tr v,204,133,20480
 mf a,136,v,212,v,168
 tr v,206,133,20992
 mf a,140,v,208,a,252
 mf a,140,v,212,v,172
 s_waitcnt lgkmcnt(4)
 mf a,144,v,192,a,240
 tr v,208,134,16384
 mf a,144,v,196,v,160
 tr v,210,134,16896
 mf a,148,v,192,a,244
 mf a,148,v,196,v,164
 mf a,152,v,192,a,248
 tr v,212,134,20480
 mf a,152,v,196,v,168
 tr v,214,134,20992
 mf a,156,v,192,a,252
 mf a,156,v,196,v,172
 s_waitcnt lgkmcnt(4)
 mf a,160,v,200,a,240
 mf a,160,v,204,v,160
 mf a,164,v,200,a,244
 mf a,164,v,204,v,164
 s_waitcnt lgkmcnt(0)
 s_barrier
 mf a,168,v,200,a,248
 tr v,192,135,0
 mf a,168,v,204,v,168
 tr v,194,135,512
 mf a,172,v,200,a,252
 tr v,196,135,4096
 mf a,172,v,204,v,172
 tr v,198,135,4608
 mf a,176,v,208,a,240
 tr v,200,136,0
 mf a,176,v,212,v,160
 tr v,202,136,512
 mf a,180,v,208,a,244
 mf a,180,v,212,v,164
 mf a,184,v,208,a,248
 tr v,204,136,4096
 mf a,184,v,212,v,168
 tr v,206,136,4608
 mf a,188,v,208,a,252
 mf a,188,v,212,v,172
 s_waitcnt vmcnt(13) lgkmcnt(4)
f_C15:
 mf a,0,v,176,v,192
 tr v,208,137,0
 v_add_u32 v131, 0xc000, v131
 mf a,0,v,240,v,196
 tr v,210,137,512
 s_add_u32 m0, s52, 49152
 mf a,4,v,180,v,192
 buffer_load_dwordx4 v129, s[16:19], s44 offen lds
 mf a,4,v,244,v,196
 mf a,8,v,184,v,192
 tr v,212,137,4096
 v_add_u32 v132, 0xc000, v132
 mf a,8,v,248,v,196
 tr v,214,137,4608
 mf a,12,v,188,v,192
 mf a,12,v,252,v,196
 s_waitcnt lgkmcnt(4)
 mf a,16,v,176,v,200
 tr v,192,138,0
 v_add_u32 v133, 0xc000, v133
 mf a,16,v,240,v,204
 tr v,194,138,512
 mf a,20,v,180,v,200
 mf a,20,v,244,v,204
 mf a,24,v,184,v,200
 tr v,196,138,4096
 v_add_u32 v134, 0xc000, v134
 mf a,24,v,248,v,204
 tr v,198,138,4608
 s_add_u32 m0, s52, 57344
 mf a,28,v,188,v,200
 buffer_load_dwordx4 v129, s[20:23], s44 offen lds
 s_sub_u32 s44, s44, 229376
 mf a,28,v,252,v,204
 s_waitcnt lgkmcnt(4)
 mf a,32,v,176,v,208
 tr v,200,135,8192
 mf a,32,v,240,v,212
 tr v,202,135,8704
 mf a,36,v,180,v,208
 mf a,36,v,244,v,212
 mf a,40,v,184,v,208
 tr v,204,135,12288
 mf a,40,v,248,v,212
 tr v,206,135,12800
 mf a,44,v,188,v,208
 mf a,44,v,252,v,212
 s_waitcnt lgkmcnt(4)
 mf a,48,v,176,v,192
 tr v,208,136,8192
 mf a,48,v,240,v,196
 tr v,210,136,8704
 s_add_u32 m0, s52, 53248
 mf a,52,v,180,v,192
 buffer_load_dwordx4 v129, s[16:19], s44 offen lds
 mf a,52,v,244,v,196
 mf a,56,v,184,v,192
 tr v,212,136,12288
 mf a,56,v,248,v,196
 tr v,214,136,12800
 mf a,60,v,188,v,192
 mf a,60,v,252,v,196
 s_waitcnt lgkmcnt(4)
 mf a,64,v,176,v,200
 tr v,192,137,8192
 mf a,64,v,240,v,204
 tr v,194,137,8704
 mf a,68,v,180,v,200
 mf a,68,v,244,v,204
 mf a,72,v,184,v,200
 tr v,196,137,12288
 mf a,72,v,248,v,204
 tr v,198,137,12800
 s_add_u32 m0, s52, 61440
 mf a,76,v,188,v,200
 buffer_load_dwordx4 v129, s[20:23], s44 offen lds
 s_sub_u32 s44, s44, 229376
 mf a,76,v,252,v,204
 s_waitcnt lgkmcnt(4)
 mf a,80,v,176,v,208
 tr v,200,138,8192
 mf a,80,v,240,v,212
 tr v,202,138,8704
 mf a,84,v,180,v,208
 mf a,84,v,244,v,212
 mf a,88,v,184,v,208
 tr v,204,138,12288
 mf a,88,v,248,v,212
 tr v,206,138,12800
 mf a,92,v,188,v,208
 mf a,92,v,252,v,212
 s_waitcnt lgkmcnt(4)
 mf a,96,v,176,v,192
 tr v,208,135,16384
 mf a,96,v,240,v,196
 tr v,210,135,16896
 mf a,100,v,180,v,192
 mf a,100,v,244,v,196
 mf a,104,v,184,v,192
 tr v,212,135,20480
 mf a,104,v,248,v,196
 tr v,214,135,20992
 mf a,108,v,188,v,192
 mf a,108,v,252,v,196
 s_waitcnt lgkmcnt(4)
 mf a,112,v,176,v,200
 tr v,192,136,16384
 mf a,112,v,240,v,204
 tr v,194,136,16896
 mf a,116,v,180,v,200
 mf a,116,v,244,v,204
 mf a,120,v,184,v,200
 tr v,196,136,20480
 mf a,120,v,248,v,204
 tr v,198,136,20992
 mf a,124,v,188,v,200
 mf a,124,v,252,v,204
 s_waitcnt lgkmcnt(4)
 mf a,128,v,208,v,176
 tr v,200,137,16384
 mf a,128,v,212,v,240
 tr v,202,137,16896
 mf a,132,v,208,v,180
 mf a,132,v,212,v,244
 mf a,136,v,208,v,184
 tr v,204,137,20480
 mf a,136,v,212,v,248
 tr v,206,137,20992
 mf a,140,v,208,v,188
 mf a,140,v,212,v,252
 s_waitcnt lgkmcnt(4)
 mf a,144,v,192,v,176
 tr v,208,138,16384
 mf a,144,v,196,v,240
 tr v,210,138,16896
 mf a,148,v,192,v,180
 mf a,148,v,196,v,244
 mf a,152,v,192,v,184
 tr v,212,138,20480
 mf a,152,v,196,v,248
 tr v,214,138,20992
 mf a,156,v,192,v,188
 mf a,156,v,196,v,252
 s_waitcnt lgkmcnt(4)
 mf a,160,v,200,v,176
 mf a,160,v,204,v,240
 mf a,164,v,200,v,180
 mf a,164,v,204,v,244
 s_waitcnt lgkmcnt(0)
 s_barrier
 mf a,168,v,200,v,184
 tr v,192,131,0
 mf a,168,v,204,v,248
 tr v,194,131,512
 mf a,172,v,200,v,188
 tr v,196,132,0
 mf a,172,v,204,v,252
 tr v,198,132,512
 mf a,176,v,208,v,176
 tr v,200,131,8192
 mf a,176,v,212,v,240
 tr v,202,131,8704
 mf a,180,v,208,v,180
 mf a,180,v,212,v,244
 mf a,184,v,208,v,184
 tr v,204,132,8192
 mf a,184,v,212,v,248
 tr v,206,132,8704
 mf a,188,v,208,v,188
 mf a,188,v,212,v,252
 s_waitcnt lgkmcnt(4)
f_C16:
 v_mfma_f32_16x16x32_bf16 v[0:3], v[192:195], v[240:243], 0
 tr v,208,133,0
 v_add_u32 v135, 0xc000, v135
 v_mfma_f32_16x16x32_bf16 v[4:7], v[192:195], v[244:247], 0
 tr v,210,133,512
 s_add_u32 m0, s52, 73728
 v_mfma_f32_16x16x32_bf16 v[8:11], v[192:195], v[248:251], 0
 buffer_load_dwordx4 v129, s[16:19], s44 offen lds
 v_mfma_f32_16x16x32_bf16 v[12:15], v[192:195], v[252:255], 0
 v_accvgpr_read_b32 v216, a128
 v_accvgpr_read_b32 v217, a129
 v_mfma_f32_16x16x32_bf16 v[16:19], v[196:199], v[240:243], 0
 tr v,212,134,0
 v_add_u32 v136, 0xc000, v136
 v_mfma_f32_16x16x32_bf16 v[20:23], v[196:199], v[244:247], 0
 tr v,214,134,512
 v_accvgpr_read_b32 v218, a130
 v_mfma_f32_16x16x32_bf16 v[24:27], v[196:199], v[248:251], 0
 v_accvgpr_read_b32 v219, a131
 v_accvgpr_read_b32 v220, a144
 v_mfma_f32_16x16x32_bf16 v[28:31], v[196:199], v[252:255], 0
 s_waitcnt lgkmcnt(4)
 v_accvgpr_read_b32 v221, a145
 v_accvgpr_read_b32 v222, a146
 v_mfma_f32_16x16x32_bf16 v[64:67], v[200:203], v[240:243], 0
 tr v,192,133,8192
 v_add_u32 v137, 0xc000, v137
 v_mfma_f32_16x16x32_bf16 v[68:71], v[200:203], v[244:247], 0
 tr v,194,133,8704
 s_add_u32 m0, s52, 81920
 v_mfma_f32_16x16x32_bf16 v[72:75], v[200:203], v[248:251], 0
 buffer_load_dwordx4 v129, s[20:23], s44 offen lds
 s_sub_u32 s44, s44, 229376
 v_mfma_f32_16x16x32_bf16 v[76:79], v[200:203], v[252:255], 0
 v_accvgpr_read_b32 v223, a147
 v_cvt_pk_bf16_f32 v236, v216, v217
 v_mfma_f32_16x16x32_bf16 v[80:83], v[204:207], v[240:243], 0
 tr v,196,134,8192
 v_add_u32 v138, 0xc000, v138
 v_mfma_f32_16x16x32_bf16 v[84:87], v[204:207], v[244:247], 0
 tr v,198,134,8704
 v_cvt_pk_bf16_f32 v237, v218, v219
 v_mfma_f32_16x16x32_bf16 v[88:91], v[204:207], v[248:251], 0
 v_cvt_pk_bf16_f32 v238, v220, v221
 v_cvt_pk_bf16_f32 v239, v222, v223
 v_mfma_f32_16x16x32_bf16 v[92:95], v[204:207], v[252:255], 0
 s_waitcnt lgkmcnt(4)
 buffer_store_dwordx4 v[236:239], v139, s[24:27], s68 offen offset:0 sc1
 v_mfma_f32_16x16x32_bf16 v[32:35], v[208:211], v[240:243], 0
 tr v,200,131,4096
 v_accvgpr_read_b32 v216, a132
 v_mfma_f32_16x16x32_bf16 v[36:39], v[208:211], v[244:247], 0
 tr v,202,131,4608
 s_add_u32 m0, s52, 77824
 v_mfma_f32_16x16x32_bf16 v[40:43], v[208:211], v[248:251], 0
 buffer_load_dwordx4 v129, s[16:19], s44 offen lds
 v_accvgpr_read_b32 v217, a133
 v_mfma_f32_16x16x32_bf16 v[44:47], v[208:211], v[252:255], 0
 v_accvgpr_read_b32 v218, a134
 v_accvgpr_read_b32 v219, a135
 v_mfma_f32_16x16x32_bf16 v[48:51], v[212:215], v[240:243], 0
 tr v,204,132,4096
 v_accvgpr_read_b32 v220, a148
 v_mfma_f32_16x16x32_bf16 v[52:55], v[212:215], v[244:247], 0
 tr v,206,132,4608
 v_accvgpr_read_b32 v221, a149
 v_mfma_f32_16x16x32_bf16 v[56:59], v[212:215], v[248:251], 0
 v_accvgpr_read_b32 v222, a150
 v_accvgpr_read_b32 v223, a151
 v_mfma_f32_16x16x32_bf16 v[60:63], v[212:215], v[252:255], 0
 s_waitcnt lgkmcnt(4)
 v_cvt_pk_bf16_f32 v232, v216, v217
 v_cvt_pk_bf16_f32 v233, v218, v219
 v_mfma_f32_16x16x32_bf16 v[96:99], v[192:195], v[240:243], 0
 tr v,208,131,12288
 v_cvt_pk_bf16_f32 v234, v220, v221
 v_mfma_f32_16x16x32_bf16 v[100:103], v[192:195], v[244:247], 0
 tr v,210,131,12800
 s_add_u32 m0, s52, 86016
 v_mfma_f32_16x16x32_bf16 v[104:107], v[192:195], v[248:251], 0
 buffer_load_dwordx4 v129, s[20:23], s44 offen lds
 s_sub_u32 s44, s44, 229376
 v_mfma_f32_16x16x32_bf16 v[108:111], v[192:195], v[252:255], 0
 v_cvt_pk_bf16_f32 v235, v222, v223
 v_mfma_f32_16x16x32_bf16 v[112:115], v[196:199], v[240:243], 0
 tr v,212,132,12288
 v_mfma_f32_16x16x32_bf16 v[116:119], v[196:199], v[244:247], 0
 tr v,214,132,12800
 v_mfma_f32_16x16x32_bf16 v[120:123], v[196:199], v[248:251], 0
 buffer_store_dwordx4 v[232:235], v140, s[24:27], s68 offen offset:0 sc1
 v_accvgpr_read_b32 v216, a136
 v_mfma_f32_16x16x32_bf16 v[124:127], v[196:199], v[252:255], 0
 s_waitcnt lgkmcnt(4)
 v_accvgpr_read_b32 v217, a137
 v_accvgpr_read_b32 v218, a138
 mf v,0,v,200,v,176
 tr v,192,133,4096
 v_accvgpr_read_b32 v219, a139
 mf v,4,v,200,v,180
 tr v,194,133,4608
 v_accvgpr_read_b32 v220, a152
 mf v,8,v,200,v,184
 buffer_load_dwordx4 v[240:243], v128, s[24:27], s48 offen offset:0 sc1
 s_sub_u32 s48, s48, 4096
 mf v,12,v,200,v,188
 v_accvgpr_read_b32 v221, a153
 v_accvgpr_read_b32 v222, a154
 mf v,16,v,204,v,176
 tr v,196,134,4096
 v_accvgpr_read_b32 v223, a155
 mf v,20,v,204,v,180
 tr v,198,134,4608
 v_cvt_pk_bf16_f32 v236, v216, v217
 mf v,24,v,204,v,184
 buffer_load_dwordx4 v[244:247], v128, s[24:27], s49 offen offset:0 sc1
 s_sub_u32 s49, s49, 4096
 mf v,28,v,204,v,188
 s_waitcnt lgkmcnt(4)
 v_cvt_pk_bf16_f32 v237, v218, v219
 v_cvt_pk_bf16_f32 v238, v220, v221
 mf v,64,v,208,v,176
 tr v,200,133,12288
 v_cvt_pk_bf16_f32 v239, v222, v223
 mf v,68,v,208,v,180
 tr v,202,133,12800
 mf v,72,v,208,v,184
 buffer_store_dwordx4 v[236:239], v139, s[24:27], s68 offen offset:2048 sc1
 v_accvgpr_read_b32 v216, a140
 mf v,76,v,208,v,188
 v_accvgpr_read_b32 v217, a141
 v_accvgpr_read_b32 v218, a142
 mf v,80,v,212,v,176
 tr v,204,134,12288
 v_accvgpr_read_b32 v219, a143
 mf v,84,v,212,v,180
 tr v,206,134,12800
 v_accvgpr_read_b32 v220, a156
 mf v,88,v,212,v,184
 buffer_load_dwordx4 v[248:251], v128, s[24:27], s50 offen offset:0 sc1
 s_sub_u32 s50, s50, 4096
 mf v,92,v,212,v,188
 s_waitcnt lgkmcnt(4)
 v_accvgpr_read_b32 v221, a157
 v_accvgpr_read_b32 v222, a158
 mf v,32,v,192,v,176
 v_accvgpr_read_b32 v223, a159
 v_cvt_pk_bf16_f32 v232, v216, v217
 mf v,36,v,192,v,180
 v_cvt_pk_bf16_f32 v233, v218, v219
 v_cvt_pk_bf16_f32 v234, v220, v221
 mf v,40,v,192,v,184
 v_cvt_pk_bf16_f32 v235, v222, v223
 mf v,44,v,192,v,188
 s_waitcnt vmcnt(23) lgkmcnt(0)
 s_barrier
 mf v,48,v,196,v,176
 tr v,208,135,0
 mf v,52,v,196,v,180
 tr v,210,135,512
 mf v,56,v,196,v,184
 tr v,212,136,0
 mf v,60,v,196,v,188
 tr v,214,136,512
 mf v,96,v,200,v,176
 tr v,192,135,8192
 mf v,100,v,200,v,180
 tr v,194,135,8704
 mf v,104,v,200,v,184
 buffer_load_dwordx4 v[252:255], v128, s[24:27], s51 offen offset:0 sc1
 s_sub_u32 s51, s51, 4096
 mf v,108,v,200,v,188
 buffer_store_dwordx4 v[232:235], v140, s[24:27], s68 offen offset:2048 sc1
 s_add_u32 s68, s68, 131072
 mf v,112,v,204,v,176
 tr v,196,136,8192
 mf v,116,v,204,v,180
 tr v,198,136,8704
 mf v,120,v,204,v,184
 mf v,124,v,204,v,188
 s_waitcnt lgkmcnt(4)
f_C17:
 s_mov_b32 s69, f_C20-f_base
 mf v,0,v,208,v,160
 tr v,200,137,0
 v_add_u32 v131, 0xfffe8000, v131
 mf v,4,v,208,v,164
 tr v,202,137,512
 v_accvgpr_read_b32 v216, a160
 mf v,8,v,208,v,168
 buffer_load_dword v146, v155, s[36:39], s69 offen
 v_accvgpr_read_b32 v217, a161
 mf v,12,v,208,v,172
 v_accvgpr_read_b32 v218, a162
 v_accvgpr_read_b32 v219, a163
 mf v,16,v,212,v,160
 tr v,204,138,0
 v_add_u32 v132, 0xfffe8000, v132
 mf v,20,v,212,v,164
 tr v,206,138,512
 v_accvgpr_read_b32 v220, a176
 mf v,24,v,212,v,168
 buffer_load_dwordx4 v[176:179], v128, s[24:27], s48 offen offset:3072 sc1
 v_accvgpr_read_b32 v221, a177
 mf v,28,v,212,v,172
 s_waitcnt lgkmcnt(4)
 v_accvgpr_read_b32 v222, a178
 v_accvgpr_read_b32 v223, a179
 mf v,64,v,192,v,160
 tr v,208,137,8192
 v_add_u32 v133, 0xfffe8000, v133
 mf v,68,v,192,v,164
 tr v,210,137,8704
 v_cvt_pk_bf16_f32 v236, v216, v217
 mf v,72,v,192,v,168
 buffer_load_dwordx4 v[180:183], v128, s[24:27], s49 offen offset:3072 sc1
 v_cvt_pk_bf16_f32 v237, v218, v219
 mf v,76,v,192,v,172
 v_cvt_pk_bf16_f32 v238, v220, v221
 v_cvt_pk_bf16_f32 v239, v222, v223
 mf v,80,v,196,v,160
 tr v,212,138,8192
 v_add_u32 v134, 0xfffe8000, v134
 mf v,84,v,196,v,164
 tr v,214,138,8704
 mf v,88,v,196,v,168
 buffer_load_dwordx4 v[184:187], v128, s[24:27], s50 offen offset:3072 sc1
 mf v,92,v,196,v,172
 s_waitcnt lgkmcnt(4)
 buffer_store_dwordx4 v[236:239], v139, s[24:27], s68 offen offset:0 sc1
 mf v,32,v,200,v,160
 tr v,192,135,4096
 v_accvgpr_read_b32 v216, a164
 mf v,36,v,200,v,164
 tr v,194,135,4608
 v_accvgpr_read_b32 v217, a165
 mf v,40,v,200,v,168
 buffer_load_dwordx4 v[188:191], v128, s[24:27], s51 offen offset:3072 sc1
 v_accvgpr_read_b32 v218, a166
 mf v,44,v,200,v,172
 v_accvgpr_read_b32 v219, a167
 v_accvgpr_read_b32 v220, a180
 mf v,48,v,204,v,160
 tr v,196,136,4096
 v_accvgpr_read_b32 v221, a181
 mf v,52,v,204,v,164
 tr v,198,136,4608
 s_add_u32 m0, s52, 98304
 mf v,56,v,204,v,168
 buffer_load_dwordx4 v129, s[16:19], s44 offen lds
 v_accvgpr_read_b32 v222, a182
 mf v,60,v,204,v,172
 s_waitcnt lgkmcnt(4)
 v_accvgpr_read_b32 v223, a183
 v_cvt_pk_bf16_f32 v232, v216, v217
 mf v,96,v,208,v,160
 tr v,200,135,12288
 v_cvt_pk_bf16_f32 v233, v218, v219
 mf v,100,v,208,v,164
 tr v,202,135,12800
 s_add_u32 m0, s52, 106496
 mf v,104,v,208,v,168
 buffer_load_dwordx4 v129, s[20:23], s44 offen lds
 s_sub_u32 s44, s44, 229376
 mf v,108,v,208,v,172
 v_cvt_pk_bf16_f32 v234, v220, v221
 v_cvt_pk_bf16_f32 v235, v222, v223
 mf v,112,v,212,v,160
 tr v,204,136,12288
 mf v,116,v,212,v,164
 tr v,206,136,12800
 mf v,120,v,212,v,168
 buffer_store_dwordx4 v[232:235], v140, s[24:27], s68 offen offset:0 sc1
 v_accvgpr_read_b32 v216, a168
 mf v,124,v,212,v,172
 s_waitcnt lgkmcnt(4)
 v_accvgpr_read_b32 v217, a169
 v_accvgpr_read_b32 v218, a170
 mf v,0,v,192,a,240
 tr v,208,137,4096
 v_accvgpr_read_b32 v219, a171
 mf v,4,v,192,a,244
 tr v,210,137,4608
 v_accvgpr_read_b32 v220, a184
 mf v,8,v,192,a,248
 buffer_load_dwordx4 v[160:163], v128, s[24:27], s48 offen offset:2048 sc1
 v_accvgpr_read_b32 v221, a185
 mf v,12,v,192,a,252
 v_accvgpr_read_b32 v222, a186
 v_accvgpr_read_b32 v223, a187
 mf v,16,v,196,a,240
 tr v,212,138,4096
 v_cvt_pk_bf16_f32 v236, v216, v217
 mf v,20,v,196,a,244
 tr v,214,138,4608
 v_cvt_pk_bf16_f32 v237, v218, v219
 mf v,24,v,196,a,248
 buffer_load_dwordx4 v[164:167], v128, s[24:27], s49 offen offset:2048 sc1
 v_cvt_pk_bf16_f32 v238, v220, v221
 mf v,28,v,196,a,252
 s_waitcnt lgkmcnt(4)
 v_cvt_pk_bf16_f32 v239, v222, v223
 mf v,64,v,200,a,240
 tr v,192,137,12288
 mf v,68,v,200,a,244
 tr v,194,137,12800
 mf v,72,v,200,a,248
 buffer_load_dwordx4 v[168:171], v128, s[24:27], s50 offen offset:2048 sc1
 mf v,76,v,200,a,252
 buffer_store_dwordx4 v[236:239], v139, s[24:27], s68 offen offset:2048 sc1
 v_accvgpr_read_b32 v216, a172
 mf v,80,v,204,a,240
 tr v,196,138,12288
 v_accvgpr_read_b32 v217, a173
 mf v,84,v,204,a,244
 tr v,198,138,12800
 v_accvgpr_read_b32 v218, a174
 mf v,88,v,204,a,248
 buffer_load_dwordx4 v[172:175], v128, s[24:27], s51 offen offset:2048 sc1
 v_accvgpr_read_b32 v219, a175
 mf v,92,v,204,a,252
 s_waitcnt lgkmcnt(4)
 v_accvgpr_read_b32 v220, a188
 v_accvgpr_read_b32 v221, a189
 mf v,32,v,208,a,240
 v_accvgpr_read_b32 v222, a190
 v_accvgpr_read_b32 v223, a191
 mf v,36,v,208,a,244
 s_add_u32 m0, s52, 102400
 v_cvt_pk_bf16_f32 v232, v216, v217
 v_cvt_pk_bf16_f32 v233, v218, v219
 mf v,40,v,208,a,248
 buffer_load_dwordx4 v129, s[16:19], s44 offen lds
 v_cvt_pk_bf16_f32 v234, v220, v221
 mf v,44,v,208,a,252
 s_waitcnt vmcnt(35) lgkmcnt(0)
 s_barrier
 v_cvt_pk_bf16_f32 v235, v222, v223
 mf v,48,v,212,a,240
 tr v,200,131,0
 mf v,52,v,212,a,244
 tr v,202,131,512
 mf v,56,v,212,a,248
 tr v,204,132,0
 mf v,60,v,212,a,252
 tr v,206,132,512
 mf v,96,v,192,a,240
 tr v,208,131,8192
 mf v,100,v,192,a,244
 tr v,210,131,8704
 s_add_u32 m0, s52, 110592
 mf v,104,v,192,a,248
 buffer_load_dwordx4 v129, s[20:23], s44 offen lds
 s_sub_u32 s44, s44, 229376
 mf v,108,v,192,a,252
 buffer_store_dwordx4 v[232:235], v140, s[24:27], s68 offen offset:2048 sc1
 s_add_u32 s68, s68, 4063232
 mf v,112,v,196,a,240
 tr v,212,132,8192
 mf v,116,v,196,a,244
 tr v,214,132,8704
 mf v,120,v,196,a,248
 mf v,124,v,196,a,252
 s_waitcnt lgkmcnt(4)
f_C18:
 mf v,0,v,200,a,224
 tr v,192,133,0
 v_add_u32 v135, 0xfffe8000, v135
 mf v,4,v,200,a,228
 tr v,194,133,512
 v_accvgpr_read_b32 v216, a0
 mf v,8,v,200,a,232
 buffer_load_dwordx4 a[240:243], v128, s[24:27], s48 offen offset:1024 sc1
 v_accvgpr_read_b32 v217, a1
 mf v,12,v,200,a,236
 v_accvgpr_read_b32 v218, a2
 v_accvgpr_read_b32 v219, a3
 mf v,16,v,204,a,224
 tr v,196,134,0
 v_add_u32 v136, 0xfffe8000, v136
 mf v,20,v,204,a,228
 tr v,198,134,512
 v_accvgpr_read_b32 v220, a4
 mf v,24,v,204,a,232
 buffer_load_dwordx4 a[244:247], v128, s[24:27], s49 offen offset:1024 sc1
 v_accvgpr_read_b32 v221, a5
 mf v,28,v,204,a,236
 s_waitcnt lgkmcnt(4)
 v_accvgpr_read_b32 v222, a6
 v_accvgpr_read_b32 v223, a7
 mf v,64,v,208,a,224
 tr v,200,133,8192
 v_add_u32 v137, 0xfffe8000, v137
 mf v,68,v,208,a,228
 tr v,202,133,8704
 v_cvt_pk_bf16_f32 v236, v216, v217
 mf v,72,v,208,a,232
 buffer_load_dwordx4 a[248:251], v128, s[24:27], s50 offen offset:1024 sc1
 v_cvt_pk_bf16_f32 v237, v218, v219
 mf v,76,v,208,a,236
 v_cvt_pk_bf16_f32 v238, v220, v221
 v_cvt_pk_bf16_f32 v239, v222, v223
 mf v,80,v,212,a,224
 tr v,204,134,8192
 v_add_u32 v138, 0xfffe8000, v138
 mf v,84,v,212,a,228
 tr v,206,134,8704
 mf v,88,v,212,a,232
 buffer_load_dwordx4 a[252:255], v128, s[24:27], s51 offen offset:1024 sc1
 mf v,92,v,212,a,236
 s_waitcnt lgkmcnt(4)
 buffer_store_dwordx4 v[236:239], v141, s[24:27], s68 offen offset:0 sc1
 mf v,32,v,192,a,224
 tr v,208,131,4096
 v_accvgpr_read_b32 v216, a8
 mf v,36,v,192,a,228
 tr v,210,131,4608
 s_add_u32 m0, s52, 122880
 mf v,40,v,192,a,232
 buffer_load_dwordx4 v129, s[16:19], s44 offen lds
 v_accvgpr_read_b32 v217, a9
 mf v,44,v,192,a,236
 v_accvgpr_read_b32 v218, a10
 v_accvgpr_read_b32 v219, a11
 mf v,48,v,196,a,224
 tr v,212,132,4096
 v_accvgpr_read_b32 v220, a12
 mf v,52,v,196,a,228
 tr v,214,132,4608
 s_add_u32 m0, s52, 131072
 mf v,56,v,196,a,232
 buffer_load_dwordx4 v129, s[20:23], s44 offen lds
 s_sub_u32 s44, s44, 229376
 mf v,60,v,196,a,236
 s_waitcnt lgkmcnt(4)
 v_accvgpr_read_b32 v221, a13
 v_accvgpr_read_b32 v222, a14
 mf v,96,v,200,a,224
 tr v,192,131,12288
 v_accvgpr_read_b32 v223, a15
 mf v,100,v,200,a,228
 tr v,194,131,12800
 s_add_u32 m0, s52, 126976
 mf v,104,v,200,a,232
 buffer_load_dwordx4 v129, s[16:19], s44 offen lds
 v_cvt_pk_bf16_f32 v232, v216, v217
 mf v,108,v,200,a,236
 v_cvt_pk_bf16_f32 v233, v218, v219
 v_cvt_pk_bf16_f32 v234, v220, v221
 mf v,112,v,204,a,224
 tr v,196,132,12288
 v_cvt_pk_bf16_f32 v235, v222, v223
 mf v,116,v,204,a,228
 tr v,198,132,12800
 mf v,120,v,204,a,232
 buffer_store_dwordx4 v[232:235], v141, s[24:27], s68 offen offset:2048 sc1
 v_accvgpr_read_b32 v216, a16
 mf v,124,v,204,a,236
 s_waitcnt lgkmcnt(4)
 v_accvgpr_read_b32 v217, a17
 v_accvgpr_read_b32 v218, a18
 mf v,0,v,208,a,208
 tr v,200,133,4096
 v_accvgpr_read_b32 v219, a19
 mf v,4,v,208,a,212
 tr v,202,133,4608
 v_accvgpr_read_b32 v220, a20
 mf v,8,v,208,a,216
 buffer_load_dwordx4 a[224:227], v128, s[24:27], s48 offen offset:0 sc1
 s_sub_u32 s48, s48, 4096
 mf v,12,v,208,a,220
 v_accvgpr_read_b32 v221, a21
 v_accvgpr_read_b32 v222, a22
 mf v,16,v,212,a,208
 tr v,204,134,4096
 v_accvgpr_read_b32 v223, a23
 mf v,20,v,212,a,212
 tr v,206,134,4608
 v_cvt_pk_bf16_f32 v236, v216, v217
 mf v,24,v,212,a,216
 buffer_load_dwordx4 a[228:231], v128, s[24:27], s49 offen offset:0 sc1
 s_sub_u32 s49, s49, 4096
 mf v,28,v,212,a,220
 s_waitcnt lgkmcnt(4)
 v_cvt_pk_bf16_f32 v237, v218, v219
 v_cvt_pk_bf16_f32 v238, v220, v221
 mf v,64,v,192,a,208
 tr v,208,133,12288
 v_cvt_pk_bf16_f32 v239, v222, v223
 mf v,68,v,192,a,212
 tr v,210,133,12800
 mf v,72,v,192,a,216
 buffer_load_dwordx4 a[232:235], v128, s[24:27], s50 offen offset:0 sc1
 s_sub_u32 s50, s50, 4096
 mf v,76,v,192,a,220
 buffer_store_dwordx4 v[236:239], v141, s[24:27], s68 offen offset:256 sc1
 v_accvgpr_read_b32 v216, a24
 mf v,80,v,196,a,208
 tr v,212,134,12288
 v_accvgpr_read_b32 v217, a25
 mf v,84,v,196,a,212
 tr v,214,134,12800
 v_accvgpr_read_b32 v218, a26
 mf v,88,v,196,a,216
 v_accvgpr_read_b32 v219, a27
 v_accvgpr_read_b32 v220, a28
 mf v,92,v,196,a,220
 s_waitcnt lgkmcnt(4)
 v_accvgpr_read_b32 v221, a29
 v_accvgpr_read_b32 v222, a30
 mf v,32,v,200,a,208
 v_accvgpr_read_b32 v223, a31
 v_cvt_pk_bf16_f32 v232, v216, v217
 mf v,36,v,200,a,212
 v_cvt_pk_bf16_f32 v233, v218, v219
 v_cvt_pk_bf16_f32 v234, v220, v221
 mf v,40,v,200,a,216
 buffer_load_dwordx4 a[236:239], v128, s[24:27], s51 offen offset:0 sc1
 s_sub_u32 s51, s51, 4096
 mf v,44,v,200,a,220
 s_waitcnt vmcnt(47) lgkmcnt(0)
 s_barrier
 v_cvt_pk_bf16_f32 v235, v222, v223
 mf v,48,v,204,a,208
 tr v,192,135,0
 mf v,52,v,204,a,212
 tr v,194,135,512
 mf v,56,v,204,a,216
 tr v,196,136,0
 mf v,60,v,204,a,220
 tr v,198,136,512
 mf v,96,v,208,a,208
 tr v,200,135,8192
 mf v,100,v,208,a,212
 tr v,202,135,8704
 s_add_u32 m0, s52, 135168
 mf v,104,v,208,a,216
 buffer_load_dwordx4 v129, s[20:23], s44 offen lds
 s_sub_u32 s44, s44, 229376
 mf v,108,v,208,a,220
 buffer_store_dwordx4 v[232:235], v141, s[24:27], s68 offen offset:2304 sc1
 s_add_u32 s68, s68, 131072
 mf v,112,v,212,a,208
 tr v,204,136,8192
 mf v,116,v,212,a,212
 tr v,206,136,8704
 mf v,120,v,212,a,216
 mf v,124,v,212,a,220
 s_waitcnt lgkmcnt(4)
f_C19:
 mf v,0,v,192,a,192
 tr v,208,137,0
 v_add_u32 v131, 0xc000, v131
 mf v,4,v,192,a,196
 tr v,210,137,512
 v_accvgpr_read_b32 v216, a32
 mf v,8,v,192,a,200
 buffer_load_dwordx4 a[208:211], v128, s[24:27], s48 offen offset:3072 sc1
 v_accvgpr_read_b32 v217, a33
 mf v,12,v,192,a,204
 v_accvgpr_read_b32 v218, a34
 v_accvgpr_read_b32 v219, a35
 mf v,16,v,196,a,192
 tr v,212,138,0
 v_add_u32 v132, 0xc000, v132
 mf v,20,v,196,a,196
 tr v,214,138,512
 v_accvgpr_read_b32 v220, a36
 mf v,24,v,196,a,200
 buffer_load_dwordx4 a[212:215], v128, s[24:27], s49 offen offset:3072 sc1
 v_accvgpr_read_b32 v221, a37
 mf v,28,v,196,a,204
 s_waitcnt lgkmcnt(4)
 v_accvgpr_read_b32 v222, a38
 v_accvgpr_read_b32 v223, a39
 mf v,64,v,200,a,192
 tr v,192,137,8192
 v_add_u32 v133, 0xc000, v133
 mf v,68,v,200,a,196
 tr v,194,137,8704
 v_cvt_pk_bf16_f32 v236, v216, v217
 mf v,72,v,200,a,200
 buffer_load_dwordx4 a[216:219], v128, s[24:27], s50 offen offset:3072 sc1
 v_cvt_pk_bf16_f32 v237, v218, v219
 mf v,76,v,200,a,204
 v_cvt_pk_bf16_f32 v238, v220, v221
 v_cvt_pk_bf16_f32 v239, v222, v223
 mf v,80,v,204,a,192
 tr v,196,138,8192
 v_add_u32 v134, 0xc000, v134
 mf v,84,v,204,a,196
 tr v,198,138,8704
 mf v,88,v,204,a,200
 buffer_load_dwordx4 a[220:223], v128, s[24:27], s51 offen offset:3072 sc1
 mf v,92,v,204,a,204
 s_waitcnt lgkmcnt(4)
 buffer_store_dwordx4 v[236:239], v141, s[24:27], s68 offen offset:0 sc1
 mf v,32,v,208,a,192
 tr v,200,135,4096
 v_accvgpr_read_b32 v216, a40
 mf v,36,v,208,a,196
 tr v,202,135,4608
 s_add_u32 m0, s52, 0
 mf v,40,v,208,a,200
 buffer_load_dwordx4 v129, s[16:19], s44 offen lds
 v_accvgpr_read_b32 v217, a41
 mf v,44,v,208,a,204
 v_accvgpr_read_b32 v218, a42
 v_accvgpr_read_b32 v219, a43
 mf v,48,v,212,a,192
 tr v,204,136,4096
 v_accvgpr_read_b32 v220, a44
 mf v,52,v,212,a,196
 tr v,206,136,4608
 s_add_u32 m0, s52, 8192
 mf v,56,v,212,a,200
 buffer_load_dwordx4 v129, s[20:23], s44 offen lds
 s_sub_u32 s44, s44, 229376
 mf v,60,v,212,a,204
 s_waitcnt lgkmcnt(4)
 v_accvgpr_read_b32 v221, a45
 v_accvgpr_read_b32 v222, a46
 mf v,96,v,192,a,192
 tr v,208,135,12288
 v_accvgpr_read_b32 v223, a47
 mf v,100,v,192,a,196
 tr v,210,135,12800
 s_add_u32 m0, s52, 4096
 mf v,104,v,192,a,200
 buffer_load_dwordx4 v129, s[16:19], s44 offen lds
 v_cvt_pk_bf16_f32 v232, v216, v217
 mf v,108,v,192,a,204
 v_cvt_pk_bf16_f32 v233, v218, v219
 v_cvt_pk_bf16_f32 v234, v220, v221
 mf v,112,v,196,a,192
 tr v,212,136,12288
 v_cvt_pk_bf16_f32 v235, v222, v223
 mf v,116,v,196,a,196
 tr v,214,136,12800
 mf v,120,v,196,a,200
 buffer_store_dwordx4 v[232:235], v141, s[24:27], s68 offen offset:2048 sc1
 v_accvgpr_read_b32 v216, a48
 mf v,124,v,196,a,204
 s_waitcnt vmcnt(43) lgkmcnt(4)
 v_accvgpr_read_b32 v217, a49
 v_accvgpr_read_b32 v218, a50
 mf v,0,v,200,v,240
 tr v,192,137,4096
 v_accvgpr_read_b32 v219, a51
 mf v,4,v,200,v,244
 tr v,194,137,4608
 v_accvgpr_read_b32 v220, a52
 mf v,8,v,200,v,248
 buffer_load_dwordx4 a[192:195], v128, s[24:27], s48 offen offset:2048 sc1
 v_accvgpr_read_b32 v221, a53
 mf v,12,v,200,v,252
 v_accvgpr_read_b32 v222, a54
 v_accvgpr_read_b32 v223, a55
 mf v,16,v,204,v,240
 tr v,196,138,4096
 v_cvt_pk_bf16_f32 v236, v216, v217
 mf v,20,v,204,v,244
 tr v,198,138,4608
 v_cvt_pk_bf16_f32 v237, v218, v219
 mf v,24,v,204,v,248
 buffer_load_dwordx4 a[196:199], v128, s[24:27], s49 offen offset:2048 sc1
 v_cvt_pk_bf16_f32 v238, v220, v221
 mf v,28,v,204,v,252
 s_waitcnt lgkmcnt(4)
 v_cvt_pk_bf16_f32 v239, v222, v223
 mf v,64,v,208,v,240
 tr v,200,137,12288
 mf v,68,v,208,v,244
 tr v,202,137,12800
 mf v,72,v,208,v,248
 buffer_load_dwordx4 a[200:203], v128, s[24:27], s50 offen offset:2048 sc1
 mf v,76,v,208,v,252
 buffer_store_dwordx4 v[236:239], v141, s[24:27], s68 offen offset:256 sc1
 v_accvgpr_read_b32 v216, a56
 mf v,80,v,212,v,240
 tr v,204,138,12288
 v_accvgpr_read_b32 v217, a57
 mf v,84,v,212,v,244
 tr v,206,138,12800
 v_accvgpr_read_b32 v218, a58
 mf v,88,v,212,v,248
 v_accvgpr_read_b32 v219, a59
 v_accvgpr_read_b32 v220, a60
 mf v,92,v,212,v,252
 s_waitcnt lgkmcnt(4)
 v_accvgpr_read_b32 v221, a61
 v_accvgpr_read_b32 v222, a62
 mf v,32,v,192,v,240
 v_accvgpr_read_b32 v223, a63
 v_cvt_pk_bf16_f32 v232, v216, v217
 mf v,36,v,192,v,244
 v_cvt_pk_bf16_f32 v233, v218, v219
 v_cvt_pk_bf16_f32 v234, v220, v221
 mf v,40,v,192,v,248
 buffer_load_dwordx4 a[204:207], v128, s[24:27], s51 offen offset:2048 sc1
 v_cvt_pk_bf16_f32 v235, v222, v223
 mf v,44,v,192,v,252
 s_waitcnt lgkmcnt(0)
 s_barrier
 mf v,48,v,196,v,240
 tr v,208,131,0
 mf v,52,v,196,v,244
 tr v,210,131,512
 mf v,56,v,196,v,248
 tr v,212,132,0
 mf v,60,v,196,v,252
 tr v,214,132,512
 mf v,96,v,200,v,240
 tr v,192,131,8192
 mf v,100,v,200,v,244
 tr v,194,131,8704
 s_add_u32 m0, s52, 12288
 mf v,104,v,200,v,248
 buffer_load_dwordx4 v129, s[20:23], s44 offen lds
 s_sub_u32 s44, s44, 229376
 mf v,108,v,200,v,252
 buffer_store_dwordx4 v[232:235], v141, s[24:27], s68 offen offset:2304 sc1
 s_add_u32 s68, s68, 131072
 mf v,112,v,204,v,240
 tr v,196,132,8192
 mf v,116,v,204,v,244
 tr v,198,132,8704
 mf v,120,v,204,v,248
 mf v,124,v,204,v,252
 s_waitcnt vmcnt(43) lgkmcnt(4)
f_C20:
 mf v,0,v,208,v,176
 tr v,200,133,0
 v_add_u32 v135, 0xc000, v135
 mf v,4,v,208,v,180
 tr v,202,133,512
 v_accvgpr_read_b32 v216, a64
 mf v,8,v,208,v,184
 buffer_load_dwordx4 v[240:243], v128, s[24:27], s48 offen offset:1024 sc1
 v_accvgpr_read_b32 v217, a65
 mf v,12,v,208,v,188
 v_accvgpr_read_b32 v218, a66
 v_accvgpr_read_b32 v219, a67
 mf v,16,v,212,v,176
 tr v,204,134,0
 v_add_u32 v136, 0xc000, v136
 mf v,20,v,212,v,180
 tr v,206,134,512
 v_accvgpr_read_b32 v220, a68
 mf v,24,v,212,v,184
 buffer_load_dwordx4 v[244:247], v128, s[24:27], s49 offen offset:1024 sc1
 v_accvgpr_read_b32 v221, a69
 mf v,28,v,212,v,188
 s_waitcnt lgkmcnt(4)
 v_accvgpr_read_b32 v222, a70
 v_accvgpr_read_b32 v223, a71
 mf v,64,v,192,v,176
 tr v,208,133,8192
 v_add_u32 v137, 0xc000, v137
 mf v,68,v,192,v,180
 tr v,210,133,8704
 v_cvt_pk_bf16_f32 v236, v216, v217
 mf v,72,v,192,v,184
 buffer_load_dwordx4 v[248:251], v128, s[24:27], s50 offen offset:1024 sc1
 v_cvt_pk_bf16_f32 v237, v218, v219
 mf v,76,v,192,v,188
 v_cvt_pk_bf16_f32 v238, v220, v221
 v_cvt_pk_bf16_f32 v239, v222, v223
 mf v,80,v,196,v,176
 tr v,212,134,8192
 v_add_u32 v138, 0xc000, v138
 mf v,84,v,196,v,180
 tr v,214,134,8704
 mf v,88,v,196,v,184
 buffer_load_dwordx4 v[252:255], v128, s[24:27], s51 offen offset:1024 sc1
 mf v,92,v,196,v,188
 s_waitcnt lgkmcnt(4)
 buffer_store_dwordx4 v[236:239], v141, s[24:27], s68 offen offset:0 sc1
 mf v,32,v,200,v,176
 tr v,192,131,4096
 v_accvgpr_read_b32 v216, a72
 mf v,36,v,200,v,180
 tr v,194,131,4608
 s_add_u32 m0, s52, 24576
 mf v,40,v,200,v,184
 buffer_load_dwordx4 v129, s[16:19], s44 offen lds
 v_accvgpr_read_b32 v217, a73
 mf v,44,v,200,v,188
 v_accvgpr_read_b32 v218, a74
 v_accvgpr_read_b32 v219, a75
 mf v,48,v,204,v,176
 tr v,196,132,4096
 v_accvgpr_read_b32 v220, a76
 mf v,52,v,204,v,180
 tr v,198,132,4608
 s_add_u32 m0, s52, 32768
 mf v,56,v,204,v,184
 buffer_load_dwordx4 v129, s[20:23], s44 offen lds
 s_sub_u32 s44, s44, 229376
 mf v,60,v,204,v,188
 s_waitcnt lgkmcnt(4)
 v_accvgpr_read_b32 v221, a77
 v_accvgpr_read_b32 v222, a78
 mf v,96,v,208,v,176
 tr v,200,131,12288
 v_accvgpr_read_b32 v223, a79
 mf v,100,v,208,v,180
 tr v,202,131,12800
 s_add_u32 m0, s52, 28672
 mf v,104,v,208,v,184
 buffer_load_dwordx4 v129, s[16:19], s44 offen lds
 v_cvt_pk_bf16_f32 v232, v216, v217
 mf v,108,v,208,v,188
 v_cvt_pk_bf16_f32 v233, v218, v219
 v_cvt_pk_bf16_f32 v234, v220, v221
 mf v,112,v,212,v,176
 tr v,204,132,12288
 v_cvt_pk_bf16_f32 v235, v222, v223
 mf v,116,v,212,v,180
 tr v,206,132,12800
 mf v,120,v,212,v,184
 buffer_store_dwordx4 v[232:235], v141, s[24:27], s68 offen offset:2048 sc1
 v_accvgpr_read_b32 v216, a80
 mf v,124,v,212,v,188
 s_waitcnt vmcnt(44) lgkmcnt(4)
 v_accvgpr_read_b32 v217, a81
 v_accvgpr_read_b32 v218, a82
 mf v,0,v,192,v,160
 tr v,208,133,4096
 v_accvgpr_read_b32 v219, a83
 mf v,4,v,192,v,164
 tr v,210,133,4608
 v_accvgpr_read_b32 v220, a84
 mf v,8,v,192,v,168
 buffer_load_dwordx4 v[176:179], v128, s[24:27], s48 offen offset:0 sc1
 s_sub_u32 s48, s48, 4096
 mf v,12,v,192,v,172
 v_accvgpr_read_b32 v221, a85
 v_accvgpr_read_b32 v222, a86
 mf v,16,v,196,v,160
 tr v,212,134,4096
 v_accvgpr_read_b32 v223, a87
 mf v,20,v,196,v,164
 tr v,214,134,4608
 v_cvt_pk_bf16_f32 v236, v216, v217
 mf v,24,v,196,v,168
 buffer_load_dwordx4 v[180:183], v128, s[24:27], s49 offen offset:0 sc1
 s_sub_u32 s49, s49, 4096
 mf v,28,v,196,v,172
 s_waitcnt lgkmcnt(4)
 v_cvt_pk_bf16_f32 v237, v218, v219
 v_cvt_pk_bf16_f32 v238, v220, v221
 mf v,64,v,200,v,160
 tr v,192,133,12288
 v_cvt_pk_bf16_f32 v239, v222, v223
 mf v,68,v,200,v,164
 tr v,194,133,12800
 mf v,72,v,200,v,168
 buffer_load_dwordx4 v[184:187], v128, s[24:27], s50 offen offset:0 sc1
 s_sub_u32 s50, s50, 4096
 mf v,76,v,200,v,172
 buffer_store_dwordx4 v[236:239], v141, s[24:27], s68 offen offset:256 sc1
 v_accvgpr_read_b32 v216, a88
 mf v,80,v,204,v,160
 tr v,196,134,12288
 v_accvgpr_read_b32 v217, a89
 mf v,84,v,204,v,164
 tr v,198,134,12800
 v_accvgpr_read_b32 v218, a90
 mf v,88,v,204,v,168
 v_accvgpr_read_b32 v219, a91
 v_accvgpr_read_b32 v220, a92
 mf v,92,v,204,v,172
 s_waitcnt lgkmcnt(4)
 v_accvgpr_read_b32 v221, a93
 v_accvgpr_read_b32 v222, a94
 mf v,32,v,208,v,160
 v_accvgpr_read_b32 v223, a95
 v_cvt_pk_bf16_f32 v232, v216, v217
 mf v,36,v,208,v,164
 v_cvt_pk_bf16_f32 v233, v218, v219
 v_cvt_pk_bf16_f32 v234, v220, v221
 mf v,40,v,208,v,168
 buffer_load_dwordx4 v[188:191], v128, s[24:27], s51 offen offset:0 sc1
 s_sub_u32 s51, s51, 4096
 mf v,44,v,208,v,172
 s_waitcnt lgkmcnt(0)
 s_barrier
 v_cvt_pk_bf16_f32 v235, v222, v223
 mf v,48,v,212,v,160
 tr v,200,135,0
 mf v,52,v,212,v,164
 tr v,202,135,512
 mf v,56,v,212,v,168
 tr v,204,136,0
 mf v,60,v,212,v,172
 tr v,206,136,512
 mf v,96,v,192,v,160
 tr v,208,135,8192
 mf v,100,v,192,v,164
 tr v,210,135,8704
 s_add_u32 m0, s52, 36864
 mf v,104,v,192,v,168
 buffer_load_dwordx4 v129, s[20:23], s44 offen lds
 s_sub_u32 s44, s44, 229376
 mf v,108,v,192,v,172
 buffer_store_dwordx4 v[232:235], v141, s[24:27], s68 offen offset:2304 sc1
 s_add_u32 s68, s68, 131072
 mf v,112,v,196,v,160
 tr v,212,136,8192
 mf v,116,v,196,v,164
 tr v,214,136,8704
 mf v,120,v,196,v,168
 mf v,124,v,196,v,172
 s_waitcnt vmcnt(44) lgkmcnt(4)
f_C21:
 s_mov_b32 s69, f_C24-f_base
 mf v,0,v,200,a,240
 tr v,192,137,0
 v_add_u32 v131, 0xc000, v131
 mf v,4,v,200,a,244
 tr v,194,137,512
 v_accvgpr_read_b32 v216, a96
 mf v,8,v,200,a,248
 buffer_load_dword v146, v155, s[36:39], s69 offen
 v_accvgpr_read_b32 v217, a97
 mf v,12,v,200,a,252
 v_accvgpr_read_b32 v218, a98
 v_accvgpr_read_b32 v219, a99
 mf v,16,v,204,a,240
 tr v,196,138,0
 v_add_u32 v132, 0xc000, v132
 mf v,20,v,204,a,244
 tr v,198,138,512
 v_accvgpr_read_b32 v220, a100
 mf v,24,v,204,a,248
 buffer_load_dwordx4 v[160:163], v128, s[24:27], s48 offen offset:3072 sc1
 v_accvgpr_read_b32 v221, a101
 mf v,28,v,204,a,252
 s_waitcnt lgkmcnt(4)
 v_accvgpr_read_b32 v222, a102
 v_accvgpr_read_b32 v223, a103
 mf v,64,v,208,a,240
 tr v,200,137,8192
 v_add_u32 v133, 0xc000, v133
 mf v,68,v,208,a,244
 tr v,202,137,8704
 v_cvt_pk_bf16_f32 v236, v216, v217
 mf v,72,v,208,a,248
 buffer_load_dwordx4 v[164:167], v128, s[24:27], s49 offen offset:3072 sc1
 v_cvt_pk_bf16_f32 v237, v218, v219
 mf v,76,v,208,a,252
 v_cvt_pk_bf16_f32 v238, v220, v221
 v_cvt_pk_bf16_f32 v239, v222, v223
 mf v,80,v,212,a,240
 tr v,204,138,8192
 v_add_u32 v134, 0xc000, v134
 mf v,84,v,212,a,244
 tr v,206,138,8704
 mf v,88,v,212,a,248
 buffer_load_dwordx4 v[168:171], v128, s[24:27], s50 offen offset:3072 sc1
 mf v,92,v,212,a,252
 s_waitcnt lgkmcnt(4)
 buffer_store_dwordx4 v[236:239], v141, s[24:27], s68 offen offset:0 sc1
 mf v,32,v,192,a,240
 tr v,208,135,4096
 v_accvgpr_read_b32 v216, a104
 mf v,36,v,192,a,244
 tr v,210,135,4608
 v_accvgpr_read_b32 v217, a105
 mf v,40,v,192,a,248
 buffer_load_dwordx4 v[172:175], v128, s[24:27], s51 offen offset:3072 sc1
 v_accvgpr_read_b32 v218, a106
 mf v,44,v,192,a,252
 v_accvgpr_read_b32 v219, a107
 v_accvgpr_read_b32 v220, a108
 mf v,48,v,196,a,240
 tr v,212,136,4096
 v_accvgpr_read_b32 v221, a109
 mf v,52,v,196,a,244
 tr v,214,136,4608
 s_add_u32 m0, s52, 49152
 mf v,56,v,196,a,248
 buffer_load_dwordx4 v129, s[16:19], s44 offen lds
 v_accvgpr_read_b32 v222, a110
 mf v,60,v,196,a,252
 s_waitcnt lgkmcnt(4)
 v_accvgpr_read_b32 v223, a111
 v_cvt_pk_bf16_f32 v232, v216, v217
 mf v,96,v,200,a,240
 tr v,192,135,12288
 v_cvt_pk_bf16_f32 v233, v218, v219
 mf v,100,v,200,a,244
 tr v,194,135,12800
 s_add_u32 m0, s52, 57344
 mf v,104,v,200,a,248
 buffer_load_dwordx4 v129, s[20:23], s44 offen lds
 s_sub_u32 s44, s44, 229376
 mf v,108,v,200,a,252
 v_cvt_pk_bf16_f32 v234, v220, v221
 v_cvt_pk_bf16_f32 v235, v222, v223
 mf v,112,v,204,a,240
 tr v,196,136,12288
 mf v,116,v,204,a,244
 tr v,198,136,12800
 mf v,120,v,204,a,248
 buffer_store_dwordx4 v[232:235], v141, s[24:27], s68 offen offset:2048 sc1
 v_accvgpr_read_b32 v216, a112
 mf v,124,v,204,a,252
 s_waitcnt vmcnt(43) lgkmcnt(4)
 v_accvgpr_read_b32 v217, a113
 v_accvgpr_read_b32 v218, a114
 mf v,0,v,208,a,224
 tr v,200,137,4096
 v_accvgpr_read_b32 v219, a115
 mf v,4,v,208,a,228
 tr v,202,137,4608
 v_accvgpr_read_b32 v220, a116
 mf v,8,v,208,a,232
 buffer_load_dwordx4 a[240:243], v128, s[24:27], s48 offen offset:2048 sc1
 v_accvgpr_read_b32 v221, a117
 mf v,12,v,208,a,236
 v_accvgpr_read_b32 v222, a118
 v_accvgpr_read_b32 v223, a119
 mf v,16,v,212,a,224
 tr v,204,138,4096
 v_cvt_pk_bf16_f32 v236, v216, v217
 mf v,20,v,212,a,228
 tr v,206,138,4608
 v_cvt_pk_bf16_f32 v237, v218, v219
 mf v,24,v,212,a,232
 buffer_load_dwordx4 a[244:247], v128, s[24:27], s49 offen offset:2048 sc1
 v_cvt_pk_bf16_f32 v238, v220, v221
 mf v,28,v,212,a,236
 s_waitcnt lgkmcnt(4)
 v_cvt_pk_bf16_f32 v239, v222, v223
 mf v,64,v,192,a,224
 tr v,208,137,12288
 mf v,68,v,192,a,228
 tr v,210,137,12800
 mf v,72,v,192,a,232
 buffer_load_dwordx4 a[248:251], v128, s[24:27], s50 offen offset:2048 sc1
 mf v,76,v,192,a,236
 buffer_store_dwordx4 v[236:239], v141, s[24:27], s68 offen offset:256 sc1
 v_accvgpr_read_b32 v216, a120
 mf v,80,v,196,a,224
 tr v,212,138,12288
 v_accvgpr_read_b32 v217, a121
 mf v,84,v,196,a,228
 tr v,214,138,12800
 v_accvgpr_read_b32 v218, a122
 mf v,88,v,196,a,232
 buffer_load_dwordx4 a[252:255], v128, s[24:27], s51 offen offset:2048 sc1
 v_accvgpr_read_b32 v219, a123
 mf v,92,v,196,a,236
 s_waitcnt lgkmcnt(4)
 v_accvgpr_read_b32 v220, a124
 v_accvgpr_read_b32 v221, a125
 mf v,32,v,200,a,224
 v_accvgpr_read_b32 v222, a126
 v_accvgpr_read_b32 v223, a127
 mf v,36,v,200,a,228
 s_add_u32 m0, s52, 53248
 v_cvt_pk_bf16_f32 v232, v216, v217
 v_cvt_pk_bf16_f32 v233, v218, v219
 mf v,40,v,200,a,232
 buffer_load_dwordx4 v129, s[16:19], s44 offen lds
 v_cvt_pk_bf16_f32 v234, v220, v221
 mf v,44,v,200,a,236
 s_waitcnt lgkmcnt(0)
 s_barrier
 v_cvt_pk_bf16_f32 v235, v222, v223
 mf v,48,v,204,a,224
 tr v,192,131,0
 mf v,52,v,204,a,228
 tr v,194,131,512
 mf v,56,v,204,a,232
 tr v,196,132,0
 mf v,60,v,204,a,236
 tr v,198,132,512
 mf v,96,v,208,a,224
 tr v,200,131,8192
 mf v,100,v,208,a,228
 tr v,202,131,8704
 s_add_u32 m0, s52, 61440
 mf v,104,v,208,a,232
 buffer_load_dwordx4 v129, s[20:23], s44 offen lds
 s_sub_u32 s44, s44, 229376
 mf v,108,v,208,a,236
 buffer_store_dwordx4 v[232:235], v141, s[24:27], s68 offen offset:2304 sc1
 mf v,112,v,212,a,224
 tr v,204,132,8192
 mf v,116,v,212,a,228
 tr v,206,132,8704
 mf v,120,v,212,a,232
 mf v,124,v,212,a,236
 s_waitcnt vmcnt(45) lgkmcnt(4)
f_C22:
 mf v,0,v,192,a,208
 tr v,208,133,0
 v_add_u32 v135, 0xc000, v135
 mf v,4,v,192,a,212
 tr v,210,133,512
 mf v,8,v,192,a,216
 buffer_load_dwordx4 a[224:227], v128, s[24:27], s48 offen offset:1024 sc1
 mf v,12,v,192,a,220
 mf v,16,v,196,a,208
 tr v,212,134,0
 v_add_u32 v136, 0xc000, v136
 mf v,20,v,196,a,212
 tr v,214,134,512
 mf v,24,v,196,a,216
 buffer_load_dwordx4 a[228:231], v128, s[24:27], s49 offen offset:1024 sc1
 mf v,28,v,196,a,220
 s_waitcnt lgkmcnt(4)
 mf v,64,v,200,a,208
 tr v,192,133,8192
 v_add_u32 v137, 0xc000, v137
 mf v,68,v,200,a,212
 tr v,194,133,8704
 mf v,72,v,200,a,216
 buffer_load_dwordx4 a[232:235], v128, s[24:27], s50 offen offset:1024 sc1
 mf v,76,v,200,a,220
 mf v,80,v,204,a,208
 tr v,196,134,8192
 v_add_u32 v138, 0xc000, v138
 mf v,84,v,204,a,212
 tr v,198,134,8704
 mf v,88,v,204,a,216
 buffer_load_dwordx4 a[236:239], v128, s[24:27], s51 offen offset:1024 sc1
 mf v,92,v,204,a,220
 s_waitcnt lgkmcnt(4)
 mf v,32,v,208,a,208
 tr v,200,131,4096
 mf v,36,v,208,a,212
 tr v,202,131,4608
 s_add_u32 m0, s52, 73728
 mf v,40,v,208,a,216
 buffer_load_dwordx4 v129, s[16:19], s44 offen lds
 mf v,44,v,208,a,220
 mf v,48,v,212,a,208
 tr v,204,132,4096
 mf v,52,v,212,a,212
 tr v,206,132,4608
 s_add_u32 m0, s52, 81920
 mf v,56,v,212,a,216
 buffer_load_dwordx4 v129, s[20:23], s44 offen lds
 s_sub_u32 s44, s44, 229376
 mf v,60,v,212,a,220
 s_waitcnt lgkmcnt(4)
 mf v,96,v,192,a,208
 tr v,208,131,12288
 mf v,100,v,192,a,212
 tr v,210,131,12800
 s_add_u32 m0, s52, 77824
 mf v,104,v,192,a,216
 buffer_load_dwordx4 v129, s[16:19], s44 offen lds
 mf v,108,v,192,a,220
 mf v,112,v,196,a,208
 tr v,212,132,12288
 mf v,116,v,196,a,212
 tr v,214,132,12800
 mf v,120,v,196,a,216
 mf v,124,v,196,a,220
 s_waitcnt vmcnt(42) lgkmcnt(4)
 mf v,0,v,200,a,192
 tr v,192,133,4096
 mf v,4,v,200,a,196
 tr v,194,133,4608
 mf v,8,v,200,a,200
 buffer_load_dwordx4 a[208:211], v128, s[24:27], s48 offen offset:0 sc1
 s_sub_u32 s48, s48, 4096
 mf v,12,v,200,a,204
 mf v,16,v,204,a,192
 tr v,196,134,4096
 mf v,20,v,204,a,196
 tr v,198,134,4608
 mf v,24,v,204,a,200
 buffer_load_dwordx4 a[212:215], v128, s[24:27], s49 offen offset:0 sc1
 s_sub_u32 s49, s49, 4096
 mf v,28,v,204,a,204
 s_waitcnt lgkmcnt(4)
 mf v,64,v,208,a,192
 tr v,200,133,12288
 mf v,68,v,208,a,196
 tr v,202,133,12800
 mf v,72,v,208,a,200
 buffer_load_dwordx4 a[216:219], v128, s[24:27], s50 offen offset:0 sc1
 s_sub_u32 s50, s50, 4096
 mf v,76,v,208,a,204
 mf v,80,v,212,a,192
 tr v,204,134,12288
 mf v,84,v,212,a,196
 tr v,206,134,12800
 mf v,88,v,212,a,200
 mf v,92,v,212,a,204
 s_waitcnt lgkmcnt(4)
 mf v,32,v,192,a,192
 mf v,36,v,192,a,196
 mf v,40,v,192,a,200
 buffer_load_dwordx4 a[220:223], v128, s[24:27], s51 offen offset:0 sc1
 s_sub_u32 s51, s51, 4096
 mf v,44,v,192,a,204
 s_waitcnt lgkmcnt(0)
 s_barrier
 mf v,48,v,196,a,192
 tr v,208,135,0
 mf v,52,v,196,a,196
 tr v,210,135,512
 mf v,56,v,196,a,200
 tr v,212,136,0
 mf v,60,v,196,a,204
 tr v,214,136,512
 mf v,96,v,200,a,192
 tr v,192,135,8192
 mf v,100,v,200,a,196
 tr v,194,135,8704
 s_add_u32 m0, s52, 86016
 mf v,104,v,200,a,200
 buffer_load_dwordx4 v129, s[20:23], s44 offen lds
 s_sub_u32 s44, s44, 229376
 mf v,108,v,200,a,204
 mf v,112,v,204,a,192
 tr v,196,136,8192
 mf v,116,v,204,a,196
 tr v,198,136,8704
 mf v,120,v,204,a,200
 mf v,124,v,204,a,204
 s_waitcnt vmcnt(41) lgkmcnt(4)
f_C23:
 mf v,0,v,208,v,240
 tr v,200,137,0
 v_add_u32 v131, 0xfffe8000, v131
 mf v,4,v,208,v,244
 tr v,202,137,512
 mf v,8,v,208,v,248
 buffer_load_dwordx4 a[192:195], v128, s[24:27], s48 offen offset:3072 sc1
 mf v,12,v,208,v,252
 mf v,16,v,212,v,240
 tr v,204,138,0
 v_add_u32 v132, 0xfffe8000, v132
 mf v,20,v,212,v,244
 tr v,206,138,512
 mf v,24,v,212,v,248
 buffer_load_dwordx4 a[196:199], v128, s[24:27], s49 offen offset:3072 sc1
 mf v,28,v,212,v,252
 s_waitcnt lgkmcnt(4)
 mf v,64,v,192,v,240
 tr v,208,137,8192
 v_add_u32 v133, 0xfffe8000, v133
 mf v,68,v,192,v,244
 tr v,210,137,8704
 mf v,72,v,192,v,248
 buffer_load_dwordx4 a[200:203], v128, s[24:27], s50 offen offset:3072 sc1
 mf v,76,v,192,v,252
 mf v,80,v,196,v,240
 tr v,212,138,8192
 v_add_u32 v134, 0xfffe8000, v134
 mf v,84,v,196,v,244
 tr v,214,138,8704
 mf v,88,v,196,v,248
 buffer_load_dwordx4 a[204:207], v128, s[24:27], s51 offen offset:3072 sc1
 mf v,92,v,196,v,252
 s_waitcnt lgkmcnt(4)
 mf v,32,v,200,v,240
 tr v,192,135,4096
 mf v,36,v,200,v,244
 tr v,194,135,4608
 s_add_u32 m0, s52, 98304
 mf v,40,v,200,v,248
 buffer_load_dwordx4 v129, s[16:19], s44 offen lds
 mf v,44,v,200,v,252
 mf v,48,v,204,v,240
 tr v,196,136,4096
 mf v,52,v,204,v,244
 tr v,198,136,4608
 s_add_u32 m0, s52, 106496
 mf v,56,v,204,v,248
 buffer_load_dwordx4 v129, s[20:23], s44 offen lds
 s_sub_u32 s44, s44, 229376
 mf v,60,v,204,v,252
 s_waitcnt lgkmcnt(4)
 mf v,96,v,208,v,240
 tr v,200,135,12288
 mf v,100,v,208,v,244
 tr v,202,135,12800
 s_add_u32 m0, s52, 102400
 mf v,104,v,208,v,248
 buffer_load_dwordx4 v129, s[16:19], s44 offen lds
 mf v,108,v,208,v,252
 mf v,112,v,212,v,240
 tr v,204,136,12288
 mf v,116,v,212,v,244
 tr v,206,136,12800
 mf v,120,v,212,v,248
 mf v,124,v,212,v,252
 s_waitcnt vmcnt(38) lgkmcnt(4)
 mf v,0,v,192,v,176
 tr v,208,137,4096
 mf v,4,v,192,v,180
 tr v,210,137,4608
 mf v,8,v,192,v,184
 buffer_load_dwordx4 v[240:243], v128, s[24:27], s48 offen offset:2048 sc1
 mf v,12,v,192,v,188
 mf v,16,v,196,v,176
 tr v,212,138,4096
 mf v,20,v,196,v,180
 tr v,214,138,4608
 mf v,24,v,196,v,184
 buffer_load_dwordx4 v[244:247], v128, s[24:27], s49 offen offset:2048 sc1
 mf v,28,v,196,v,188
 s_waitcnt lgkmcnt(4)
 mf v,64,v,200,v,176
 tr v,192,137,12288
 mf v,68,v,200,v,180
 tr v,194,137,12800
 mf v,72,v,200,v,184
 buffer_load_dwordx4 v[248:251], v128, s[24:27], s50 offen offset:2048 sc1
 mf v,76,v,200,v,188
 mf v,80,v,204,v,176
 tr v,196,138,12288
 mf v,84,v,204,v,180
 tr v,198,138,12800
 mf v,88,v,204,v,184
 buffer_load_dwordx4 v[252:255], v128, s[24:27], s51 offen offset:2048 sc1
 mf v,92,v,204,v,188
 s_waitcnt lgkmcnt(4)
 mf v,32,v,208,v,176
 mf v,36,v,208,v,180
 s_add_u32 m0, s52, 110592
 mf v,40,v,208,v,184
 buffer_load_dwordx4 v129, s[20:23], s44 offen lds
 s_sub_u32 s44, s44, 229376
 mf v,44,v,208,v,188
 s_waitcnt vmcnt(24) lgkmcnt(0)
 s_barrier
 mf v,48,v,212,v,176
 tr v,200,131,0
 mf v,52,v,212,v,180
 tr v,202,131,512
 mf v,56,v,212,v,184
 tr v,204,132,0
 mf v,60,v,212,v,188
 tr v,206,132,512
 mf v,96,v,192,v,176
 tr v,208,131,8192
 mf v,100,v,192,v,180
 tr v,210,131,8704
 mf v,104,v,192,v,184
 buffer_store_dword v144, v143, s[24:27], s72 offen sc1
 mf v,108,v,192,v,188
 mf v,112,v,196,v,176
 tr v,212,132,8192
 mf v,116,v,196,v,180
 tr v,214,132,8704
 mf v,120,v,196,v,184
 mf v,124,v,196,v,188
 s_waitcnt lgkmcnt(4)
f_C24:
 mf v,0,v,200,v,160
 tr v,192,133,0
 v_add_u32 v135, 0xfffe8000, v135
 mf v,4,v,200,v,164
 tr v,194,133,512
 mf v,8,v,200,v,168
 buffer_load_dwordx4 v[176:179], v128, s[24:27], s48 offen offset:1024 sc1
 mf v,12,v,200,v,172
 mf v,16,v,204,v,160
 tr v,196,134,0
 v_add_u32 v136, 0xfffe8000, v136
 mf v,20,v,204,v,164
 tr v,198,134,512
 mf v,24,v,204,v,168
 buffer_load_dwordx4 v[180:183], v128, s[24:27], s49 offen offset:1024 sc1
 mf v,28,v,204,v,172
 s_waitcnt lgkmcnt(4)
 mf v,64,v,208,v,160
 tr v,200,133,8192
 v_add_u32 v137, 0xfffe8000, v137
 mf v,68,v,208,v,164
 tr v,202,133,8704
 mf v,72,v,208,v,168
 buffer_load_dwordx4 v[184:187], v128, s[24:27], s50 offen offset:1024 sc1
 mf v,76,v,208,v,172
 mf v,80,v,212,v,160
 tr v,204,134,8192
 v_add_u32 v138, 0xfffe8000, v138
 mf v,84,v,212,v,164
 tr v,206,134,8704
 mf v,88,v,212,v,168
 buffer_load_dwordx4 v[188:191], v128, s[24:27], s51 offen offset:1024 sc1
 mf v,92,v,212,v,172
 s_waitcnt lgkmcnt(4)
 mf v,32,v,192,v,160
 tr v,208,131,4096
 mf v,36,v,192,v,164
 tr v,210,131,4608
 s_add_u32 m0, s52, 122880
 mf v,40,v,192,v,168
 buffer_load_dwordx4 v129, s[16:19], s44 offen lds
 mf v,44,v,192,v,172
 mf v,48,v,196,v,160
 tr v,212,132,4096
 mf v,52,v,196,v,164
 tr v,214,132,4608
 s_add_u32 m0, s52, 131072
 mf v,56,v,196,v,168
 buffer_load_dwordx4 v129, s[20:23], s44 offen lds
 s_sub_u32 s44, s44, 229376
 mf v,60,v,196,v,172
 s_waitcnt lgkmcnt(4)
 mf v,96,v,200,v,160
 tr v,192,131,12288
 mf v,100,v,200,v,164
 tr v,194,131,12800
 s_add_u32 m0, s52, 126976
 mf v,104,v,200,v,168
 buffer_load_dwordx4 v129, s[16:19], s44 offen lds
 mf v,108,v,200,v,172
 mf v,112,v,204,v,160
 tr v,196,132,12288
 mf v,116,v,204,v,164
 tr v,198,132,12800
 mf v,120,v,204,v,168
 mf v,124,v,204,v,172
 s_waitcnt lgkmcnt(4)
 mf v,0,v,208,a,240
 tr v,200,133,4096
 mf v,4,v,208,a,244
 tr v,202,133,4608
 mf v,8,v,208,a,248
 buffer_load_dwordx4 v[160:163], v128, s[24:27], s48 offen offset:0 sc1
 s_sub_u32 s48, s48, 4096
 mf v,12,v,208,a,252
 mf v,16,v,212,a,240
 tr v,204,134,4096
 mf v,20,v,212,a,244
 tr v,206,134,4608
 mf v,24,v,212,a,248
 buffer_load_dwordx4 v[164:167], v128, s[24:27], s49 offen offset:0 sc1
 s_sub_u32 s49, s49, 4096
 mf v,28,v,212,a,252
 s_waitcnt lgkmcnt(4)
 mf v,64,v,192,a,240
 tr v,208,133,12288
 mf v,68,v,192,a,244
 tr v,210,133,12800
 mf v,72,v,192,a,248
 buffer_load_dwordx4 v[168:171], v128, s[24:27], s50 offen offset:0 sc1
 s_sub_u32 s50, s50, 4096
 mf v,76,v,192,a,252
 mf v,80,v,196,a,240
 tr v,212,134,12288
 mf v,84,v,196,a,244
 tr v,214,134,12800
 mf v,88,v,196,a,248
 mf v,92,v,196,a,252
 s_waitcnt lgkmcnt(4)
 mf v,32,v,200,a,240
 mf v,36,v,200,a,244
 mf v,40,v,200,a,248
 buffer_load_dwordx4 v[172:175], v128, s[24:27], s51 offen offset:0 sc1
 s_sub_u32 s51, s51, 4096
 mf v,44,v,200,a,252
 s_waitcnt lgkmcnt(0)
 s_barrier
 mf v,48,v,204,a,240
 tr v,192,135,0
 mf v,52,v,204,a,244
 tr v,194,135,512
 mf v,56,v,204,a,248
 tr v,196,136,0
 mf v,60,v,204,a,252
 tr v,198,136,512
 mf v,96,v,208,a,240
 tr v,200,135,8192
 mf v,100,v,208,a,244
 tr v,202,135,8704
 s_add_u32 m0, s52, 135168
 mf v,104,v,208,a,248
 buffer_load_dwordx4 v129, s[20:23], s44 offen lds
 s_sub_u32 s44, s44, 229376
 mf v,108,v,208,a,252
 mf v,112,v,212,a,240
 tr v,204,136,8192
 mf v,116,v,212,a,244
 tr v,206,136,8704
 mf v,120,v,212,a,248
 mf v,124,v,212,a,252
 s_waitcnt vmcnt(33) lgkmcnt(4)
f_C25:
 s_mov_b32 s69, f_C28-f_base
 mf v,0,v,192,a,224
 tr v,208,137,0
 v_add_u32 v131, 0xc000, v131
 mf v,4,v,192,a,228
 tr v,210,137,512
 mf v,8,v,192,a,232
 buffer_load_dword v146, v155, s[36:39], s69 offen
 mf v,12,v,192,a,236
 mf v,16,v,196,a,224
 tr v,212,138,0
 v_add_u32 v132, 0xc000, v132
 mf v,20,v,196,a,228
 tr v,214,138,512
 mf v,24,v,196,a,232
 buffer_load_dwordx4 a[240:243], v128, s[24:27], s48 offen offset:3072 sc1
 mf v,28,v,196,a,236
 s_waitcnt lgkmcnt(4)
 mf v,64,v,200,a,224
 tr v,192,137,8192
 v_add_u32 v133, 0xc000, v133
 mf v,68,v,200,a,228
 tr v,194,137,8704
 mf v,72,v,200,a,232
 buffer_load_dwordx4 a[244:247], v128, s[24:27], s49 offen offset:3072 sc1
 mf v,76,v,200,a,236
 mf v,80,v,204,a,224
 tr v,196,138,8192
 v_add_u32 v134, 0xc000, v134
 mf v,84,v,204,a,228
 tr v,198,138,8704
 mf v,88,v,204,a,232
 buffer_load_dwordx4 a[248:251], v128, s[24:27], s50 offen offset:3072 sc1
 mf v,92,v,204,a,236
 s_waitcnt lgkmcnt(4)
 mf v,32,v,208,a,224
 tr v,200,135,4096
 mf v,36,v,208,a,228
 tr v,202,135,4608
 mf v,40,v,208,a,232
 buffer_load_dwordx4 a[252:255], v128, s[24:27], s51 offen offset:3072 sc1
 mf v,44,v,208,a,236
 mf v,48,v,212,a,224
 tr v,204,136,4096
 mf v,52,v,212,a,228
 tr v,206,136,4608
 s_add_u32 m0, s52, 0
 mf v,56,v,212,a,232
 buffer_load_dwordx4 v129, s[16:19], s44 offen lds
 mf v,60,v,212,a,236
 s_waitcnt lgkmcnt(4)
 mf v,96,v,192,a,224
 tr v,208,135,12288
 mf v,100,v,192,a,228
 tr v,210,135,12800
 s_add_u32 m0, s52, 8192
 mf v,104,v,192,a,232
 buffer_load_dwordx4 v129, s[20:23], s44 offen lds
 s_sub_u32 s44, s44, 229376
 mf v,108,v,192,a,236
 mf v,112,v,196,a,224
 tr v,212,136,12288
 mf v,116,v,196,a,228
 tr v,214,136,12800
 mf v,120,v,196,a,232
 mf v,124,v,196,a,236
 s_waitcnt vmcnt(33) lgkmcnt(4)
 mf v,0,v,200,a,208
 tr v,192,137,4096
 mf v,4,v,200,a,212
 tr v,194,137,4608
 mf v,8,v,200,a,216
 buffer_load_dwordx4 a[224:227], v128, s[24:27], s48 offen offset:2048 sc1
 mf v,12,v,200,a,220
 mf v,16,v,204,a,208
 tr v,196,138,4096
 mf v,20,v,204,a,212
 tr v,198,138,4608
 mf v,24,v,204,a,216
 buffer_load_dwordx4 a[228:231], v128, s[24:27], s49 offen offset:2048 sc1
 mf v,28,v,204,a,220
 s_waitcnt lgkmcnt(4)
 mf v,64,v,208,a,208
 tr v,200,137,12288
 mf v,68,v,208,a,212
 tr v,202,137,12800
 mf v,72,v,208,a,216
 buffer_load_dwordx4 a[232:235], v128, s[24:27], s50 offen offset:2048 sc1
 mf v,76,v,208,a,220
 mf v,80,v,212,a,208
 tr v,204,138,12288
 mf v,84,v,212,a,212
 tr v,206,138,12800
 mf v,88,v,212,a,216
 buffer_load_dwordx4 a[236:239], v128, s[24:27], s51 offen offset:2048 sc1
 mf v,92,v,212,a,220
 s_waitcnt lgkmcnt(4)
 mf v,32,v,192,a,208
 mf v,36,v,192,a,212
 s_add_u32 m0, s52, 4096
 mf v,40,v,192,a,216
 buffer_load_dwordx4 v129, s[16:19], s44 offen lds
 mf v,44,v,192,a,220
 s_waitcnt lgkmcnt(0)
 s_barrier
 mf v,48,v,196,a,208
 tr v,208,131,0
 mf v,52,v,196,a,212
 tr v,210,131,512
 mf v,56,v,196,a,216
 tr v,212,132,0
 mf v,60,v,196,a,220
 tr v,214,132,512
 mf v,96,v,200,a,208
 tr v,192,131,8192
 mf v,100,v,200,a,212
 tr v,194,131,8704
 s_add_u32 m0, s52, 12288
 mf v,104,v,200,a,216
 buffer_load_dwordx4 v129, s[20:23], s44 offen lds
 s_sub_u32 s44, s44, 229376
 mf v,108,v,200,a,220
 mf v,112,v,204,a,208
 tr v,196,132,8192
 mf v,116,v,204,a,212
 tr v,198,132,8704
 mf v,120,v,204,a,216
 mf v,124,v,204,a,220
 s_waitcnt vmcnt(34) lgkmcnt(4)
f_C26:
 mf v,0,v,208,a,192
 tr v,200,133,0
 v_add_u32 v135, 0xc000, v135
 mf v,4,v,208,a,196
 tr v,202,133,512
 mf v,8,v,208,a,200
 buffer_load_dwordx4 a[208:211], v128, s[24:27], s48 offen offset:1024 sc1
 mf v,12,v,208,a,204
 mf v,16,v,212,a,192
 tr v,204,134,0
 v_add_u32 v136, 0xc000, v136
 mf v,20,v,212,a,196
 tr v,206,134,512
 mf v,24,v,212,a,200
 buffer_load_dwordx4 a[212:215], v128, s[24:27], s49 offen offset:1024 sc1
 mf v,28,v,212,a,204
 s_waitcnt lgkmcnt(4)
 mf v,64,v,192,a,192
 tr v,208,133,8192
 v_add_u32 v137, 0xc000, v137
 mf v,68,v,192,a,196
 tr v,210,133,8704
 mf v,72,v,192,a,200
 buffer_load_dwordx4 a[216:219], v128, s[24:27], s50 offen offset:1024 sc1
 mf v,76,v,192,a,204
 mf v,80,v,196,a,192
 tr v,212,134,8192
 v_add_u32 v138, 0xc000, v138
 mf v,84,v,196,a,196
 tr v,214,134,8704
 mf v,88,v,196,a,200
 buffer_load_dwordx4 a[220:223], v128, s[24:27], s51 offen offset:1024 sc1
 mf v,92,v,196,a,204
 s_waitcnt lgkmcnt(4)
 mf v,32,v,200,a,192
 tr v,192,131,4096
 mf v,36,v,200,a,196
 tr v,194,131,4608
 s_add_u32 m0, s52, 24576
 mf v,40,v,200,a,200
 buffer_load_dwordx4 v129, s[16:19], s44 offen lds
 mf v,44,v,200,a,204
 mf v,48,v,204,a,192
 tr v,196,132,4096
 mf v,52,v,204,a,196
 tr v,198,132,4608
 s_add_u32 m0, s52, 32768
 mf v,56,v,204,a,200
 buffer_load_dwordx4 v129, s[20:23], s44 offen lds
 s_sub_u32 s44, s44, 229376
 mf v,60,v,204,a,204
 s_waitcnt lgkmcnt(4)
 mf v,96,v,208,a,192
 tr v,200,131,12288
 mf v,100,v,208,a,196
 tr v,202,131,12800
 s_add_u32 m0, s52, 28672
 mf v,104,v,208,a,200
 buffer_load_dwordx4 v129, s[16:19], s44 offen lds
 mf v,108,v,208,a,204
 mf v,112,v,212,a,192
 tr v,204,132,12288
 mf v,116,v,212,a,196
 tr v,206,132,12800
 mf v,120,v,212,a,200
 mf v,124,v,212,a,204
 s_waitcnt vmcnt(34) lgkmcnt(4)
 mf v,0,v,192,v,240
 tr v,208,133,4096
 mf v,4,v,192,v,244
 tr v,210,133,4608
 mf v,8,v,192,v,248
 buffer_load_dwordx4 a[192:195], v128, s[24:27], s48 offen offset:0 sc1
 s_sub_u32 s48, s48, 4096
 mf v,12,v,192,v,252
 mf v,16,v,196,v,240
 tr v,212,134,4096
 mf v,20,v,196,v,244
 tr v,214,134,4608
 mf v,24,v,196,v,248
 buffer_load_dwordx4 a[196:199], v128, s[24:27], s49 offen offset:0 sc1
 s_sub_u32 s49, s49, 4096
 mf v,28,v,196,v,252
 s_waitcnt lgkmcnt(4)
 mf v,64,v,200,v,240
 tr v,192,133,12288
 mf v,68,v,200,v,244
 tr v,194,133,12800
 mf v,72,v,200,v,248
 buffer_load_dwordx4 a[200:203], v128, s[24:27], s50 offen offset:0 sc1
 s_sub_u32 s50, s50, 4096
 mf v,76,v,200,v,252
 mf v,80,v,204,v,240
 tr v,196,134,12288
 mf v,84,v,204,v,244
 tr v,198,134,12800
 mf v,88,v,204,v,248
 mf v,92,v,204,v,252
 s_waitcnt lgkmcnt(4)
 mf v,32,v,208,v,240
 mf v,36,v,208,v,244
 mf v,40,v,208,v,248
 buffer_load_dwordx4 a[204:207], v128, s[24:27], s51 offen offset:0 sc1
 s_sub_u32 s51, s51, 4096
 mf v,44,v,208,v,252
 s_waitcnt lgkmcnt(0)
 s_barrier
 mf v,48,v,212,v,240
 tr v,200,135,0
 mf v,52,v,212,v,244
 tr v,202,135,512
 mf v,56,v,212,v,248
 tr v,204,136,0
 mf v,60,v,212,v,252
 tr v,206,136,512
 mf v,96,v,192,v,240
 tr v,208,135,8192
 mf v,100,v,192,v,244
 tr v,210,135,8704
 s_add_u32 m0, s52, 36864
 mf v,104,v,192,v,248
 buffer_load_dwordx4 v129, s[20:23], s44 offen lds
 s_sub_u32 s44, s44, 229376
 mf v,108,v,192,v,252
 mf v,112,v,196,v,240
 tr v,212,136,8192
 mf v,116,v,196,v,244
 tr v,214,136,8704
 mf v,120,v,196,v,248
 mf v,124,v,196,v,252
 s_waitcnt vmcnt(33) lgkmcnt(4)
f_C27:
 mf v,0,v,200,v,176
 tr v,192,137,0
 v_add_u32 v131, 0xc000, v131
 mf v,4,v,200,v,180
 tr v,194,137,512
 mf v,8,v,200,v,184
 buffer_load_dwordx4 v[240:243], v128, s[24:27], s48 offen offset:3072 sc1
 mf v,12,v,200,v,188
 mf v,16,v,204,v,176
 tr v,196,138,0
 v_add_u32 v132, 0xc000, v132
 mf v,20,v,204,v,180
 tr v,198,138,512
 mf v,24,v,204,v,184
 mf v,28,v,204,v,188
 s_waitcnt lgkmcnt(4)
 mf v,64,v,208,v,176
 tr v,200,137,8192
 v_add_u32 v133, 0xc000, v133
 mf v,68,v,208,v,180
 tr v,202,137,8704
 mf v,72,v,208,v,184
 buffer_load_dwordx4 v[244:247], v128, s[24:27], s49 offen offset:3072 sc1
 mf v,76,v,208,v,188
 mf v,80,v,212,v,176
 tr v,204,138,8192
 v_add_u32 v134, 0xc000, v134
 mf v,84,v,212,v,180
 tr v,206,138,8704
 mf v,88,v,212,v,184
 mf v,92,v,212,v,188
 s_waitcnt lgkmcnt(4)
 mf v,32,v,192,v,176
 tr v,208,135,4096
 mf v,36,v,192,v,180
 tr v,210,135,4608
 mf v,40,v,192,v,184
 buffer_load_dwordx4 v[248:251], v128, s[24:27], s50 offen offset:3072 sc1
 mf v,44,v,192,v,188
 mf v,48,v,196,v,176
 tr v,212,136,4096
 mf v,52,v,196,v,180
 tr v,214,136,4608
 mf v,56,v,196,v,184
 mf v,60,v,196,v,188
 s_waitcnt lgkmcnt(4)
 mf v,96,v,200,v,176
 tr v,192,135,12288
 mf v,100,v,200,v,180
 tr v,194,135,12800
 mf v,104,v,200,v,184
 buffer_load_dwordx4 v[252:255], v128, s[24:27], s51 offen offset:3072 sc1
 mf v,108,v,200,v,188
 mf v,112,v,204,v,176
 tr v,196,136,12288
 mf v,116,v,204,v,180
 tr v,198,136,12800
 mf v,120,v,204,v,184
 mf v,124,v,204,v,188
 s_waitcnt vmcnt(30) lgkmcnt(4)
 mf v,0,v,208,v,160
 tr v,200,137,4096
 mf v,4,v,208,v,164
 tr v,202,137,4608
 mf v,8,v,208,v,168
 buffer_load_dwordx4 v[176:179], v128, s[24:27], s48 offen offset:2048 sc1
 mf v,12,v,208,v,172
 mf v,16,v,212,v,160
 tr v,204,138,4096
 mf v,20,v,212,v,164
 tr v,206,138,4608
 mf v,24,v,212,v,168
 buffer_load_dwordx4 v[180:183], v128, s[24:27], s49 offen offset:2048 sc1
 mf v,28,v,212,v,172
 s_waitcnt lgkmcnt(4)
 mf v,64,v,192,v,160
 tr v,208,137,12288
 mf v,68,v,192,v,164
 tr v,210,137,12800
 mf v,72,v,192,v,168
 mf v,76,v,192,v,172
 mf v,80,v,196,v,160
 tr v,212,138,12288
 mf v,84,v,196,v,164
 tr v,214,138,12800
 mf v,88,v,196,v,168
 buffer_load_dwordx4 v[184:187], v128, s[24:27], s50 offen offset:2048 sc1
 mf v,92,v,196,v,172
 s_waitcnt lgkmcnt(4)
 mf v,32,v,200,v,160
 mf v,36,v,200,v,164
 mf v,40,v,200,v,168
 mf v,44,v,200,v,172
 s_waitcnt lgkmcnt(0)
 s_barrier
 mf v,48,v,204,v,160
 tr v,192,131,0
 mf v,52,v,204,v,164
 tr v,194,131,512
 mf v,56,v,204,v,168
 tr v,196,132,0
 mf v,60,v,204,v,172
 tr v,198,132,512
 mf v,96,v,208,v,160
 tr v,200,131,8192
 mf v,100,v,208,v,164
 tr v,202,131,8704
 mf v,104,v,208,v,168
 buffer_load_dwordx4 v[188:191], v128, s[24:27], s51 offen offset:2048 sc1
 mf v,108,v,208,v,172
 mf v,112,v,212,v,160
 tr v,204,132,8192
 mf v,116,v,212,v,164
 tr v,206,132,8704
 mf v,120,v,212,v,168
 mf v,124,v,212,v,172
 s_waitcnt vmcnt(28) lgkmcnt(4)
f_C28:
 mf v,0,v,192,a,240
 tr v,208,133,0
 v_add_u32 v135, 0xc000, v135
 mf v,4,v,192,a,244
 tr v,210,133,512
 mf v,8,v,192,a,248
 buffer_load_dword v154, v145, s[24:27], s73 offen offset:0 sc1
 mf v,12,v,192,a,252
 mf v,16,v,196,a,240
 tr v,212,134,0
 v_add_u32 v136, 0xc000, v136
 mf v,20,v,196,a,244
 tr v,214,134,512
 mf v,24,v,196,a,248
 buffer_load_dwordx4 v[160:163], v128, s[24:27], s48 offen offset:1024 sc1
 mf v,28,v,196,a,252
 s_waitcnt lgkmcnt(4)
 mf v,64,v,200,a,240
 tr v,192,133,8192
 v_add_u32 v137, 0xc000, v137
 mf v,68,v,200,a,244
 tr v,194,133,8704
 mf v,72,v,200,a,248
 mf v,76,v,200,a,252
 mf v,80,v,204,a,240
 tr v,196,134,8192
 v_add_u32 v138, 0xc000, v138
 mf v,84,v,204,a,244
 tr v,198,134,8704
 mf v,88,v,204,a,248
 buffer_load_dwordx4 v[164:167], v128, s[24:27], s49 offen offset:1024 sc1
 mf v,92,v,204,a,252
 s_waitcnt lgkmcnt(4)
 mf v,32,v,208,a,240
 tr v,200,131,4096
 mf v,36,v,208,a,244
 tr v,202,131,4608
 mf v,40,v,208,a,248
 buffer_load_dwordx4 v[168:171], v128, s[24:27], s50 offen offset:1024 sc1
 mf v,44,v,208,a,252
 mf v,48,v,212,a,240
 tr v,204,132,4096
 mf v,52,v,212,a,244
 tr v,206,132,4608
 mf v,56,v,212,a,248
 mf v,60,v,212,a,252
 s_waitcnt lgkmcnt(4)
 mf v,96,v,192,a,240
 tr v,208,131,12288
 mf v,100,v,192,a,244
 tr v,210,131,12800
 mf v,104,v,192,a,248
 buffer_load_dwordx4 v[172:175], v128, s[24:27], s51 offen offset:1024 sc1
 mf v,108,v,192,a,252
 mf v,112,v,196,a,240
 tr v,212,132,12288
 mf v,116,v,196,a,244
 tr v,214,132,12800
 mf v,120,v,196,a,248
 mf v,124,v,196,a,252
 s_waitcnt vmcnt(27) lgkmcnt(4)
 mf v,0,v,200,a,224
 tr v,192,133,4096
 mf v,4,v,200,a,228
 tr v,194,133,4608
 mf v,8,v,200,a,232
 buffer_load_dwordx4 a[240:243], v128, s[24:27], s48 offen offset:0 sc1
 mf v,12,v,200,a,236
 mf v,16,v,204,a,224
 tr v,196,134,4096
 mf v,20,v,204,a,228
 tr v,198,134,4608
 mf v,24,v,204,a,232
 buffer_load_dwordx4 a[244:247], v128, s[24:27], s49 offen offset:0 sc1
 mf v,28,v,204,a,236
 s_waitcnt lgkmcnt(4)
 mf v,64,v,208,a,224
 tr v,200,133,12288
 mf v,68,v,208,a,228
 tr v,202,133,12800
 mf v,72,v,208,a,232
 mf v,76,v,208,a,236
 mf v,80,v,212,a,224
 tr v,204,134,12288
 mf v,84,v,212,a,228
 tr v,206,134,12800
 mf v,88,v,212,a,232
 buffer_load_dwordx4 a[248:251], v128, s[24:27], s50 offen offset:0 sc1
 mf v,92,v,212,a,236
 s_waitcnt lgkmcnt(4)
 mf v,32,v,192,a,224
 mf v,36,v,192,a,228
 mf v,40,v,192,a,232
 mf v,44,v,192,a,236
 s_waitcnt lgkmcnt(0)
 s_barrier
 mf v,48,v,196,a,224
 tr v,208,135,0
 mf v,52,v,196,a,228
 tr v,210,135,512
 mf v,56,v,196,a,232
 tr v,212,136,0
 mf v,60,v,196,a,236
 tr v,214,136,512
 mf v,96,v,200,a,224
 tr v,192,135,8192
 mf v,100,v,200,a,228
 tr v,194,135,8704
 mf v,104,v,200,a,232
 buffer_load_dwordx4 a[252:255], v128, s[24:27], s51 offen offset:0 sc1
 mf v,108,v,200,a,236
 mf v,112,v,204,a,224
 tr v,196,136,8192
 mf v,116,v,204,a,228
 tr v,198,136,8704
 mf v,120,v,204,a,232
 mf v,124,v,204,a,236
 s_waitcnt vmcnt(25) lgkmcnt(4)
f_C29:
 s_mov_b32 s69, f_att-f_base
 mf v,0,v,208,a,208
 tr v,200,137,0
 v_add_u32 v131, 0xfffe8000, v131
 mf v,4,v,208,a,212
 tr v,202,137,512
 mf v,8,v,208,a,216
 buffer_load_dword v146, v155, s[36:39], s69 offen
 mf v,12,v,208,a,220
 mf v,16,v,212,a,208
 tr v,204,138,0
 v_add_u32 v132, 0xfffe8000, v132
 mf v,20,v,212,a,212
 tr v,206,138,512
 mf v,24,v,212,a,216
 mf v,28,v,212,a,220
 s_waitcnt lgkmcnt(4)
 mf v,64,v,192,a,208
 tr v,208,137,8192
 v_add_u32 v133, 0xfffe8000, v133
 mf v,68,v,192,a,212
 tr v,210,137,8704
 mf v,72,v,192,a,216
 mf v,76,v,192,a,220
 mf v,80,v,196,a,208
 tr v,212,138,8192
 v_add_u32 v134, 0xfffe8000, v134
 mf v,84,v,196,a,212
 tr v,214,138,8704
 mf v,88,v,196,a,216
 mf v,92,v,196,a,220
 s_waitcnt lgkmcnt(4)
 mf v,32,v,200,a,208
 tr v,192,135,4096
 mf v,36,v,200,a,212
 tr v,194,135,4608
 mf v,40,v,200,a,216
 mf v,44,v,200,a,220
 mf v,48,v,204,a,208
 tr v,196,136,4096
 mf v,52,v,204,a,212
 tr v,198,136,4608
 mf v,56,v,204,a,216
 mf v,60,v,204,a,220
 s_waitcnt lgkmcnt(4)
 mf v,96,v,208,a,208
 tr v,200,135,12288
 mf v,100,v,208,a,212
 tr v,202,135,12800
 mf v,104,v,208,a,216
 mf v,108,v,208,a,220
 mf v,112,v,212,a,208
 tr v,204,136,12288
 mf v,116,v,212,a,212
 tr v,206,136,12800
 mf v,120,v,212,a,216
 mf v,124,v,212,a,220
 s_waitcnt vmcnt(19) lgkmcnt(4)
 mf v,0,v,192,a,192
 tr v,208,137,4096
 mf v,4,v,192,a,196
 tr v,210,137,4608
 mf v,8,v,192,a,200
 mf v,12,v,192,a,204
 mf v,16,v,196,a,192
 tr v,212,138,4096
 mf v,20,v,196,a,196
 tr v,214,138,4608
 mf v,24,v,196,a,200
 mf v,28,v,196,a,204
 s_waitcnt lgkmcnt(4)
 mf v,64,v,200,a,192
 tr v,192,137,12288
 mf v,68,v,200,a,196
 tr v,194,137,12800
 mf v,72,v,200,a,200
 mf v,76,v,200,a,204
 mf v,80,v,204,a,192
 tr v,196,138,12288
 mf v,84,v,204,a,196
 tr v,198,138,12800
 mf v,88,v,204,a,200
 mf v,92,v,204,a,204
 s_waitcnt lgkmcnt(4)
 mf v,32,v,208,a,192
 mf v,36,v,208,a,196
 mf v,40,v,208,a,200
 mf v,44,v,208,a,204
 s_waitcnt lgkmcnt(0)
 s_barrier
 mf v,48,v,212,a,192
 tr v,200,131,0
 mf v,52,v,212,a,196
 tr v,202,131,512
 mf v,56,v,212,a,200
 tr v,204,132,0
 mf v,60,v,212,a,204
 tr v,206,132,512
 mf v,96,v,192,a,192
 tr v,208,131,8192
 mf v,100,v,192,a,196
 tr v,210,131,8704
 mf v,104,v,192,a,200
 mf v,108,v,192,a,204
 mf v,112,v,196,a,192
 tr v,212,132,8192
 mf v,116,v,196,a,196
 tr v,214,132,8704
 mf v,120,v,196,a,200
 mf v,124,v,196,a,204
 s_waitcnt vmcnt(14) lgkmcnt(4)
f_C30:
 s_waitcnt vmcnt(9)
 v_cmp_ne_u32 vcc, v144, v154
 s_cbranch_vccnz f_pqC
f_pqC_back:
 mf v,0,v,200,v,240
 tr v,192,133,0
 v_add_u32 v135, 0xfffe8000, v135
 mf v,4,v,200,v,244
 tr v,194,133,512
 mf v,8,v,200,v,248
 buffer_load_dwordx4 a[32:35], v128, s[24:27], s63 offen offset:0 sc1
 mf v,12,v,200,v,252
 mf v,16,v,204,v,240
 tr v,196,134,0
 v_add_u32 v136, 0xfffe8000, v136
 mf v,20,v,204,v,244
 tr v,198,134,512
 mf v,24,v,204,v,248
 buffer_load_dwordx4 a[36:39], v128, s[24:27], s63 offen offset:1024 sc1
 mf v,28,v,204,v,252
 s_waitcnt lgkmcnt(4)
 mf v,64,v,208,v,240
 tr v,200,133,8192
 v_add_u32 v137, 0xfffe8000, v137
 mf v,68,v,208,v,244
 tr v,202,133,8704
 mf v,72,v,208,v,248
 buffer_load_dwordx4 a[0:3], v128, s[24:27], s65 offen offset:0 sc1
 mf v,76,v,208,v,252
 mf v,80,v,212,v,240
 tr v,204,134,8192
 v_add_u32 v138, 0xfffe8000, v138
 mf v,84,v,212,v,244
 tr v,206,134,8704
 mf v,88,v,212,v,248
 buffer_load_dwordx4 a[4:7], v128, s[24:27], s65 offen offset:1024 sc1
 mf v,92,v,212,v,252
 s_waitcnt lgkmcnt(4)
 mf v,32,v,192,v,240
 tr v,208,131,4096
 mf v,36,v,192,v,244
 tr v,210,131,4608
 mf v,40,v,192,v,248
 buffer_load_dwordx4 a[8:11], v128, s[24:27], s65 offen offset:2048 sc1
 mf v,44,v,192,v,252
 mf v,48,v,196,v,240
 tr v,212,132,4096
 mf v,52,v,196,v,244
 tr v,214,132,4608
 mf v,56,v,196,v,248
 buffer_load_dwordx4 a[12:15], v128, s[24:27], s65 offen offset:3072 sc1
 mf v,60,v,196,v,252
 s_waitcnt lgkmcnt(4)
 mf v,96,v,200,v,240
 tr v,192,131,12288
 mf v,100,v,200,v,244
 tr v,194,131,12800
 mf v,104,v,200,v,248
 buffer_load_dwordx4 a[16:19], v128, s[24:27], s66 offen offset:0 sc1
 mf v,108,v,200,v,252
 mf v,112,v,204,v,240
 tr v,196,132,12288
 mf v,116,v,204,v,244
 tr v,198,132,12800
 mf v,120,v,204,v,248
 buffer_load_dwordx4 a[20:23], v128, s[24:27], s66 offen offset:1024 sc1
 mf v,124,v,204,v,252
 s_waitcnt lgkmcnt(4)
 mf v,0,v,208,v,176
 tr v,200,133,4096
 mf v,4,v,208,v,180
 tr v,202,133,4608
 mf v,8,v,208,v,184
 buffer_load_dwordx4 a[64:67], v128, s[24:27], s64 offen offset:0 sc1
 mf v,12,v,208,v,188
 mf v,16,v,212,v,176
 tr v,204,134,4096
 mf v,20,v,212,v,180
 tr v,206,134,4608
 mf v,24,v,212,v,184
 buffer_load_dwordx4 a[68:71], v128, s[24:27], s64 offen offset:1024 sc1
 mf v,28,v,212,v,188
 s_waitcnt lgkmcnt(4)
 mf v,64,v,192,v,176
 tr v,208,133,12288
 mf v,68,v,192,v,180
 tr v,210,133,12800
 mf v,72,v,192,v,184
 buffer_load_dwordx4 a[24:27], v128, s[24:27], s66 offen offset:2048 sc1
 mf v,76,v,192,v,188
 mf v,80,v,196,v,176
 tr v,212,134,12288
 mf v,84,v,196,v,180
 tr v,214,134,12800
 mf v,88,v,196,v,184
 buffer_load_dwordx4 a[28:31], v128, s[24:27], s66 offen offset:3072 sc1
 mf v,92,v,196,v,188
 s_waitcnt lgkmcnt(4)
 mf v,32,v,200,v,176
 mf v,36,v,200,v,180
 mf v,40,v,200,v,184
 buffer_load_dwordx4 a[40:43], v128, s[24:27], s63 offen offset:2048 sc1
 mf v,44,v,200,v,188
 s_waitcnt lgkmcnt(0)
 s_barrier
 mf v,48,v,204,v,176
 tr v,192,135,0
 mf v,52,v,204,v,180
 tr v,194,135,512
 mf v,56,v,204,v,184
 tr v,196,135,4096
 mf v,60,v,204,v,188
 tr v,198,135,4608
 mf v,96,v,208,v,176
 tr v,200,136,0
 mf v,100,v,208,v,180
 tr v,202,136,512
 mf v,104,v,208,v,184
 buffer_load_dwordx4 a[44:47], v128, s[24:27], s63 offen offset:3072 sc1
 mf v,108,v,208,v,188
 mf v,112,v,212,v,176
 tr v,204,136,4096
 mf v,116,v,212,v,180
 tr v,206,136,4608
 mf v,120,v,212,v,184
 mf v,124,v,212,v,188
 s_waitcnt vmcnt(15) lgkmcnt(4)
f_C31:
 s_add_u32 s63, s63, 4096
 mf v,0,v,192,v,160
 tr v,208,135,8192
 mf v,0,v,196,a,240
 tr v,210,135,8704
 mf v,4,v,192,v,164
 buffer_load_dwordx4 a[72:75], v128, s[24:27], s64 offen offset:2048 sc1
 mf v,4,v,196,a,244
 mf v,8,v,192,v,168
 tr v,212,135,12288
 mf v,8,v,196,a,248
 tr v,214,135,12800
 mf v,12,v,192,v,172
 buffer_load_dwordx4 a[76:79], v128, s[24:27], s64 offen offset:3072 sc1
 s_add_u32 s64, s64, 4096
 mf v,12,v,196,a,252
 s_waitcnt lgkmcnt(4)
 mf v,16,v,200,v,160
 tr v,192,136,8192
 mf v,16,v,204,a,240
 tr v,194,136,8704
 mf v,20,v,200,v,164
 buffer_load_dwordx4 a[48:51], v128, s[24:27], s63 offen offset:0 sc1
 mf v,20,v,204,a,244
 mf v,24,v,200,v,168
 tr v,196,136,12288
 mf v,24,v,204,a,248
 tr v,198,136,12800
 mf v,28,v,200,v,172
 mf v,28,v,204,a,252
 s_waitcnt lgkmcnt(4)
 mf v,64,v,208,v,160
 tr v,200,137,0
 mf v,64,v,212,a,240
 tr v,202,137,512
 mf v,68,v,208,v,164
 buffer_load_dwordx4 a[52:55], v128, s[24:27], s63 offen offset:1024 sc1
 mf v,68,v,212,a,244
 mf v,72,v,208,v,168
 tr v,204,137,4096
 mf v,72,v,212,a,248
 tr v,206,137,4608
 mf v,76,v,208,v,172
 buffer_load_dwordx4 a[80:83], v128, s[24:27], s64 offen offset:0 sc1
 mf v,76,v,212,a,252
 s_waitcnt lgkmcnt(4)
 mf v,80,v,192,v,160
 tr v,208,138,0
 mf v,80,v,196,a,240
 tr v,210,138,512
 mf v,84,v,192,v,164
 buffer_load_dwordx4 a[84:87], v128, s[24:27], s64 offen offset:1024 sc1
 mf v,84,v,196,a,244
 mf v,88,v,192,v,168
 tr v,212,138,4096
 mf v,88,v,196,a,248
 tr v,214,138,4608
 mf v,92,v,192,v,172
 mf v,92,v,196,a,252
 s_waitcnt lgkmcnt(4)
 mf v,32,v,200,v,160
 tr v,192,137,8192
 mf v,32,v,204,a,240
 tr v,194,137,8704
 mf v,36,v,200,v,164
 mf v,36,v,204,a,244
 v_mul_f32 v216, v0, v64
 v_mul_f32 v217, v1, v65
 mf v,40,v,200,v,168
 tr v,196,137,12288
 v_mul_f32 v218, v2, v66
 mf v,40,v,204,a,248
 tr v,198,137,12800
 v_mul_f32 v219, v3, v67
 mf v,44,v,200,v,172
 v_mul_f32 v220, v16, v80
 v_mul_f32 v221, v17, v81
 mf v,44,v,204,a,252
 s_waitcnt lgkmcnt(4)
 v_mul_f32 v222, v18, v82
 v_mul_f32 v223, v19, v83
 mf v,48,v,208,v,160
 tr v,200,138,8192
 v_cvt_pk_bf16_f32 v236, v216, v217
 mf v,48,v,212,a,240
 tr v,202,138,8704
 v_cvt_pk_bf16_f32 v237, v218, v219
 mf v,52,v,208,v,164
 v_cvt_pk_bf16_f32 v238, v220, v221
 v_cvt_pk_bf16_f32 v239, v222, v223
 mf v,52,v,212,a,244
 buffer_store_dwordx4 v[236:239], v128, s[24:27], s67 offen offset:0 sc1
 s_add_u32 s67, s67, 147456
 mf v,56,v,208,v,168
 tr v,204,138,12288
 v_mul_f32 v216, v4, v68
 mf v,56,v,212,a,248
 tr v,206,138,12800
 v_mul_f32 v217, v5, v69
 mf v,60,v,208,v,172
 v_mul_f32 v218, v6, v70
 v_mul_f32 v219, v7, v71
 mf v,60,v,212,a,252
 s_waitcnt lgkmcnt(4)
 v_mul_f32 v220, v20, v84
 v_mul_f32 v221, v21, v85
 mf v,96,v,192,v,160
 v_mul_f32 v222, v22, v86
 v_mul_f32 v223, v23, v87
 mf v,96,v,196,a,240
 v_cvt_pk_bf16_f32 v232, v216, v217
 v_cvt_pk_bf16_f32 v233, v218, v219
 mf v,100,v,192,v,164
 v_cvt_pk_bf16_f32 v234, v220, v221
 v_cvt_pk_bf16_f32 v235, v222, v223
 mf v,100,v,196,a,244
 buffer_store_dwordx4 v[232:235], v128, s[24:27], s67 offen offset:0 sc1
 s_add_u32 s67, s67, 147456
 mf v,104,v,192,v,168
 v_mul_f32 v216, v8, v72
 v_mul_f32 v217, v9, v73
 mf v,104,v,196,a,248
 v_mul_f32 v218, v10, v74
 v_mul_f32 v219, v11, v75
 mf v,108,v,192,v,172
 v_mul_f32 v220, v24, v88
 v_mul_f32 v221, v25, v89
 mf v,108,v,196,a,252
 s_waitcnt lgkmcnt(0)
 v_mul_f32 v222, v26, v90
 v_mul_f32 v223, v27, v91
 mf v,112,v,200,v,160
 v_cvt_pk_bf16_f32 v236, v216, v217
 v_cvt_pk_bf16_f32 v237, v218, v219
 mf v,112,v,204,a,240
 v_cvt_pk_bf16_f32 v238, v220, v221
 v_cvt_pk_bf16_f32 v239, v222, v223
 mf v,116,v,200,v,164
 buffer_store_dwordx4 v[236:239], v128, s[24:27], s67 offen offset:0 sc1
 s_add_u32 s67, s67, 147456
 mf v,116,v,204,a,244
 v_mul_f32 v216, v12, v76
 v_mul_f32 v217, v13, v77
 mf v,120,v,200,v,168
 v_mul_f32 v218, v14, v78
 v_mul_f32 v219, v15, v79
 mf v,120,v,204,a,248
 v_mul_f32 v220, v28, v92
 v_mul_f32 v221, v29, v93
 mf v,124,v,200,v,172
 v_mul_f32 v222, v30, v94
 v_mul_f32 v223, v31, v95
 mf v,124,v,204,a,252
 v_cvt_pk_bf16_f32 v232, v216, v217
 v_cvt_pk_bf16_f32 v233, v218, v219
 v_cvt_pk_bf16_f32 v234, v220, v221
 v_cvt_pk_bf16_f32 v235, v222, v223
 buffer_store_dwordx4 v[232:235], v128, s[24:27], s67 offen offset:0 sc1
f_att:
 s_waitcnt vmcnt(20)
 v_mfma_f32_32x32x16_bf16 v[0:15], a[32:35], a[0:3], 0
 mg v,0,a,36,a,4
 v_lshrrev_b32 v145, 9, v128
 v_bfe_u32 v129, v128, 4, 5
 v_lshlrev_b32 v129, 4, v129
 v_lshl_add_u32 v145, v145, 2, v129
 s_load_dwordx2 s[20:21], s[0:1], 56
 s_mov_b32 s22, 4194304
 s_mov_b32 s23, 0x00020000
 s_load_dwordx2 s[28:29], s[0:1], 48
 s_load_dwordx2 s[32:33], s[0:1], 16
 s_mov_b32 s30, 7340032
 s_mov_b32 s34, 2097152
 s_xor_b32 s10, s3, 2
 s_mul_i32 s10, s10, 40960
 v_add_u32 v131, s10, v128
 v_add_u32 v132, s53, v128
 v_lshrrev_b32 v134, 1, v128
 v_add_u32 v134, 0x7000, v134
 v_add_u32 v133, s10, v134
 v_add_u32 v134, s53, v134
 v_bfe_u32 v129, v128, 8, 1
 v_lshrrev_b32 v130, 9, v128
 v_and_b32 v146, 0xf0, v128
 v_lshl_add_u32 v146, v130, 8, v146
 s_mov_b32 s10, 147456
 v_mad_u32_u24 v146, v129, s10, v146
 s_mov_b32 s10, 81920
 s_bitcmp1_b32 s2, 0
 s_cselect_b32 s10, 4294885376, s10
 v_add_u32 v135, s10, v151
 v_bfe_i32 v137, v128, 4, 1
 v_and_b32 v137, 0xaaaaaaaa, v137
 v_or_b32 v137, 0x44444444, v137
 v_xor_b32 v152, 32, v151
 v_xor_b32 v141, 64, v151
 v_xor_b32 v130, 96, v151
 v_xor_b32 v136, 32, v135
 v_xor_b32 v138, 64, v135
 v_xor_b32 v140, 96, v135
 v_pk_mul_f32 v[216:217], v[44:45], v[108:109]
 v_pk_mul_f32 v[218:219], v[46:47], v[110:111]
 v_pk_mul_f32 v[220:221], v[60:61], v[124:125]
 v_pk_mul_f32 v[222:223], v[62:63], v[126:127]
 v_cvt_pk_bf16_f32 v236, v216, v217
 v_cvt_pk_bf16_f32 v237, v218, v219
 v_cvt_pk_bf16_f32 v238, v220, v221
 v_cvt_pk_bf16_f32 v239, v222, v223
 buffer_store_dwordx4 v[236:239], v128, s[24:27], s67 offen offset:1024 sc1
 s_sub_u32 s67, s67, 147456
 v_pk_mul_f32 v[216:217], v[40:41], v[104:105]
 v_pk_mul_f32 v[218:219], v[42:43], v[106:107]
 v_pk_mul_f32 v[220:221], v[56:57], v[120:121]
 v_pk_mul_f32 v[222:223], v[58:59], v[122:123]
 v_cvt_pk_bf16_f32 v232, v216, v217
 v_cvt_pk_bf16_f32 v233, v218, v219
 v_cvt_pk_bf16_f32 v234, v220, v221
 v_cvt_pk_bf16_f32 v235, v222, v223
 buffer_store_dwordx4 v[232:235], v128, s[24:27], s67 offen offset:1024 sc1
 s_sub_u32 s67, s67, 147456
 v_pk_mul_f32 v[216:217], v[36:37], v[100:101]
 v_pk_mul_f32 v[218:219], v[38:39], v[102:103]
 v_pk_mul_f32 v[220:221], v[52:53], v[116:117]
 v_pk_mul_f32 v[222:223], v[54:55], v[118:119]
 v_cvt_pk_bf16_f32 v236, v216, v217
 v_cvt_pk_bf16_f32 v237, v218, v219
 v_cvt_pk_bf16_f32 v238, v220, v221
 v_cvt_pk_bf16_f32 v239, v222, v223
 buffer_store_dwordx4 v[236:239], v128, s[24:27], s67 offen offset:1024 sc1
 s_sub_u32 s67, s67, 147456
 v_pk_mul_f32 v[216:217], v[32:33], v[96:97]
 v_pk_mul_f32 v[218:219], v[34:35], v[98:99]
 v_pk_mul_f32 v[220:221], v[48:49], v[112:113]
 v_pk_mul_f32 v[222:223], v[50:51], v[114:115]
 v_cvt_pk_bf16_f32 v232, v216, v217
 v_cvt_pk_bf16_f32 v233, v218, v219
 v_cvt_pk_bf16_f32 v234, v220, v221
 v_cvt_pk_bf16_f32 v235, v222, v223
 buffer_store_dwordx4 v[232:235], v128, s[24:27], s67 offen offset:1024 sc1
 v_mov_b64 v[112:113], 0
 v_mov_b64 v[114:115], 0
 v_mov_b64 v[116:117], 0
 v_mov_b64 v[118:119], 0
 v_mov_b64 v[120:121], 0
 v_mov_b64 v[122:123], 0
 v_mov_b64 v[124:125], 0
 v_mov_b64 v[126:127], 0
 s_waitcnt vmcnt(22)
f_t0:
 v_mfma_f32_32x32x16_bf16 v[16:31], a[32:35], a[8:11], 0
 buffer_load_dwordx4 a[56:59], v128, s[24:27], s63 offen offset:2048 sc1
 v_exp_f32 v0, v0
 v_exp_f32 v1, v1
 v_exp_f32 v2, v2
 v_exp_f32 v3, v3
 mg v,16,a,36,a,12
 v_exp_f32 v4, v4
 v_cvt_pk_bf16_f32 v32, v0, v1
 v_exp_f32 v5, v5
 v_cvt_pk_bf16_f32 v33, v2, v3
 v_exp_f32 v6, v6
 v_exp_f32 v7, v7
 v_cvt_pk_bf16_f32 v34, v4, v5
 v_exp_f32 v8, v8
 v_exp_f32 v9, v9
 v_cvt_pk_bf16_f32 v35, v6, v7
 v_exp_f32 v10, v10
 v_exp_f32 v11, v11
 v_cvt_pk_bf16_f32 v36, v8, v9
 v_exp_f32 v12, v12
 v_exp_f32 v13, v13
 v_cvt_pk_bf16_f32 v37, v10, v11
 v_exp_f32 v14, v14
 v_exp_f32 v15, v15
 v_cvt_pk_bf16_f32 v38, v12, v13
 v_cvt_pk_bf16_f32 v39, v14, v15
 s_waitcnt vmcnt(21)
 s_waitcnt vmcnt(19)
 s_waitcnt lgkmcnt(0)
f_t1:
 v_mfma_f32_32x32x16_bf16 v[0:15], a[32:35], a[16:19], 0
 buffer_load_dwordx4 a[60:63], v128, s[24:27], s63 offen offset:3072 sc1
 v_exp_f32 v16, v16
 v_exp_f32 v17, v17
 v_exp_f32 v18, v18
 v_exp_f32 v19, v19
 mg v,0,a,36,a,20
 v_exp_f32 v20, v20
 v_cvt_pk_bf16_f32 v40, v16, v17
 v_exp_f32 v21, v21
 v_cvt_pk_bf16_f32 v41, v18, v19
 v_exp_f32 v22, v22
 v_mfma_f32_32x32x16_bf16 v[48:63], a[64:67], v[32:35], 0
 v_exp_f32 v23, v23
 v_cvt_pk_bf16_f32 v42, v20, v21
 v_exp_f32 v24, v24
 v_exp_f32 v25, v25
 v_cvt_pk_bf16_f32 v43, v22, v23
 v_smfmac_f32_16x16x64_bf16 v[112:115], v[156:159], v[32:39], v137
 s_add_u32 s63, s63, 4096
 v_exp_f32 v26, v26
 v_exp_f32 v27, v27
 v_cvt_pk_bf16_f32 v44, v24, v25
 mg v,48,a,68,v,36
 v_exp_f32 v28, v28
 v_exp_f32 v29, v29
 v_cvt_pk_bf16_f32 v45, v26, v27
 v_exp_f32 v30, v30
 v_exp_f32 v31, v31
 v_cvt_pk_bf16_f32 v46, v28, v29
 v_cvt_pk_bf16_f32 v47, v30, v31
 s_waitcnt vmcnt(18)
f_t2:
 v_mfma_f32_32x32x16_bf16 v[16:31], a[32:35], a[24:27], 0
 buffer_load_dwordx4 a[88:91], v128, s[24:27], s64 offen offset:2048 sc1
 v_exp_f32 v0, v0
 v_exp_f32 v1, v1
 v_exp_f32 v2, v2
 v_exp_f32 v3, v3
 mg v,16,a,36,a,28
 v_exp_f32 v4, v4
 v_cvt_pk_bf16_f32 v32, v0, v1
 v_exp_f32 v5, v5
 v_cvt_pk_bf16_f32 v33, v2, v3
 v_exp_f32 v6, v6
 v_mfma_f32_32x32x16_bf16 v[64:79], a[64:67], v[40:43], 0
 v_exp_f32 v7, v7
 v_cvt_pk_bf16_f32 v34, v4, v5
 v_exp_f32 v8, v8
 v_exp_f32 v9, v9
 v_cvt_pk_bf16_f32 v35, v6, v7
 v_smfmac_f32_16x16x64_bf16 v[116:119], v[156:159], v[40:47], v137
 v_exp_f32 v10, v10
 v_exp_f32 v11, v11
 v_cvt_pk_bf16_f32 v36, v8, v9
 mg v,64,a,68,v,44
 v_exp_f32 v12, v12
 v_exp_f32 v13, v13
 v_cvt_pk_bf16_f32 v37, v10, v11
 v_exp_f32 v14, v14
 v_exp_f32 v15, v15
 v_cvt_pk_bf16_f32 v38, v12, v13
 v_cvt_pk_bf16_f32 v39, v14, v15
 s_waitcnt vmcnt(15)
f_t3:
 v_mfma_f32_32x32x16_bf16 v[0:15], a[40:43], a[0:3], 0
 buffer_load_dwordx4 a[92:95], v128, s[24:27], s64 offen offset:3072 sc1
 v_exp_f32 v16, v16
 v_exp_f32 v17, v17
 v_exp_f32 v18, v18
 v_exp_f32 v19, v19
 mg v,0,a,44,a,4
 buffer_load_dword v129, v142, s[28:31], s77 offen
 v_exp_f32 v20, v20
 v_cvt_pk_bf16_f32 v40, v16, v17
 v_exp_f32 v21, v21
 v_cvt_pk_bf16_f32 v41, v18, v19
 v_exp_f32 v22, v22
 v_mfma_f32_32x32x16_bf16 v[80:95], a[64:67], v[32:35], 0
 v_exp_f32 v23, v23
 v_cvt_pk_bf16_f32 v42, v20, v21
 v_exp_f32 v24, v24
 v_exp_f32 v25, v25
 v_cvt_pk_bf16_f32 v43, v22, v23
 v_smfmac_f32_16x16x64_bf16 v[120:123], v[156:159], v[32:39], v137
 s_add_u32 s64, s64, 4096
 v_exp_f32 v26, v26
 v_exp_f32 v27, v27
 v_cvt_pk_bf16_f32 v44, v24, v25
 mg v,80,a,68,v,36
 v_exp_f32 v28, v28
 v_exp_f32 v29, v29
 v_cvt_pk_bf16_f32 v45, v26, v27
 v_exp_f32 v30, v30
 v_exp_f32 v31, v31
 s_add_u32 s77, s77, 0x200000
 v_cvt_pk_bf16_f32 v46, v28, v29
 v_cvt_pk_bf16_f32 v47, v30, v31
f_t4:
 v_mfma_f32_32x32x16_bf16 v[16:31], a[40:43], a[8:11], 0
 buffer_load_dwordx4 a[32:35], v128, s[24:27], s63 offen offset:0 sc1
 v_exp_f32 v0, v0
 v_exp_f32 v1, v1
 v_exp_f32 v2, v2
 v_exp_f32 v3, v3
 mg v,16,a,44,a,12
 v_exp_f32 v4, v4
 v_cvt_pk_bf16_f32 v32, v0, v1
 v_exp_f32 v5, v5
 v_cvt_pk_bf16_f32 v33, v2, v3
 v_exp_f32 v6, v6
 v_mfma_f32_32x32x16_bf16 v[96:111], a[64:67], v[40:43], 0
 v_exp_f32 v7, v7
 v_cvt_pk_bf16_f32 v34, v4, v5
 v_exp_f32 v8, v8
 v_exp_f32 v9, v9
 v_cvt_pk_bf16_f32 v35, v6, v7
 v_smfmac_f32_16x16x64_bf16 v[124:127], v[156:159], v[40:47], v137
 v_exp_f32 v10, v10
 v_exp_f32 v11, v11
 v_cvt_pk_bf16_f32 v36, v8, v9
 mg v,96,a,68,v,44
 v_exp_f32 v12, v12
 v_exp_f32 v13, v13
 v_cvt_pk_bf16_f32 v37, v10, v11
 v_exp_f32 v14, v14
 v_exp_f32 v15, v15
 v_cvt_pk_bf16_f32 v38, v12, v13
 v_cvt_pk_bf16_f32 v39, v14, v15
f_t5:
 v_mfma_f32_32x32x16_bf16 v[0:15], a[40:43], a[16:19], 0
 buffer_load_dwordx4 a[36:39], v128, s[24:27], s63 offen offset:1024 sc1
 v_exp_f32 v16, v16
 v_exp_f32 v17, v17
 v_exp_f32 v18, v18
 v_exp_f32 v19, v19
 mg v,0,a,44,a,20
 v_exp_f32 v20, v20
 v_cvt_pk_bf16_f32 v40, v16, v17
 v_exp_f32 v21, v21
 v_cvt_pk_bf16_f32 v41, v18, v19
 v_exp_f32 v22, v22
 mg v,48,a,72,v,32
 v_exp_f32 v23, v23
 v_cvt_pk_bf16_f32 v42, v20, v21
 v_exp_f32 v24, v24
 v_exp_f32 v25, v25
 v_cvt_pk_bf16_f32 v43, v22, v23
 v_smfmac_f32_16x16x64_bf16 v[112:115], v[156:159], v[32:39], v137
 v_exp_f32 v26, v26
 v_exp_f32 v27, v27
 v_cvt_pk_bf16_f32 v44, v24, v25
 mg v,48,a,76,v,36
 v_exp_f32 v28, v28
 v_exp_f32 v29, v29
 v_cvt_pk_bf16_f32 v45, v26, v27
 v_exp_f32 v30, v30
 v_exp_f32 v31, v31
 v_cvt_pk_bf16_f32 v46, v28, v29
 v_cvt_pk_bf16_f32 v47, v30, v31
f_t6:
 v_mfma_f32_32x32x16_bf16 v[16:31], a[40:43], a[24:27], 0
 buffer_load_dwordx4 a[64:67], v128, s[24:27], s64 offen offset:0 sc1
 v_exp_f32 v0, v0
 v_exp_f32 v1, v1
 v_exp_f32 v2, v2
 v_exp_f32 v3, v3
 mg v,16,a,44,a,28
 v_exp_f32 v4, v4
 v_cvt_pk_bf16_f32 v32, v0, v1
 v_exp_f32 v5, v5
 v_cvt_pk_bf16_f32 v33, v2, v3
 v_exp_f32 v6, v6
 mg v,64,a,72,v,40
 v_exp_f32 v7, v7
 v_cvt_pk_bf16_f32 v34, v4, v5
 v_exp_f32 v8, v8
 v_exp_f32 v9, v9
 v_cvt_pk_bf16_f32 v35, v6, v7
 v_smfmac_f32_16x16x64_bf16 v[116:119], v[156:159], v[40:47], v137
 v_exp_f32 v10, v10
 v_exp_f32 v11, v11
 v_cvt_pk_bf16_f32 v36, v8, v9
 mg v,64,a,76,v,44
 v_exp_f32 v12, v12
 v_exp_f32 v13, v13
 v_cvt_pk_bf16_f32 v37, v10, v11
 v_exp_f32 v14, v14
 v_exp_f32 v15, v15
 v_cvt_pk_bf16_f32 v38, v12, v13
 v_cvt_pk_bf16_f32 v39, v14, v15
 s_waitcnt vmcnt(16)
f_t7:
 v_mfma_f32_32x32x16_bf16 v[0:15], a[48:51], a[0:3], 0
 buffer_load_dwordx4 a[68:71], v128, s[24:27], s64 offen offset:1024 sc1
 v_exp_f32 v16, v16
 v_exp_f32 v17, v17
 v_exp_f32 v18, v18
 v_exp_f32 v19, v19
 mg v,0,a,52,a,4
 v_exp_f32 v20, v20
 v_cvt_pk_bf16_f32 v40, v16, v17
 v_exp_f32 v21, v21
 v_cvt_pk_bf16_f32 v41, v18, v19
 v_exp_f32 v22, v22
 mg v,80,a,72,v,32
 v_exp_f32 v23, v23
 v_cvt_pk_bf16_f32 v42, v20, v21
 v_exp_f32 v24, v24
 v_exp_f32 v25, v25
 v_cvt_pk_bf16_f32 v43, v22, v23
 v_smfmac_f32_16x16x64_bf16 v[120:123], v[156:159], v[32:39], v137
 v_exp_f32 v26, v26
 v_exp_f32 v27, v27
 v_cvt_pk_bf16_f32 v44, v24, v25
 mg v,80,a,76,v,36
 v_exp_f32 v28, v28
 v_exp_f32 v29, v29
 v_cvt_pk_bf16_f32 v45, v26, v27
 v_exp_f32 v30, v30
 v_exp_f32 v31, v31
 v_cvt_pk_bf16_f32 v46, v28, v29
 v_cvt_pk_bf16_f32 v47, v30, v31
f_t8:
 v_mfma_f32_32x32x16_bf16 v[16:31], a[48:51], a[8:11], 0
 buffer_load_dwordx4 a[40:43], v128, s[24:27], s63 offen offset:2048 sc1
 v_exp_f32 v0, v0
 v_exp_f32 v1, v1
 v_exp_f32 v2, v2
 v_exp_f32 v3, v3
 mg v,16,a,52,a,12
 v_exp_f32 v4, v4
 v_cvt_pk_bf16_f32 v32, v0, v1
 v_exp_f32 v5, v5
 v_cvt_pk_bf16_f32 v33, v2, v3
 v_exp_f32 v6, v6
 mg v,96,a,72,v,40
 v_exp_f32 v7, v7
 v_cvt_pk_bf16_f32 v34, v4, v5
 v_exp_f32 v8, v8
 v_exp_f32 v9, v9
 v_cvt_pk_bf16_f32 v35, v6, v7
 v_smfmac_f32_16x16x64_bf16 v[124:127], v[156:159], v[40:47], v137
 v_exp_f32 v10, v10
 v_exp_f32 v11, v11
 v_cvt_pk_bf16_f32 v36, v8, v9
 mg v,96,a,76,v,44
 v_exp_f32 v12, v12
 v_exp_f32 v13, v13
 v_cvt_pk_bf16_f32 v37, v10, v11
 v_exp_f32 v14, v14
 v_exp_f32 v15, v15
 v_cvt_pk_bf16_f32 v38, v12, v13
 v_cvt_pk_bf16_f32 v39, v14, v15
f_t9:
 v_mfma_f32_32x32x16_bf16 v[0:15], a[48:51], a[16:19], 0
 buffer_load_dwordx4 a[44:47], v128, s[24:27], s63 offen offset:3072 sc1
 v_exp_f32 v16, v16
 v_exp_f32 v17, v17
 v_exp_f32 v18, v18
 v_exp_f32 v19, v19
 mg v,0,a,52,a,20
 v_exp_f32 v20, v20
 v_cvt_pk_bf16_f32 v40, v16, v17
 v_exp_f32 v21, v21
 v_cvt_pk_bf16_f32 v41, v18, v19
 v_exp_f32 v22, v22
 mg v,48,a,80,v,32
 v_exp_f32 v23, v23
 v_cvt_pk_bf16_f32 v42, v20, v21
 v_exp_f32 v24, v24
 v_exp_f32 v25, v25
 v_cvt_pk_bf16_f32 v43, v22, v23
 v_smfmac_f32_16x16x64_bf16 v[112:115], v[156:159], v[32:39], v137
 s_add_u32 s63, s63, 4096
 v_exp_f32 v26, v26
 v_exp_f32 v27, v27
 v_cvt_pk_bf16_f32 v44, v24, v25
 mg v,48,a,84,v,36
 v_exp_f32 v28, v28
 v_exp_f32 v29, v29
 v_cvt_pk_bf16_f32 v45, v26, v27
 v_exp_f32 v30, v30
 v_exp_f32 v31, v31
 v_cvt_pk_bf16_f32 v46, v28, v29
 v_cvt_pk_bf16_f32 v47, v30, v31
f_t10:
 s_mov_b32 s69, f_t30-f_base
 v_mfma_f32_32x32x16_bf16 v[16:31], a[48:51], a[24:27], 0
 buffer_load_dwordx4 a[72:75], v128, s[24:27], s64 offen offset:2048 sc1
 v_exp_f32 v0, v0
 v_exp_f32 v1, v1
 v_exp_f32 v2, v2
 v_exp_f32 v3, v3
 mg v,16,a,52,a,28
 buffer_load_dword v129, v155, s[36:39], s69 offen
 v_exp_f32 v4, v4
 v_cvt_pk_bf16_f32 v32, v0, v1
 v_exp_f32 v5, v5
 v_cvt_pk_bf16_f32 v33, v2, v3
 v_exp_f32 v6, v6
 mg v,64,a,80,v,40
 v_exp_f32 v7, v7
 v_cvt_pk_bf16_f32 v34, v4, v5
 v_exp_f32 v8, v8
 v_exp_f32 v9, v9
 v_cvt_pk_bf16_f32 v35, v6, v7
 v_smfmac_f32_16x16x64_bf16 v[116:119], v[156:159], v[40:47], v137
 v_exp_f32 v10, v10
 v_exp_f32 v11, v11
 v_cvt_pk_bf16_f32 v36, v8, v9
 mg v,64,a,84,v,44
 v_exp_f32 v12, v12
 v_exp_f32 v13, v13
 v_cvt_pk_bf16_f32 v37, v10, v11
 v_exp_f32 v14, v14
 v_exp_f32 v15, v15
 v_cvt_pk_bf16_f32 v38, v12, v13
 v_cvt_pk_bf16_f32 v39, v14, v15
 s_waitcnt vmcnt(9)
f_t11:
 v_mfma_f32_32x32x16_bf16 v[0:15], a[56:59], a[0:3], 0
 buffer_load_dwordx4 a[76:79], v128, s[24:27], s64 offen offset:3072 sc1
 v_exp_f32 v16, v16
 v_exp_f32 v17, v17
 v_exp_f32 v18, v18
 v_exp_f32 v19, v19
 mg v,0,a,60,a,4
 buffer_load_dword v129, v142, s[28:31], s77 offen
 v_exp_f32 v20, v20
 v_cvt_pk_bf16_f32 v40, v16, v17
 v_exp_f32 v21, v21
 v_cvt_pk_bf16_f32 v41, v18, v19
 v_exp_f32 v22, v22
 mg v,80,a,80,v,32
 v_exp_f32 v23, v23
 v_cvt_pk_bf16_f32 v42, v20, v21
 v_exp_f32 v24, v24
 v_exp_f32 v25, v25
 v_cvt_pk_bf16_f32 v43, v22, v23
 v_smfmac_f32_16x16x64_bf16 v[120:123], v[156:159], v[32:39], v137
 s_add_u32 s64, s64, 4096
 v_exp_f32 v26, v26
 v_exp_f32 v27, v27
 v_cvt_pk_bf16_f32 v44, v24, v25
 mg v,80,a,84,v,36
 v_exp_f32 v28, v28
 v_exp_f32 v29, v29
 v_cvt_pk_bf16_f32 v45, v26, v27
 v_exp_f32 v30, v30
 v_exp_f32 v31, v31
 s_add_u32 s77, s77, 0x200000
 v_cvt_pk_bf16_f32 v46, v28, v29
 v_cvt_pk_bf16_f32 v47, v30, v31
f_t12:
 v_mfma_f32_32x32x16_bf16 v[16:31], a[56:59], a[8:11], 0
 buffer_load_dwordx4 a[48:51], v128, s[24:27], s63 offen offset:0 sc1
 v_exp_f32 v0, v0
 v_exp_f32 v1, v1
 v_exp_f32 v2, v2
 v_exp_f32 v3, v3
 mg v,16,a,60,a,12
 v_exp_f32 v4, v4
 v_cvt_pk_bf16_f32 v32, v0, v1
 v_exp_f32 v5, v5
 v_cvt_pk_bf16_f32 v33, v2, v3
 v_exp_f32 v6, v6
 mg v,96,a,80,v,40
 v_exp_f32 v7, v7
 v_cvt_pk_bf16_f32 v34, v4, v5
 v_exp_f32 v8, v8
 v_exp_f32 v9, v9
 v_cvt_pk_bf16_f32 v35, v6, v7
 v_smfmac_f32_16x16x64_bf16 v[124:127], v[156:159], v[40:47], v137
 v_exp_f32 v10, v10
 v_exp_f32 v11, v11
 v_cvt_pk_bf16_f32 v36, v8, v9
 mg v,96,a,84,v,44
 v_exp_f32 v12, v12
 v_exp_f32 v13, v13
 v_cvt_pk_bf16_f32 v37, v10, v11
 v_exp_f32 v14, v14
 v_exp_f32 v15, v15
 v_cvt_pk_bf16_f32 v38, v12, v13
 v_cvt_pk_bf16_f32 v39, v14, v15
f_t13:
 v_mfma_f32_32x32x16_bf16 v[0:15], a[56:59], a[16:19], 0
 buffer_load_dwordx4 a[52:55], v128, s[24:27], s63 offen offset:1024 sc1
 v_exp_f32 v16, v16
 v_exp_f32 v17, v17
 v_exp_f32 v18, v18
 v_exp_f32 v19, v19
 mg v,0,a,60,a,20
 v_exp_f32 v20, v20
 v_cvt_pk_bf16_f32 v40, v16, v17
 v_exp_f32 v21, v21
 v_cvt_pk_bf16_f32 v41, v18, v19
 v_exp_f32 v22, v22
 mg v,48,a,88,v,32
 v_exp_f32 v23, v23
 v_cvt_pk_bf16_f32 v42, v20, v21
 v_exp_f32 v24, v24
 v_exp_f32 v25, v25
 v_cvt_pk_bf16_f32 v43, v22, v23
 v_smfmac_f32_16x16x64_bf16 v[112:115], v[156:159], v[32:39], v137
 v_exp_f32 v26, v26
 v_exp_f32 v27, v27
 v_cvt_pk_bf16_f32 v44, v24, v25
 mg v,48,a,92,v,36
 v_exp_f32 v28, v28
 v_exp_f32 v29, v29
 v_cvt_pk_bf16_f32 v45, v26, v27
 v_exp_f32 v30, v30
 v_exp_f32 v31, v31
 v_cvt_pk_bf16_f32 v46, v28, v29
 v_cvt_pk_bf16_f32 v47, v30, v31
f_t14:
 v_mfma_f32_32x32x16_bf16 v[16:31], a[56:59], a[24:27], 0
 buffer_load_dwordx4 a[80:83], v128, s[24:27], s64 offen offset:0 sc1
 v_exp_f32 v0, v0
 v_exp_f32 v1, v1
 v_exp_f32 v2, v2
 v_exp_f32 v3, v3
 mg v,16,a,60,a,28
 v_exp_f32 v4, v4
 v_cvt_pk_bf16_f32 v32, v0, v1
 v_exp_f32 v5, v5
 v_cvt_pk_bf16_f32 v33, v2, v3
 v_exp_f32 v6, v6
 mg v,64,a,88,v,40
 v_exp_f32 v7, v7
 v_cvt_pk_bf16_f32 v34, v4, v5
 v_exp_f32 v8, v8
 v_exp_f32 v9, v9
 v_cvt_pk_bf16_f32 v35, v6, v7
 v_smfmac_f32_16x16x64_bf16 v[116:119], v[156:159], v[40:47], v137
 v_exp_f32 v10, v10
 v_exp_f32 v11, v11
 v_cvt_pk_bf16_f32 v36, v8, v9
 mg v,64,a,92,v,44
 v_exp_f32 v12, v12
 v_exp_f32 v13, v13
 v_cvt_pk_bf16_f32 v37, v10, v11
 v_exp_f32 v14, v14
 v_exp_f32 v15, v15
 v_cvt_pk_bf16_f32 v38, v12, v13
 v_cvt_pk_bf16_f32 v39, v14, v15
 s_waitcnt vmcnt(9)
f_t15:
 v_mfma_f32_32x32x16_bf16 v[0:15], a[32:35], a[0:3], 0
 buffer_load_dwordx4 a[84:87], v128, s[24:27], s64 offen offset:1024 sc1
 v_exp_f32 v16, v16
 v_exp_f32 v17, v17
 v_exp_f32 v18, v18
 v_exp_f32 v19, v19
 mg v,0,a,36,a,4
 v_exp_f32 v20, v20
 v_cvt_pk_bf16_f32 v40, v16, v17
 v_exp_f32 v21, v21
 v_cvt_pk_bf16_f32 v41, v18, v19
 v_exp_f32 v22, v22
 mg v,80,a,88,v,32
 v_exp_f32 v23, v23
 v_cvt_pk_bf16_f32 v42, v20, v21
 v_exp_f32 v24, v24
 v_exp_f32 v25, v25
 v_cvt_pk_bf16_f32 v43, v22, v23
 v_smfmac_f32_16x16x64_bf16 v[120:123], v[156:159], v[32:39], v137
 v_exp_f32 v26, v26
 v_exp_f32 v27, v27
 v_cvt_pk_bf16_f32 v44, v24, v25
 mg v,80,a,92,v,36
 v_exp_f32 v28, v28
 v_exp_f32 v29, v29
 v_cvt_pk_bf16_f32 v45, v26, v27
 v_exp_f32 v30, v30
 v_exp_f32 v31, v31
 v_cvt_pk_bf16_f32 v46, v28, v29
 v_cvt_pk_bf16_f32 v47, v30, v31
f_t16:
 v_mfma_f32_32x32x16_bf16 v[16:31], a[32:35], a[8:11], 0
 buffer_load_dwordx4 a[56:59], v128, s[24:27], s63 offen offset:2048 sc1
 v_exp_f32 v0, v0
 v_exp_f32 v1, v1
 v_exp_f32 v2, v2
 v_exp_f32 v3, v3
 mg v,16,a,36,a,12
 buffer_store_dword v144, v143, s[24:27], s74 offen sc1
 v_exp_f32 v4, v4
 v_cvt_pk_bf16_f32 v32, v0, v1
 v_exp_f32 v5, v5
 v_cvt_pk_bf16_f32 v33, v2, v3
 v_exp_f32 v6, v6
 mg v,96,a,88,v,40
 v_exp_f32 v7, v7
 v_cvt_pk_bf16_f32 v34, v4, v5
 v_exp_f32 v8, v8
 v_exp_f32 v9, v9
 v_cvt_pk_bf16_f32 v35, v6, v7
 v_smfmac_f32_16x16x64_bf16 v[124:127], v[156:159], v[40:47], v137
 v_exp_f32 v10, v10
 v_exp_f32 v11, v11
 v_cvt_pk_bf16_f32 v36, v8, v9
 mg v,96,a,92,v,44
 v_exp_f32 v12, v12
 v_exp_f32 v13, v13
 v_cvt_pk_bf16_f32 v37, v10, v11
 v_exp_f32 v14, v14
 v_exp_f32 v15, v15
 v_cvt_pk_bf16_f32 v38, v12, v13
 v_cvt_pk_bf16_f32 v39, v14, v15
f_t17:
 v_mfma_f32_32x32x16_bf16 v[0:15], a[32:35], a[16:19], 0
 buffer_load_dwordx4 a[60:63], v128, s[24:27], s63 offen offset:3072 sc1
 v_exp_f32 v16, v16
 v_exp_f32 v17, v17
 v_exp_f32 v18, v18
 v_exp_f32 v19, v19
 mg v,0,a,36,a,20
 v_exp_f32 v20, v20
 v_cvt_pk_bf16_f32 v40, v16, v17
 v_exp_f32 v21, v21
 v_cvt_pk_bf16_f32 v41, v18, v19
 v_exp_f32 v22, v22
 mg v,48,a,64,v,32
 v_exp_f32 v23, v23
 v_cvt_pk_bf16_f32 v42, v20, v21
 v_exp_f32 v24, v24
 v_exp_f32 v25, v25
 v_cvt_pk_bf16_f32 v43, v22, v23
 v_smfmac_f32_16x16x64_bf16 v[112:115], v[156:159], v[32:39], v137
 s_add_u32 s63, s63, 4096
 v_exp_f32 v26, v26
 v_exp_f32 v27, v27
 v_cvt_pk_bf16_f32 v44, v24, v25
 mg v,48,a,68,v,36
 v_exp_f32 v28, v28
 v_exp_f32 v29, v29
 v_cvt_pk_bf16_f32 v45, v26, v27
 v_exp_f32 v30, v30
 v_exp_f32 v31, v31
 v_cvt_pk_bf16_f32 v46, v28, v29
 v_cvt_pk_bf16_f32 v47, v30, v31
f_t18:
 v_mfma_f32_32x32x16_bf16 v[16:31], a[32:35], a[24:27], 0
 buffer_load_dwordx4 a[88:91], v128, s[24:27], s64 offen offset:2048 sc1
 v_exp_f32 v0, v0
 v_exp_f32 v1, v1
 v_exp_f32 v2, v2
 v_exp_f32 v3, v3
 mg v,16,a,36,a,28
 v_exp_f32 v4, v4
 v_cvt_pk_bf16_f32 v32, v0, v1
 v_exp_f32 v5, v5
 v_cvt_pk_bf16_f32 v33, v2, v3
 v_exp_f32 v6, v6
 mg v,64,a,64,v,40
 v_exp_f32 v7, v7
 v_cvt_pk_bf16_f32 v34, v4, v5
 v_exp_f32 v8, v8
 v_exp_f32 v9, v9
 v_cvt_pk_bf16_f32 v35, v6, v7
 v_smfmac_f32_16x16x64_bf16 v[116:119], v[156:159], v[40:47], v137
 v_exp_f32 v10, v10
 v_exp_f32 v11, v11
 v_cvt_pk_bf16_f32 v36, v8, v9
 mg v,64,a,68,v,44
 v_exp_f32 v12, v12
 v_exp_f32 v13, v13
 v_cvt_pk_bf16_f32 v37, v10, v11
 v_exp_f32 v14, v14
 v_exp_f32 v15, v15
 v_cvt_pk_bf16_f32 v38, v12, v13
 v_cvt_pk_bf16_f32 v39, v14, v15
 s_waitcnt vmcnt(9)
f_t19:
 v_mfma_f32_32x32x16_bf16 v[0:15], a[40:43], a[0:3], 0
 buffer_load_dwordx4 a[92:95], v128, s[24:27], s64 offen offset:3072 sc1
 v_exp_f32 v16, v16
 v_exp_f32 v17, v17
 v_exp_f32 v18, v18
 v_exp_f32 v19, v19
 mg v,0,a,44,a,4
 buffer_load_dword v129, v142, s[28:31], s77 offen
 v_exp_f32 v20, v20
 v_cvt_pk_bf16_f32 v40, v16, v17
 v_exp_f32 v21, v21
 v_cvt_pk_bf16_f32 v41, v18, v19
 v_exp_f32 v22, v22
 mg v,80,a,64,v,32
 v_exp_f32 v23, v23
 v_cvt_pk_bf16_f32 v42, v20, v21
 v_exp_f32 v24, v24
 v_exp_f32 v25, v25
 v_cvt_pk_bf16_f32 v43, v22, v23
 v_smfmac_f32_16x16x64_bf16 v[120:123], v[156:159], v[32:39], v137
 s_add_u32 s64, s64, 4096
 v_exp_f32 v26, v26
 v_exp_f32 v27, v27
 v_cvt_pk_bf16_f32 v44, v24, v25
 mg v,80,a,68,v,36
 v_exp_f32 v28, v28
 v_exp_f32 v29, v29
 v_cvt_pk_bf16_f32 v45, v26, v27
 v_exp_f32 v30, v30
 v_exp_f32 v31, v31
 s_add_u32 s77, s77, 0x200000
 v_cvt_pk_bf16_f32 v46, v28, v29
 v_cvt_pk_bf16_f32 v47, v30, v31
f_t20:
 v_mfma_f32_32x32x16_bf16 v[16:31], a[40:43], a[8:11], 0
 buffer_load_dwordx4 a[32:35], v128, s[24:27], s63 offen offset:0 sc1
 v_exp_f32 v0, v0
 v_exp_f32 v1, v1
 v_exp_f32 v2, v2
 v_exp_f32 v3, v3
 mg v,16,a,44,a,12
 v_exp_f32 v4, v4
 v_cvt_pk_bf16_f32 v32, v0, v1
 v_exp_f32 v5, v5
 v_cvt_pk_bf16_f32 v33, v2, v3
 v_exp_f32 v6, v6
 mg v,96,a,64,v,40
 v_exp_f32 v7, v7
 v_cvt_pk_bf16_f32 v34, v4, v5
 v_exp_f32 v8, v8
 v_exp_f32 v9, v9
 v_cvt_pk_bf16_f32 v35, v6, v7
 v_smfmac_f32_16x16x64_bf16 v[124:127], v[156:159], v[40:47], v137
 v_exp_f32 v10, v10
 v_exp_f32 v11, v11
 v_cvt_pk_bf16_f32 v36, v8, v9
 mg v,96,a,68,v,44
 v_exp_f32 v12, v12
 v_exp_f32 v13, v13
 v_cvt_pk_bf16_f32 v37, v10, v11
 v_exp_f32 v14, v14
 v_exp_f32 v15, v15
 v_cvt_pk_bf16_f32 v38, v12, v13
 v_cvt_pk_bf16_f32 v39, v14, v15
f_t21:
 v_mfma_f32_32x32x16_bf16 v[0:15], a[40:43], a[16:19], 0
 buffer_load_dwordx4 a[36:39], v128, s[24:27], s63 offen offset:1024 sc1
 v_exp_f32 v16, v16
 v_exp_f32 v17, v17
 v_exp_f32 v18, v18
 v_exp_f32 v19, v19
 mg v,0,a,44,a,20
 v_exp_f32 v20, v20
 v_cvt_pk_bf16_f32 v40, v16, v17
 v_exp_f32 v21, v21
 v_cvt_pk_bf16_f32 v41, v18, v19
 v_exp_f32 v22, v22
 mg v,48,a,72,v,32
 v_exp_f32 v23, v23
 v_cvt_pk_bf16_f32 v42, v20, v21
 v_exp_f32 v24, v24
 v_exp_f32 v25, v25
 v_cvt_pk_bf16_f32 v43, v22, v23
 v_smfmac_f32_16x16x64_bf16 v[112:115], v[156:159], v[32:39], v137
 v_exp_f32 v26, v26
 v_exp_f32 v27, v27
 v_cvt_pk_bf16_f32 v44, v24, v25
 mg v,48,a,76,v,36
 v_exp_f32 v28, v28
 v_exp_f32 v29, v29
 v_cvt_pk_bf16_f32 v45, v26, v27
 v_exp_f32 v30, v30
 v_exp_f32 v31, v31
 v_cvt_pk_bf16_f32 v46, v28, v29
 v_cvt_pk_bf16_f32 v47, v30, v31
f_t22:
 v_mfma_f32_32x32x16_bf16 v[16:31], a[40:43], a[24:27], 0
 buffer_load_dwordx4 a[64:67], v128, s[24:27], s64 offen offset:0 sc1
 v_exp_f32 v0, v0
 v_exp_f32 v1, v1
 v_exp_f32 v2, v2
 v_exp_f32 v3, v3
 mg v,16,a,44,a,28
 v_exp_f32 v4, v4
 v_cvt_pk_bf16_f32 v32, v0, v1
 v_exp_f32 v5, v5
 v_cvt_pk_bf16_f32 v33, v2, v3
 v_exp_f32 v6, v6
 mg v,64,a,72,v,40
 v_exp_f32 v7, v7
 v_cvt_pk_bf16_f32 v34, v4, v5
 v_exp_f32 v8, v8
 v_exp_f32 v9, v9
 v_cvt_pk_bf16_f32 v35, v6, v7
 v_smfmac_f32_16x16x64_bf16 v[116:119], v[156:159], v[40:47], v137
 v_exp_f32 v10, v10
 v_exp_f32 v11, v11
 v_cvt_pk_bf16_f32 v36, v8, v9
 mg v,64,a,76,v,44
 v_exp_f32 v12, v12
 v_exp_f32 v13, v13
 v_cvt_pk_bf16_f32 v37, v10, v11
 v_exp_f32 v14, v14
 v_exp_f32 v15, v15
 v_cvt_pk_bf16_f32 v38, v12, v13
 v_cvt_pk_bf16_f32 v39, v14, v15
 s_waitcnt vmcnt(9)
f_t23:
 v_mfma_f32_32x32x16_bf16 v[0:15], a[48:51], a[0:3], 0
 buffer_load_dwordx4 a[68:71], v128, s[24:27], s64 offen offset:1024 sc1
 v_exp_f32 v16, v16
 v_exp_f32 v17, v17
 v_exp_f32 v18, v18
 v_exp_f32 v19, v19
 mg v,0,a,52,a,4
 v_exp_f32 v20, v20
 v_cvt_pk_bf16_f32 v40, v16, v17
 v_exp_f32 v21, v21
 v_cvt_pk_bf16_f32 v41, v18, v19
 v_exp_f32 v22, v22
 mg v,80,a,72,v,32
 v_exp_f32 v23, v23
 v_cvt_pk_bf16_f32 v42, v20, v21
 v_exp_f32 v24, v24
 v_exp_f32 v25, v25
 v_cvt_pk_bf16_f32 v43, v22, v23
 v_smfmac_f32_16x16x64_bf16 v[120:123], v[156:159], v[32:39], v137
 v_exp_f32 v26, v26
 v_exp_f32 v27, v27
 v_cvt_pk_bf16_f32 v44, v24, v25
 mg v,80,a,76,v,36
 v_exp_f32 v28, v28
 v_exp_f32 v29, v29
 v_cvt_pk_bf16_f32 v45, v26, v27
 v_exp_f32 v30, v30
 v_exp_f32 v31, v31
 v_cvt_pk_bf16_f32 v46, v28, v29
 v_cvt_pk_bf16_f32 v47, v30, v31
f_t24:
 v_mfma_f32_32x32x16_bf16 v[16:31], a[48:51], a[8:11], 0
 buffer_load_dwordx4 a[40:43], v128, s[24:27], s63 offen offset:2048 sc1
 v_exp_f32 v0, v0
 v_exp_f32 v1, v1
 v_exp_f32 v2, v2
 v_exp_f32 v3, v3
 mg v,16,a,52,a,12
 v_exp_f32 v4, v4
 v_cvt_pk_bf16_f32 v32, v0, v1
 v_exp_f32 v5, v5
 v_cvt_pk_bf16_f32 v33, v2, v3
 v_exp_f32 v6, v6
 mg v,96,a,72,v,40
 v_exp_f32 v7, v7
 v_cvt_pk_bf16_f32 v34, v4, v5
 v_exp_f32 v8, v8
 v_exp_f32 v9, v9
 v_cvt_pk_bf16_f32 v35, v6, v7
 v_smfmac_f32_16x16x64_bf16 v[124:127], v[156:159], v[40:47], v137
 v_exp_f32 v10, v10
 v_exp_f32 v11, v11
 v_cvt_pk_bf16_f32 v36, v8, v9
 mg v,96,a,76,v,44
 v_exp_f32 v12, v12
 v_exp_f32 v13, v13
 v_cvt_pk_bf16_f32 v37, v10, v11
 v_exp_f32 v14, v14
 v_exp_f32 v15, v15
 v_cvt_pk_bf16_f32 v38, v12, v13
 v_cvt_pk_bf16_f32 v39, v14, v15
f_t25:
 v_mfma_f32_32x32x16_bf16 v[0:15], a[48:51], a[16:19], 0
 buffer_load_dwordx4 a[44:47], v128, s[24:27], s63 offen offset:3072 sc1
 v_exp_f32 v16, v16
 v_exp_f32 v17, v17
 v_exp_f32 v18, v18
 v_exp_f32 v19, v19
 mg v,0,a,52,a,20
 v_exp_f32 v20, v20
 v_cvt_pk_bf16_f32 v40, v16, v17
 v_exp_f32 v21, v21
 v_cvt_pk_bf16_f32 v41, v18, v19
 v_exp_f32 v22, v22
 mg v,48,a,80,v,32
 v_exp_f32 v23, v23
 v_cvt_pk_bf16_f32 v42, v20, v21
 v_exp_f32 v24, v24
 v_exp_f32 v25, v25
 v_cvt_pk_bf16_f32 v43, v22, v23
 v_smfmac_f32_16x16x64_bf16 v[112:115], v[156:159], v[32:39], v137
 s_add_u32 s63, s63, 4096
 v_exp_f32 v26, v26
 v_exp_f32 v27, v27
 v_cvt_pk_bf16_f32 v44, v24, v25
 mg v,48,a,84,v,36
 v_exp_f32 v28, v28
 v_exp_f32 v29, v29
 v_cvt_pk_bf16_f32 v45, v26, v27
 v_exp_f32 v30, v30
 v_exp_f32 v31, v31
 v_cvt_pk_bf16_f32 v46, v28, v29
 v_cvt_pk_bf16_f32 v47, v30, v31
f_t26:
 v_mfma_f32_32x32x16_bf16 v[16:31], a[48:51], a[24:27], 0
 buffer_load_dwordx4 a[72:75], v128, s[24:27], s64 offen offset:2048 sc1
 v_exp_f32 v0, v0
 v_exp_f32 v1, v1
 v_exp_f32 v2, v2
 v_exp_f32 v3, v3
 mg v,16,a,52,a,28
 v_exp_f32 v4, v4
 v_cvt_pk_bf16_f32 v32, v0, v1
 v_exp_f32 v5, v5
 v_cvt_pk_bf16_f32 v33, v2, v3
 v_exp_f32 v6, v6
 mg v,64,a,80,v,40
 v_exp_f32 v7, v7
 v_cvt_pk_bf16_f32 v34, v4, v5
 v_exp_f32 v8, v8
 v_exp_f32 v9, v9
 v_cvt_pk_bf16_f32 v35, v6, v7
 v_smfmac_f32_16x16x64_bf16 v[116:119], v[156:159], v[40:47], v137
 v_exp_f32 v10, v10
 v_exp_f32 v11, v11
 v_cvt_pk_bf16_f32 v36, v8, v9
 mg v,64,a,84,v,44
 v_exp_f32 v12, v12
 v_exp_f32 v13, v13
 v_cvt_pk_bf16_f32 v37, v10, v11
 v_exp_f32 v14, v14
 v_exp_f32 v15, v15
 v_cvt_pk_bf16_f32 v38, v12, v13
 v_cvt_pk_bf16_f32 v39, v14, v15
 s_waitcnt vmcnt(8)
f_t27:
 v_mfma_f32_32x32x16_bf16 v[0:15], a[56:59], a[0:3], 0
 buffer_load_dwordx4 a[76:79], v128, s[24:27], s64 offen offset:3072 sc1
 v_exp_f32 v16, v16
 v_exp_f32 v17, v17
 v_exp_f32 v18, v18
 v_exp_f32 v19, v19
 mg v,0,a,60,a,4
 buffer_load_dword v129, v142, s[28:31], s77 offen
 v_exp_f32 v20, v20
 v_cvt_pk_bf16_f32 v40, v16, v17
 v_exp_f32 v21, v21
 v_cvt_pk_bf16_f32 v41, v18, v19
 v_exp_f32 v22, v22
 mg v,80,a,80,v,32
 v_exp_f32 v23, v23
 v_cvt_pk_bf16_f32 v42, v20, v21
 v_exp_f32 v24, v24
 v_exp_f32 v25, v25
 v_cvt_pk_bf16_f32 v43, v22, v23
 v_smfmac_f32_16x16x64_bf16 v[120:123], v[156:159], v[32:39], v137
 s_add_u32 s64, s64, 4096
 v_exp_f32 v26, v26
 v_exp_f32 v27, v27
 v_cvt_pk_bf16_f32 v44, v24, v25
 mg v,80,a,84,v,36
 v_exp_f32 v28, v28
 v_exp_f32 v29, v29
 v_cvt_pk_bf16_f32 v45, v26, v27
 v_exp_f32 v30, v30
 v_exp_f32 v31, v31
 s_and_b32 s77, s77, 0x1fffff
 v_cvt_pk_bf16_f32 v46, v28, v29
 v_cvt_pk_bf16_f32 v47, v30, v31
f_t28:
 v_mfma_f32_32x32x16_bf16 v[16:31], a[56:59], a[8:11], 0
 buffer_load_dwordx4 a[48:51], v128, s[24:27], s63 offen offset:0 sc1
 v_exp_f32 v0, v0
 v_exp_f32 v1, v1
 v_exp_f32 v2, v2
 v_exp_f32 v3, v3
 mg v,16,a,60,a,12
 v_exp_f32 v4, v4
 v_cvt_pk_bf16_f32 v32, v0, v1
 v_exp_f32 v5, v5
 v_cvt_pk_bf16_f32 v33, v2, v3
 v_exp_f32 v6, v6
 mg v,96,a,80,v,40
 v_exp_f32 v7, v7
 v_cvt_pk_bf16_f32 v34, v4, v5
 v_exp_f32 v8, v8
 v_exp_f32 v9, v9
 v_cvt_pk_bf16_f32 v35, v6, v7
 v_smfmac_f32_16x16x64_bf16 v[124:127], v[156:159], v[40:47], v137
 v_exp_f32 v10, v10
 v_exp_f32 v11, v11
 v_cvt_pk_bf16_f32 v36, v8, v9
 mg v,96,a,84,v,44
 v_exp_f32 v12, v12
 v_exp_f32 v13, v13
 v_cvt_pk_bf16_f32 v37, v10, v11
 v_exp_f32 v14, v14
 v_exp_f32 v15, v15
 v_cvt_pk_bf16_f32 v38, v12, v13
 v_cvt_pk_bf16_f32 v39, v14, v15
f_t29:
 v_mfma_f32_32x32x16_bf16 v[0:15], a[56:59], a[16:19], 0
 buffer_load_dwordx4 a[52:55], v128, s[24:27], s63 offen offset:1024 sc1
 v_exp_f32 v16, v16
 v_exp_f32 v17, v17
 v_exp_f32 v18, v18
 v_exp_f32 v19, v19
 mg v,0,a,60,a,20
 v_exp_f32 v20, v20
 v_cvt_pk_bf16_f32 v40, v16, v17
 v_exp_f32 v21, v21
 v_cvt_pk_bf16_f32 v41, v18, v19
 v_exp_f32 v22, v22
 mg v,48,a,88,v,32
 v_exp_f32 v23, v23
 v_cvt_pk_bf16_f32 v42, v20, v21
 v_exp_f32 v24, v24
 v_exp_f32 v25, v25
 v_cvt_pk_bf16_f32 v43, v22, v23
 v_smfmac_f32_16x16x64_bf16 v[112:115], v[156:159], v[32:39], v137
 v_exp_f32 v26, v26
 v_exp_f32 v27, v27
 v_cvt_pk_bf16_f32 v44, v24, v25
 mg v,48,a,92,v,36
 v_exp_f32 v28, v28
 v_exp_f32 v29, v29
 v_cvt_pk_bf16_f32 v45, v26, v27
 v_exp_f32 v30, v30
 v_exp_f32 v31, v31
 v_cvt_pk_bf16_f32 v46, v28, v29
 v_cvt_pk_bf16_f32 v47, v30, v31
f_t30:
 v_mfma_f32_32x32x16_bf16 v[16:31], a[56:59], a[24:27], 0
 buffer_load_dwordx4 a[80:83], v128, s[24:27], s64 offen offset:0 sc1
 v_exp_f32 v0, v0
 v_exp_f32 v1, v1
 v_exp_f32 v2, v2
 v_exp_f32 v3, v3
 mg v,16,a,60,a,28
 v_exp_f32 v4, v4
 v_cvt_pk_bf16_f32 v32, v0, v1
 v_exp_f32 v5, v5
 v_cvt_pk_bf16_f32 v33, v2, v3
 v_exp_f32 v6, v6
 mg v,64,a,88,v,40
 v_exp_f32 v7, v7
 v_cvt_pk_bf16_f32 v34, v4, v5
 v_exp_f32 v8, v8
 v_exp_f32 v9, v9
 v_cvt_pk_bf16_f32 v35, v6, v7
 v_smfmac_f32_16x16x64_bf16 v[116:119], v[156:159], v[40:47], v137
 v_exp_f32 v10, v10
 v_exp_f32 v11, v11
 v_cvt_pk_bf16_f32 v36, v8, v9
 mg v,64,a,92,v,44
 v_exp_f32 v12, v12
 v_exp_f32 v13, v13
 v_cvt_pk_bf16_f32 v37, v10, v11
 v_exp_f32 v14, v14
 v_exp_f32 v15, v15
 v_cvt_pk_bf16_f32 v38, v12, v13
 v_cvt_pk_bf16_f32 v39, v14, v15
 s_waitcnt vmcnt(8)
f_t31:
 v_mfma_f32_32x32x16_bf16 v[0:15], a[32:35], a[0:3], 0
 buffer_load_dwordx4 a[84:87], v128, s[24:27], s64 offen offset:1024 sc1
 v_exp_f32 v16, v16
 v_exp_f32 v17, v17
 v_exp_f32 v18, v18
 v_exp_f32 v19, v19
 mg v,0,a,36,a,4
 v_exp_f32 v20, v20
 v_cvt_pk_bf16_f32 v40, v16, v17
 v_exp_f32 v21, v21
 v_cvt_pk_bf16_f32 v41, v18, v19
 v_exp_f32 v22, v22
 mg v,80,a,88,v,32
 v_exp_f32 v23, v23
 v_cvt_pk_bf16_f32 v42, v20, v21
 v_exp_f32 v24, v24
 v_exp_f32 v25, v25
 v_cvt_pk_bf16_f32 v43, v22, v23
 v_smfmac_f32_16x16x64_bf16 v[120:123], v[156:159], v[32:39], v137
 v_exp_f32 v26, v26
 v_exp_f32 v27, v27
 v_cvt_pk_bf16_f32 v44, v24, v25
 mg v,80,a,92,v,36
 v_exp_f32 v28, v28
 v_exp_f32 v29, v29
 v_cvt_pk_bf16_f32 v45, v26, v27
 v_exp_f32 v30, v30
 v_exp_f32 v31, v31
 v_cvt_pk_bf16_f32 v46, v28, v29
 v_cvt_pk_bf16_f32 v47, v30, v31
f_t32:
 v_mfma_f32_32x32x16_bf16 v[16:31], a[32:35], a[8:11], 0
 buffer_load_dwordx4 a[56:59], v128, s[24:27], s63 offen offset:2048 sc1
 v_exp_f32 v0, v0
 v_exp_f32 v1, v1
 v_exp_f32 v2, v2
 v_exp_f32 v3, v3
 mg v,16,a,36,a,12
 v_exp_f32 v4, v4
 v_cvt_pk_bf16_f32 v32, v0, v1
 v_exp_f32 v5, v5
 v_cvt_pk_bf16_f32 v33, v2, v3
 v_exp_f32 v6, v6
 mg v,96,a,88,v,40
 v_exp_f32 v7, v7
 v_cvt_pk_bf16_f32 v34, v4, v5
 v_exp_f32 v8, v8
 v_exp_f32 v9, v9
 v_cvt_pk_bf16_f32 v35, v6, v7
 v_smfmac_f32_16x16x64_bf16 v[124:127], v[156:159], v[40:47], v137
 v_exp_f32 v10, v10
 v_exp_f32 v11, v11
 v_cvt_pk_bf16_f32 v36, v8, v9
 mg v,96,a,92,v,44
 v_exp_f32 v12, v12
 v_exp_f32 v13, v13
 v_cvt_pk_bf16_f32 v37, v10, v11
 v_exp_f32 v14, v14
 v_exp_f32 v15, v15
 v_cvt_pk_bf16_f32 v38, v12, v13
 v_cvt_pk_bf16_f32 v39, v14, v15
f_t33:
 v_mfma_f32_32x32x16_bf16 v[0:15], a[32:35], a[16:19], 0
 buffer_load_dwordx4 a[60:63], v128, s[24:27], s63 offen offset:3072 sc1
 v_exp_f32 v16, v16
 v_exp_f32 v17, v17
 v_exp_f32 v18, v18
 v_exp_f32 v19, v19
 mg v,0,a,36,a,20
 v_exp_f32 v20, v20
 v_cvt_pk_bf16_f32 v40, v16, v17
 v_exp_f32 v21, v21
 v_cvt_pk_bf16_f32 v41, v18, v19
 v_exp_f32 v22, v22
 mg v,48,a,64,v,32
 v_exp_f32 v23, v23
 v_cvt_pk_bf16_f32 v42, v20, v21
 v_exp_f32 v24, v24
 v_exp_f32 v25, v25
 v_cvt_pk_bf16_f32 v43, v22, v23
 v_smfmac_f32_16x16x64_bf16 v[112:115], v[156:159], v[32:39], v137
 s_add_u32 s63, s63, 4096
 v_exp_f32 v26, v26
 v_exp_f32 v27, v27
 v_cvt_pk_bf16_f32 v44, v24, v25
 mg v,48,a,68,v,36
 v_exp_f32 v28, v28
 v_exp_f32 v29, v29
 v_cvt_pk_bf16_f32 v45, v26, v27
 v_exp_f32 v30, v30
 v_exp_f32 v31, v31
 v_cvt_pk_bf16_f32 v46, v28, v29
 v_cvt_pk_bf16_f32 v47, v30, v31
f_t34:
 v_mfma_f32_32x32x16_bf16 v[16:31], a[32:35], a[24:27], 0
 buffer_load_dwordx4 a[88:91], v128, s[24:27], s64 offen offset:2048 sc1
 v_exp_f32 v0, v0
 v_exp_f32 v1, v1
 v_exp_f32 v2, v2
 v_exp_f32 v3, v3
 mg v,16,a,36,a,28
 v_exp_f32 v4, v4
 v_cvt_pk_bf16_f32 v32, v0, v1
 v_exp_f32 v5, v5
 v_cvt_pk_bf16_f32 v33, v2, v3
 v_exp_f32 v6, v6
 mg v,64,a,64,v,40
 v_exp_f32 v7, v7
 v_cvt_pk_bf16_f32 v34, v4, v5
 v_exp_f32 v8, v8
 v_exp_f32 v9, v9
 v_cvt_pk_bf16_f32 v35, v6, v7
 v_smfmac_f32_16x16x64_bf16 v[116:119], v[156:159], v[40:47], v137
 v_exp_f32 v10, v10
 v_exp_f32 v11, v11
 v_cvt_pk_bf16_f32 v36, v8, v9
 mg v,64,a,68,v,44
 v_exp_f32 v12, v12
 v_exp_f32 v13, v13
 v_cvt_pk_bf16_f32 v37, v10, v11
 v_exp_f32 v14, v14
 v_exp_f32 v15, v15
 v_cvt_pk_bf16_f32 v38, v12, v13
 v_cvt_pk_bf16_f32 v39, v14, v15
 s_waitcnt vmcnt(8)
f_t35:
 v_mfma_f32_32x32x16_bf16 v[0:15], a[40:43], a[0:3], 0
 buffer_load_dwordx4 a[92:95], v128, s[24:27], s64 offen offset:3072 sc1
 v_exp_f32 v16, v16
 v_exp_f32 v17, v17
 v_exp_f32 v18, v18
 v_exp_f32 v19, v19
 mg v,0,a,44,a,4
 buffer_load_dword v129, v142, s[32:35], s77 offen
 v_exp_f32 v20, v20
 v_cvt_pk_bf16_f32 v40, v16, v17
 v_exp_f32 v21, v21
 v_cvt_pk_bf16_f32 v41, v18, v19
 v_exp_f32 v22, v22
 mg v,80,a,64,v,32
 v_exp_f32 v23, v23
 v_cvt_pk_bf16_f32 v42, v20, v21
 v_exp_f32 v24, v24
 v_exp_f32 v25, v25
 v_cvt_pk_bf16_f32 v43, v22, v23
 v_smfmac_f32_16x16x64_bf16 v[120:123], v[156:159], v[32:39], v137
 s_add_u32 s64, s64, 4096
 v_exp_f32 v26, v26
 v_exp_f32 v27, v27
 v_cvt_pk_bf16_f32 v44, v24, v25
 mg v,80,a,68,v,36
 v_exp_f32 v28, v28
 v_exp_f32 v29, v29
 v_cvt_pk_bf16_f32 v45, v26, v27
 v_exp_f32 v30, v30
 v_exp_f32 v31, v31
 v_cvt_pk_bf16_f32 v46, v28, v29
 v_cvt_pk_bf16_f32 v47, v30, v31
f_t36:
 v_mfma_f32_32x32x16_bf16 v[16:31], a[40:43], a[8:11], 0
 buffer_load_dwordx4 a[32:35], v128, s[24:27], s63 offen offset:0 sc1
 v_exp_f32 v0, v0
 v_exp_f32 v1, v1
 v_exp_f32 v2, v2
 v_exp_f32 v3, v3
 mg v,16,a,44,a,12
 v_exp_f32 v4, v4
 v_cvt_pk_bf16_f32 v32, v0, v1
 v_exp_f32 v5, v5
 v_cvt_pk_bf16_f32 v33, v2, v3
 v_exp_f32 v6, v6
 mg v,96,a,64,v,40
 v_exp_f32 v7, v7
 v_cvt_pk_bf16_f32 v34, v4, v5
 v_exp_f32 v8, v8
 v_exp_f32 v9, v9
 v_cvt_pk_bf16_f32 v35, v6, v7
 v_smfmac_f32_16x16x64_bf16 v[124:127], v[156:159], v[40:47], v137
 v_exp_f32 v10, v10
 v_exp_f32 v11, v11
 v_cvt_pk_bf16_f32 v36, v8, v9
 mg v,96,a,68,v,44
 v_exp_f32 v12, v12
 v_exp_f32 v13, v13
 v_cvt_pk_bf16_f32 v37, v10, v11
 v_exp_f32 v14, v14
 v_exp_f32 v15, v15
 s_and_b32 s48, s2, 1
 v_cvt_pk_bf16_f32 v38, v12, v13
 v_cvt_pk_bf16_f32 v39, v14, v15
f_t37:
 v_mfma_f32_32x32x16_bf16 v[0:15], a[40:43], a[16:19], 0
 buffer_load_dwordx4 a[36:39], v128, s[24:27], s63 offen offset:1024 sc1
 v_exp_f32 v16, v16
 v_exp_f32 v17, v17
 v_exp_f32 v18, v18
 v_exp_f32 v19, v19
 mg v,0,a,44,a,20
 v_exp_f32 v20, v20
 v_cvt_pk_bf16_f32 v40, v16, v17
 v_exp_f32 v21, v21
 v_cvt_pk_bf16_f32 v41, v18, v19
 v_exp_f32 v22, v22
 mg v,48,a,72,v,32
 v_exp_f32 v23, v23
 v_cvt_pk_bf16_f32 v42, v20, v21
 v_exp_f32 v24, v24
 v_exp_f32 v25, v25
 v_cvt_pk_bf16_f32 v43, v22, v23
 v_smfmac_f32_16x16x64_bf16 v[112:115], v[156:159], v[32:39], v137
 v_exp_f32 v26, v26
 v_exp_f32 v27, v27
 v_cvt_pk_bf16_f32 v44, v24, v25
 mg v,48,a,76,v,36
 v_exp_f32 v28, v28
 v_exp_f32 v29, v29
 v_cvt_pk_bf16_f32 v45, v26, v27
 v_exp_f32 v30, v30
 v_exp_f32 v31, v31
 s_mul_i32 s44, s48, 4294959104
 v_cvt_pk_bf16_f32 v46, v28, v29
 v_cvt_pk_bf16_f32 v47, v30, v31
f_t38:
 v_mfma_f32_32x32x16_bf16 v[16:31], a[40:43], a[24:27], 0
 buffer_load_dwordx4 a[64:67], v128, s[24:27], s64 offen offset:0 sc1
 v_exp_f32 v0, v0
 v_exp_f32 v1, v1
 v_exp_f32 v2, v2
 v_exp_f32 v3, v3
 mg v,16,a,44,a,28
 v_exp_f32 v4, v4
 v_cvt_pk_bf16_f32 v32, v0, v1
 v_exp_f32 v5, v5
 v_cvt_pk_bf16_f32 v33, v2, v3
 v_exp_f32 v6, v6
 mg v,64,a,72,v,40
 v_exp_f32 v7, v7
 v_cvt_pk_bf16_f32 v34, v4, v5
 v_exp_f32 v8, v8
 v_exp_f32 v9, v9
 v_cvt_pk_bf16_f32 v35, v6, v7
 v_smfmac_f32_16x16x64_bf16 v[116:119], v[156:159], v[40:47], v137
 v_exp_f32 v10, v10
 v_exp_f32 v11, v11
 v_cvt_pk_bf16_f32 v36, v8, v9
 mg v,64,a,76,v,44
 v_exp_f32 v12, v12
 v_exp_f32 v13, v13
 v_cvt_pk_bf16_f32 v37, v10, v11
 v_exp_f32 v14, v14
 v_exp_f32 v15, v15
 s_add_u32 s44, s44, 4096
 v_cvt_pk_bf16_f32 v38, v12, v13
 v_cvt_pk_bf16_f32 v39, v14, v15
 s_waitcnt vmcnt(8)
f_t39:
 v_mfma_f32_32x32x16_bf16 v[0:15], a[48:51], a[0:3], 0
 buffer_load_dwordx4 a[68:71], v128, s[24:27], s64 offen offset:1024 sc1
 v_exp_f32 v16, v16
 v_exp_f32 v17, v17
 v_exp_f32 v18, v18
 v_exp_f32 v19, v19
 mg v,0,a,52,a,4
 v_exp_f32 v20, v20
 v_cvt_pk_bf16_f32 v40, v16, v17
 v_exp_f32 v21, v21
 v_cvt_pk_bf16_f32 v41, v18, v19
 v_exp_f32 v22, v22
 mg v,80,a,72,v,32
 v_exp_f32 v23, v23
 v_cvt_pk_bf16_f32 v42, v20, v21
 v_exp_f32 v24, v24
 v_exp_f32 v25, v25
 v_cvt_pk_bf16_f32 v43, v22, v23
 v_smfmac_f32_16x16x64_bf16 v[120:123], v[156:159], v[32:39], v137
 v_exp_f32 v26, v26
 v_exp_f32 v27, v27
 v_cvt_pk_bf16_f32 v44, v24, v25
 mg v,80,a,76,v,36
 v_exp_f32 v28, v28
 v_exp_f32 v29, v29
 v_cvt_pk_bf16_f32 v45, v26, v27
 v_exp_f32 v30, v30
 v_exp_f32 v31, v31
 s_mul_i32 s46, s48, 4294443008
 v_cvt_pk_bf16_f32 v46, v28, v29
 v_cvt_pk_bf16_f32 v47, v30, v31
f_t40:
 v_mfma_f32_32x32x16_bf16 v[16:31], a[48:51], a[8:11], 0
 buffer_load_dwordx4 a[40:43], v128, s[24:27], s63 offen offset:2048 sc1
 v_exp_f32 v0, v0
 v_exp_f32 v1, v1
 v_exp_f32 v2, v2
 v_exp_f32 v3, v3
 mg v,16,a,52,a,12
 v_exp_f32 v4, v4
 v_cvt_pk_bf16_f32 v32, v0, v1
 v_exp_f32 v5, v5
 v_cvt_pk_bf16_f32 v33, v2, v3
 v_exp_f32 v6, v6
 mg v,96,a,72,v,40
 v_exp_f32 v7, v7
 v_cvt_pk_bf16_f32 v34, v4, v5
 v_exp_f32 v8, v8
 v_exp_f32 v9, v9
 v_cvt_pk_bf16_f32 v35, v6, v7
 v_smfmac_f32_16x16x64_bf16 v[124:127], v[156:159], v[40:47], v137
 v_exp_f32 v10, v10
 v_exp_f32 v11, v11
 v_cvt_pk_bf16_f32 v36, v8, v9
 mg v,96,a,76,v,44
 v_exp_f32 v12, v12
 v_exp_f32 v13, v13
 v_cvt_pk_bf16_f32 v37, v10, v11
 v_exp_f32 v14, v14
 v_exp_f32 v15, v15
 s_add_u32 s46, s46, 65536
 v_cvt_pk_bf16_f32 v38, v12, v13
 v_cvt_pk_bf16_f32 v39, v14, v15
f_t41:
 v_mfma_f32_32x32x16_bf16 v[0:15], a[48:51], a[16:19], 0
 buffer_load_dwordx4 a[44:47], v128, s[24:27], s63 offen offset:3072 sc1
 v_exp_f32 v16, v16
 v_exp_f32 v17, v17
 v_exp_f32 v18, v18
 v_exp_f32 v19, v19
 mg v,0,a,52,a,20
 v_exp_f32 v20, v20
 v_cvt_pk_bf16_f32 v40, v16, v17
 v_exp_f32 v21, v21
 v_cvt_pk_bf16_f32 v41, v18, v19
 v_exp_f32 v22, v22
 mg v,48,a,80,v,32
 v_exp_f32 v23, v23
 v_cvt_pk_bf16_f32 v42, v20, v21
 v_exp_f32 v24, v24
 v_exp_f32 v25, v25
 v_cvt_pk_bf16_f32 v43, v22, v23
 v_smfmac_f32_16x16x64_bf16 v[112:115], v[156:159], v[32:39], v137
 s_add_u32 s63, s63, 4096
 v_exp_f32 v26, v26
 v_exp_f32 v27, v27
 v_cvt_pk_bf16_f32 v44, v24, v25
 mg v,48,a,84,v,36
 v_exp_f32 v28, v28
 v_exp_f32 v29, v29
 v_cvt_pk_bf16_f32 v45, v26, v27
 v_exp_f32 v30, v30
 v_exp_f32 v31, v31
 s_lshl_b32 s48, s2, 7
 v_cvt_pk_bf16_f32 v46, v28, v29
 v_cvt_pk_bf16_f32 v47, v30, v31
f_t42:
 s_mov_b32 s69, f_t62-f_base
 v_mfma_f32_32x32x16_bf16 v[16:31], a[48:51], a[24:27], 0
 buffer_load_dwordx4 a[72:75], v128, s[24:27], s64 offen offset:2048 sc1
 v_exp_f32 v0, v0
 v_exp_f32 v1, v1
 v_exp_f32 v2, v2
 v_exp_f32 v3, v3
 mg v,16,a,52,a,28
 buffer_load_dword v129, v155, s[36:39], s69 offen
 v_exp_f32 v4, v4
 v_cvt_pk_bf16_f32 v32, v0, v1
 v_exp_f32 v5, v5
 v_cvt_pk_bf16_f32 v33, v2, v3
 v_exp_f32 v6, v6
 mg v,64,a,80,v,40
 v_exp_f32 v7, v7
 v_cvt_pk_bf16_f32 v34, v4, v5
 v_exp_f32 v8, v8
 v_exp_f32 v9, v9
 v_cvt_pk_bf16_f32 v35, v6, v7
 v_smfmac_f32_16x16x64_bf16 v[116:119], v[156:159], v[40:47], v137
 v_exp_f32 v10, v10
 v_exp_f32 v11, v11
 v_cvt_pk_bf16_f32 v36, v8, v9
 mg v,64,a,84,v,44
 v_exp_f32 v12, v12
 v_exp_f32 v13, v13
 v_cvt_pk_bf16_f32 v37, v10, v11
 v_exp_f32 v14, v14
 v_exp_f32 v15, v15
 s_add_u32 s48, s48, 42139648
 v_cvt_pk_bf16_f32 v38, v12, v13
 v_cvt_pk_bf16_f32 v39, v14, v15
 s_waitcnt vmcnt(9)
f_t43:
 v_mfma_f32_32x32x16_bf16 v[0:15], a[56:59], a[0:3], 0
 buffer_load_dwordx4 a[76:79], v128, s[24:27], s64 offen offset:3072 sc1
 v_exp_f32 v16, v16
 v_exp_f32 v17, v17
 v_exp_f32 v18, v18
 v_exp_f32 v19, v19
 mg v,0,a,60,a,4
 v_exp_f32 v20, v20
 v_cvt_pk_bf16_f32 v40, v16, v17
 v_exp_f32 v21, v21
 v_cvt_pk_bf16_f32 v41, v18, v19
 v_exp_f32 v22, v22
 mg v,80,a,80,v,32
 v_exp_f32 v23, v23
 v_cvt_pk_bf16_f32 v42, v20, v21
 v_exp_f32 v24, v24
 v_exp_f32 v25, v25
 v_cvt_pk_bf16_f32 v43, v22, v23
 v_smfmac_f32_16x16x64_bf16 v[120:123], v[156:159], v[32:39], v137
 s_add_u32 s64, s64, 4096
 v_exp_f32 v26, v26
 v_exp_f32 v27, v27
 v_cvt_pk_bf16_f32 v44, v24, v25
 mg v,80,a,84,v,36
 v_exp_f32 v28, v28
 v_exp_f32 v29, v29
 v_cvt_pk_bf16_f32 v45, v26, v27
 v_exp_f32 v30, v30
 v_exp_f32 v31, v31
 s_xor_b32 s49, s48, 128
 v_cvt_pk_bf16_f32 v46, v28, v29
 v_cvt_pk_bf16_f32 v47, v30, v31
f_t44:
 v_mfma_f32_32x32x16_bf16 v[16:31], a[56:59], a[8:11], 0
 buffer_load_dwordx4 a[48:51], v128, s[24:27], s63 offen offset:0 sc1
 v_exp_f32 v0, v0
 v_exp_f32 v1, v1
 v_exp_f32 v2, v2
 v_exp_f32 v3, v3
 mg v,16,a,60,a,12
 v_exp_f32 v4, v4
 v_cvt_pk_bf16_f32 v32, v0, v1
 v_exp_f32 v5, v5
 v_cvt_pk_bf16_f32 v33, v2, v3
 v_exp_f32 v6, v6
 mg v,96,a,80,v,40
 v_exp_f32 v7, v7
 v_cvt_pk_bf16_f32 v34, v4, v5
 v_exp_f32 v8, v8
 v_exp_f32 v9, v9
 v_cvt_pk_bf16_f32 v35, v6, v7
 v_smfmac_f32_16x16x64_bf16 v[124:127], v[156:159], v[40:47], v137
 v_exp_f32 v10, v10
 v_exp_f32 v11, v11
 v_cvt_pk_bf16_f32 v36, v8, v9
 mg v,96,a,84,v,44
 v_exp_f32 v12, v12
 v_exp_f32 v13, v13
 v_cvt_pk_bf16_f32 v37, v10, v11
 v_exp_f32 v14, v14
 v_exp_f32 v15, v15
 v_cvt_pk_bf16_f32 v38, v12, v13
 v_cvt_pk_bf16_f32 v39, v14, v15
f_t45:
 v_mfma_f32_32x32x16_bf16 v[0:15], a[56:59], a[16:19], 0
 buffer_load_dwordx4 a[52:55], v128, s[24:27], s63 offen offset:1024 sc1
 v_exp_f32 v16, v16
 v_exp_f32 v17, v17
 v_exp_f32 v18, v18
 v_exp_f32 v19, v19
 mg v,0,a,60,a,20
 v_exp_f32 v20, v20
 v_cvt_pk_bf16_f32 v40, v16, v17
 v_exp_f32 v21, v21
 v_cvt_pk_bf16_f32 v41, v18, v19
 v_exp_f32 v22, v22
 mg v,48,a,88,v,32
 v_exp_f32 v23, v23
 v_cvt_pk_bf16_f32 v42, v20, v21
 v_exp_f32 v24, v24
 v_exp_f32 v25, v25
 v_cvt_pk_bf16_f32 v43, v22, v23
 v_smfmac_f32_16x16x64_bf16 v[112:115], v[156:159], v[32:39], v137
 v_exp_f32 v26, v26
 v_exp_f32 v27, v27
 v_cvt_pk_bf16_f32 v44, v24, v25
 mg v,48,a,92,v,36
 v_exp_f32 v28, v28
 v_exp_f32 v29, v29
 v_cvt_pk_bf16_f32 v45, v26, v27
 v_exp_f32 v30, v30
 v_exp_f32 v31, v31
 v_cvt_pk_bf16_f32 v46, v28, v29
 v_cvt_pk_bf16_f32 v47, v30, v31
f_t46:
 v_mfma_f32_32x32x16_bf16 v[16:31], a[56:59], a[24:27], 0
 buffer_load_dwordx4 a[80:83], v128, s[24:27], s64 offen offset:0 sc1
 v_exp_f32 v0, v0
 v_exp_f32 v1, v1
 v_exp_f32 v2, v2
 v_exp_f32 v3, v3
 mg v,16,a,60,a,28
 v_exp_f32 v4, v4
 v_cvt_pk_bf16_f32 v32, v0, v1
 v_exp_f32 v5, v5
 v_cvt_pk_bf16_f32 v33, v2, v3
 v_exp_f32 v6, v6
 mg v,64,a,88,v,40
 v_exp_f32 v7, v7
 v_cvt_pk_bf16_f32 v34, v4, v5
 v_exp_f32 v8, v8
 v_exp_f32 v9, v9
 v_cvt_pk_bf16_f32 v35, v6, v7
 v_smfmac_f32_16x16x64_bf16 v[116:119], v[156:159], v[40:47], v137
 v_exp_f32 v10, v10
 v_exp_f32 v11, v11
 v_cvt_pk_bf16_f32 v36, v8, v9
 mg v,64,a,92,v,44
 v_exp_f32 v12, v12
 v_exp_f32 v13, v13
 v_cvt_pk_bf16_f32 v37, v10, v11
 v_exp_f32 v14, v14
 v_exp_f32 v15, v15
 v_cvt_pk_bf16_f32 v38, v12, v13
 v_cvt_pk_bf16_f32 v39, v14, v15
 s_waitcnt vmcnt(8)
f_t47:
 v_mfma_f32_32x32x16_bf16 v[0:15], a[32:35], a[0:3], 0
 buffer_load_dwordx4 a[84:87], v128, s[24:27], s64 offen offset:1024 sc1
 v_exp_f32 v16, v16
 v_exp_f32 v17, v17
 v_exp_f32 v18, v18
 v_exp_f32 v19, v19
 mg v,0,a,36,a,4
 v_exp_f32 v20, v20
 v_cvt_pk_bf16_f32 v40, v16, v17
 v_exp_f32 v21, v21
 v_cvt_pk_bf16_f32 v41, v18, v19
 v_exp_f32 v22, v22
 mg v,80,a,88,v,32
 v_exp_f32 v23, v23
 v_cvt_pk_bf16_f32 v42, v20, v21
 v_exp_f32 v24, v24
 v_exp_f32 v25, v25
 v_cvt_pk_bf16_f32 v43, v22, v23
 v_smfmac_f32_16x16x64_bf16 v[120:123], v[156:159], v[32:39], v137
 v_exp_f32 v26, v26
 v_exp_f32 v27, v27
 v_cvt_pk_bf16_f32 v44, v24, v25
 mg v,80,a,92,v,36
 v_exp_f32 v28, v28
 v_exp_f32 v29, v29
 v_cvt_pk_bf16_f32 v45, v26, v27
 v_exp_f32 v30, v30
 v_exp_f32 v31, v31
 v_cvt_pk_bf16_f32 v46, v28, v29
 v_cvt_pk_bf16_f32 v47, v30, v31
f_t48:
 v_mfma_f32_32x32x16_bf16 v[16:31], a[32:35], a[8:11], 0
 buffer_load_dwordx4 a[56:59], v128, s[24:27], s63 offen offset:2048 sc1
 v_exp_f32 v0, v0
 v_exp_f32 v1, v1
 v_exp_f32 v2, v2
 v_exp_f32 v3, v3
 mg v,16,a,36,a,12
 buffer_load_dword v154, v145, s[24:27], s76 offen offset:0 sc1
 v_exp_f32 v4, v4
 v_cvt_pk_bf16_f32 v32, v0, v1
 v_exp_f32 v5, v5
 v_cvt_pk_bf16_f32 v33, v2, v3
 v_exp_f32 v6, v6
 mg v,96,a,88,v,40
 v_exp_f32 v7, v7
 v_cvt_pk_bf16_f32 v34, v4, v5
 v_exp_f32 v8, v8
 v_exp_f32 v9, v9
 v_cvt_pk_bf16_f32 v35, v6, v7
 v_smfmac_f32_16x16x64_bf16 v[124:127], v[156:159], v[40:47], v137
 v_exp_f32 v10, v10
 v_exp_f32 v11, v11
 v_cvt_pk_bf16_f32 v36, v8, v9
 mg v,96,a,92,v,44
 v_exp_f32 v12, v12
 v_exp_f32 v13, v13
 v_cvt_pk_bf16_f32 v37, v10, v11
 v_exp_f32 v14, v14
 v_exp_f32 v15, v15
 v_cvt_pk_bf16_f32 v38, v12, v13
 v_cvt_pk_bf16_f32 v39, v14, v15
f_t49:
 v_mfma_f32_32x32x16_bf16 v[0:15], a[32:35], a[16:19], 0
 buffer_load_dwordx4 a[60:63], v128, s[24:27], s63 offen offset:3072 sc1
 v_exp_f32 v16, v16
 v_exp_f32 v17, v17
 v_exp_f32 v18, v18
 v_exp_f32 v19, v19
 mg v,0,a,36,a,20
 v_exp_f32 v20, v20
 v_cvt_pk_bf16_f32 v40, v16, v17
 v_exp_f32 v21, v21
 v_cvt_pk_bf16_f32 v41, v18, v19
 v_exp_f32 v22, v22
 mg v,48,a,64,v,32
 v_exp_f32 v23, v23
 v_cvt_pk_bf16_f32 v42, v20, v21
 v_exp_f32 v24, v24
 v_exp_f32 v25, v25
 v_cvt_pk_bf16_f32 v43, v22, v23
 v_smfmac_f32_16x16x64_bf16 v[112:115], v[156:159], v[32:39], v137
 s_add_u32 s63, s63, 4096
 v_exp_f32 v26, v26
 v_exp_f32 v27, v27
 v_cvt_pk_bf16_f32 v44, v24, v25
 mg v,48,a,68,v,36
 v_exp_f32 v28, v28
 v_exp_f32 v29, v29
 v_cvt_pk_bf16_f32 v45, v26, v27
 v_exp_f32 v30, v30
 v_exp_f32 v31, v31
 v_cvt_pk_bf16_f32 v46, v28, v29
 v_cvt_pk_bf16_f32 v47, v30, v31
f_t50:
 v_mfma_f32_32x32x16_bf16 v[16:31], a[32:35], a[24:27], 0
 buffer_load_dwordx4 a[88:91], v128, s[24:27], s64 offen offset:2048 sc1
 v_exp_f32 v0, v0
 v_exp_f32 v1, v1
 v_exp_f32 v2, v2
 v_exp_f32 v3, v3
 mg v,16,a,36,a,28
 v_exp_f32 v4, v4
 v_cvt_pk_bf16_f32 v32, v0, v1
 v_exp_f32 v5, v5
 v_cvt_pk_bf16_f32 v33, v2, v3
 v_exp_f32 v6, v6
 mg v,64,a,64,v,40
 v_exp_f32 v7, v7
 v_cvt_pk_bf16_f32 v34, v4, v5
 v_exp_f32 v8, v8
 v_exp_f32 v9, v9
 v_cvt_pk_bf16_f32 v35, v6, v7
 v_smfmac_f32_16x16x64_bf16 v[116:119], v[156:159], v[40:47], v137
 v_exp_f32 v10, v10
 v_exp_f32 v11, v11
 v_cvt_pk_bf16_f32 v36, v8, v9
 mg v,64,a,68,v,44
 v_exp_f32 v12, v12
 v_exp_f32 v13, v13
 v_cvt_pk_bf16_f32 v37, v10, v11
 v_exp_f32 v14, v14
 v_exp_f32 v15, v15
 v_cvt_pk_bf16_f32 v38, v12, v13
 v_cvt_pk_bf16_f32 v39, v14, v15
 s_waitcnt vmcnt(8)
f_t51:
 v_mfma_f32_32x32x16_bf16 v[0:15], a[40:43], a[0:3], 0
 buffer_load_dwordx4 a[92:95], v128, s[24:27], s64 offen offset:3072 sc1
 v_exp_f32 v16, v16
 v_exp_f32 v17, v17
 v_exp_f32 v18, v18
 v_exp_f32 v19, v19
 mg v,0,a,44,a,4
 v_exp_f32 v20, v20
 v_cvt_pk_bf16_f32 v40, v16, v17
 v_exp_f32 v21, v21
 v_cvt_pk_bf16_f32 v41, v18, v19
 v_exp_f32 v22, v22
 mg v,80,a,64,v,32
 v_exp_f32 v23, v23
 v_cvt_pk_bf16_f32 v42, v20, v21
 v_exp_f32 v24, v24
 v_exp_f32 v25, v25
 v_cvt_pk_bf16_f32 v43, v22, v23
 v_smfmac_f32_16x16x64_bf16 v[120:123], v[156:159], v[32:39], v137
 s_add_u32 s64, s64, 4096
 v_exp_f32 v26, v26
 v_exp_f32 v27, v27
 v_cvt_pk_bf16_f32 v44, v24, v25
 mg v,80,a,68,v,36
 v_exp_f32 v28, v28
 v_exp_f32 v29, v29
 v_cvt_pk_bf16_f32 v45, v26, v27
 v_exp_f32 v30, v30
 v_exp_f32 v31, v31
 v_cvt_pk_bf16_f32 v46, v28, v29
 v_cvt_pk_bf16_f32 v47, v30, v31
f_t52:
 v_mfma_f32_32x32x16_bf16 v[16:31], a[40:43], a[8:11], 0
 buffer_load_dwordx4 a[32:35], v128, s[24:27], s63 offen offset:0 sc1
 v_exp_f32 v0, v0
 v_exp_f32 v1, v1
 v_exp_f32 v2, v2
 v_exp_f32 v3, v3
 mg v,16,a,44,a,12
 v_exp_f32 v4, v4
 v_cvt_pk_bf16_f32 v32, v0, v1
 v_exp_f32 v5, v5
 v_cvt_pk_bf16_f32 v33, v2, v3
 v_exp_f32 v6, v6
 mg v,96,a,64,v,40
 v_exp_f32 v7, v7
 v_cvt_pk_bf16_f32 v34, v4, v5
 v_exp_f32 v8, v8
 v_exp_f32 v9, v9
 v_cvt_pk_bf16_f32 v35, v6, v7
 v_smfmac_f32_16x16x64_bf16 v[124:127], v[156:159], v[40:47], v137
 v_exp_f32 v10, v10
 v_exp_f32 v11, v11
 v_cvt_pk_bf16_f32 v36, v8, v9
 mg v,96,a,68,v,44
 v_exp_f32 v12, v12
 v_exp_f32 v13, v13
 v_cvt_pk_bf16_f32 v37, v10, v11
 v_exp_f32 v14, v14
 v_exp_f32 v15, v15
 v_cvt_pk_bf16_f32 v38, v12, v13
 v_cvt_pk_bf16_f32 v39, v14, v15
f_t53:
 v_mfma_f32_32x32x16_bf16 v[0:15], a[40:43], a[16:19], 0
 buffer_load_dwordx4 a[36:39], v128, s[24:27], s63 offen offset:1024 sc1
 v_exp_f32 v16, v16
 v_exp_f32 v17, v17
 v_exp_f32 v18, v18
 v_exp_f32 v19, v19
 mg v,0,a,44,a,20
 v_exp_f32 v20, v20
 v_cvt_pk_bf16_f32 v40, v16, v17
 v_exp_f32 v21, v21
 v_cvt_pk_bf16_f32 v41, v18, v19
 v_exp_f32 v22, v22
 mg v,48,a,72,v,32
 v_exp_f32 v23, v23
 v_cvt_pk_bf16_f32 v42, v20, v21
 v_exp_f32 v24, v24
 v_exp_f32 v25, v25
 v_cvt_pk_bf16_f32 v43, v22, v23
 v_smfmac_f32_16x16x64_bf16 v[112:115], v[156:159], v[32:39], v137
 v_exp_f32 v26, v26
 v_exp_f32 v27, v27
 v_cvt_pk_bf16_f32 v44, v24, v25
 mg v,48,a,76,v,36
 v_exp_f32 v28, v28
 v_exp_f32 v29, v29
 v_cvt_pk_bf16_f32 v45, v26, v27
 v_exp_f32 v30, v30
 v_exp_f32 v31, v31
 v_cvt_pk_bf16_f32 v46, v28, v29
 v_cvt_pk_bf16_f32 v47, v30, v31
f_t54:
 v_mfma_f32_32x32x16_bf16 v[16:31], a[40:43], a[24:27], 0
 buffer_load_dwordx4 a[64:67], v128, s[24:27], s64 offen offset:0 sc1
 v_exp_f32 v0, v0
 v_exp_f32 v1, v1
 v_exp_f32 v2, v2
 v_exp_f32 v3, v3
 mg v,16,a,44,a,28
 v_exp_f32 v4, v4
 v_cvt_pk_bf16_f32 v32, v0, v1
 v_exp_f32 v5, v5
 v_cvt_pk_bf16_f32 v33, v2, v3
 v_exp_f32 v6, v6
 mg v,64,a,72,v,40
 v_exp_f32 v7, v7
 v_cvt_pk_bf16_f32 v34, v4, v5
 v_exp_f32 v8, v8
 v_exp_f32 v9, v9
 v_cvt_pk_bf16_f32 v35, v6, v7
 v_smfmac_f32_16x16x64_bf16 v[116:119], v[156:159], v[40:47], v137
 v_exp_f32 v10, v10
 v_exp_f32 v11, v11
 v_cvt_pk_bf16_f32 v36, v8, v9
 mg v,64,a,76,v,44
 v_exp_f32 v12, v12
 v_exp_f32 v13, v13
 v_cvt_pk_bf16_f32 v37, v10, v11
 v_exp_f32 v14, v14
 v_exp_f32 v15, v15
 v_cvt_pk_bf16_f32 v38, v12, v13
 v_cvt_pk_bf16_f32 v39, v14, v15
 s_waitcnt vmcnt(8)
f_t55:
 v_mfma_f32_32x32x16_bf16 v[0:15], a[48:51], a[0:3], 0
 buffer_load_dwordx4 a[68:71], v128, s[24:27], s64 offen offset:1024 sc1
 v_exp_f32 v16, v16
 v_exp_f32 v17, v17
 v_exp_f32 v18, v18
 v_exp_f32 v19, v19
 mg v,0,a,52,a,4
 v_exp_f32 v20, v20
 v_cvt_pk_bf16_f32 v40, v16, v17
 v_exp_f32 v21, v21
 v_cvt_pk_bf16_f32 v41, v18, v19
 v_exp_f32 v22, v22
 mg v,80,a,72,v,32
 v_exp_f32 v23, v23
 v_cvt_pk_bf16_f32 v42, v20, v21
 v_exp_f32 v24, v24
 v_exp_f32 v25, v25
 v_cvt_pk_bf16_f32 v43, v22, v23
 v_smfmac_f32_16x16x64_bf16 v[120:123], v[156:159], v[32:39], v137
 v_exp_f32 v26, v26
 v_exp_f32 v27, v27
 v_cvt_pk_bf16_f32 v44, v24, v25
 mg v,80,a,76,v,36
 v_exp_f32 v28, v28
 v_exp_f32 v29, v29
 v_cvt_pk_bf16_f32 v45, v26, v27
 v_exp_f32 v30, v30
 v_exp_f32 v31, v31
 v_cvt_pk_bf16_f32 v46, v28, v29
 v_cvt_pk_bf16_f32 v47, v30, v31
f_t56:
 v_mfma_f32_32x32x16_bf16 v[16:31], a[48:51], a[8:11], 0
 buffer_load_dwordx4 a[40:43], v128, s[24:27], s63 offen offset:2048 sc1
 v_exp_f32 v0, v0
 v_exp_f32 v1, v1
 v_exp_f32 v2, v2
 v_exp_f32 v3, v3
 mg v,16,a,52,a,12
 v_exp_f32 v4, v4
 v_cvt_pk_bf16_f32 v32, v0, v1
 v_exp_f32 v5, v5
 v_cvt_pk_bf16_f32 v33, v2, v3
 v_exp_f32 v6, v6
 mg v,96,a,72,v,40
 v_exp_f32 v7, v7
 v_cvt_pk_bf16_f32 v34, v4, v5
 v_exp_f32 v8, v8
 v_exp_f32 v9, v9
 v_cvt_pk_bf16_f32 v35, v6, v7
 v_smfmac_f32_16x16x64_bf16 v[124:127], v[156:159], v[40:47], v137
 v_exp_f32 v10, v10
 v_exp_f32 v11, v11
 v_cvt_pk_bf16_f32 v36, v8, v9
 mg v,96,a,76,v,44
 v_exp_f32 v12, v12
 v_exp_f32 v13, v13
 v_cvt_pk_bf16_f32 v37, v10, v11
 v_exp_f32 v14, v14
 v_exp_f32 v15, v15
 v_cvt_pk_bf16_f32 v38, v12, v13
 v_cvt_pk_bf16_f32 v39, v14, v15
f_t57:
 v_mfma_f32_32x32x16_bf16 v[0:15], a[48:51], a[16:19], 0
 buffer_load_dwordx4 a[44:47], v128, s[24:27], s63 offen offset:3072 sc1
 v_exp_f32 v16, v16
 v_exp_f32 v17, v17
 v_exp_f32 v18, v18
 v_exp_f32 v19, v19
 mg v,0,a,52,a,20
 v_exp_f32 v20, v20
 v_cvt_pk_bf16_f32 v40, v16, v17
 v_exp_f32 v21, v21
 v_cvt_pk_bf16_f32 v41, v18, v19
 v_exp_f32 v22, v22
 mg v,48,a,80,v,32
 v_exp_f32 v23, v23
 v_cvt_pk_bf16_f32 v42, v20, v21
 v_exp_f32 v24, v24
 v_exp_f32 v25, v25
 v_cvt_pk_bf16_f32 v43, v22, v23
 v_smfmac_f32_16x16x64_bf16 v[112:115], v[156:159], v[32:39], v137
 s_add_u32 s63, s63, 4096
 v_exp_f32 v26, v26
 v_exp_f32 v27, v27
 v_cvt_pk_bf16_f32 v44, v24, v25
 mg v,48,a,84,v,36
 v_exp_f32 v28, v28
 v_exp_f32 v29, v29
 v_cvt_pk_bf16_f32 v45, v26, v27
 v_exp_f32 v30, v30
 v_exp_f32 v31, v31
 v_cvt_pk_bf16_f32 v46, v28, v29
 v_cvt_pk_bf16_f32 v47, v30, v31
f_t58:
 v_mfma_f32_32x32x16_bf16 v[16:31], a[48:51], a[24:27], 0
 buffer_load_dwordx4 a[72:75], v128, s[24:27], s64 offen offset:2048 sc1
 v_exp_f32 v0, v0
 v_exp_f32 v1, v1
 v_exp_f32 v2, v2
 v_exp_f32 v3, v3
 mg v,16,a,52,a,28
 v_exp_f32 v4, v4
 v_cvt_pk_bf16_f32 v32, v0, v1
 v_exp_f32 v5, v5
 v_cvt_pk_bf16_f32 v33, v2, v3
 v_exp_f32 v6, v6
 mg v,64,a,80,v,40
 v_exp_f32 v7, v7
 v_cvt_pk_bf16_f32 v34, v4, v5
 v_exp_f32 v8, v8
 v_exp_f32 v9, v9
 v_cvt_pk_bf16_f32 v35, v6, v7
 v_smfmac_f32_16x16x64_bf16 v[116:119], v[156:159], v[40:47], v137
 v_exp_f32 v10, v10
 v_exp_f32 v11, v11
 v_cvt_pk_bf16_f32 v36, v8, v9
 mg v,64,a,84,v,44
 v_exp_f32 v12, v12
 v_exp_f32 v13, v13
 v_cvt_pk_bf16_f32 v37, v10, v11
 v_exp_f32 v14, v14
 v_exp_f32 v15, v15
 v_cvt_pk_bf16_f32 v38, v12, v13
 v_cvt_pk_bf16_f32 v39, v14, v15
 s_waitcnt vmcnt(7)
 v_cmp_ne_u32 vcc, v144, v154
 s_cbranch_vccnz f_ph
f_ph_back:
 s_waitcnt lgkmcnt(0)
 s_barrier
f_t59:
 v_mfma_f32_32x32x16_bf16 v[0:15], a[56:59], a[0:3], 0
 buffer_load_dwordx4 a[76:79], v128, s[24:27], s64 offen offset:3072 sc1
 v_exp_f32 v16, v16
 v_exp_f32 v17, v17
 v_exp_f32 v18, v18
 v_exp_f32 v19, v19
 mg v,0,a,60,a,4
 v_exp_f32 v20, v20
 v_cvt_pk_bf16_f32 v40, v16, v17
 v_exp_f32 v21, v21
 v_cvt_pk_bf16_f32 v41, v18, v19
 v_exp_f32 v22, v22
 mg v,80,a,80,v,32
 v_exp_f32 v23, v23
 v_cvt_pk_bf16_f32 v42, v20, v21
 v_exp_f32 v24, v24
 v_exp_f32 v25, v25
 v_cvt_pk_bf16_f32 v43, v22, v23
 v_smfmac_f32_16x16x64_bf16 v[120:123], v[156:159], v[32:39], v137
 s_add_u32 s64, s64, 4096
 v_exp_f32 v26, v26
 v_exp_f32 v27, v27
 v_cvt_pk_bf16_f32 v44, v24, v25
 mg v,80,a,84,v,36
 v_exp_f32 v28, v28
 v_exp_f32 v29, v29
 v_cvt_pk_bf16_f32 v45, v26, v27
 v_exp_f32 v30, v30
 v_exp_f32 v31, v31
 v_cvt_pk_bf16_f32 v46, v28, v29
 v_cvt_pk_bf16_f32 v47, v30, v31
f_t60:
 v_mfma_f32_32x32x16_bf16 v[16:31], a[56:59], a[8:11], 0
 buffer_load_dwordx4 a[48:51], v128, s[24:27], s63 offen offset:0 sc1
 v_exp_f32 v0, v0
 v_exp_f32 v1, v1
 v_exp_f32 v2, v2
 v_exp_f32 v3, v3
 mg v,16,a,60,a,12
 s_add_u32 m0, s53, 0
 v_exp_f32 v4, v4
 v_cvt_pk_bf16_f32 v32, v0, v1
 v_exp_f32 v5, v5
 v_cvt_pk_bf16_f32 v33, v2, v3
 v_exp_f32 v6, v6
 mg v,96,a,80,v,40
 buffer_load_dwordx4 v147, s[28:31], s62 offen lds
 v_exp_f32 v7, v7
 v_cvt_pk_bf16_f32 v34, v4, v5
 v_exp_f32 v8, v8
 v_exp_f32 v9, v9
 v_cvt_pk_bf16_f32 v35, v6, v7
 v_smfmac_f32_16x16x64_bf16 v[124:127], v[156:159], v[40:47], v137
 s_add_u32 m0, s53, 1024
 v_exp_f32 v10, v10
 v_exp_f32 v11, v11
 v_cvt_pk_bf16_f32 v36, v8, v9
 mg v,96,a,84,v,44
 buffer_load_dwordx4 v148, s[28:31], s62 offen lds
 v_exp_f32 v12, v12
 v_exp_f32 v13, v13
 v_cvt_pk_bf16_f32 v37, v10, v11
 v_exp_f32 v14, v14
 v_exp_f32 v15, v15
 v_cvt_pk_bf16_f32 v38, v12, v13
 v_cvt_pk_bf16_f32 v39, v14, v15
f_t61:
 v_mfma_f32_32x32x16_bf16 v[0:15], a[56:59], a[16:19], 0
 buffer_load_dwordx4 a[52:55], v128, s[24:27], s63 offen offset:1024 sc1
 v_exp_f32 v16, v16
 v_exp_f32 v17, v17
 v_exp_f32 v18, v18
 v_exp_f32 v19, v19
 mg v,0,a,60,a,20
 s_add_u32 m0, s53, 2048
 v_exp_f32 v20, v20
 v_cvt_pk_bf16_f32 v40, v16, v17
 v_exp_f32 v21, v21
 v_cvt_pk_bf16_f32 v41, v18, v19
 v_exp_f32 v22, v22
 mg v,48,a,88,v,32
 buffer_load_dwordx4 v149, s[28:31], s62 offen lds
 v_exp_f32 v23, v23
 v_cvt_pk_bf16_f32 v42, v20, v21
 v_exp_f32 v24, v24
 v_exp_f32 v25, v25
 v_cvt_pk_bf16_f32 v43, v22, v23
 v_smfmac_f32_16x16x64_bf16 v[112:115], v[156:159], v[32:39], v137
 s_add_u32 m0, s53, 3072
 v_exp_f32 v26, v26
 v_exp_f32 v27, v27
 v_cvt_pk_bf16_f32 v44, v24, v25
 mg v,48,a,92,v,36
 buffer_load_dwordx4 v150, s[28:31], s62 offen lds
 v_exp_f32 v28, v28
 v_exp_f32 v29, v29
 v_cvt_pk_bf16_f32 v45, v26, v27
 v_exp_f32 v30, v30
 v_exp_f32 v31, v31
 s_add_u32 s62, s62, 65536
 v_cvt_pk_bf16_f32 v46, v28, v29
 v_cvt_pk_bf16_f32 v47, v30, v31
f_t62:
 v_mfma_f32_32x32x16_bf16 v[16:31], a[56:59], a[24:27], 0
 buffer_load_dwordx4 a[80:83], v128, s[24:27], s64 offen offset:0 sc1
 v_exp_f32 v0, v0
 v_exp_f32 v1, v1
 v_exp_f32 v2, v2
 v_exp_f32 v3, v3
 mg v,16,a,60,a,28
 v_exp_f32 v4, v4
 v_cvt_pk_bf16_f32 v32, v0, v1
 v_exp_f32 v5, v5
 v_cvt_pk_bf16_f32 v33, v2, v3
 v_exp_f32 v6, v6
 mg v,64,a,88,v,40
 buffer_load_dwordx4 v[160:163], v128, s[24:27], s54 offen offset:0 sc1
 v_exp_f32 v7, v7
 v_cvt_pk_bf16_f32 v34, v4, v5
 v_exp_f32 v8, v8
 v_exp_f32 v9, v9
 v_cvt_pk_bf16_f32 v35, v6, v7
 v_smfmac_f32_16x16x64_bf16 v[116:119], v[156:159], v[40:47], v137
 v_exp_f32 v10, v10
 v_exp_f32 v11, v11
 v_cvt_pk_bf16_f32 v36, v8, v9
 mg v,64,a,92,v,44
 v_exp_f32 v12, v12
 v_exp_f32 v13, v13
 v_cvt_pk_bf16_f32 v37, v10, v11
 v_exp_f32 v14, v14
 v_exp_f32 v15, v15
 v_cvt_pk_bf16_f32 v38, v12, v13
 v_cvt_pk_bf16_f32 v39, v14, v15
 s_waitcnt vmcnt(12)
f_t63:
 v_mfma_f32_32x32x16_bf16 v[0:15], a[32:35], a[0:3], 0
 buffer_load_dwordx4 a[84:87], v128, s[24:27], s64 offen offset:1024 sc1
 v_exp_f32 v16, v16
 v_exp_f32 v17, v17
 v_exp_f32 v18, v18
 v_exp_f32 v19, v19
 mg v,0,a,36,a,4
 v_exp_f32 v20, v20
 v_cvt_pk_bf16_f32 v40, v16, v17
 v_exp_f32 v21, v21
 v_cvt_pk_bf16_f32 v41, v18, v19
 v_exp_f32 v22, v22
 mg v,80,a,88,v,32
 buffer_load_dwordx4 v[164:167], v128, s[24:27], s55 offen offset:0 sc1
 v_exp_f32 v23, v23
 v_cvt_pk_bf16_f32 v42, v20, v21
 v_exp_f32 v24, v24
 v_exp_f32 v25, v25
 v_cvt_pk_bf16_f32 v43, v22, v23
 v_smfmac_f32_16x16x64_bf16 v[120:123], v[156:159], v[32:39], v137
 v_exp_f32 v26, v26
 v_exp_f32 v27, v27
 v_cvt_pk_bf16_f32 v44, v24, v25
 mg v,80,a,92,v,36
 buffer_load_dwordx4 v[168:171], v128, s[24:27], s56 offen offset:0 sc1
 v_exp_f32 v28, v28
 v_exp_f32 v29, v29
 v_cvt_pk_bf16_f32 v45, v26, v27
 v_exp_f32 v30, v30
 v_exp_f32 v31, v31
 v_cvt_pk_bf16_f32 v46, v28, v29
 v_cvt_pk_bf16_f32 v47, v30, v31
 s_cmp_lg_u32 s75, 42074112
 s_cbranch_scc1 f_ep
 s_mov_b32 s10, 42270720
 buffer_store_dword v144, v143, s[24:27], s10 offen sc1
f_ep:
f_t64:
 v_mfma_f32_32x32x16_bf16 v[16:31], a[32:35], a[8:11], 0
 buffer_load_dwordx4 a[56:59], v128, s[24:27], s63 offen offset:2048 sc1
 v_exp_f32 v0, v0
 v_exp_f32 v1, v1
 v_exp_f32 v2, v2
 v_exp_f32 v3, v3
 mg v,16,a,36,a,12
 v_exp_f32 v4, v4
 v_cvt_pk_bf16_f32 v32, v0, v1
 v_exp_f32 v5, v5
 v_cvt_pk_bf16_f32 v33, v2, v3
 v_exp_f32 v6, v6
 mg v,96,a,88,v,40
 buffer_load_dwordx4 v[172:175], v128, s[24:27], s57 offen offset:0 sc1
 v_exp_f32 v7, v7
 v_cvt_pk_bf16_f32 v34, v4, v5
 v_exp_f32 v8, v8
 v_exp_f32 v9, v9
 v_cvt_pk_bf16_f32 v35, v6, v7
 v_smfmac_f32_16x16x64_bf16 v[124:127], v[156:159], v[40:47], v137
 v_exp_f32 v10, v10
 v_exp_f32 v11, v11
 v_cvt_pk_bf16_f32 v36, v8, v9
 mg v,96,a,92,v,44
 v_exp_f32 v12, v12
 v_exp_f32 v13, v13
 v_cvt_pk_bf16_f32 v37, v10, v11
 v_exp_f32 v14, v14
 v_exp_f32 v15, v15
 v_cvt_pk_bf16_f32 v38, v12, v13
 v_cvt_pk_bf16_f32 v39, v14, v15
f_t65:
 v_mfma_f32_32x32x16_bf16 v[0:15], a[32:35], a[16:19], 0
 buffer_load_dwordx4 a[60:63], v128, s[24:27], s63 offen offset:3072 sc1
 v_exp_f32 v16, v16
 v_exp_f32 v17, v17
 v_exp_f32 v18, v18
 v_exp_f32 v19, v19
 mg v,0,a,36,a,20
 v_exp_f32 v20, v20
 v_cvt_pk_bf16_f32 v40, v16, v17
 v_exp_f32 v21, v21
 v_cvt_pk_bf16_f32 v41, v18, v19
 v_exp_f32 v22, v22
 mg v,48,a,64,v,32
 buffer_load_dwordx4 a[96:99], v128, s[24:27], s54 offen offset:1024 sc1
 v_exp_f32 v23, v23
 v_cvt_pk_bf16_f32 v42, v20, v21
 v_exp_f32 v24, v24
 v_exp_f32 v25, v25
 v_cvt_pk_bf16_f32 v43, v22, v23
 v_smfmac_f32_16x16x64_bf16 v[112:115], v[156:159], v[32:39], v137
 s_add_u32 s63, s63, 4096
 v_exp_f32 v26, v26
 v_exp_f32 v27, v27
 v_cvt_pk_bf16_f32 v44, v24, v25
 mg v,48,a,68,v,36
 buffer_load_dwordx4 a[100:103], v128, s[24:27], s55 offen offset:1024 sc1
 v_exp_f32 v28, v28
 v_exp_f32 v29, v29
 v_cvt_pk_bf16_f32 v45, v26, v27
 v_exp_f32 v30, v30
 v_exp_f32 v31, v31
 v_cvt_pk_bf16_f32 v46, v28, v29
 v_cvt_pk_bf16_f32 v47, v30, v31
f_t66:
 v_mfma_f32_32x32x16_bf16 v[16:31], a[32:35], a[24:27], 0
 buffer_load_dwordx4 a[88:91], v128, s[24:27], s64 offen offset:2048 sc1
 v_exp_f32 v0, v0
 v_exp_f32 v1, v1
 v_exp_f32 v2, v2
 v_exp_f32 v3, v3
 mg v,16,a,36,a,28
 v_exp_f32 v4, v4
 v_cvt_pk_bf16_f32 v32, v0, v1
 v_exp_f32 v5, v5
 v_cvt_pk_bf16_f32 v33, v2, v3
 v_exp_f32 v6, v6
 mg v,64,a,64,v,40
 buffer_load_dwordx4 a[104:107], v128, s[24:27], s56 offen offset:1024 sc1
 v_exp_f32 v7, v7
 v_cvt_pk_bf16_f32 v34, v4, v5
 v_exp_f32 v8, v8
 v_exp_f32 v9, v9
 v_cvt_pk_bf16_f32 v35, v6, v7
 v_smfmac_f32_16x16x64_bf16 v[116:119], v[156:159], v[40:47], v137
 v_exp_f32 v10, v10
 v_exp_f32 v11, v11
 v_cvt_pk_bf16_f32 v36, v8, v9
 mg v,64,a,68,v,44
 v_exp_f32 v12, v12
 v_exp_f32 v13, v13
 v_cvt_pk_bf16_f32 v37, v10, v11
 v_exp_f32 v14, v14
 v_exp_f32 v15, v15
 v_cvt_pk_bf16_f32 v38, v12, v13
 v_cvt_pk_bf16_f32 v39, v14, v15
 s_waitcnt vmcnt(18)
f_t67:
 v_mfma_f32_32x32x16_bf16 v[0:15], a[40:43], a[0:3], 0
 buffer_load_dwordx4 a[92:95], v128, s[24:27], s64 offen offset:3072 sc1
 v_exp_f32 v16, v16
 v_exp_f32 v17, v17
 v_exp_f32 v18, v18
 v_exp_f32 v19, v19
 mg v,0,a,44,a,4
 v_exp_f32 v20, v20
 v_cvt_pk_bf16_f32 v40, v16, v17
 v_exp_f32 v21, v21
 v_cvt_pk_bf16_f32 v41, v18, v19
 v_exp_f32 v22, v22
 mg v,80,a,64,v,32
 buffer_load_dwordx4 a[108:111], v128, s[24:27], s57 offen offset:1024 sc1
 v_exp_f32 v23, v23
 v_cvt_pk_bf16_f32 v42, v20, v21
 v_exp_f32 v24, v24
 v_exp_f32 v25, v25
 v_cvt_pk_bf16_f32 v43, v22, v23
 v_smfmac_f32_16x16x64_bf16 v[120:123], v[156:159], v[32:39], v137
 s_add_u32 s64, s64, 4096
 s_add_u32 m0, s53, 4096
 v_exp_f32 v26, v26
 v_exp_f32 v27, v27
 v_cvt_pk_bf16_f32 v44, v24, v25
 mg v,80,a,68,v,36
 buffer_load_dwordx4 v147, s[28:31], s62 offen lds
 v_exp_f32 v28, v28
 v_exp_f32 v29, v29
 v_cvt_pk_bf16_f32 v45, v26, v27
 v_exp_f32 v30, v30
 v_exp_f32 v31, v31
 v_cvt_pk_bf16_f32 v46, v28, v29
 v_cvt_pk_bf16_f32 v47, v30, v31
f_t68:
 v_mfma_f32_32x32x16_bf16 v[16:31], a[40:43], a[8:11], 0
 buffer_load_dwordx4 a[32:35], v128, s[24:27], s63 offen offset:0 sc1
 v_exp_f32 v0, v0
 v_exp_f32 v1, v1
 v_exp_f32 v2, v2
 v_exp_f32 v3, v3
 mg v,16,a,44,a,12
 s_add_u32 m0, s53, 5120
 v_exp_f32 v4, v4
 v_cvt_pk_bf16_f32 v32, v0, v1
 v_exp_f32 v5, v5
 v_cvt_pk_bf16_f32 v33, v2, v3
 v_exp_f32 v6, v6
 mg v,96,a,64,v,40
 buffer_load_dwordx4 v148, s[28:31], s62 offen lds
 v_exp_f32 v7, v7
 v_cvt_pk_bf16_f32 v34, v4, v5
 v_exp_f32 v8, v8
 v_exp_f32 v9, v9
 v_cvt_pk_bf16_f32 v35, v6, v7
 v_smfmac_f32_16x16x64_bf16 v[124:127], v[156:159], v[40:47], v137
 v_exp_f32 v10, v10
 v_exp_f32 v11, v11
 v_cvt_pk_bf16_f32 v36, v8, v9
 mg v,96,a,68,v,44
 v_exp_f32 v12, v12
 v_exp_f32 v13, v13
 v_cvt_pk_bf16_f32 v37, v10, v11
 v_exp_f32 v14, v14
 v_exp_f32 v15, v15
 v_cvt_pk_bf16_f32 v38, v12, v13
 v_cvt_pk_bf16_f32 v39, v14, v15
f_t69:
 v_mfma_f32_32x32x16_bf16 v[0:15], a[40:43], a[16:19], 0
 buffer_load_dwordx4 a[36:39], v128, s[24:27], s63 offen offset:1024 sc1
 v_exp_f32 v16, v16
 v_exp_f32 v17, v17
 v_exp_f32 v18, v18
 v_exp_f32 v19, v19
 mg v,0,a,44,a,20
 s_add_u32 m0, s53, 6144
 v_exp_f32 v20, v20
 v_cvt_pk_bf16_f32 v40, v16, v17
 v_exp_f32 v21, v21
 v_cvt_pk_bf16_f32 v41, v18, v19
 v_exp_f32 v22, v22
 mg v,48,a,72,v,32
 buffer_load_dwordx4 v149, s[28:31], s62 offen lds
 v_exp_f32 v23, v23
 v_cvt_pk_bf16_f32 v42, v20, v21
 v_exp_f32 v24, v24
 v_exp_f32 v25, v25
 v_cvt_pk_bf16_f32 v43, v22, v23
 v_smfmac_f32_16x16x64_bf16 v[112:115], v[156:159], v[32:39], v137
 s_add_u32 m0, s53, 7168
 v_exp_f32 v26, v26
 v_exp_f32 v27, v27
 v_cvt_pk_bf16_f32 v44, v24, v25
 mg v,48,a,76,v,36
 buffer_load_dwordx4 v150, s[28:31], s62 offen lds
 v_exp_f32 v28, v28
 v_exp_f32 v29, v29
 v_cvt_pk_bf16_f32 v45, v26, v27
 v_exp_f32 v30, v30
 v_exp_f32 v31, v31
 s_add_u32 s62, s62, 65536
 v_cvt_pk_bf16_f32 v46, v28, v29
 v_cvt_pk_bf16_f32 v47, v30, v31
f_t70:
 v_mfma_f32_32x32x16_bf16 v[16:31], a[40:43], a[24:27], 0
 buffer_load_dwordx4 a[64:67], v128, s[24:27], s64 offen offset:0 sc1
 v_exp_f32 v0, v0
 v_exp_f32 v1, v1
 v_exp_f32 v2, v2
 v_exp_f32 v3, v3
 mg v,16,a,44,a,28
 v_exp_f32 v4, v4
 v_cvt_pk_bf16_f32 v32, v0, v1
 v_exp_f32 v5, v5
 v_cvt_pk_bf16_f32 v33, v2, v3
 v_exp_f32 v6, v6
 mg v,64,a,72,v,40
 buffer_load_dwordx4 a[112:115], v128, s[24:27], s54 offen offset:2048 sc1
 v_exp_f32 v7, v7
 v_cvt_pk_bf16_f32 v34, v4, v5
 v_exp_f32 v8, v8
 v_exp_f32 v9, v9
 v_cvt_pk_bf16_f32 v35, v6, v7
 v_smfmac_f32_16x16x64_bf16 v[116:119], v[156:159], v[40:47], v137
 v_exp_f32 v10, v10
 v_exp_f32 v11, v11
 v_cvt_pk_bf16_f32 v36, v8, v9
 mg v,64,a,76,v,44
 v_exp_f32 v12, v12
 v_exp_f32 v13, v13
 v_cvt_pk_bf16_f32 v37, v10, v11
 v_exp_f32 v14, v14
 v_exp_f32 v15, v15
 v_cvt_pk_bf16_f32 v38, v12, v13
 v_cvt_pk_bf16_f32 v39, v14, v15
 s_waitcnt vmcnt(19)
f_t71:
 v_mfma_f32_32x32x16_bf16 v[0:15], a[48:51], a[0:3], 0
 buffer_load_dwordx4 a[68:71], v128, s[24:27], s64 offen offset:1024 sc1
 v_exp_f32 v16, v16
 v_exp_f32 v17, v17
 v_exp_f32 v18, v18
 v_exp_f32 v19, v19
 mg v,0,a,52,a,4
 v_exp_f32 v20, v20
 v_cvt_pk_bf16_f32 v40, v16, v17
 v_exp_f32 v21, v21
 v_cvt_pk_bf16_f32 v41, v18, v19
 v_exp_f32 v22, v22
 mg v,80,a,72,v,32
 buffer_load_dwordx4 a[116:119], v128, s[24:27], s55 offen offset:2048 sc1
 v_exp_f32 v23, v23
 v_cvt_pk_bf16_f32 v42, v20, v21
 v_exp_f32 v24, v24
 v_exp_f32 v25, v25
 v_cvt_pk_bf16_f32 v43, v22, v23
 v_smfmac_f32_16x16x64_bf16 v[120:123], v[156:159], v[32:39], v137
 v_exp_f32 v26, v26
 v_exp_f32 v27, v27
 v_cvt_pk_bf16_f32 v44, v24, v25
 mg v,80,a,76,v,36
 buffer_load_dwordx4 a[120:123], v128, s[24:27], s56 offen offset:2048 sc1
 v_exp_f32 v28, v28
 v_exp_f32 v29, v29
 v_cvt_pk_bf16_f32 v45, v26, v27
 v_exp_f32 v30, v30
 v_exp_f32 v31, v31
 v_cvt_pk_bf16_f32 v46, v28, v29
 v_cvt_pk_bf16_f32 v47, v30, v31
f_t72:
 v_mfma_f32_32x32x16_bf16 v[16:31], a[48:51], a[8:11], 0
 buffer_load_dwordx4 a[40:43], v128, s[24:27], s63 offen offset:2048 sc1
 v_exp_f32 v0, v0
 v_exp_f32 v1, v1
 v_exp_f32 v2, v2
 v_exp_f32 v3, v3
 mg v,16,a,52,a,12
 v_exp_f32 v4, v4
 v_cvt_pk_bf16_f32 v32, v0, v1
 v_exp_f32 v5, v5
 v_cvt_pk_bf16_f32 v33, v2, v3
 v_exp_f32 v6, v6
 mg v,96,a,72,v,40
 buffer_load_dwordx4 a[124:127], v128, s[24:27], s57 offen offset:2048 sc1
 v_exp_f32 v7, v7
 v_cvt_pk_bf16_f32 v34, v4, v5
 v_exp_f32 v8, v8
 v_exp_f32 v9, v9
 v_cvt_pk_bf16_f32 v35, v6, v7
 v_smfmac_f32_16x16x64_bf16 v[124:127], v[156:159], v[40:47], v137
 v_exp_f32 v10, v10
 v_exp_f32 v11, v11
 v_cvt_pk_bf16_f32 v36, v8, v9
 mg v,96,a,76,v,44
 v_exp_f32 v12, v12
 v_exp_f32 v13, v13
 v_cvt_pk_bf16_f32 v37, v10, v11
 v_exp_f32 v14, v14
 v_exp_f32 v15, v15
 v_cvt_pk_bf16_f32 v38, v12, v13
 v_cvt_pk_bf16_f32 v39, v14, v15
f_t73:
 v_mfma_f32_32x32x16_bf16 v[0:15], a[48:51], a[16:19], 0
 buffer_load_dwordx4 a[44:47], v128, s[24:27], s63 offen offset:3072 sc1
 v_exp_f32 v16, v16
 v_exp_f32 v17, v17
 v_exp_f32 v18, v18
 v_exp_f32 v19, v19
 mg v,0,a,52,a,20
 v_exp_f32 v20, v20
 v_cvt_pk_bf16_f32 v40, v16, v17
 v_exp_f32 v21, v21
 v_cvt_pk_bf16_f32 v41, v18, v19
 v_exp_f32 v22, v22
 mg v,48,a,80,v,32
 buffer_load_dwordx4 v[176:179], v128, s[24:27], s54 offen offset:3072 sc1
 v_exp_f32 v23, v23
 v_cvt_pk_bf16_f32 v42, v20, v21
 v_exp_f32 v24, v24
 v_exp_f32 v25, v25
 v_cvt_pk_bf16_f32 v43, v22, v23
 v_smfmac_f32_16x16x64_bf16 v[112:115], v[156:159], v[32:39], v137
 s_add_u32 s63, s63, 4096
 v_exp_f32 v26, v26
 v_exp_f32 v27, v27
 v_cvt_pk_bf16_f32 v44, v24, v25
 mg v,48,a,84,v,36
 buffer_load_dwordx4 v[180:183], v128, s[24:27], s55 offen offset:3072 sc1
 v_exp_f32 v28, v28
 v_exp_f32 v29, v29
 v_cvt_pk_bf16_f32 v45, v26, v27
 v_exp_f32 v30, v30
 v_exp_f32 v31, v31
 s_add_u32 s54, s54, s44
 s_add_u32 s55, s55, s44
 v_cvt_pk_bf16_f32 v46, v28, v29
 v_cvt_pk_bf16_f32 v47, v30, v31
f_t74:
 s_mov_b32 s69, f_t94-f_base
 v_mfma_f32_32x32x16_bf16 v[16:31], a[48:51], a[24:27], 0
 buffer_load_dwordx4 a[72:75], v128, s[24:27], s64 offen offset:2048 sc1
 v_exp_f32 v0, v0
 v_exp_f32 v1, v1
 v_exp_f32 v2, v2
 v_exp_f32 v3, v3
 mg v,16,a,52,a,28
 buffer_load_dword v129, v155, s[36:39], s69 offen
 v_exp_f32 v4, v4
 v_cvt_pk_bf16_f32 v32, v0, v1
 v_exp_f32 v5, v5
 v_cvt_pk_bf16_f32 v33, v2, v3
 v_exp_f32 v6, v6
 mg v,64,a,80,v,40
 buffer_load_dwordx4 v[184:187], v128, s[24:27], s56 offen offset:3072 sc1
 v_exp_f32 v7, v7
 v_cvt_pk_bf16_f32 v34, v4, v5
 v_exp_f32 v8, v8
 v_exp_f32 v9, v9
 v_cvt_pk_bf16_f32 v35, v6, v7
 v_smfmac_f32_16x16x64_bf16 v[116:119], v[156:159], v[40:47], v137
 v_exp_f32 v10, v10
 v_exp_f32 v11, v11
 v_cvt_pk_bf16_f32 v36, v8, v9
 mg v,64,a,84,v,44
 v_exp_f32 v12, v12
 v_exp_f32 v13, v13
 v_cvt_pk_bf16_f32 v37, v10, v11
 v_exp_f32 v14, v14
 v_exp_f32 v15, v15
 s_add_u32 s56, s56, s44
 v_cvt_pk_bf16_f32 v38, v12, v13
 v_cvt_pk_bf16_f32 v39, v14, v15
 s_waitcnt vmcnt(20)
f_t75:
 v_mfma_f32_32x32x16_bf16 v[0:15], a[56:59], a[0:3], 0
 buffer_load_dwordx4 a[76:79], v128, s[24:27], s64 offen offset:3072 sc1
 v_exp_f32 v16, v16
 v_exp_f32 v17, v17
 v_exp_f32 v18, v18
 v_exp_f32 v19, v19
 mg v,0,a,60,a,4
 v_exp_f32 v20, v20
 v_cvt_pk_bf16_f32 v40, v16, v17
 v_exp_f32 v21, v21
 v_cvt_pk_bf16_f32 v41, v18, v19
 v_exp_f32 v22, v22
 mg v,80,a,80,v,32
 buffer_load_dwordx4 v[188:191], v128, s[24:27], s57 offen offset:3072 sc1
 v_exp_f32 v23, v23
 v_cvt_pk_bf16_f32 v42, v20, v21
 v_exp_f32 v24, v24
 v_exp_f32 v25, v25
 v_cvt_pk_bf16_f32 v43, v22, v23
 v_smfmac_f32_16x16x64_bf16 v[120:123], v[156:159], v[32:39], v137
 s_add_u32 s64, s64, 4096
 s_add_u32 m0, s53, 8192
 v_exp_f32 v26, v26
 v_exp_f32 v27, v27
 v_cvt_pk_bf16_f32 v44, v24, v25
 mg v,80,a,84,v,36
 buffer_load_dwordx4 v147, s[28:31], s62 offen lds
 v_exp_f32 v28, v28
 v_exp_f32 v29, v29
 v_cvt_pk_bf16_f32 v45, v26, v27
 v_exp_f32 v30, v30
 v_exp_f32 v31, v31
 s_add_u32 s57, s57, s44
 v_cvt_pk_bf16_f32 v46, v28, v29
 v_cvt_pk_bf16_f32 v47, v30, v31
f_t76:
 v_mfma_f32_32x32x16_bf16 v[16:31], a[56:59], a[8:11], 0
 buffer_load_dwordx4 a[48:51], v128, s[24:27], s63 offen offset:0 sc1
 v_exp_f32 v0, v0
 v_exp_f32 v1, v1
 v_exp_f32 v2, v2
 v_exp_f32 v3, v3
 mg v,16,a,60,a,12
 s_add_u32 m0, s53, 9216
 v_exp_f32 v4, v4
 v_cvt_pk_bf16_f32 v32, v0, v1
 v_exp_f32 v5, v5
 v_cvt_pk_bf16_f32 v33, v2, v3
 v_exp_f32 v6, v6
 mg v,96,a,80,v,40
 buffer_load_dwordx4 v148, s[28:31], s62 offen lds
 v_exp_f32 v7, v7
 v_cvt_pk_bf16_f32 v34, v4, v5
 v_exp_f32 v8, v8
 v_exp_f32 v9, v9
 v_cvt_pk_bf16_f32 v35, v6, v7
 v_smfmac_f32_16x16x64_bf16 v[124:127], v[156:159], v[40:47], v137
 s_add_u32 m0, s53, 10240
 v_exp_f32 v10, v10
 v_exp_f32 v11, v11
 v_cvt_pk_bf16_f32 v36, v8, v9
 mg v,96,a,84,v,44
 buffer_load_dwordx4 v149, s[28:31], s62 offen lds
 v_exp_f32 v12, v12
 v_exp_f32 v13, v13
 v_cvt_pk_bf16_f32 v37, v10, v11
 v_exp_f32 v14, v14
 v_exp_f32 v15, v15
 v_cvt_pk_bf16_f32 v38, v12, v13
 v_cvt_pk_bf16_f32 v39, v14, v15
f_t77:
 v_mfma_f32_32x32x16_bf16 v[0:15], a[56:59], a[16:19], 0
 buffer_load_dwordx4 a[52:55], v128, s[24:27], s63 offen offset:1024 sc1
 v_exp_f32 v16, v16
 v_exp_f32 v17, v17
 v_exp_f32 v18, v18
 v_exp_f32 v19, v19
 mg v,0,a,60,a,20
 s_add_u32 m0, s53, 11264
 v_exp_f32 v20, v20
 v_cvt_pk_bf16_f32 v40, v16, v17
 v_exp_f32 v21, v21
 v_cvt_pk_bf16_f32 v41, v18, v19
 v_exp_f32 v22, v22
 mg v,48,a,88,v,32
 buffer_load_dwordx4 v150, s[28:31], s62 offen lds
 v_exp_f32 v23, v23
 v_cvt_pk_bf16_f32 v42, v20, v21
 v_exp_f32 v24, v24
 v_exp_f32 v25, v25
 v_cvt_pk_bf16_f32 v43, v22, v23
 v_smfmac_f32_16x16x64_bf16 v[112:115], v[156:159], v[32:39], v137
 v_exp_f32 v26, v26
 v_exp_f32 v27, v27
 v_cvt_pk_bf16_f32 v44, v24, v25
 mg v,48,a,92,v,36
 v_exp_f32 v28, v28
 v_exp_f32 v29, v29
 v_cvt_pk_bf16_f32 v45, v26, v27
 v_exp_f32 v30, v30
 v_exp_f32 v31, v31
 s_add_u32 s62, s62, 65536
 v_cvt_pk_bf16_f32 v46, v28, v29
 v_cvt_pk_bf16_f32 v47, v30, v31
f_t78:
 v_mfma_f32_32x32x16_bf16 v[16:31], a[56:59], a[24:27], 0
 buffer_load_dwordx4 a[80:83], v128, s[24:27], s64 offen offset:0 sc1
 v_exp_f32 v0, v0
 v_exp_f32 v1, v1
 v_exp_f32 v2, v2
 v_exp_f32 v3, v3
 mg v,16,a,60,a,28
 v_exp_f32 v4, v4
 v_cvt_pk_bf16_f32 v32, v0, v1
 v_exp_f32 v5, v5
 v_cvt_pk_bf16_f32 v33, v2, v3
 v_exp_f32 v6, v6
 mg v,64,a,88,v,40
 buffer_load_dwordx4 a[128:131], v128, s[24:27], s54 offen offset:0 sc1
 v_exp_f32 v7, v7
 v_cvt_pk_bf16_f32 v34, v4, v5
 v_exp_f32 v8, v8
 v_exp_f32 v9, v9
 v_cvt_pk_bf16_f32 v35, v6, v7
 v_smfmac_f32_16x16x64_bf16 v[116:119], v[156:159], v[40:47], v137
 v_exp_f32 v10, v10
 v_exp_f32 v11, v11
 v_cvt_pk_bf16_f32 v36, v8, v9
 mg v,64,a,92,v,44
 buffer_load_dwordx4 a[132:135], v128, s[24:27], s55 offen offset:0 sc1
 v_exp_f32 v12, v12
 v_exp_f32 v13, v13
 v_cvt_pk_bf16_f32 v37, v10, v11
 v_exp_f32 v14, v14
 v_exp_f32 v15, v15
 v_cvt_pk_bf16_f32 v38, v12, v13
 v_cvt_pk_bf16_f32 v39, v14, v15
 s_waitcnt vmcnt(21)
f_t79:
 v_mfma_f32_32x32x16_bf16 v[0:15], a[32:35], a[0:3], 0
 buffer_load_dwordx4 a[84:87], v128, s[24:27], s64 offen offset:1024 sc1
 v_exp_f32 v16, v16
 v_exp_f32 v17, v17
 v_exp_f32 v18, v18
 v_exp_f32 v19, v19
 mg v,0,a,36,a,4
 v_exp_f32 v20, v20
 v_cvt_pk_bf16_f32 v40, v16, v17
 v_exp_f32 v21, v21
 v_cvt_pk_bf16_f32 v41, v18, v19
 v_exp_f32 v22, v22
 mg v,80,a,88,v,32
 buffer_load_dwordx4 a[136:139], v128, s[24:27], s56 offen offset:0 sc1
 v_exp_f32 v23, v23
 v_cvt_pk_bf16_f32 v42, v20, v21
 v_exp_f32 v24, v24
 v_exp_f32 v25, v25
 v_cvt_pk_bf16_f32 v43, v22, v23
 v_smfmac_f32_16x16x64_bf16 v[120:123], v[156:159], v[32:39], v137
 v_exp_f32 v26, v26
 v_exp_f32 v27, v27
 v_cvt_pk_bf16_f32 v44, v24, v25
 mg v,80,a,92,v,36
 v_exp_f32 v28, v28
 v_exp_f32 v29, v29
 v_cvt_pk_bf16_f32 v45, v26, v27
 v_exp_f32 v30, v30
 v_exp_f32 v31, v31
 v_cvt_pk_bf16_f32 v46, v28, v29
 v_cvt_pk_bf16_f32 v47, v30, v31
f_t80:
 v_mfma_f32_32x32x16_bf16 v[16:31], a[32:35], a[8:11], 0
 buffer_load_dwordx4 a[56:59], v128, s[24:27], s63 offen offset:2048 sc1
 v_exp_f32 v0, v0
 v_exp_f32 v1, v1
 v_exp_f32 v2, v2
 v_exp_f32 v3, v3
 mg v,16,a,36,a,12
 v_exp_f32 v4, v4
 v_cvt_pk_bf16_f32 v32, v0, v1
 v_exp_f32 v5, v5
 v_cvt_pk_bf16_f32 v33, v2, v3
 v_exp_f32 v6, v6
 mg v,96,a,88,v,40
 buffer_load_dwordx4 a[140:143], v128, s[24:27], s57 offen offset:0 sc1
 v_exp_f32 v7, v7
 v_cvt_pk_bf16_f32 v34, v4, v5
 v_exp_f32 v8, v8
 v_exp_f32 v9, v9
 v_cvt_pk_bf16_f32 v35, v6, v7
 v_smfmac_f32_16x16x64_bf16 v[124:127], v[156:159], v[40:47], v137
 v_exp_f32 v10, v10
 v_exp_f32 v11, v11
 v_cvt_pk_bf16_f32 v36, v8, v9
 mg v,96,a,92,v,44
 buffer_load_dwordx4 v[192:195], v128, s[24:27], s54 offen offset:1024 sc1
 v_exp_f32 v12, v12
 v_exp_f32 v13, v13
 v_cvt_pk_bf16_f32 v37, v10, v11
 v_exp_f32 v14, v14
 v_exp_f32 v15, v15
 v_cvt_pk_bf16_f32 v38, v12, v13
 v_cvt_pk_bf16_f32 v39, v14, v15
f_t81:
 v_mfma_f32_32x32x16_bf16 v[0:15], a[32:35], a[16:19], 0
 buffer_load_dwordx4 a[60:63], v128, s[24:27], s63 offen offset:3072 sc1
 v_exp_f32 v16, v16
 v_exp_f32 v17, v17
 v_exp_f32 v18, v18
 v_exp_f32 v19, v19
 mg v,0,a,36,a,20
 v_exp_f32 v20, v20
 v_cvt_pk_bf16_f32 v40, v16, v17
 v_exp_f32 v21, v21
 v_cvt_pk_bf16_f32 v41, v18, v19
 v_exp_f32 v22, v22
 mg v,48,a,64,v,32
 buffer_load_dwordx4 v[196:199], v128, s[24:27], s55 offen offset:1024 sc1
 v_exp_f32 v23, v23
 v_cvt_pk_bf16_f32 v42, v20, v21
 v_exp_f32 v24, v24
 v_exp_f32 v25, v25
 v_cvt_pk_bf16_f32 v43, v22, v23
 v_smfmac_f32_16x16x64_bf16 v[112:115], v[156:159], v[32:39], v137
 s_add_u32 s63, s63, 4096
 v_exp_f32 v26, v26
 v_exp_f32 v27, v27
 v_cvt_pk_bf16_f32 v44, v24, v25
 mg v,48,a,68,v,36
 v_exp_f32 v28, v28
 v_exp_f32 v29, v29
 v_cvt_pk_bf16_f32 v45, v26, v27
 v_exp_f32 v30, v30
 v_exp_f32 v31, v31
 v_cvt_pk_bf16_f32 v46, v28, v29
 v_cvt_pk_bf16_f32 v47, v30, v31
f_t82:
 v_mfma_f32_32x32x16_bf16 v[16:31], a[32:35], a[24:27], 0
 buffer_load_dwordx4 a[88:91], v128, s[24:27], s64 offen offset:2048 sc1
 v_exp_f32 v0, v0
 v_exp_f32 v1, v1
 v_exp_f32 v2, v2
 v_exp_f32 v3, v3
 mg v,16,a,36,a,28
 v_exp_f32 v4, v4
 v_cvt_pk_bf16_f32 v32, v0, v1
 v_exp_f32 v5, v5
 v_cvt_pk_bf16_f32 v33, v2, v3
 v_exp_f32 v6, v6
 mg v,64,a,64,v,40
 buffer_load_dwordx4 v[200:203], v128, s[24:27], s56 offen offset:1024 sc1
 v_exp_f32 v7, v7
 v_cvt_pk_bf16_f32 v34, v4, v5
 v_exp_f32 v8, v8
 v_exp_f32 v9, v9
 v_cvt_pk_bf16_f32 v35, v6, v7
 v_smfmac_f32_16x16x64_bf16 v[116:119], v[156:159], v[40:47], v137
 v_exp_f32 v10, v10
 v_exp_f32 v11, v11
 v_cvt_pk_bf16_f32 v36, v8, v9
 mg v,64,a,68,v,44
 buffer_load_dwordx4 v[204:207], v128, s[24:27], s57 offen offset:1024 sc1
 v_exp_f32 v12, v12
 v_exp_f32 v13, v13
 v_cvt_pk_bf16_f32 v37, v10, v11
 v_exp_f32 v14, v14
 v_exp_f32 v15, v15
 v_cvt_pk_bf16_f32 v38, v12, v13
 v_cvt_pk_bf16_f32 v39, v14, v15
 s_waitcnt vmcnt(20)
f_t83:
 v_mfma_f32_32x32x16_bf16 v[0:15], a[40:43], a[0:3], 0
 buffer_load_dwordx4 a[92:95], v128, s[24:27], s64 offen offset:3072 sc1
 v_exp_f32 v16, v16
 v_exp_f32 v17, v17
 v_exp_f32 v18, v18
 v_exp_f32 v19, v19
 mg v,0,a,44,a,4
 s_add_u32 m0, s53, 12288
 v_exp_f32 v20, v20
 v_cvt_pk_bf16_f32 v40, v16, v17
 v_exp_f32 v21, v21
 v_cvt_pk_bf16_f32 v41, v18, v19
 v_exp_f32 v22, v22
 mg v,80,a,64,v,32
 buffer_load_dwordx4 v147, s[28:31], s62 offen lds
 v_exp_f32 v23, v23
 v_cvt_pk_bf16_f32 v42, v20, v21
 v_exp_f32 v24, v24
 v_exp_f32 v25, v25
 v_cvt_pk_bf16_f32 v43, v22, v23
 v_smfmac_f32_16x16x64_bf16 v[120:123], v[156:159], v[32:39], v137
 s_add_u32 s64, s64, 4096
 v_exp_f32 v26, v26
 v_exp_f32 v27, v27
 v_cvt_pk_bf16_f32 v44, v24, v25
 mg v,80,a,68,v,36
 v_exp_f32 v28, v28
 v_exp_f32 v29, v29
 v_cvt_pk_bf16_f32 v45, v26, v27
 v_exp_f32 v30, v30
 v_exp_f32 v31, v31
 v_cvt_pk_bf16_f32 v46, v28, v29
 v_cvt_pk_bf16_f32 v47, v30, v31
f_t84:
 v_mfma_f32_32x32x16_bf16 v[16:31], a[40:43], a[8:11], 0
 buffer_load_dwordx4 a[32:35], v128, s[24:27], s63 offen offset:0 sc1
 v_exp_f32 v0, v0
 v_exp_f32 v1, v1
 v_exp_f32 v2, v2
 v_exp_f32 v3, v3
 mg v,16,a,44,a,12
 s_add_u32 m0, s53, 13312
 v_exp_f32 v4, v4
 v_cvt_pk_bf16_f32 v32, v0, v1
 v_exp_f32 v5, v5
 v_cvt_pk_bf16_f32 v33, v2, v3
 v_exp_f32 v6, v6
 mg v,96,a,64,v,40
 buffer_load_dwordx4 v148, s[28:31], s62 offen lds
 v_exp_f32 v7, v7
 v_cvt_pk_bf16_f32 v34, v4, v5
 v_exp_f32 v8, v8
 v_exp_f32 v9, v9
 v_cvt_pk_bf16_f32 v35, v6, v7
 v_smfmac_f32_16x16x64_bf16 v[124:127], v[156:159], v[40:47], v137
 s_add_u32 m0, s53, 14336
 v_exp_f32 v10, v10
 v_exp_f32 v11, v11
 v_cvt_pk_bf16_f32 v36, v8, v9
 mg v,96,a,68,v,44
 buffer_load_dwordx4 v149, s[28:31], s62 offen lds
 v_exp_f32 v12, v12
 v_exp_f32 v13, v13
 v_cvt_pk_bf16_f32 v37, v10, v11
 v_exp_f32 v14, v14
 v_exp_f32 v15, v15
 v_cvt_pk_bf16_f32 v38, v12, v13
 v_cvt_pk_bf16_f32 v39, v14, v15
f_t85:
 v_mfma_f32_32x32x16_bf16 v[0:15], a[40:43], a[16:19], 0
 buffer_load_dwordx4 a[36:39], v128, s[24:27], s63 offen offset:1024 sc1
 v_exp_f32 v16, v16
 v_exp_f32 v17, v17
 v_exp_f32 v18, v18
 v_exp_f32 v19, v19
 mg v,0,a,44,a,20
 s_add_u32 m0, s53, 15360
 v_exp_f32 v20, v20
 v_cvt_pk_bf16_f32 v40, v16, v17
 v_exp_f32 v21, v21
 v_cvt_pk_bf16_f32 v41, v18, v19
 v_exp_f32 v22, v22
 mg v,48,a,72,v,32
 buffer_load_dwordx4 v150, s[28:31], s62 offen lds
 v_exp_f32 v23, v23
 v_cvt_pk_bf16_f32 v42, v20, v21
 v_exp_f32 v24, v24
 v_exp_f32 v25, v25
 v_cvt_pk_bf16_f32 v43, v22, v23
 v_smfmac_f32_16x16x64_bf16 v[112:115], v[156:159], v[32:39], v137
 v_exp_f32 v26, v26
 v_exp_f32 v27, v27
 v_cvt_pk_bf16_f32 v44, v24, v25
 mg v,48,a,76,v,36
 v_exp_f32 v28, v28
 v_exp_f32 v29, v29
 v_cvt_pk_bf16_f32 v45, v26, v27
 v_exp_f32 v30, v30
 v_exp_f32 v31, v31
 s_add_u32 s62, s62, s46
 v_cvt_pk_bf16_f32 v46, v28, v29
 v_cvt_pk_bf16_f32 v47, v30, v31
f_t86:
 v_mfma_f32_32x32x16_bf16 v[16:31], a[40:43], a[24:27], 0
 buffer_load_dwordx4 a[64:67], v128, s[24:27], s64 offen offset:0 sc1
 v_exp_f32 v0, v0
 v_exp_f32 v1, v1
 v_exp_f32 v2, v2
 v_exp_f32 v3, v3
 mg v,16,a,44,a,28
 v_exp_f32 v4, v4
 v_cvt_pk_bf16_f32 v32, v0, v1
 v_exp_f32 v5, v5
 v_cvt_pk_bf16_f32 v33, v2, v3
 v_exp_f32 v6, v6
 mg v,64,a,72,v,40
 buffer_load_dwordx4 a[144:147], v128, s[24:27], s54 offen offset:2048 sc1
 v_exp_f32 v7, v7
 v_cvt_pk_bf16_f32 v34, v4, v5
 v_exp_f32 v8, v8
 v_exp_f32 v9, v9
 v_cvt_pk_bf16_f32 v35, v6, v7
 v_smfmac_f32_16x16x64_bf16 v[116:119], v[156:159], v[40:47], v137
 v_exp_f32 v10, v10
 v_exp_f32 v11, v11
 v_cvt_pk_bf16_f32 v36, v8, v9
 mg v,64,a,76,v,44
 buffer_load_dwordx4 a[148:151], v128, s[24:27], s55 offen offset:2048 sc1
 v_exp_f32 v12, v12
 v_exp_f32 v13, v13
 v_cvt_pk_bf16_f32 v37, v10, v11
 v_exp_f32 v14, v14
 v_exp_f32 v15, v15
 v_cvt_pk_bf16_f32 v38, v12, v13
 v_cvt_pk_bf16_f32 v39, v14, v15
 s_waitcnt vmcnt(19)
f_t87:
 v_mfma_f32_32x32x16_bf16 v[0:15], a[48:51], a[0:3], 0
 buffer_load_dwordx4 a[68:71], v128, s[24:27], s64 offen offset:1024 sc1
 v_exp_f32 v16, v16
 v_exp_f32 v17, v17
 v_exp_f32 v18, v18
 v_exp_f32 v19, v19
 mg v,0,a,52,a,4
 v_exp_f32 v20, v20
 v_cvt_pk_bf16_f32 v40, v16, v17
 v_exp_f32 v21, v21
 v_cvt_pk_bf16_f32 v41, v18, v19
 v_exp_f32 v22, v22
 mg v,80,a,72,v,32
 buffer_load_dwordx4 a[152:155], v128, s[24:27], s56 offen offset:2048 sc1
 v_exp_f32 v23, v23
 v_cvt_pk_bf16_f32 v42, v20, v21
 v_exp_f32 v24, v24
 v_exp_f32 v25, v25
 v_cvt_pk_bf16_f32 v43, v22, v23
 v_smfmac_f32_16x16x64_bf16 v[120:123], v[156:159], v[32:39], v137
 v_exp_f32 v26, v26
 v_exp_f32 v27, v27
 v_cvt_pk_bf16_f32 v44, v24, v25
 mg v,80,a,76,v,36
 v_exp_f32 v28, v28
 v_exp_f32 v29, v29
 v_cvt_pk_bf16_f32 v45, v26, v27
 v_exp_f32 v30, v30
 v_exp_f32 v31, v31
 v_cvt_pk_bf16_f32 v46, v28, v29
 v_cvt_pk_bf16_f32 v47, v30, v31
f_t88:
 v_mfma_f32_32x32x16_bf16 v[16:31], a[48:51], a[8:11], 0
 buffer_load_dwordx4 a[40:43], v128, s[24:27], s63 offen offset:2048 sc1
 v_exp_f32 v0, v0
 v_exp_f32 v1, v1
 v_exp_f32 v2, v2
 v_exp_f32 v3, v3
 mg v,16,a,52,a,12
 v_exp_f32 v4, v4
 v_cvt_pk_bf16_f32 v32, v0, v1
 v_exp_f32 v5, v5
 v_cvt_pk_bf16_f32 v33, v2, v3
 v_exp_f32 v6, v6
 mg v,96,a,72,v,40
 buffer_load_dwordx4 a[156:159], v128, s[24:27], s57 offen offset:2048 sc1
 v_exp_f32 v7, v7
 v_cvt_pk_bf16_f32 v34, v4, v5
 v_exp_f32 v8, v8
 v_exp_f32 v9, v9
 v_cvt_pk_bf16_f32 v35, v6, v7
 v_smfmac_f32_16x16x64_bf16 v[124:127], v[156:159], v[40:47], v137
 v_exp_f32 v10, v10
 v_exp_f32 v11, v11
 v_cvt_pk_bf16_f32 v36, v8, v9
 mg v,96,a,76,v,44
 buffer_load_dwordx4 a[160:163], v128, s[24:27], s54 offen offset:3072 sc1
 v_exp_f32 v12, v12
 v_exp_f32 v13, v13
 v_cvt_pk_bf16_f32 v37, v10, v11
 v_exp_f32 v14, v14
 v_exp_f32 v15, v15
 s_add_u32 s54, s54, s44
 v_cvt_pk_bf16_f32 v38, v12, v13
 v_cvt_pk_bf16_f32 v39, v14, v15
f_t89:
 v_mfma_f32_32x32x16_bf16 v[0:15], a[48:51], a[16:19], 0
 buffer_load_dwordx4 a[44:47], v128, s[24:27], s63 offen offset:3072 sc1
 v_exp_f32 v16, v16
 v_exp_f32 v17, v17
 v_exp_f32 v18, v18
 v_exp_f32 v19, v19
 mg v,0,a,52,a,20
 v_exp_f32 v20, v20
 v_cvt_pk_bf16_f32 v40, v16, v17
 v_exp_f32 v21, v21
 v_cvt_pk_bf16_f32 v41, v18, v19
 v_exp_f32 v22, v22
 mg v,48,a,80,v,32
 buffer_load_dwordx4 a[164:167], v128, s[24:27], s55 offen offset:3072 sc1
 v_exp_f32 v23, v23
 v_cvt_pk_bf16_f32 v42, v20, v21
 v_exp_f32 v24, v24
 v_exp_f32 v25, v25
 v_cvt_pk_bf16_f32 v43, v22, v23
 v_smfmac_f32_16x16x64_bf16 v[112:115], v[156:159], v[32:39], v137
 s_add_u32 s63, s63, 4096
 v_exp_f32 v26, v26
 v_exp_f32 v27, v27
 v_cvt_pk_bf16_f32 v44, v24, v25
 mg v,48,a,84,v,36
 v_exp_f32 v28, v28
 v_exp_f32 v29, v29
 v_cvt_pk_bf16_f32 v45, v26, v27
 v_exp_f32 v30, v30
 v_exp_f32 v31, v31
 s_add_u32 s55, s55, s44
 v_cvt_pk_bf16_f32 v46, v28, v29
 v_cvt_pk_bf16_f32 v47, v30, v31
f_t90:
 v_mfma_f32_32x32x16_bf16 v[16:31], a[48:51], a[24:27], 0
 buffer_load_dwordx4 a[72:75], v128, s[24:27], s64 offen offset:2048 sc1
 v_exp_f32 v0, v0
 v_exp_f32 v1, v1
 v_exp_f32 v2, v2
 v_exp_f32 v3, v3
 mg v,16,a,52,a,28
 v_exp_f32 v4, v4
 v_cvt_pk_bf16_f32 v32, v0, v1
 v_exp_f32 v5, v5
 v_cvt_pk_bf16_f32 v33, v2, v3
 v_exp_f32 v6, v6
 mg v,64,a,80,v,40
 buffer_load_dwordx4 a[168:171], v128, s[24:27], s56 offen offset:3072 sc1
 v_exp_f32 v7, v7
 v_cvt_pk_bf16_f32 v34, v4, v5
 v_exp_f32 v8, v8
 v_exp_f32 v9, v9
 v_cvt_pk_bf16_f32 v35, v6, v7
 v_smfmac_f32_16x16x64_bf16 v[116:119], v[156:159], v[40:47], v137
 v_exp_f32 v10, v10
 v_exp_f32 v11, v11
 v_cvt_pk_bf16_f32 v36, v8, v9
 mg v,64,a,84,v,44
 buffer_load_dwordx4 a[172:175], v128, s[24:27], s57 offen offset:3072 sc1
 v_exp_f32 v12, v12
 v_exp_f32 v13, v13
 v_cvt_pk_bf16_f32 v37, v10, v11
 v_exp_f32 v14, v14
 v_exp_f32 v15, v15
 s_add_u32 s56, s56, s44
 s_add_u32 s57, s57, s44
 v_cvt_pk_bf16_f32 v38, v12, v13
 v_cvt_pk_bf16_f32 v39, v14, v15
 s_waitcnt vmcnt(19)
f_t91:
 v_mfma_f32_32x32x16_bf16 v[0:15], a[56:59], a[0:3], 0
 buffer_load_dwordx4 a[76:79], v128, s[24:27], s64 offen offset:3072 sc1
 v_exp_f32 v16, v16
 v_exp_f32 v17, v17
 v_exp_f32 v18, v18
 v_exp_f32 v19, v19
 mg v,0,a,60,a,4
 s_add_u32 m0, s53, 16384
 v_exp_f32 v20, v20
 v_cvt_pk_bf16_f32 v40, v16, v17
 v_exp_f32 v21, v21
 v_cvt_pk_bf16_f32 v41, v18, v19
 v_exp_f32 v22, v22
 mg v,80,a,80,v,32
 buffer_load_dwordx4 v147, s[28:31], s62 offen lds
 v_exp_f32 v23, v23
 v_cvt_pk_bf16_f32 v42, v20, v21
 v_exp_f32 v24, v24
 v_exp_f32 v25, v25
 v_cvt_pk_bf16_f32 v43, v22, v23
 v_smfmac_f32_16x16x64_bf16 v[120:123], v[156:159], v[32:39], v137
 s_add_u32 s64, s64, 4096
 s_add_u32 m0, s53, 17408
 v_exp_f32 v26, v26
 v_exp_f32 v27, v27
 v_cvt_pk_bf16_f32 v44, v24, v25
 mg v,80,a,84,v,36
 buffer_load_dwordx4 v148, s[28:31], s62 offen lds
 v_exp_f32 v28, v28
 v_exp_f32 v29, v29
 v_cvt_pk_bf16_f32 v45, v26, v27
 v_exp_f32 v30, v30
 v_exp_f32 v31, v31
 v_cvt_pk_bf16_f32 v46, v28, v29
 v_cvt_pk_bf16_f32 v47, v30, v31
 s_cmp_lg_u32 s3, 0
 s_cbranch_scc1 f_rc92
 v_mov_b32 v139, v144
 s_mov_b64 exec, 1
 buffer_atomic_swap v139, v128, s[24:27], s49 offen sc0 sc1
 s_mov_b64 exec, -1
f_rc92:
f_t92:
 v_mfma_f32_32x32x16_bf16 v[16:31], a[56:59], a[8:11], 0
 buffer_load_dwordx4 a[48:51], v128, s[24:27], s63 offen offset:0 sc1
 v_exp_f32 v0, v0
 v_exp_f32 v1, v1
 v_exp_f32 v2, v2
 v_exp_f32 v3, v3
 mg v,16,a,60,a,12
 s_add_u32 m0, s53, 18432
 v_exp_f32 v4, v4
 v_cvt_pk_bf16_f32 v32, v0, v1
 v_exp_f32 v5, v5
 v_cvt_pk_bf16_f32 v33, v2, v3
 v_exp_f32 v6, v6
 mg v,96,a,80,v,40
 buffer_load_dwordx4 v149, s[28:31], s62 offen lds
 v_exp_f32 v7, v7
 v_cvt_pk_bf16_f32 v34, v4, v5
 v_exp_f32 v8, v8
 v_exp_f32 v9, v9
 v_cvt_pk_bf16_f32 v35, v6, v7
 v_smfmac_f32_16x16x64_bf16 v[124:127], v[156:159], v[40:47], v137
 v_exp_f32 v10, v10
 v_exp_f32 v11, v11
 v_cvt_pk_bf16_f32 v36, v8, v9
 mg v,96,a,84,v,44
 v_exp_f32 v12, v12
 v_exp_f32 v13, v13
 v_cvt_pk_bf16_f32 v37, v10, v11
 v_exp_f32 v14, v14
 v_exp_f32 v15, v15
 v_cvt_pk_bf16_f32 v38, v12, v13
 v_cvt_pk_bf16_f32 v39, v14, v15
f_t93:
 v_mfma_f32_32x32x16_bf16 v[0:15], a[56:59], a[16:19], 0
 buffer_load_dwordx4 a[52:55], v128, s[24:27], s63 offen offset:1024 sc1
 v_exp_f32 v16, v16
 v_exp_f32 v17, v17
 v_exp_f32 v18, v18
 v_exp_f32 v19, v19
 mg v,0,a,60,a,20
 s_add_u32 m0, s53, 19456
 v_exp_f32 v20, v20
 v_cvt_pk_bf16_f32 v40, v16, v17
 v_exp_f32 v21, v21
 v_cvt_pk_bf16_f32 v41, v18, v19
 v_exp_f32 v22, v22
 mg v,48,a,88,v,32
 buffer_load_dwordx4 v150, s[28:31], s62 offen lds
 v_exp_f32 v23, v23
 v_cvt_pk_bf16_f32 v42, v20, v21
 v_exp_f32 v24, v24
 v_exp_f32 v25, v25
 v_cvt_pk_bf16_f32 v43, v22, v23
 v_smfmac_f32_16x16x64_bf16 v[112:115], v[156:159], v[32:39], v137
 v_exp_f32 v26, v26
 v_exp_f32 v27, v27
 v_cvt_pk_bf16_f32 v44, v24, v25
 mg v,48,a,92,v,36
 buffer_load_dwordx4 v[208:211], v128, s[24:27], s54 offen offset:0 sc1
 v_exp_f32 v28, v28
 v_exp_f32 v29, v29
 v_cvt_pk_bf16_f32 v45, v26, v27
 v_exp_f32 v30, v30
 v_exp_f32 v31, v31
 s_add_u32 s62, s62, 65536
 v_cvt_pk_bf16_f32 v46, v28, v29
 v_cvt_pk_bf16_f32 v47, v30, v31
f_t94:
 v_mfma_f32_32x32x16_bf16 v[16:31], a[56:59], a[24:27], 0
 buffer_load_dwordx4 a[80:83], v128, s[24:27], s64 offen offset:0 sc1
 v_exp_f32 v0, v0
 v_exp_f32 v1, v1
 v_exp_f32 v2, v2
 v_exp_f32 v3, v3
 mg v,16,a,60,a,28
 v_exp_f32 v4, v4
 v_cvt_pk_bf16_f32 v32, v0, v1
 v_exp_f32 v5, v5
 v_cvt_pk_bf16_f32 v33, v2, v3
 v_exp_f32 v6, v6
 mg v,64,a,88,v,40
 buffer_load_dwordx4 v[212:215], v128, s[24:27], s55 offen offset:0 sc1
 v_exp_f32 v7, v7
 v_cvt_pk_bf16_f32 v34, v4, v5
 v_exp_f32 v8, v8
 v_exp_f32 v9, v9
 v_cvt_pk_bf16_f32 v35, v6, v7
 v_smfmac_f32_16x16x64_bf16 v[116:119], v[156:159], v[40:47], v137
 v_exp_f32 v10, v10
 v_exp_f32 v11, v11
 v_cvt_pk_bf16_f32 v36, v8, v9
 mg v,64,a,92,v,44
 v_exp_f32 v12, v12
 v_exp_f32 v13, v13
 v_cvt_pk_bf16_f32 v37, v10, v11
 v_exp_f32 v14, v14
 v_exp_f32 v15, v15
 v_cvt_pk_bf16_f32 v38, v12, v13
 v_cvt_pk_bf16_f32 v39, v14, v15
 s_waitcnt vmcnt(19)
f_t95:
 v_mfma_f32_32x32x16_bf16 v[0:15], a[32:35], a[0:3], 0
 buffer_load_dwordx4 a[84:87], v128, s[24:27], s64 offen offset:1024 sc1
 v_exp_f32 v16, v16
 v_exp_f32 v17, v17
 v_exp_f32 v18, v18
 v_exp_f32 v19, v19
 mg v,0,a,36,a,4
 v_exp_f32 v20, v20
 v_cvt_pk_bf16_f32 v40, v16, v17
 v_exp_f32 v21, v21
 v_cvt_pk_bf16_f32 v41, v18, v19
 v_exp_f32 v22, v22
 mg v,80,a,88,v,32
 buffer_load_dwordx4 v[216:219], v128, s[24:27], s56 offen offset:0 sc1
 v_exp_f32 v23, v23
 v_cvt_pk_bf16_f32 v42, v20, v21
 v_exp_f32 v24, v24
 v_exp_f32 v25, v25
 v_cvt_pk_bf16_f32 v43, v22, v23
 v_smfmac_f32_16x16x64_bf16 v[120:123], v[156:159], v[32:39], v137
 v_exp_f32 v26, v26
 v_exp_f32 v27, v27
 v_cvt_pk_bf16_f32 v44, v24, v25
 mg v,80,a,92,v,36
 buffer_load_dwordx4 v[220:223], v128, s[24:27], s57 offen offset:0 sc1
 v_exp_f32 v28, v28
 v_exp_f32 v29, v29
 v_cvt_pk_bf16_f32 v45, v26, v27
 v_exp_f32 v30, v30
 v_exp_f32 v31, v31
 v_cvt_pk_bf16_f32 v46, v28, v29
 v_cvt_pk_bf16_f32 v47, v30, v31
f_t96:
 v_mfma_f32_32x32x16_bf16 v[16:31], a[32:35], a[8:11], 0
 buffer_load_dwordx4 a[56:59], v128, s[24:27], s63 offen offset:2048 sc1
 v_exp_f32 v0, v0
 v_exp_f32 v1, v1
 v_exp_f32 v2, v2
 v_exp_f32 v3, v3
 mg v,16,a,36,a,12
 v_exp_f32 v4, v4
 v_cvt_pk_bf16_f32 v32, v0, v1
 v_exp_f32 v5, v5
 v_cvt_pk_bf16_f32 v33, v2, v3
 v_exp_f32 v6, v6
 mg v,96,a,88,v,40
 buffer_load_dwordx4 a[176:179], v128, s[24:27], s54 offen offset:1024 sc1
 v_exp_f32 v7, v7
 v_cvt_pk_bf16_f32 v34, v4, v5
 v_exp_f32 v8, v8
 v_exp_f32 v9, v9
 v_cvt_pk_bf16_f32 v35, v6, v7
 v_smfmac_f32_16x16x64_bf16 v[124:127], v[156:159], v[40:47], v137
 v_exp_f32 v10, v10
 v_exp_f32 v11, v11
 v_cvt_pk_bf16_f32 v36, v8, v9
 mg v,96,a,92,v,44
 v_exp_f32 v12, v12
 v_exp_f32 v13, v13
 v_cvt_pk_bf16_f32 v37, v10, v11
 v_exp_f32 v14, v14
 v_exp_f32 v15, v15
 v_cvt_pk_bf16_f32 v38, v12, v13
 v_cvt_pk_bf16_f32 v39, v14, v15
f_t97:
 v_mfma_f32_32x32x16_bf16 v[0:15], a[32:35], a[16:19], 0
 buffer_load_dwordx4 a[60:63], v128, s[24:27], s63 offen offset:3072 sc1
 v_exp_f32 v16, v16
 v_exp_f32 v17, v17
 v_exp_f32 v18, v18
 v_exp_f32 v19, v19
 mg v,0,a,36,a,20
 v_exp_f32 v20, v20
 v_cvt_pk_bf16_f32 v40, v16, v17
 v_exp_f32 v21, v21
 v_cvt_pk_bf16_f32 v41, v18, v19
 v_exp_f32 v22, v22
 mg v,48,a,64,v,32
 buffer_load_dwordx4 a[180:183], v128, s[24:27], s55 offen offset:1024 sc1
 v_exp_f32 v23, v23
 v_cvt_pk_bf16_f32 v42, v20, v21
 v_exp_f32 v24, v24
 v_exp_f32 v25, v25
 v_cvt_pk_bf16_f32 v43, v22, v23
 v_smfmac_f32_16x16x64_bf16 v[112:115], v[156:159], v[32:39], v137
 s_add_u32 s63, s63, 4096
 v_exp_f32 v26, v26
 v_exp_f32 v27, v27
 v_cvt_pk_bf16_f32 v44, v24, v25
 mg v,48,a,68,v,36
 buffer_load_dwordx4 a[184:187], v128, s[24:27], s56 offen offset:1024 sc1
 v_exp_f32 v28, v28
 v_exp_f32 v29, v29
 v_cvt_pk_bf16_f32 v45, v26, v27
 v_exp_f32 v30, v30
 v_exp_f32 v31, v31
 v_cvt_pk_bf16_f32 v46, v28, v29
 v_cvt_pk_bf16_f32 v47, v30, v31
f_t98:
 v_mfma_f32_32x32x16_bf16 v[16:31], a[32:35], a[24:27], 0
 buffer_load_dwordx4 a[88:91], v128, s[24:27], s64 offen offset:2048 sc1
 v_exp_f32 v0, v0
 v_exp_f32 v1, v1
 v_exp_f32 v2, v2
 v_exp_f32 v3, v3
 mg v,16,a,36,a,28
 v_exp_f32 v4, v4
 v_cvt_pk_bf16_f32 v32, v0, v1
 v_exp_f32 v5, v5
 v_cvt_pk_bf16_f32 v33, v2, v3
 v_exp_f32 v6, v6
 mg v,64,a,64,v,40
 buffer_load_dwordx4 a[188:191], v128, s[24:27], s57 offen offset:1024 sc1
 v_exp_f32 v7, v7
 v_cvt_pk_bf16_f32 v34, v4, v5
 v_exp_f32 v8, v8
 v_exp_f32 v9, v9
 v_cvt_pk_bf16_f32 v35, v6, v7
 v_smfmac_f32_16x16x64_bf16 v[116:119], v[156:159], v[40:47], v137
 v_exp_f32 v10, v10
 v_exp_f32 v11, v11
 v_cvt_pk_bf16_f32 v36, v8, v9
 mg v,64,a,68,v,44
 v_exp_f32 v12, v12
 v_exp_f32 v13, v13
 v_cvt_pk_bf16_f32 v37, v10, v11
 v_exp_f32 v14, v14
 v_exp_f32 v15, v15
 v_cvt_pk_bf16_f32 v38, v12, v13
 v_cvt_pk_bf16_f32 v39, v14, v15
 s_waitcnt vmcnt(19)
f_t99:
 v_mfma_f32_32x32x16_bf16 v[0:15], a[40:43], a[0:3], 0
 buffer_load_dwordx4 a[92:95], v128, s[24:27], s64 offen offset:3072 sc1
 v_exp_f32 v16, v16
 v_exp_f32 v17, v17
 v_exp_f32 v18, v18
 v_exp_f32 v19, v19
 mg v,0,a,44,a,4
 s_add_u32 m0, s53, 20480
 v_exp_f32 v20, v20
 v_cvt_pk_bf16_f32 v40, v16, v17
 v_exp_f32 v21, v21
 v_cvt_pk_bf16_f32 v41, v18, v19
 v_exp_f32 v22, v22
 mg v,80,a,64,v,32
 buffer_load_dwordx4 v147, s[28:31], s62 offen lds
 v_exp_f32 v23, v23
 v_cvt_pk_bf16_f32 v42, v20, v21
 v_exp_f32 v24, v24
 v_exp_f32 v25, v25
 v_cvt_pk_bf16_f32 v43, v22, v23
 v_smfmac_f32_16x16x64_bf16 v[120:123], v[156:159], v[32:39], v137
 s_add_u32 s64, s64, 4096
 s_add_u32 m0, s53, 21504
 v_exp_f32 v26, v26
 v_exp_f32 v27, v27
 v_cvt_pk_bf16_f32 v44, v24, v25
 mg v,80,a,68,v,36
 buffer_load_dwordx4 v148, s[28:31], s62 offen lds
 v_exp_f32 v28, v28
 v_exp_f32 v29, v29
 v_cvt_pk_bf16_f32 v45, v26, v27
 v_exp_f32 v30, v30
 v_exp_f32 v31, v31
 v_cvt_pk_bf16_f32 v46, v28, v29
 v_cvt_pk_bf16_f32 v47, v30, v31
 s_cmp_lg_u32 s3, 0
 s_cbranch_scc1 f_rc100
 v_mov_b32 v142, v144
 buffer_atomic_swap v142, v143, s[24:27], s48 offen offset:0 sc0 sc1
f_rc100:
f_t100:
 v_mfma_f32_32x32x16_bf16 v[16:31], a[40:43], a[8:11], 0
 buffer_load_dwordx4 a[32:35], v128, s[24:27], s63 offen offset:0 sc1
 v_exp_f32 v0, v0
 v_exp_f32 v1, v1
 v_exp_f32 v2, v2
 v_exp_f32 v3, v3
 mg v,16,a,44,a,12
 s_add_u32 m0, s53, 22528
 v_exp_f32 v4, v4
 v_cvt_pk_bf16_f32 v32, v0, v1
 v_exp_f32 v5, v5
 v_cvt_pk_bf16_f32 v33, v2, v3
 v_exp_f32 v6, v6
 mg v,96,a,64,v,40
 buffer_load_dwordx4 v149, s[28:31], s62 offen lds
 v_exp_f32 v7, v7
 v_cvt_pk_bf16_f32 v34, v4, v5
 v_exp_f32 v8, v8
 v_exp_f32 v9, v9
 v_cvt_pk_bf16_f32 v35, v6, v7
 v_smfmac_f32_16x16x64_bf16 v[124:127], v[156:159], v[40:47], v137
 v_exp_f32 v10, v10
 v_exp_f32 v11, v11
 v_cvt_pk_bf16_f32 v36, v8, v9
 mg v,96,a,68,v,44
 v_exp_f32 v12, v12
 v_exp_f32 v13, v13
 v_cvt_pk_bf16_f32 v37, v10, v11
 v_exp_f32 v14, v14
 v_exp_f32 v15, v15
 v_cvt_pk_bf16_f32 v38, v12, v13
 v_cvt_pk_bf16_f32 v39, v14, v15
f_t101:
 v_mfma_f32_32x32x16_bf16 v[0:15], a[40:43], a[16:19], 0
 buffer_load_dwordx4 a[36:39], v128, s[24:27], s63 offen offset:1024 sc1
 v_exp_f32 v16, v16
 v_exp_f32 v17, v17
 v_exp_f32 v18, v18
 v_exp_f32 v19, v19
 mg v,0,a,44,a,20
 s_add_u32 m0, s53, 23552
 v_exp_f32 v20, v20
 v_cvt_pk_bf16_f32 v40, v16, v17
 v_exp_f32 v21, v21
 v_cvt_pk_bf16_f32 v41, v18, v19
 v_exp_f32 v22, v22
 mg v,48,a,72,v,32
 buffer_load_dwordx4 v150, s[28:31], s62 offen lds
 v_exp_f32 v23, v23
 v_cvt_pk_bf16_f32 v42, v20, v21
 v_exp_f32 v24, v24
 v_exp_f32 v25, v25
 v_cvt_pk_bf16_f32 v43, v22, v23
 v_smfmac_f32_16x16x64_bf16 v[112:115], v[156:159], v[32:39], v137
 v_exp_f32 v26, v26
 v_exp_f32 v27, v27
 v_cvt_pk_bf16_f32 v44, v24, v25
 mg v,48,a,76,v,36
 buffer_load_dwordx4 a[192:195], v128, s[24:27], s54 offen offset:2048 sc1
 v_exp_f32 v28, v28
 v_exp_f32 v29, v29
 v_cvt_pk_bf16_f32 v45, v26, v27
 v_exp_f32 v30, v30
 v_exp_f32 v31, v31
 s_add_u32 s62, s62, 65536
 v_cvt_pk_bf16_f32 v46, v28, v29
 v_cvt_pk_bf16_f32 v47, v30, v31
f_t102:
 v_mfma_f32_32x32x16_bf16 v[16:31], a[40:43], a[24:27], 0
 buffer_load_dwordx4 a[64:67], v128, s[24:27], s64 offen offset:0 sc1
 v_exp_f32 v0, v0
 v_exp_f32 v1, v1
 v_exp_f32 v2, v2
 v_exp_f32 v3, v3
 mg v,16,a,44,a,28
 v_exp_f32 v4, v4
 v_cvt_pk_bf16_f32 v32, v0, v1
 v_exp_f32 v5, v5
 v_cvt_pk_bf16_f32 v33, v2, v3
 v_exp_f32 v6, v6
 mg v,64,a,72,v,40
 buffer_load_dwordx4 a[196:199], v128, s[24:27], s55 offen offset:2048 sc1
 v_exp_f32 v7, v7
 v_cvt_pk_bf16_f32 v34, v4, v5
 v_exp_f32 v8, v8
 v_exp_f32 v9, v9
 v_cvt_pk_bf16_f32 v35, v6, v7
 v_smfmac_f32_16x16x64_bf16 v[116:119], v[156:159], v[40:47], v137
 v_exp_f32 v10, v10
 v_exp_f32 v11, v11
 v_cvt_pk_bf16_f32 v36, v8, v9
 mg v,64,a,76,v,44
 v_exp_f32 v12, v12
 v_exp_f32 v13, v13
 v_cvt_pk_bf16_f32 v37, v10, v11
 v_exp_f32 v14, v14
 v_exp_f32 v15, v15
 v_cvt_pk_bf16_f32 v38, v12, v13
 v_cvt_pk_bf16_f32 v39, v14, v15
 s_waitcnt vmcnt(19)
f_t103:
 v_mfma_f32_32x32x16_bf16 v[0:15], a[48:51], a[0:3], 0
 buffer_load_dwordx4 a[68:71], v128, s[24:27], s64 offen offset:1024 sc1
 v_exp_f32 v16, v16
 v_exp_f32 v17, v17
 v_exp_f32 v18, v18
 v_exp_f32 v19, v19
 mg v,0,a,52,a,4
 v_exp_f32 v20, v20
 v_cvt_pk_bf16_f32 v40, v16, v17
 v_exp_f32 v21, v21
 v_cvt_pk_bf16_f32 v41, v18, v19
 v_exp_f32 v22, v22
 mg v,80,a,72,v,32
 buffer_load_dwordx4 a[200:203], v128, s[24:27], s56 offen offset:2048 sc1
 v_exp_f32 v23, v23
 v_cvt_pk_bf16_f32 v42, v20, v21
 v_exp_f32 v24, v24
 v_exp_f32 v25, v25
 v_cvt_pk_bf16_f32 v43, v22, v23
 v_smfmac_f32_16x16x64_bf16 v[120:123], v[156:159], v[32:39], v137
 v_exp_f32 v26, v26
 v_exp_f32 v27, v27
 v_cvt_pk_bf16_f32 v44, v24, v25
 mg v,80,a,76,v,36
 buffer_load_dwordx4 a[204:207], v128, s[24:27], s57 offen offset:2048 sc1
 v_exp_f32 v28, v28
 v_exp_f32 v29, v29
 v_cvt_pk_bf16_f32 v45, v26, v27
 v_exp_f32 v30, v30
 v_exp_f32 v31, v31
 v_cvt_pk_bf16_f32 v46, v28, v29
 v_cvt_pk_bf16_f32 v47, v30, v31
f_t104:
 v_mfma_f32_32x32x16_bf16 v[16:31], a[48:51], a[8:11], 0
 buffer_load_dwordx4 a[40:43], v128, s[24:27], s63 offen offset:2048 sc1
 v_exp_f32 v0, v0
 v_exp_f32 v1, v1
 v_exp_f32 v2, v2
 v_exp_f32 v3, v3
 mg v,16,a,52,a,12
 v_exp_f32 v4, v4
 v_cvt_pk_bf16_f32 v32, v0, v1
 v_exp_f32 v5, v5
 v_cvt_pk_bf16_f32 v33, v2, v3
 v_exp_f32 v6, v6
 mg v,96,a,72,v,40
 buffer_load_dwordx4 v[224:227], v128, s[24:27], s54 offen offset:3072 sc1
 v_exp_f32 v7, v7
 v_cvt_pk_bf16_f32 v34, v4, v5
 v_exp_f32 v8, v8
 v_exp_f32 v9, v9
 v_cvt_pk_bf16_f32 v35, v6, v7
 v_smfmac_f32_16x16x64_bf16 v[124:127], v[156:159], v[40:47], v137
 v_exp_f32 v10, v10
 v_exp_f32 v11, v11
 v_cvt_pk_bf16_f32 v36, v8, v9
 mg v,96,a,76,v,44
 v_exp_f32 v12, v12
 v_exp_f32 v13, v13
 v_cvt_pk_bf16_f32 v37, v10, v11
 v_exp_f32 v14, v14
 v_exp_f32 v15, v15
 s_add_u32 s54, s54, s44
 v_cvt_pk_bf16_f32 v38, v12, v13
 v_cvt_pk_bf16_f32 v39, v14, v15
f_t105:
 v_mfma_f32_32x32x16_bf16 v[0:15], a[48:51], a[16:19], 0
 buffer_load_dwordx4 a[44:47], v128, s[24:27], s63 offen offset:3072 sc1
 v_exp_f32 v16, v16
 v_exp_f32 v17, v17
 v_exp_f32 v18, v18
 v_exp_f32 v19, v19
 mg v,0,a,52,a,20
 v_exp_f32 v20, v20
 v_cvt_pk_bf16_f32 v40, v16, v17
 v_exp_f32 v21, v21
 v_cvt_pk_bf16_f32 v41, v18, v19
 v_exp_f32 v22, v22
 mg v,48,a,80,v,32
 buffer_load_dwordx4 v[228:231], v128, s[24:27], s55 offen offset:3072 sc1
 v_exp_f32 v23, v23
 v_cvt_pk_bf16_f32 v42, v20, v21
 v_exp_f32 v24, v24
 v_exp_f32 v25, v25
 v_cvt_pk_bf16_f32 v43, v22, v23
 v_smfmac_f32_16x16x64_bf16 v[112:115], v[156:159], v[32:39], v137
 s_add_u32 s63, s63, 4096
 v_exp_f32 v26, v26
 v_exp_f32 v27, v27
 v_cvt_pk_bf16_f32 v44, v24, v25
 mg v,48,a,84,v,36
 buffer_load_dwordx4 v[232:235], v128, s[24:27], s56 offen offset:3072 sc1
 v_exp_f32 v28, v28
 v_exp_f32 v29, v29
 v_cvt_pk_bf16_f32 v45, v26, v27
 v_exp_f32 v30, v30
 v_exp_f32 v31, v31
 s_add_u32 s55, s55, s44
 s_add_u32 s56, s56, s44
 v_cvt_pk_bf16_f32 v46, v28, v29
 v_cvt_pk_bf16_f32 v47, v30, v31
f_t106:
 s_mov_b32 s69, f_t126-f_base
 v_mfma_f32_32x32x16_bf16 v[16:31], a[48:51], a[24:27], 0
 buffer_load_dwordx4 a[72:75], v128, s[24:27], s64 offen offset:2048 sc1
 v_exp_f32 v0, v0
 v_exp_f32 v1, v1
 v_exp_f32 v2, v2
 v_exp_f32 v3, v3
 mg v,16,a,52,a,28
 buffer_load_dword v129, v155, s[36:39], s69 offen
 v_exp_f32 v4, v4
 v_cvt_pk_bf16_f32 v32, v0, v1
 v_exp_f32 v5, v5
 v_cvt_pk_bf16_f32 v33, v2, v3
 v_exp_f32 v6, v6
 mg v,64,a,80,v,40
 buffer_load_dwordx4 v[236:239], v128, s[24:27], s57 offen offset:3072 sc1
 v_exp_f32 v7, v7
 v_cvt_pk_bf16_f32 v34, v4, v5
 v_exp_f32 v8, v8
 v_exp_f32 v9, v9
 v_cvt_pk_bf16_f32 v35, v6, v7
 v_smfmac_f32_16x16x64_bf16 v[116:119], v[156:159], v[40:47], v137
 s_add_u32 m0, s53, 24576
 v_exp_f32 v10, v10
 v_exp_f32 v11, v11
 v_cvt_pk_bf16_f32 v36, v8, v9
 mg v,64,a,84,v,44
 buffer_load_dwordx4 v147, s[28:31], s62 offen lds
 v_exp_f32 v12, v12
 v_exp_f32 v13, v13
 v_cvt_pk_bf16_f32 v37, v10, v11
 v_exp_f32 v14, v14
 v_exp_f32 v15, v15
 s_add_u32 s57, s57, s44
 v_cvt_pk_bf16_f32 v38, v12, v13
 v_cvt_pk_bf16_f32 v39, v14, v15
 s_waitcnt vmcnt(21)
f_t107:
 v_mfma_f32_32x32x16_bf16 v[0:15], a[56:59], a[0:3], 0
 buffer_load_dwordx4 a[76:79], v128, s[24:27], s64 offen offset:3072 sc1
 v_exp_f32 v16, v16
 v_exp_f32 v17, v17
 v_exp_f32 v18, v18
 v_exp_f32 v19, v19
 mg v,0,a,60,a,4
 s_add_u32 m0, s53, 25600
 v_exp_f32 v20, v20
 v_cvt_pk_bf16_f32 v40, v16, v17
 v_exp_f32 v21, v21
 v_cvt_pk_bf16_f32 v41, v18, v19
 v_exp_f32 v22, v22
 mg v,80,a,80,v,32
 buffer_load_dwordx4 v148, s[28:31], s62 offen lds
 v_exp_f32 v23, v23
 v_cvt_pk_bf16_f32 v42, v20, v21
 v_exp_f32 v24, v24
 v_exp_f32 v25, v25
 v_cvt_pk_bf16_f32 v43, v22, v23
 v_smfmac_f32_16x16x64_bf16 v[120:123], v[156:159], v[32:39], v137
 s_add_u32 s64, s64, 4096
 v_exp_f32 v26, v26
 v_exp_f32 v27, v27
 v_cvt_pk_bf16_f32 v44, v24, v25
 mg v,80,a,84,v,36
 v_exp_f32 v28, v28
 v_exp_f32 v29, v29
 v_cvt_pk_bf16_f32 v45, v26, v27
 v_exp_f32 v30, v30
 v_exp_f32 v31, v31
 v_cvt_pk_bf16_f32 v46, v28, v29
 v_cvt_pk_bf16_f32 v47, v30, v31
f_t108:
 v_mfma_f32_32x32x16_bf16 v[16:31], a[56:59], a[8:11], 0
 buffer_load_dwordx4 a[48:51], v128, s[24:27], s63 offen offset:0 sc1
 v_exp_f32 v0, v0
 v_exp_f32 v1, v1
 v_exp_f32 v2, v2
 v_exp_f32 v3, v3
 mg v,16,a,60,a,12
 s_add_u32 m0, s53, 26624
 v_exp_f32 v4, v4
 v_cvt_pk_bf16_f32 v32, v0, v1
 v_exp_f32 v5, v5
 v_cvt_pk_bf16_f32 v33, v2, v3
 v_exp_f32 v6, v6
 mg v,96,a,80,v,40
 buffer_load_dwordx4 v149, s[28:31], s62 offen lds
 v_exp_f32 v7, v7
 v_cvt_pk_bf16_f32 v34, v4, v5
 v_exp_f32 v8, v8
 v_exp_f32 v9, v9
 v_cvt_pk_bf16_f32 v35, v6, v7
 v_smfmac_f32_16x16x64_bf16 v[124:127], v[156:159], v[40:47], v137
 s_add_u32 m0, s53, 27648
 v_exp_f32 v10, v10
 v_exp_f32 v11, v11
 v_cvt_pk_bf16_f32 v36, v8, v9
 mg v,96,a,84,v,44
 buffer_load_dwordx4 v150, s[28:31], s62 offen lds
 v_exp_f32 v12, v12
 v_exp_f32 v13, v13
 v_cvt_pk_bf16_f32 v37, v10, v11
 v_exp_f32 v14, v14
 v_exp_f32 v15, v15
 s_add_u32 s62, s62, 65536
 v_cvt_pk_bf16_f32 v38, v12, v13
 v_cvt_pk_bf16_f32 v39, v14, v15
f_t109:
 v_mfma_f32_32x32x16_bf16 v[0:15], a[56:59], a[16:19], 0
 buffer_load_dwordx4 a[52:55], v128, s[24:27], s63 offen offset:1024 sc1
 v_exp_f32 v16, v16
 v_exp_f32 v17, v17
 v_exp_f32 v18, v18
 v_exp_f32 v19, v19
 mg v,0,a,60,a,20
 v_exp_f32 v20, v20
 v_cvt_pk_bf16_f32 v40, v16, v17
 v_exp_f32 v21, v21
 v_cvt_pk_bf16_f32 v41, v18, v19
 v_exp_f32 v22, v22
 mg v,48,a,88,v,32
 buffer_load_dwordx4 a[208:211], v128, s[24:27], s54 offen offset:0 sc1
 v_exp_f32 v23, v23
 v_cvt_pk_bf16_f32 v42, v20, v21
 v_exp_f32 v24, v24
 v_exp_f32 v25, v25
 v_cvt_pk_bf16_f32 v43, v22, v23
 v_smfmac_f32_16x16x64_bf16 v[112:115], v[156:159], v[32:39], v137
 v_exp_f32 v26, v26
 v_exp_f32 v27, v27
 v_cvt_pk_bf16_f32 v44, v24, v25
 mg v,48,a,92,v,36
 v_exp_f32 v28, v28
 v_exp_f32 v29, v29
 v_cvt_pk_bf16_f32 v45, v26, v27
 v_exp_f32 v30, v30
 v_exp_f32 v31, v31
 v_cvt_pk_bf16_f32 v46, v28, v29
 v_cvt_pk_bf16_f32 v47, v30, v31
f_t110:
 v_mfma_f32_32x32x16_bf16 v[16:31], a[56:59], a[24:27], 0
 buffer_load_dwordx4 a[80:83], v128, s[24:27], s64 offen offset:0 sc1
 v_exp_f32 v0, v0
 v_exp_f32 v1, v1
 v_exp_f32 v2, v2
 v_exp_f32 v3, v3
 mg v,16,a,60,a,28
 v_exp_f32 v4, v4
 v_cvt_pk_bf16_f32 v32, v0, v1
 v_exp_f32 v5, v5
 v_cvt_pk_bf16_f32 v33, v2, v3
 v_exp_f32 v6, v6
 mg v,64,a,88,v,40
 buffer_load_dwordx4 a[212:215], v128, s[24:27], s55 offen offset:0 sc1
 v_exp_f32 v7, v7
 v_cvt_pk_bf16_f32 v34, v4, v5
 v_exp_f32 v8, v8
 v_exp_f32 v9, v9
 v_cvt_pk_bf16_f32 v35, v6, v7
 v_smfmac_f32_16x16x64_bf16 v[116:119], v[156:159], v[40:47], v137
 v_exp_f32 v10, v10
 v_exp_f32 v11, v11
 v_cvt_pk_bf16_f32 v36, v8, v9
 mg v,64,a,92,v,44
 buffer_load_dwordx4 a[216:219], v128, s[24:27], s56 offen offset:0 sc1
 v_exp_f32 v12, v12
 v_exp_f32 v13, v13
 v_cvt_pk_bf16_f32 v37, v10, v11
 v_exp_f32 v14, v14
 v_exp_f32 v15, v15
 v_cvt_pk_bf16_f32 v38, v12, v13
 v_cvt_pk_bf16_f32 v39, v14, v15
 s_waitcnt vmcnt(21)
f_t111:
 v_mfma_f32_32x32x16_bf16 v[0:15], a[32:35], a[0:3], 0
 buffer_load_dwordx4 a[84:87], v128, s[24:27], s64 offen offset:1024 sc1
 v_exp_f32 v16, v16
 v_exp_f32 v17, v17
 v_exp_f32 v18, v18
 v_exp_f32 v19, v19
 mg v,0,a,36,a,4
 v_exp_f32 v20, v20
 v_cvt_pk_bf16_f32 v40, v16, v17
 v_exp_f32 v21, v21
 v_cvt_pk_bf16_f32 v41, v18, v19
 v_exp_f32 v22, v22
 mg v,80,a,88,v,32
 buffer_load_dwordx4 a[220:223], v128, s[24:27], s57 offen offset:0 sc1
 v_exp_f32 v23, v23
 v_cvt_pk_bf16_f32 v42, v20, v21
 v_exp_f32 v24, v24
 v_exp_f32 v25, v25
 v_cvt_pk_bf16_f32 v43, v22, v23
 v_smfmac_f32_16x16x64_bf16 v[120:123], v[156:159], v[32:39], v137
 v_exp_f32 v26, v26
 v_exp_f32 v27, v27
 v_cvt_pk_bf16_f32 v44, v24, v25
 mg v,80,a,92,v,36
 v_exp_f32 v28, v28
 v_exp_f32 v29, v29
 v_cvt_pk_bf16_f32 v45, v26, v27
 v_exp_f32 v30, v30
 v_exp_f32 v31, v31
 v_cvt_pk_bf16_f32 v46, v28, v29
 v_cvt_pk_bf16_f32 v47, v30, v31
f_t112:
 v_mfma_f32_32x32x16_bf16 v[16:31], a[32:35], a[8:11], 0
 buffer_load_dwordx4 a[56:59], v128, s[24:27], s63 offen offset:2048 sc1
 v_exp_f32 v0, v0
 v_exp_f32 v1, v1
 v_exp_f32 v2, v2
 v_exp_f32 v3, v3
 mg v,16,a,36,a,12
 v_exp_f32 v4, v4
 v_cvt_pk_bf16_f32 v32, v0, v1
 v_exp_f32 v5, v5
 v_cvt_pk_bf16_f32 v33, v2, v3
 v_exp_f32 v6, v6
 mg v,96,a,88,v,40
 buffer_load_dwordx4 v[240:243], v128, s[24:27], s54 offen offset:1024 sc1
 v_exp_f32 v7, v7
 v_cvt_pk_bf16_f32 v34, v4, v5
 v_exp_f32 v8, v8
 v_exp_f32 v9, v9
 v_cvt_pk_bf16_f32 v35, v6, v7
 v_smfmac_f32_16x16x64_bf16 v[124:127], v[156:159], v[40:47], v137
 v_exp_f32 v10, v10
 v_exp_f32 v11, v11
 v_cvt_pk_bf16_f32 v36, v8, v9
 mg v,96,a,92,v,44
 buffer_load_dwordx4 v[244:247], v128, s[24:27], s55 offen offset:1024 sc1
 v_exp_f32 v12, v12
 v_exp_f32 v13, v13
 v_cvt_pk_bf16_f32 v37, v10, v11
 v_exp_f32 v14, v14
 v_exp_f32 v15, v15
 v_cvt_pk_bf16_f32 v38, v12, v13
 v_cvt_pk_bf16_f32 v39, v14, v15
f_t113:
 v_mfma_f32_32x32x16_bf16 v[0:15], a[32:35], a[16:19], 0
 buffer_load_dwordx4 a[60:63], v128, s[24:27], s63 offen offset:3072 sc1
 v_exp_f32 v16, v16
 v_exp_f32 v17, v17
 v_exp_f32 v18, v18
 v_exp_f32 v19, v19
 mg v,0,a,36,a,20
 v_exp_f32 v20, v20
 v_cvt_pk_bf16_f32 v40, v16, v17
 v_exp_f32 v21, v21
 v_cvt_pk_bf16_f32 v41, v18, v19
 v_exp_f32 v22, v22
 mg v,48,a,64,v,32
 buffer_load_dwordx4 v[248:251], v128, s[24:27], s56 offen offset:1024 sc1
 v_exp_f32 v23, v23
 v_cvt_pk_bf16_f32 v42, v20, v21
 v_exp_f32 v24, v24
 v_exp_f32 v25, v25
 v_cvt_pk_bf16_f32 v43, v22, v23
 v_smfmac_f32_16x16x64_bf16 v[112:115], v[156:159], v[32:39], v137
 s_add_u32 s63, s63, 4096
 v_exp_f32 v26, v26
 v_exp_f32 v27, v27
 v_cvt_pk_bf16_f32 v44, v24, v25
 mg v,48,a,68,v,36
 v_exp_f32 v28, v28
 v_exp_f32 v29, v29
 v_cvt_pk_bf16_f32 v45, v26, v27
 v_exp_f32 v30, v30
 v_exp_f32 v31, v31
 v_cvt_pk_bf16_f32 v46, v28, v29
 v_cvt_pk_bf16_f32 v47, v30, v31
 s_cmp_lg_u32 s3, 0
 s_cbranch_scc1 f_rc114
 v_cmp_ne_u32 vcc, v139, v144
 s_and_b32 s10, vcc_lo, 1
 s_bcnt1_i32_b32 s10, s10
 v_cmp_ne_u32 vcc, v142, v144
 s_bitcmp1_b32 vcc_lo, 0
 s_addc_u32 s10, s10, 0
 v_bfe_u32 v142, v128, 4, 2
 v_mov_b32 v139, s10
 v_mul_u32_u24 v142, 40960, v142
 s_mov_b32 s11, f_g0-f_base
 ds_write_b32 v142, v139 offset:29184
 v_lshlrev_b32 v154, 3, v128
 s_cmp_eq_u32 s10, 0
 s_cselect_b32 s11, f_S0g-f_base, s11
 s_cmp_eq_u32 s10, 2
 s_cselect_b32 s11, f_L0g-f_base, s11
 buffer_load_dword v129, v154, s[36:39], s11 offen
f_rc114:
f_t114:
 v_mfma_f32_32x32x16_bf16 v[16:31], a[32:35], a[24:27], 0
 buffer_load_dwordx4 a[88:91], v128, s[24:27], s64 offen offset:2048 sc1
 v_exp_f32 v0, v0
 v_exp_f32 v1, v1
 v_exp_f32 v2, v2
 v_exp_f32 v3, v3
 mg v,16,a,36,a,28
 v_exp_f32 v4, v4
 v_cvt_pk_bf16_f32 v32, v0, v1
 v_exp_f32 v5, v5
 v_cvt_pk_bf16_f32 v33, v2, v3
 v_exp_f32 v6, v6
 mg v,64,a,64,v,40
 buffer_load_dwordx4 v[252:255], v128, s[24:27], s57 offen offset:1024 sc1
 v_exp_f32 v7, v7
 v_cvt_pk_bf16_f32 v34, v4, v5
 v_exp_f32 v8, v8
 v_exp_f32 v9, v9
 v_cvt_pk_bf16_f32 v35, v6, v7
 v_smfmac_f32_16x16x64_bf16 v[116:119], v[156:159], v[40:47], v137
 v_exp_f32 v10, v10
 v_exp_f32 v11, v11
 v_cvt_pk_bf16_f32 v36, v8, v9
 mg v,64,a,68,v,44
 buffer_load_dwordx4 a[224:227], v128, s[24:27], s54 offen offset:2048 sc1
 v_exp_f32 v12, v12
 v_exp_f32 v13, v13
 v_cvt_pk_bf16_f32 v37, v10, v11
 v_exp_f32 v14, v14
 v_exp_f32 v15, v15
 v_cvt_pk_bf16_f32 v38, v12, v13
 v_cvt_pk_bf16_f32 v39, v14, v15
 s_waitcnt vmcnt(19)
f_t115:
 v_mfma_f32_32x32x16_bf16 v[0:15], a[40:43], a[0:3], 0
 buffer_load_dwordx4 a[92:95], v128, s[24:27], s64 offen offset:3072 sc1
 v_exp_f32 v16, v16
 v_exp_f32 v17, v17
 v_exp_f32 v18, v18
 v_exp_f32 v19, v19
 mg v,0,a,44,a,4
 v_exp_f32 v20, v20
 v_cvt_pk_bf16_f32 v40, v16, v17
 v_exp_f32 v21, v21
 v_cvt_pk_bf16_f32 v41, v18, v19
 v_exp_f32 v22, v22
 mg v,80,a,64,v,32
 buffer_load_dwordx4 a[228:231], v128, s[24:27], s55 offen offset:2048 sc1
 v_exp_f32 v23, v23
 v_cvt_pk_bf16_f32 v42, v20, v21
 v_exp_f32 v24, v24
 v_exp_f32 v25, v25
 v_cvt_pk_bf16_f32 v43, v22, v23
 v_smfmac_f32_16x16x64_bf16 v[120:123], v[156:159], v[32:39], v137
 s_add_u32 s64, s64, 4096
 v_exp_f32 v26, v26
 v_exp_f32 v27, v27
 v_cvt_pk_bf16_f32 v44, v24, v25
 mg v,80,a,68,v,36
 v_exp_f32 v28, v28
 v_exp_f32 v29, v29
 v_cvt_pk_bf16_f32 v45, v26, v27
 v_exp_f32 v30, v30
 v_exp_f32 v31, v31
 v_cvt_pk_bf16_f32 v46, v28, v29
 v_cvt_pk_bf16_f32 v47, v30, v31
f_t116:
 v_mfma_f32_32x32x16_bf16 v[16:31], a[40:43], a[8:11], 0
 v_exp_f32 v0, v0
 v_exp_f32 v1, v1
 v_exp_f32 v2, v2
 v_exp_f32 v3, v3
 mg v,16,a,44,a,12
 v_exp_f32 v4, v4
 v_cvt_pk_bf16_f32 v32, v0, v1
 v_exp_f32 v5, v5
 v_cvt_pk_bf16_f32 v33, v2, v3
 v_exp_f32 v6, v6
 mg v,96,a,64,v,40
 buffer_load_dwordx4 a[232:235], v128, s[24:27], s56 offen offset:2048 sc1
 v_exp_f32 v7, v7
 v_cvt_pk_bf16_f32 v34, v4, v5
 v_exp_f32 v8, v8
 v_exp_f32 v9, v9
 v_cvt_pk_bf16_f32 v35, v6, v7
 v_smfmac_f32_16x16x64_bf16 v[124:127], v[156:159], v[40:47], v137
 v_exp_f32 v10, v10
 v_exp_f32 v11, v11
 v_cvt_pk_bf16_f32 v36, v8, v9
 mg v,96,a,68,v,44
 buffer_load_dwordx4 a[236:239], v128, s[24:27], s57 offen offset:2048 sc1
 v_exp_f32 v12, v12
 v_exp_f32 v13, v13
 v_cvt_pk_bf16_f32 v37, v10, v11
 v_exp_f32 v14, v14
 v_exp_f32 v15, v15
 v_cvt_pk_bf16_f32 v38, v12, v13
 v_cvt_pk_bf16_f32 v39, v14, v15
 s_waitcnt vmcnt(18)
f_t117:
 v_mfma_f32_32x32x16_bf16 v[0:15], a[48:51], a[0:3], 0
 v_exp_f32 v16, v16
 v_exp_f32 v17, v17
 v_exp_f32 v18, v18
 v_exp_f32 v19, v19
 mg v,0,a,52,a,4
 v_exp_f32 v20, v20
 v_cvt_pk_bf16_f32 v40, v16, v17
 v_exp_f32 v21, v21
 v_cvt_pk_bf16_f32 v41, v18, v19
 v_exp_f32 v22, v22
 mg v,48,a,72,v,32
 buffer_load_dwordx4 a[240:243], v128, s[24:27], s54 offen offset:3072 sc1
 v_exp_f32 v23, v23
 v_cvt_pk_bf16_f32 v42, v20, v21
 v_exp_f32 v24, v24
 v_exp_f32 v25, v25
 v_cvt_pk_bf16_f32 v43, v22, v23
 v_smfmac_f32_16x16x64_bf16 v[112:115], v[156:159], v[32:39], v137
 v_exp_f32 v26, v26
 v_exp_f32 v27, v27
 v_cvt_pk_bf16_f32 v44, v24, v25
 mg v,48,a,76,v,36
 v_exp_f32 v28, v28
 v_exp_f32 v29, v29
 v_cvt_pk_bf16_f32 v45, v26, v27
 v_exp_f32 v30, v30
 v_exp_f32 v31, v31
 s_add_u32 s54, s54, s44
 v_cvt_pk_bf16_f32 v46, v28, v29
 v_cvt_pk_bf16_f32 v47, v30, v31
f_t118:
 v_mfma_f32_32x32x16_bf16 v[16:31], a[48:51], a[8:11], 0
 v_exp_f32 v0, v0
 v_exp_f32 v1, v1
 v_exp_f32 v2, v2
 v_exp_f32 v3, v3
 mg v,16,a,52,a,12
 v_exp_f32 v4, v4
 v_cvt_pk_bf16_f32 v32, v0, v1
 v_exp_f32 v5, v5
 v_cvt_pk_bf16_f32 v33, v2, v3
 v_exp_f32 v6, v6
 mg v,64,a,72,v,40
 buffer_load_dwordx4 a[244:247], v128, s[24:27], s55 offen offset:3072 sc1
 v_exp_f32 v7, v7
 v_cvt_pk_bf16_f32 v34, v4, v5
 v_exp_f32 v8, v8
 v_exp_f32 v9, v9
 v_cvt_pk_bf16_f32 v35, v6, v7
 v_smfmac_f32_16x16x64_bf16 v[116:119], v[156:159], v[40:47], v137
 v_exp_f32 v10, v10
 v_exp_f32 v11, v11
 v_cvt_pk_bf16_f32 v36, v8, v9
 mg v,64,a,76,v,44
 buffer_load_dwordx4 a[248:251], v128, s[24:27], s56 offen offset:3072 sc1
 v_exp_f32 v12, v12
 v_exp_f32 v13, v13
 v_cvt_pk_bf16_f32 v37, v10, v11
 v_exp_f32 v14, v14
 v_exp_f32 v15, v15
 s_add_u32 s55, s55, s44
 s_add_u32 s56, s56, s44
 v_cvt_pk_bf16_f32 v38, v12, v13
 v_cvt_pk_bf16_f32 v39, v14, v15
 s_waitcnt vmcnt(11)
f_t119:
 v_mfma_f32_32x32x16_bf16 v[0:15], a[56:59], a[0:3], 0
 v_exp_f32 v16, v16
 v_exp_f32 v17, v17
 v_exp_f32 v18, v18
 v_exp_f32 v19, v19
 mg v,0,a,60,a,4
 v_exp_f32 v20, v20
 v_cvt_pk_bf16_f32 v40, v16, v17
 v_exp_f32 v21, v21
 v_cvt_pk_bf16_f32 v41, v18, v19
 v_exp_f32 v22, v22
 mg v,48,a,80,v,32
 buffer_load_dwordx4 a[252:255], v128, s[24:27], s57 offen offset:3072 sc1
 v_exp_f32 v23, v23
 v_cvt_pk_bf16_f32 v42, v20, v21
 v_exp_f32 v24, v24
 v_exp_f32 v25, v25
 v_cvt_pk_bf16_f32 v43, v22, v23
 v_smfmac_f32_16x16x64_bf16 v[112:115], v[156:159], v[32:39], v137
 v_exp_f32 v26, v26
 v_exp_f32 v27, v27
 v_cvt_pk_bf16_f32 v44, v24, v25
 mg v,48,a,84,v,36
 v_exp_f32 v28, v28
 v_exp_f32 v29, v29
 v_cvt_pk_bf16_f32 v45, v26, v27
 v_exp_f32 v30, v30
 v_exp_f32 v31, v31
 s_add_u32 s57, s57, s44
 v_cvt_pk_bf16_f32 v46, v28, v29
 v_cvt_pk_bf16_f32 v47, v30, v31
f_t120:
 v_mfma_f32_32x32x16_bf16 v[16:31], a[56:59], a[8:11], 0
 v_exp_f32 v0, v0
 v_exp_f32 v1, v1
 v_exp_f32 v2, v2
 v_exp_f32 v3, v3
 mg v,16,a,60,a,12
 v_exp_f32 v4, v4
 v_cvt_pk_bf16_f32 v32, v0, v1
 v_exp_f32 v5, v5
 v_cvt_pk_bf16_f32 v33, v2, v3
 v_exp_f32 v6, v6
 mg v,64,a,80,v,40
 v_exp_f32 v7, v7
 v_cvt_pk_bf16_f32 v34, v4, v5
 v_exp_f32 v8, v8
 v_exp_f32 v9, v9
 v_cvt_pk_bf16_f32 v35, v6, v7
 v_smfmac_f32_16x16x64_bf16 v[116:119], v[156:159], v[40:47], v137
 v_exp_f32 v10, v10
 v_exp_f32 v11, v11
 v_cvt_pk_bf16_f32 v36, v8, v9
 mg v,64,a,84,v,44
 v_exp_f32 v12, v12
 v_exp_f32 v13, v13
 v_cvt_pk_bf16_f32 v37, v10, v11
 v_exp_f32 v14, v14
 v_exp_f32 v15, v15
 v_cvt_pk_bf16_f32 v38, v12, v13
 v_cvt_pk_bf16_f32 v39, v14, v15
 s_waitcnt vmcnt(7)
f_t121:
 v_mfma_f32_32x32x16_bf16 v[0:15], a[40:43], a[16:19], 0
 v_exp_f32 v16, v16
 v_exp_f32 v17, v17
 v_exp_f32 v18, v18
 v_exp_f32 v19, v19
 mg v,0,a,44,a,20
 v_exp_f32 v20, v20
 v_cvt_pk_bf16_f32 v40, v16, v17
 v_exp_f32 v21, v21
 v_cvt_pk_bf16_f32 v41, v18, v19
 v_exp_f32 v22, v22
 mg v,48,a,88,v,32
 v_exp_f32 v23, v23
 v_cvt_pk_bf16_f32 v42, v20, v21
 v_exp_f32 v24, v24
 v_exp_f32 v25, v25
 v_cvt_pk_bf16_f32 v43, v22, v23
 v_smfmac_f32_16x16x64_bf16 v[112:115], v[156:159], v[32:39], v137
 v_exp_f32 v26, v26
 v_exp_f32 v27, v27
 v_cvt_pk_bf16_f32 v44, v24, v25
 mg v,48,a,92,v,36
 v_exp_f32 v28, v28
 v_exp_f32 v29, v29
 v_cvt_pk_bf16_f32 v45, v26, v27
 v_exp_f32 v30, v30
 v_exp_f32 v31, v31
 v_cvt_pk_bf16_f32 v46, v28, v29
 v_cvt_pk_bf16_f32 v47, v30, v31
f_t122:
 v_mfma_f32_32x32x16_bf16 v[16:31], a[40:43], a[24:27], 0
 v_exp_f32 v0, v0
 v_exp_f32 v1, v1
 v_exp_f32 v2, v2
 v_exp_f32 v3, v3
 mg v,16,a,44,a,28
 v_exp_f32 v4, v4
 v_cvt_pk_bf16_f32 v32, v0, v1
 v_exp_f32 v5, v5
 v_cvt_pk_bf16_f32 v33, v2, v3
 v_exp_f32 v6, v6
 mg v,64,a,88,v,40
 ds_write_b128 v131, v[48:51] offset:32768
 v_exp_f32 v7, v7
 v_cvt_pk_bf16_f32 v34, v4, v5
 v_exp_f32 v8, v8
 v_exp_f32 v9, v9
 v_cvt_pk_bf16_f32 v35, v6, v7
 v_smfmac_f32_16x16x64_bf16 v[116:119], v[156:159], v[40:47], v137
 ds_write_b128 v131, v[52:55] offset:33792
 v_exp_f32 v10, v10
 v_exp_f32 v11, v11
 v_cvt_pk_bf16_f32 v36, v8, v9
 mg v,64,a,92,v,44
 ds_write_b128 v131, v[56:59] offset:34816
 v_exp_f32 v12, v12
 v_exp_f32 v13, v13
 v_cvt_pk_bf16_f32 v37, v10, v11
 v_exp_f32 v14, v14
 v_exp_f32 v15, v15
 ds_write_b128 v131, v[60:63] offset:35840
 v_cvt_pk_bf16_f32 v38, v12, v13
 v_cvt_pk_bf16_f32 v39, v14, v15
f_t123:
 v_mfma_f32_32x32x16_bf16 v[0:15], a[48:51], a[16:19], 0
 v_exp_f32 v16, v16
 v_exp_f32 v17, v17
 v_exp_f32 v18, v18
 v_exp_f32 v19, v19
 mg v,0,a,52,a,20
 v_mov_b32 v142, s53
 v_add_f32 v112, v112, v113
 v_add_f32 v116, v116, v117
 v_exp_f32 v20, v20
 v_cvt_pk_bf16_f32 v40, v16, v17
 v_exp_f32 v21, v21
 v_cvt_pk_bf16_f32 v41, v18, v19
 v_exp_f32 v22, v22
 mg v,80,a,72,v,32
 ds_write_b128 v131, v[64:67] offset:36864
 v_exp_f32 v23, v23
 v_cvt_pk_bf16_f32 v42, v20, v21
 v_exp_f32 v24, v24
 v_exp_f32 v25, v25
 v_cvt_pk_bf16_f32 v43, v22, v23
 v_smfmac_f32_16x16x64_bf16 v[120:123], v[156:159], v[32:39], v137
 ds_write_b128 v131, v[68:71] offset:37888
 ds_write2_b32 v133, v112, v116 offset0:0 offset1:1
 v_exp_f32 v26, v26
 v_exp_f32 v27, v27
 v_cvt_pk_bf16_f32 v44, v24, v25
 mg v,80,a,76,v,36
 ds_write_b128 v131, v[72:75] offset:38912
 v_exp_f32 v28, v28
 v_exp_f32 v29, v29
 v_cvt_pk_bf16_f32 v45, v26, v27
 v_exp_f32 v30, v30
 v_exp_f32 v31, v31
 ds_write_b128 v131, v[76:79] offset:39936
 v_cvt_pk_bf16_f32 v46, v28, v29
 v_cvt_pk_bf16_f32 v47, v30, v31
f_t124:
 v_mfma_f32_32x32x16_bf16 v[16:31], a[48:51], a[24:27], 0
 v_exp_f32 v0, v0
 v_exp_f32 v1, v1
 v_exp_f32 v2, v2
 v_exp_f32 v3, v3
 mg v,16,a,52,a,28
 v_exp_f32 v4, v4
 v_cvt_pk_bf16_f32 v32, v0, v1
 v_exp_f32 v5, v5
 v_cvt_pk_bf16_f32 v33, v2, v3
 v_exp_f32 v6, v6
 mg v,96,a,72,v,40
 s_waitcnt lgkmcnt(0)
 s_barrier
 ds_read_b32 v139, v142 offset:29184
 v_exp_f32 v7, v7
 v_cvt_pk_bf16_f32 v34, v4, v5
 v_exp_f32 v8, v8
 v_exp_f32 v9, v9
 v_cvt_pk_bf16_f32 v35, v6, v7
 v_smfmac_f32_16x16x64_bf16 v[124:127], v[156:159], v[40:47], v137
 ds_read_b64 v[112:113], v134
 v_exp_f32 v10, v10
 v_exp_f32 v11, v11
 v_cvt_pk_bf16_f32 v36, v8, v9
 mg v,96,a,76,v,44
 ds_read_b128 v[48:51], v132 offset:32768
 v_exp_f32 v12, v12
 v_exp_f32 v13, v13
 v_cvt_pk_bf16_f32 v37, v10, v11
 v_exp_f32 v14, v14
 v_exp_f32 v15, v15
 ds_read_b128 v[52:55], v132 offset:33792
 v_cvt_pk_bf16_f32 v38, v12, v13
 v_cvt_pk_bf16_f32 v39, v14, v15
f_t125:
 v_mfma_f32_32x32x16_bf16 v[0:15], a[56:59], a[16:19], 0
 ds_read_b128 v[56:59], v132 offset:34816
 v_exp_f32 v16, v16
 v_exp_f32 v17, v17
 v_exp_f32 v18, v18
 v_exp_f32 v19, v19
 mg v,0,a,60,a,20
 ds_read_b128 v[60:63], v132 offset:35840
 v_exp_f32 v20, v20
 v_cvt_pk_bf16_f32 v40, v16, v17
 v_exp_f32 v21, v21
 v_cvt_pk_bf16_f32 v41, v18, v19
 v_exp_f32 v22, v22
 mg v,80,a,80,v,32
 ds_read_b128 v[64:67], v132 offset:36864
 v_exp_f32 v23, v23
 v_cvt_pk_bf16_f32 v42, v20, v21
 v_exp_f32 v24, v24
 v_exp_f32 v25, v25
 v_cvt_pk_bf16_f32 v43, v22, v23
 v_smfmac_f32_16x16x64_bf16 v[120:123], v[156:159], v[32:39], v137
 ds_read_b128 v[68:71], v132 offset:37888
 v_exp_f32 v26, v26
 v_exp_f32 v27, v27
 v_cvt_pk_bf16_f32 v44, v24, v25
 mg v,80,a,84,v,36
 ds_read_b128 v[72:75], v132 offset:38912
 v_exp_f32 v28, v28
 v_exp_f32 v29, v29
 v_cvt_pk_bf16_f32 v45, v26, v27
 v_exp_f32 v30, v30
 v_exp_f32 v31, v31
 ds_read_b128 v[76:79], v132 offset:39936
 v_cvt_pk_bf16_f32 v46, v28, v29
 v_cvt_pk_bf16_f32 v47, v30, v31
 s_waitcnt lgkmcnt(8)
f_t126:
 v_mfma_f32_32x32x16_bf16 v[16:31], a[56:59], a[24:27], 0
 s_add_u32 m0, s53, 28672
 v_exp_f32 v0, v0
 v_exp_f32 v1, v1
 v_exp_f32 v2, v2
 v_exp_f32 v3, v3
 mg v,16,a,60,a,28
 buffer_load_dwordx4 v147, s[28:31], s62 offen lds
 s_add_u32 m0, s53, 29696
 v_exp_f32 v4, v4
 v_cvt_pk_bf16_f32 v32, v0, v1
 v_exp_f32 v5, v5
 v_cvt_pk_bf16_f32 v33, v2, v3
 v_exp_f32 v6, v6
 mg v,96,a,80,v,40
 buffer_load_dwordx4 v148, s[28:31], s62 offen lds
 s_add_u32 m0, s53, 30720
 s_waitcnt lgkmcnt(4)
 v_pk_add_f32 v[80:81], v[80:81], v[48:49]
 v_pk_add_f32 v[82:83], v[82:83], v[50:51]
 v_exp_f32 v7, v7
 v_cvt_pk_bf16_f32 v34, v4, v5
 v_exp_f32 v8, v8
 v_exp_f32 v9, v9
 v_cvt_pk_bf16_f32 v35, v6, v7
 v_smfmac_f32_16x16x64_bf16 v[124:127], v[156:159], v[40:47], v137
 buffer_load_dwordx4 v149, s[28:31], s62 offen lds
 s_add_u32 m0, s53, 31744
 v_pk_add_f32 v[84:85], v[84:85], v[52:53]
 v_pk_add_f32 v[86:87], v[86:87], v[54:55]
 v_exp_f32 v10, v10
 v_exp_f32 v11, v11
 v_cvt_pk_bf16_f32 v36, v8, v9
 mg v,96,a,84,v,44
 buffer_load_dwordx4 v150, s[28:31], s62 offen lds
 v_pk_add_f32 v[88:89], v[88:89], v[56:57]
 v_pk_add_f32 v[90:91], v[90:91], v[58:59]
 v_add_f32 v120, v120, v112
 v_exp_f32 v12, v12
 v_exp_f32 v13, v13
 v_cvt_pk_bf16_f32 v37, v10, v11
 v_exp_f32 v14, v14
 v_exp_f32 v15, v15
 s_add_u32 s62, s62, s46
 v_pk_add_f32 v[92:93], v[92:93], v[60:61]
 v_pk_add_f32 v[94:95], v[94:95], v[62:63]
 v_cvt_pk_bf16_f32 v38, v12, v13
 v_cvt_pk_bf16_f32 v39, v14, v15
 s_waitcnt lgkmcnt(0)
f_t127:
 tr a,40,135,0
 tr a,42,135,2048
 tr a,44,136,0
 tr a,46,136,2048
 s_mov_b32 s10, 0x1f800000
 s_mov_b32 s11, 0x5f800000
 v_exp_f32 v16, v16
 v_exp_f32 v17, v17
 v_exp_f32 v18, v18
 v_exp_f32 v19, v19
 tr a,48,138,0
 tr a,50,138,2048
 tr a,52,140,0
 tr a,54,140,2048
 v_readfirstlane_b32 s48, v139
 v_exp_f32 v20, v20
 v_cvt_pk_bf16_f32 v40, v16, v17
 v_exp_f32 v21, v21
 v_cvt_pk_bf16_f32 v41, v18, v19
 v_exp_f32 v22, v22
 mg v,80,a,88,v,32
 v_pk_add_f32 v[96:97], v[96:97], v[64:65]
 v_pk_add_f32 v[98:99], v[98:99], v[66:67]
 v_exp_f32 v23, v23
 v_cvt_pk_bf16_f32 v42, v20, v21
 v_exp_f32 v24, v24
 v_exp_f32 v25, v25
 v_cvt_pk_bf16_f32 v43, v22, v23
 v_smfmac_f32_16x16x64_bf16 v[120:123], v[156:159], v[32:39], v137
 v_pk_add_f32 v[100:101], v[100:101], v[68:69]
 v_pk_add_f32 v[102:103], v[102:103], v[70:71]
 v_exp_f32 v26, v26
 v_exp_f32 v27, v27
 v_cvt_pk_bf16_f32 v44, v24, v25
 mg v,80,a,92,v,36
 v_pk_add_f32 v[104:105], v[104:105], v[72:73]
 v_pk_add_f32 v[106:107], v[106:107], v[74:75]
 v_add_f32 v124, v124, v113
 v_exp_f32 v28, v28
 v_exp_f32 v29, v29
 v_cvt_pk_bf16_f32 v45, v26, v27
 v_exp_f32 v30, v30
 v_exp_f32 v31, v31
 v_pk_add_f32 v[108:109], v[108:109], v[76:77]
 v_pk_add_f32 v[110:111], v[110:111], v[78:79]
 v_cvt_pk_bf16_f32 v46, v28, v29
 v_cvt_pk_bf16_f32 v47, v30, v31
 mg v,96,a,88,v,40
 v_add_f32 v120, v120, v121
 v_smfmac_f32_16x16x64_bf16 v[124:127], v[156:159], v[40:47], v137
 mg v,96,a,92,v,44
 v_cmp_le_f32 s[12:13], s10, v120
 v_cmp_ge_f32 s[16:17], s11, v120
 v_rcp_f32 v120, v120
 s_nop 0
 v_pk_mul_f32 v[80:81], v[80:81], v[120:121] op_sel_hi:[1,0]
 v_pk_mul_f32 v[82:83], v[82:83], v[120:121] op_sel_hi:[1,0]
 v_pk_mul_f32 v[84:85], v[84:85], v[120:121] op_sel_hi:[1,0]
 v_pk_mul_f32 v[86:87], v[86:87], v[120:121] op_sel_hi:[1,0]
 v_pk_mul_f32 v[88:89], v[88:89], v[120:121] op_sel_hi:[1,0]
 v_pk_mul_f32 v[90:91], v[90:91], v[120:121] op_sel_hi:[1,0]
 v_pk_mul_f32 v[92:93], v[92:93], v[120:121] op_sel_hi:[1,0]
 v_pk_mul_f32 v[94:95], v[94:95], v[120:121] op_sel_hi:[1,0]
 v_add_f32 v124, v124, v125
 v_cmp_le_f32 s[14:15], s10, v124
 v_cmp_ge_f32 s[18:19], s11, v124
 s_and_b64 s[12:13], s[12:13], s[14:15]
 s_and_b64 s[16:17], s[16:17], s[18:19]
 s_and_b64 s[12:13], s[12:13], s[16:17]
 s_cmp_eq_u64 s[12:13], -1
 s_cbranch_scc0 f_slow
f_fin:
 v_rcp_f32 v124, v124
 s_xor_b32 s11, s3, 1
 s_mul_i32 s11, s11, 40960
 v_add_u32 v137, s11, v128
 v_cvt_pk_bf16_f32 v64, v80, v81
 v_cvt_pk_bf16_f32 v65, v82, v83
 v_cvt_pk_bf16_f32 v66, v88, v89
 v_cvt_pk_bf16_f32 v67, v90, v91
 buffer_store_dwordx4 v[64:67], v146, s[24:27], s4 offen offset:0 sc1
 v_cvt_pk_bf16_f32 v68, v84, v85
 v_cvt_pk_bf16_f32 v69, v86, v87
 v_cvt_pk_bf16_f32 v70, v92, v93
 v_cvt_pk_bf16_f32 v71, v94, v95
 buffer_store_dwordx4 v[68:71], v146, s[24:27], s4 offen offset:512 sc1
 v_pk_mul_f32 v[96:97], v[96:97], v[124:125] op_sel_hi:[1,0]
 v_pk_mul_f32 v[98:99], v[98:99], v[124:125] op_sel_hi:[1,0]
 v_pk_mul_f32 v[100:101], v[100:101], v[124:125] op_sel_hi:[1,0]
 v_pk_mul_f32 v[102:103], v[102:103], v[124:125] op_sel_hi:[1,0]
 v_pk_mul_f32 v[104:105], v[104:105], v[124:125] op_sel_hi:[1,0]
 v_pk_mul_f32 v[106:107], v[106:107], v[124:125] op_sel_hi:[1,0]
 v_pk_mul_f32 v[108:109], v[108:109], v[124:125] op_sel_hi:[1,0]
 v_pk_mul_f32 v[110:111], v[110:111], v[124:125] op_sel_hi:[1,0]
 v_cvt_pk_bf16_f32 v72, v96, v97
 v_cvt_pk_bf16_f32 v73, v98, v99
 v_cvt_pk_bf16_f32 v74, v104, v105
 v_cvt_pk_bf16_f32 v75, v106, v107
 buffer_store_dwordx4 v[72:75], v146, s[24:27], s5 offen offset:0 sc1
 v_cvt_pk_bf16_f32 v76, v100, v101
 v_cvt_pk_bf16_f32 v77, v102, v103
 v_cvt_pk_bf16_f32 v78, v108, v109
 v_cvt_pk_bf16_f32 v79, v110, v111
 buffer_store_dwordx4 v[76:79], v146, s[24:27], s5 offen offset:512 sc1
 s_cmp_eq_u32 s48, 0
 s_cbranch_scc1 f_S0g
 s_cmp_eq_u32 s48, 2
 s_cbranch_scc1 f_L0g
 s_waitcnt lgkmcnt(4)
f_g0:
 v_mfma_f32_16x16x32_bf16 v[64:67], a[40:43], v[160:163], 0
 tr a,56,151,0
 v_mfma_f32_16x16x32_bf16 v[80:83], a[40:43], v[164:167], 0
 tr a,58,151,2048
 s_add_u32 m0, s53, 32768
 v_mfma_f32_16x16x32_bf16 v[96:99], a[40:43], v[168:171], 0
 buffer_load_dwordx4 v147, s[28:31], s62 offen lds
 s_mul_i32 s10, s44, 6
 v_mfma_f32_16x16x32_bf16 v[112:115], a[40:43], v[172:175], 0
 s_sub_u32 s9, s9, s10
 v_mfma_f32_16x16x32_bf16 v[68:71], a[44:47], v[160:163], 0
 tr a,60,152,0
 v_mfma_f32_16x16x32_bf16 v[84:87], a[44:47], v[164:167], 0
 tr a,62,152,2048
 v_mfma_f32_16x16x32_bf16 v[100:103], a[44:47], v[168:171], 0
 v_mfma_f32_16x16x32_bf16 v[116:119], a[44:47], v[172:175], 0
 s_waitcnt lgkmcnt(4)
 v_mfma_f32_16x16x32_bf16 v[72:75], a[48:51], v[160:163], 0
 tr a,40,141,0
 v_mfma_f32_16x16x32_bf16 v[88:91], a[48:51], v[164:167], 0
 tr a,42,141,2048
 s_add_u32 m0, s53, 33792
 v_mfma_f32_16x16x32_bf16 v[104:107], a[48:51], v[168:171], 0
 buffer_load_dwordx4 v148, s[28:31], s62 offen lds
 v_mfma_f32_16x16x32_bf16 v[120:123], a[48:51], v[172:175], 0
 v_mfma_f32_16x16x32_bf16 v[76:79], a[52:55], v[160:163], 0
 tr a,44,130,0
 v_mfma_f32_16x16x32_bf16 v[92:95], a[52:55], v[164:167], 0
 tr a,46,130,2048
 v_mfma_f32_16x16x32_bf16 v[108:111], a[52:55], v[168:171], 0
 v_mfma_f32_16x16x32_bf16 v[124:127], a[52:55], v[172:175], 0
 s_waitcnt lgkmcnt(4)
 v_mfma_f32_16x16x32_bf16 v[0:3], a[56:59], v[160:163], 0
 tr a,48,135,4096
 v_mfma_f32_16x16x32_bf16 v[16:19], a[56:59], v[164:167], 0
 tr a,50,135,6144
 s_add_u32 m0, s53, 34816
 v_mfma_f32_16x16x32_bf16 v[32:35], a[56:59], v[168:171], 0
 buffer_load_dwordx4 v149, s[28:31], s62 offen lds
 v_mfma_f32_16x16x32_bf16 v[48:51], a[56:59], v[172:175], 0
 v_mfma_f32_16x16x32_bf16 v[4:7], a[60:63], v[160:163], 0
 tr a,52,136,4096
 v_mfma_f32_16x16x32_bf16 v[20:23], a[60:63], v[164:167], 0
 tr a,54,136,6144
 v_mfma_f32_16x16x32_bf16 v[36:39], a[60:63], v[168:171], 0
 v_mfma_f32_16x16x32_bf16 v[52:55], a[60:63], v[172:175], 0
 s_waitcnt lgkmcnt(4)
 v_mfma_f32_16x16x32_bf16 v[8:11], a[40:43], v[160:163], 0
 tr a,56,138,4096
 v_mfma_f32_16x16x32_bf16 v[24:27], a[40:43], v[164:167], 0
 tr a,58,138,6144
 s_add_u32 m0, s53, 35840
 v_mfma_f32_16x16x32_bf16 v[40:43], a[40:43], v[168:171], 0
 buffer_load_dwordx4 v150, s[28:31], s62 offen lds
 s_add_u32 s62, s62, 65536
 v_mfma_f32_16x16x32_bf16 v[56:59], a[40:43], v[172:175], 0
 v_mfma_f32_16x16x32_bf16 v[12:15], a[44:47], v[160:163], 0
 tr a,60,140,4096
 v_mfma_f32_16x16x32_bf16 v[28:31], a[44:47], v[164:167], 0
 tr a,62,140,6144
 v_mfma_f32_16x16x32_bf16 v[44:47], a[44:47], v[168:171], 0
 v_mfma_f32_16x16x32_bf16 v[60:63], a[44:47], v[172:175], 0
 s_waitcnt lgkmcnt(4)
f_g1:
 mf v,64,a,48,a,96
 tr a,40,151,4096
 mf v,80,a,48,a,100
 tr a,42,151,6144
 s_add_u32 m0, s53, 36864
 mf v,96,a,48,a,104
 buffer_load_dwordx4 v147, s[28:31], s62 offen lds
 mf v,112,a,48,a,108
 mf v,68,a,52,a,96
 tr a,44,152,4096
 mf v,84,a,52,a,100
 tr a,46,152,6144
 mf v,100,a,52,a,104
 buffer_load_dwordx4 v[160:163], v128, s[24:27], s54 offen offset:0 sc1
 mf v,116,a,52,a,108
 s_waitcnt lgkmcnt(4)
 mf v,72,a,56,a,96
 tr a,48,141,4096
 mf v,88,a,56,a,100
 tr a,50,141,6144
 s_add_u32 m0, s53, 37888
 mf v,104,a,56,a,104
 buffer_load_dwordx4 v148, s[28:31], s62 offen lds
 mf v,120,a,56,a,108
 mf v,76,a,60,a,96
 tr a,52,130,4096
 mf v,92,a,60,a,100
 tr a,54,130,6144
 mf v,108,a,60,a,104
 buffer_load_dwordx4 v[164:167], v128, s[24:27], s55 offen offset:0 sc1
 mf v,124,a,60,a,108
 s_waitcnt lgkmcnt(4)
 s_add_u32 m0, s53, 38912
 mf v,0,a,40,a,96
 buffer_load_dwordx4 v149, s[28:31], s62 offen lds
 mf v,16,a,40,a,100
 mf v,32,a,40,a,104
 buffer_load_dwordx4 v[168:171], v128, s[24:27], s56 offen offset:0 sc1
 mf v,48,a,40,a,108
 s_waitcnt lgkmcnt(0)
 s_barrier
 mf v,4,a,44,a,96
 tr a,56,135,8192
 mf v,20,a,44,a,100
 tr a,58,135,10240
 mf v,36,a,44,a,104
 tr a,60,136,8192
 mf v,52,a,44,a,108
 tr a,62,136,10240
 mf v,8,a,48,a,96
 tr a,40,138,8192
 mf v,24,a,48,a,100
 tr a,42,138,10240
 s_add_u32 m0, s53, 39936
 mf v,40,a,48,a,104
 buffer_load_dwordx4 v150, s[28:31], s62 offen lds
 s_add_u32 s62, s62, 65536
 mf v,56,a,48,a,108
 mf v,12,a,52,a,96
 tr a,44,140,8192
 mf v,28,a,52,a,100
 tr a,46,140,10240
 mf v,44,a,52,a,104
 mf v,60,a,52,a,108
 s_waitcnt lgkmcnt(4)
f_g2:
 mf v,64,a,56,a,112
 tr a,48,151,8192
 mf v,80,a,56,a,116
 tr a,50,151,10240
 s_add_u32 m0, s53, 0
 mf v,96,a,56,a,120
 buffer_load_dwordx4 v147, s[28:31], s62 offen lds
 mf v,112,a,56,a,124
 mf v,68,a,60,a,112
 tr a,52,152,8192
 mf v,84,a,60,a,116
 tr a,54,152,10240
 mf v,100,a,60,a,120
 buffer_load_dwordx4 v[172:175], v128, s[24:27], s57 offen offset:0 sc1
 mf v,116,a,60,a,124
 s_waitcnt lgkmcnt(4)
 mf v,72,a,40,a,112
 tr a,56,141,8192
 mf v,88,a,40,a,116
 tr a,58,141,10240
 s_add_u32 m0, s53, 1024
 mf v,104,a,40,a,120
 buffer_load_dwordx4 v148, s[28:31], s62 offen lds
 mf v,120,a,40,a,124
 mf v,76,a,44,a,112
 tr a,60,130,8192
 mf v,92,a,44,a,116
 tr a,62,130,10240
 mf v,108,a,44,a,120
 mf v,124,a,44,a,124
 s_waitcnt lgkmcnt(4)
 mf v,0,a,48,a,112
 tr a,40,135,12288
 mf v,16,a,48,a,116
 tr a,42,135,14336
 mf v,32,a,48,a,120
 buffer_load_dwordx4 a[96:99], v128, s[24:27], s54 offen offset:1024 sc1
 mf v,48,a,48,a,124
 mf v,4,a,52,a,112
 tr a,44,136,12288
 mf v,20,a,52,a,116
 tr a,46,136,14336
 s_add_u32 m0, s53, 2048
 mf v,36,a,52,a,120
 buffer_load_dwordx4 v149, s[28:31], s62 offen lds
 mf v,52,a,52,a,124
 s_waitcnt lgkmcnt(4)
 mf v,8,a,56,a,112
 tr a,48,138,12288
 mf v,24,a,56,a,116
 tr a,50,138,14336
 s_add_u32 m0, s53, 3072
 mf v,40,a,56,a,120
 buffer_load_dwordx4 v150, s[28:31], s62 offen lds
 s_add_u32 s62, s62, 65536
 mf v,56,a,56,a,124
 mf v,12,a,60,a,112
 tr a,52,140,12288
 mf v,28,a,60,a,116
 tr a,54,140,14336
 mf v,44,a,60,a,120
 mf v,60,a,60,a,124
 s_waitcnt lgkmcnt(4)
 s_waitcnt vmcnt(17)
f_g3:
 mf v,64,a,40,v,176
 tr a,56,151,12288
 mf v,80,a,40,v,180
 tr a,58,151,14336
 s_add_u32 m0, s53, 4096
 mf v,96,a,40,v,184
 buffer_load_dwordx4 v147, s[28:31], s62 offen lds
 mf v,112,a,40,v,188
 mf v,68,a,44,v,176
 tr a,60,152,12288
 mf v,84,a,44,v,180
 tr a,62,152,14336
 mf v,100,a,44,v,184
 buffer_store_dword v144, v143, s[24:27], s75 offen sc1
 s_add_u32 s76, s76, 65536
 mf v,116,a,44,v,188
 s_waitcnt lgkmcnt(4)
 mf v,72,a,48,v,176
 tr a,40,141,12288
 mf v,88,a,48,v,180
 tr a,42,141,14336
 s_add_u32 m0, s53, 5120
 mf v,104,a,48,v,184
 buffer_load_dwordx4 v148, s[28:31], s62 offen lds
 mf v,120,a,48,v,188
 mf v,76,a,52,v,176
 tr a,44,130,12288
 mf v,92,a,52,v,180
 tr a,46,130,14336
 mf v,108,a,52,v,184
 buffer_load_dwordx4 a[100:103], v128, s[24:27], s55 offen offset:1024 sc1
 mf v,124,a,52,v,188
 s_waitcnt lgkmcnt(4)
 s_add_u32 m0, s53, 6144
 mf v,0,a,56,v,176
 buffer_load_dwordx4 v149, s[28:31], s62 offen lds
 mf v,16,a,56,v,180
 mf v,32,a,56,v,184
 buffer_load_dwordx4 a[104:107], v128, s[24:27], s56 offen offset:1024 sc1
 mf v,48,a,56,v,188
 s_waitcnt lgkmcnt(0)
 s_barrier
 mf v,4,a,60,v,176
 tr a,48,135,16384
 mf v,20,a,60,v,180
 tr a,50,135,18432
 mf v,36,a,60,v,184
 tr a,52,136,16384
 mf v,52,a,60,v,188
 tr a,54,136,18432
 mf v,8,a,40,v,176
 tr a,56,138,16384
 mf v,24,a,40,v,180
 tr a,58,138,18432
 s_add_u32 m0, s53, 7168
 mf v,40,a,40,v,184
 buffer_load_dwordx4 v150, s[28:31], s62 offen lds
 s_add_u32 s62, s62, s46
 mf v,56,a,40,v,188
 mf v,12,a,44,v,176
 tr a,60,140,16384
 mf v,28,a,44,v,180
 tr a,62,140,18432
 mf v,44,a,44,v,184
 buffer_load_dwordx4 a[108:111], v128, s[24:27], s57 offen offset:1024 sc1
 mf v,60,a,44,v,188
 s_waitcnt lgkmcnt(4)
f_g4:
 mf v,64,a,48,a,128
 tr a,40,151,16384
 mf v,80,a,48,a,132
 tr a,42,151,18432
 s_add_u32 m0, s53, 8192
 mf v,96,a,48,a,136
 buffer_load_dwordx4 v147, s[28:31], s62 offen lds
 mf v,112,a,48,a,140
 mf v,68,a,52,a,128
 tr a,44,152,16384
 mf v,84,a,52,a,132
 tr a,46,152,18432
 mf v,100,a,52,a,136
 buffer_load_dwordx4 a[112:115], v128, s[24:27], s54 offen offset:2048 sc1
 mf v,116,a,52,a,140
 s_waitcnt lgkmcnt(4)
 mf v,72,a,56,a,128
 tr a,48,141,16384
 mf v,88,a,56,a,132
 tr a,50,141,18432
 s_add_u32 m0, s53, 9216
 mf v,104,a,56,a,136
 buffer_load_dwordx4 v148, s[28:31], s62 offen lds
 mf v,120,a,56,a,140
 mf v,76,a,60,a,128
 tr a,52,130,16384
 mf v,92,a,60,a,132
 tr a,54,130,18432
 mf v,108,a,60,a,136
 mf v,124,a,60,a,140
 s_waitcnt lgkmcnt(4)
 mf v,0,a,40,a,128
 tr a,56,135,20480
 mf v,16,a,40,a,132
 tr a,58,135,22528
 mf v,32,a,40,a,136
 buffer_load_dwordx4 a[116:119], v128, s[24:27], s55 offen offset:2048 sc1
 mf v,48,a,40,a,140
 mf v,4,a,44,a,128
 tr a,60,136,20480
 mf v,20,a,44,a,132
 tr a,62,136,22528
 s_add_u32 m0, s53, 10240
 mf v,36,a,44,a,136
 buffer_load_dwordx4 v149, s[28:31], s62 offen lds
 mf v,52,a,44,a,140
 s_waitcnt lgkmcnt(4)
 mf v,8,a,48,a,128
 tr a,40,138,20480
 mf v,24,a,48,a,132
 tr a,42,138,22528
 s_add_u32 m0, s53, 11264
 mf v,40,a,48,a,136
 buffer_load_dwordx4 v150, s[28:31], s62 offen lds
 s_add_u32 s62, s62, 65536
 mf v,56,a,48,a,140
 mf v,12,a,52,a,128
 tr a,44,140,20480
 mf v,28,a,52,a,132
 tr a,46,140,22528
 mf v,44,a,52,a,136
 mf v,60,a,52,a,140
 s_waitcnt lgkmcnt(4)
f_g5:
 mf v,64,a,56,v,192
 tr a,48,151,20480
 mf v,80,a,56,v,196
 tr a,50,151,22528
 s_add_u32 m0, s53, 12288
 mf v,96,a,56,v,200
 buffer_load_dwordx4 v147, s[28:31], s62 offen lds
 mf v,112,a,56,v,204
 mf v,68,a,60,v,192
 tr a,52,152,20480
 mf v,84,a,60,v,196
 tr a,54,152,22528
 mf v,100,a,60,v,200
 buffer_load_dwordx4 a[120:123], v128, s[24:27], s56 offen offset:2048 sc1
 mf v,116,a,60,v,204
 s_waitcnt lgkmcnt(4)
 mf v,72,a,40,v,192
 tr a,56,141,20480
 mf v,88,a,40,v,196
 tr a,58,141,22528
 s_add_u32 m0, s53, 13312
 mf v,104,a,40,v,200
 buffer_load_dwordx4 v148, s[28:31], s62 offen lds
 mf v,120,a,40,v,204
 mf v,76,a,44,v,192
 tr a,60,130,20480
 mf v,92,a,44,v,196
 tr a,62,130,22528
 mf v,108,a,44,v,200
 mf v,124,a,44,v,204
 s_waitcnt lgkmcnt(4)
 mf v,0,a,48,v,192
 buffer_load_dwordx4 a[124:127], v128, s[24:27], s57 offen offset:2048 sc1
 mf v,16,a,48,v,196
 s_add_u32 m0, s53, 14336
 mf v,32,a,48,v,200
 buffer_load_dwordx4 v149, s[28:31], s62 offen lds
 mf v,48,a,48,v,204
 s_waitcnt lgkmcnt(0)
 s_barrier
 mf v,4,a,52,v,192
 tr a,40,135,24576
 mf v,20,a,52,v,196
 tr a,42,135,26624
 mf v,36,a,52,v,200
 tr a,44,136,24576
 mf v,52,a,52,v,204
 tr a,46,136,26624
 mf v,8,a,56,v,192
 tr a,48,138,24576
 mf v,24,a,56,v,196
 tr a,50,138,26624
 s_add_u32 m0, s53, 15360
 mf v,40,a,56,v,200
 buffer_load_dwordx4 v150, s[28:31], s62 offen lds
 s_add_u32 s62, s62, 65536
 mf v,56,a,56,v,204
 mf v,12,a,60,v,192
 tr a,52,140,24576
 mf v,28,a,60,v,196
 tr a,54,140,26624
 mf v,44,a,60,v,200
 mf v,60,a,60,v,204
 s_waitcnt lgkmcnt(4)
f_g6:
 mf v,64,a,40,a,144
 tr a,56,151,24576
 mf v,80,a,40,a,148
 tr a,58,151,26624
 s_add_u32 m0, s53, 16384
 mf v,96,a,40,a,152
 buffer_load_dwordx4 v147, s[28:31], s62 offen lds
 mf v,112,a,40,a,156
 mf v,68,a,44,a,144
 tr a,60,152,24576
 mf v,84,a,44,a,148
 tr a,62,152,26624
 s_mov_b32 s69, f_p48-f_base
 mf v,100,a,44,a,152
 buffer_load_dword v129, v155, s[36:39], s69 offen
 mf v,116,a,44,a,156
 s_waitcnt lgkmcnt(4)
 mf v,72,a,48,a,144
 tr a,40,141,24576
 mf v,88,a,48,a,148
 tr a,42,141,26624
 s_add_u32 m0, s53, 17408
 mf v,104,a,48,a,152
 buffer_load_dwordx4 v148, s[28:31], s62 offen lds
 mf v,120,a,48,a,156
 mf v,76,a,52,a,144
 tr a,44,130,24576
 mf v,92,a,52,a,148
 tr a,46,130,26624
 mf v,108,a,52,a,152
 buffer_load_dwordx4 v[176:179], v128, s[24:27], s54 offen offset:3072 sc1
 s_add_u32 s54, s54, s44
 mf v,124,a,52,a,156
 s_waitcnt lgkmcnt(4)
 mf v,0,a,56,a,144
 tr a,48,135,28672
 mf v,16,a,56,a,148
 tr a,50,135,30720
 s_add_u32 m0, s53, 18432
 mf v,32,a,56,a,152
 buffer_load_dwordx4 v149, s[28:31], s62 offen lds
 mf v,48,a,56,a,156
 mf v,4,a,60,a,144
 tr a,52,136,28672
 mf v,20,a,60,a,148
 tr a,54,136,30720
 mf v,36,a,60,a,152
 buffer_load_dwordx4 v[180:183], v128, s[24:27], s55 offen offset:3072 sc1
 s_add_u32 s55, s55, s44
 mf v,52,a,60,a,156
 s_waitcnt lgkmcnt(4)
 mf v,8,a,40,a,144
 tr a,56,138,28672
 mf v,24,a,40,a,148
 tr a,58,138,30720
 s_add_u32 m0, s53, 19456
 mf v,40,a,40,a,152
 buffer_load_dwordx4 v150, s[28:31], s62 offen lds
 s_add_u32 s62, s62, 65536
 mf v,56,a,40,a,156
 mf v,12,a,44,a,144
 tr a,60,140,28672
 mf v,28,a,44,a,148
 tr a,62,140,30720
 mf v,44,a,44,a,152
 buffer_load_dwordx4 v[184:187], v128, s[24:27], s56 offen offset:3072 sc1
 s_add_u32 s56, s56, s44
 mf v,60,a,44,a,156
 s_waitcnt lgkmcnt(4)
f_g7:
 mf v,64,a,48,a,160
 tr a,40,151,28672
 mf v,80,a,48,a,164
 tr a,42,151,30720
 s_add_u32 m0, s53, 20480
 mf v,96,a,48,a,168
 buffer_load_dwordx4 v147, s[28:31], s62 offen lds
 mf v,112,a,48,a,172
 mf v,68,a,52,a,160
 tr a,44,152,28672
 mf v,84,a,52,a,164
 tr a,46,152,30720
 mf v,100,a,52,a,168
 buffer_load_dwordx4 v[188:191], v128, s[24:27], s57 offen offset:3072 sc1
 s_add_u32 s57, s57, s44
 mf v,116,a,52,a,172
 s_waitcnt lgkmcnt(4)
 mf v,72,a,56,a,160
 tr a,48,141,28672
 mf v,88,a,56,a,164
 tr a,50,141,30720
 s_add_u32 m0, s53, 21504
 mf v,104,a,56,a,168
 buffer_load_dwordx4 v148, s[28:31], s62 offen lds
 mf v,120,a,56,a,172
 mf v,76,a,60,a,160
 tr a,52,130,28672
 mf v,92,a,60,a,164
 tr a,54,130,30720
 mf v,108,a,60,a,168
 mf v,124,a,60,a,172
 s_waitcnt lgkmcnt(4)
 mf v,0,a,40,a,160
 buffer_load_dwordx4 a[128:131], v128, s[24:27], s54 offen offset:0 sc1
 mf v,16,a,40,a,164
 s_add_u32 m0, s53, 22528
 mf v,32,a,40,a,168
 buffer_load_dwordx4 v149, s[28:31], s62 offen lds
 mf v,48,a,40,a,172
 s_waitcnt vmcnt(39) lgkmcnt(0)
 s_barrier
 mf v,4,a,44,a,160
 tr a,56,135,32768
 mf v,20,a,44,a,164
 tr a,58,135,34816
 mf v,36,a,44,a,168
 tr a,60,136,32768
 mf v,52,a,44,a,172
 tr a,62,136,34816
 mf v,8,a,48,a,160
 tr a,40,138,32768
 mf v,24,a,48,a,164
 tr a,42,138,34816
 s_add_u32 m0, s53, 23552
 mf v,40,a,48,a,168
 buffer_load_dwordx4 v150, s[28:31], s62 offen lds
 s_add_u32 s62, s62, s46
 mf v,56,a,48,a,172
 mf v,12,a,52,a,160
 tr a,44,140,32768
 mf v,28,a,52,a,164
 tr a,46,140,34816
 mf v,44,a,52,a,168
 mf v,60,a,52,a,172
 s_waitcnt lgkmcnt(4)
f_g8:
 mf v,64,a,56,v,208
 tr a,48,151,32768
 mf v,80,a,56,v,212
 tr a,50,151,34816
 s_add_u32 m0, s53, 24576
 mf v,96,a,56,v,216
 buffer_load_dwordx4 v147, s[28:31], s62 offen lds
 mf v,112,a,56,v,220
 mf v,68,a,60,v,208
 tr a,52,152,32768
 mf v,84,a,60,v,212
 tr a,54,152,34816
 mf v,100,a,60,v,216
 buffer_load_dwordx4 a[132:135], v128, s[24:27], s55 offen offset:0 sc1
 mf v,116,a,60,v,220
 s_waitcnt lgkmcnt(4)
 mf v,72,a,40,v,208
 tr a,56,141,32768
 mf v,88,a,40,v,212
 tr a,58,141,34816
 s_add_u32 m0, s53, 25600
 mf v,104,a,40,v,216
 buffer_load_dwordx4 v148, s[28:31], s62 offen lds
 mf v,120,a,40,v,220
 mf v,76,a,44,v,208
 tr a,60,130,32768
 mf v,92,a,44,v,212
 tr a,62,130,34816
 mf v,108,a,44,v,216
 buffer_load_dwordx4 a[136:139], v128, s[24:27], s56 offen offset:0 sc1
 mf v,124,a,44,v,220
 s_waitcnt lgkmcnt(4)
 mf v,0,a,48,v,208
 tr a,40,135,36864
 mf v,16,a,48,v,212
 tr a,42,135,38912
 s_add_u32 m0, s53, 26624
 mf v,32,a,48,v,216
 buffer_load_dwordx4 v149, s[28:31], s62 offen lds
 mf v,48,a,48,v,220
 mf v,4,a,52,v,208
 tr a,44,136,36864
 mf v,20,a,52,v,212
 tr a,46,136,38912
 mf v,36,a,52,v,216
 buffer_load_dwordx4 a[140:143], v128, s[24:27], s57 offen offset:0 sc1
 mf v,52,a,52,v,220
 s_waitcnt lgkmcnt(4)
 mf v,8,a,56,v,208
 tr a,48,138,36864
 mf v,24,a,56,v,212
 tr a,50,138,38912
 s_add_u32 m0, s53, 27648
 mf v,40,a,56,v,216
 buffer_load_dwordx4 v150, s[28:31], s62 offen lds
 s_add_u32 s62, s62, 65536
 mf v,56,a,56,v,220
 mf v,12,a,60,v,208
 tr a,52,140,36864
 mf v,28,a,60,v,212
 tr a,54,140,38912
 mf v,44,a,60,v,216
 mf v,60,a,60,v,220
 s_waitcnt lgkmcnt(4)
f_g9:
 mf v,64,a,40,a,176
 tr a,56,151,36864
 mf v,80,a,40,a,180
 tr a,58,151,38912
 s_add_u32 m0, s53, 28672
 mf v,96,a,40,a,184
 buffer_load_dwordx4 v147, s[28:31], s62 offen lds
 mf v,112,a,40,a,188
 mf v,68,a,44,a,176
 tr a,60,152,36864
 mf v,84,a,44,a,180
 tr a,62,152,38912
 mf v,100,a,44,a,184
 buffer_load_dwordx4 v[192:195], v128, s[24:27], s54 offen offset:1024 sc1
 mf v,116,a,44,a,188
 s_waitcnt lgkmcnt(4)
 mf v,72,a,48,a,176
 tr a,40,141,36864
 mf v,88,a,48,a,180
 tr a,42,141,38912
 s_add_u32 m0, s53, 29696
 mf v,104,a,48,a,184
 buffer_load_dwordx4 v148, s[28:31], s62 offen lds
 mf v,120,a,48,a,188
 mf v,76,a,52,a,176
 tr a,44,130,36864
 mf v,92,a,52,a,180
 tr a,46,130,38912
 mf v,108,a,52,a,184
 mf v,124,a,52,a,188
 s_waitcnt lgkmcnt(4)
 mf v,0,a,56,a,176
 buffer_load_dwordx4 v[196:199], v128, s[24:27], s55 offen offset:1024 sc1
 mf v,16,a,56,a,180
 s_add_u32 m0, s53, 30720
 mf v,32,a,56,a,184
 buffer_load_dwordx4 v149, s[28:31], s62 offen lds
 mf v,48,a,56,a,188
 s_waitcnt vmcnt(39) lgkmcnt(0)
 s_barrier
 mf v,4,a,60,a,176
 tr a,48,135,0
 mf v,20,a,60,a,180
 tr a,50,135,2048
 mf v,36,a,60,a,184
 tr a,52,136,0
 mf v,52,a,60,a,188
 tr a,54,136,2048
 mf v,8,a,40,a,176
 tr a,56,138,0
 mf v,24,a,40,a,180
 tr a,58,138,2048
 s_add_u32 m0, s53, 31744
 mf v,40,a,40,a,184
 buffer_load_dwordx4 v150, s[28:31], s62 offen lds
 s_add_u32 s62, s62, 65536
 mf v,56,a,40,a,188
 mf v,12,a,44,a,176
 tr a,60,140,0
 mf v,28,a,44,a,180
 tr a,62,140,2048
 mf v,44,a,44,a,184
 mf v,60,a,44,a,188
 s_waitcnt lgkmcnt(4)
f_g10:
 mf v,64,a,48,a,192
 tr a,40,151,0
 mf v,80,a,48,a,196
 tr a,42,151,2048
 s_add_u32 m0, s53, 32768
 mf v,96,a,48,a,200
 buffer_load_dwordx4 v147, s[28:31], s62 offen lds
 mf v,112,a,48,a,204
 mf v,68,a,52,a,192
 tr a,44,152,0
 mf v,84,a,52,a,196
 tr a,46,152,2048
 mf v,100,a,52,a,200
 buffer_load_dwordx4 v[200:203], v128, s[24:27], s56 offen offset:1024 sc1
 mf v,116,a,52,a,204
 s_waitcnt lgkmcnt(4)
 mf v,72,a,56,a,192
 tr a,48,141,0
 mf v,88,a,56,a,196
 tr a,50,141,2048
 s_add_u32 m0, s53, 33792
 mf v,104,a,56,a,200
 buffer_load_dwordx4 v148, s[28:31], s62 offen lds
 mf v,120,a,56,a,204
 mf v,76,a,60,a,192
 tr a,52,130,0
 mf v,92,a,60,a,196
 tr a,54,130,2048
 mf v,108,a,60,a,200
 mf v,124,a,60,a,204
 s_waitcnt lgkmcnt(4)
 mf v,0,a,40,a,192
 tr a,56,135,4096
 mf v,16,a,40,a,196
 tr a,58,135,6144
 mf v,32,a,40,a,200
 buffer_load_dwordx4 v[204:207], v128, s[24:27], s57 offen offset:1024 sc1
 mf v,48,a,40,a,204
 mf v,4,a,44,a,192
 tr a,60,136,4096
 mf v,20,a,44,a,196
 tr a,62,136,6144
 s_add_u32 m0, s53, 34816
 mf v,36,a,44,a,200
 buffer_load_dwordx4 v149, s[28:31], s62 offen lds
 mf v,52,a,44,a,204
 s_waitcnt lgkmcnt(4)
 mf v,8,a,48,a,192
 tr a,40,138,4096
 mf v,24,a,48,a,196
 tr a,42,138,6144
 s_add_u32 m0, s53, 35840
 mf v,40,a,48,a,200
 buffer_load_dwordx4 v150, s[28:31], s62 offen lds
 s_add_u32 s62, s62, 65536
 mf v,56,a,48,a,204
 mf v,12,a,52,a,192
 tr a,44,140,4096
 mf v,28,a,52,a,196
 tr a,46,140,6144
 mf v,44,a,52,a,200
 mf v,60,a,52,a,204
 s_waitcnt lgkmcnt(4)
f_g11:
 mf v,64,a,56,v,224
 tr a,48,151,4096
 mf v,80,a,56,v,228
 tr a,50,151,6144
 s_add_u32 m0, s53, 36864
 mf v,96,a,56,v,232
 buffer_load_dwordx4 v147, s[28:31], s62 offen lds
 mf v,112,a,56,v,236
 mf v,68,a,60,v,224
 tr a,52,152,4096
 mf v,84,a,60,v,228
 tr a,54,152,6144
 mf v,100,a,60,v,232
 buffer_load_dwordx4 a[144:147], v128, s[24:27], s54 offen offset:2048 sc1
 mf v,116,a,60,v,236
 s_waitcnt lgkmcnt(4)
 mf v,72,a,40,v,224
 tr a,56,141,4096
 mf v,88,a,40,v,228
 tr a,58,141,6144
 s_add_u32 m0, s53, 37888
 mf v,104,a,40,v,232
 buffer_load_dwordx4 v148, s[28:31], s62 offen lds
 mf v,120,a,40,v,236
 mf v,76,a,44,v,224
 tr a,60,130,4096
 mf v,92,a,44,v,228
 tr a,62,130,6144
 mf v,108,a,44,v,232
 buffer_load_dwordx4 a[148:151], v128, s[24:27], s55 offen offset:2048 sc1
 mf v,124,a,44,v,236
 s_waitcnt lgkmcnt(4)
 s_add_u32 m0, s53, 38912
 mf v,0,a,48,v,224
 buffer_load_dwordx4 v149, s[28:31], s62 offen lds
 mf v,16,a,48,v,228
 mf v,32,a,48,v,232
 buffer_load_dwordx4 a[152:155], v128, s[24:27], s56 offen offset:2048 sc1
 mf v,48,a,48,v,236
 s_waitcnt vmcnt(39) lgkmcnt(0)
 s_barrier
 mf v,4,a,52,v,224
 tr a,40,135,8192
 mf v,20,a,52,v,228
 tr a,42,135,10240
 mf v,36,a,52,v,232
 tr a,44,136,8192
 mf v,52,a,52,v,236
 tr a,46,136,10240
 mf v,8,a,56,v,224
 tr a,48,138,8192
 mf v,24,a,56,v,228
 tr a,50,138,10240
 s_add_u32 m0, s53, 39936
 mf v,40,a,56,v,232
 buffer_load_dwordx4 v150, s[28:31], s62 offen lds
 s_add_u32 s62, s62, s46
 mf v,56,a,56,v,236
 mf v,12,a,60,v,224
 tr a,52,140,8192
 mf v,28,a,60,v,228
 tr a,54,140,10240
 mf v,44,a,60,v,232
 mf v,60,a,60,v,236
 s_waitcnt lgkmcnt(4)
f_g12:
f_p48:
 mf v,64,a,40,a,208
 tr a,56,151,8192
 mf v,80,a,40,a,212
 tr a,58,151,10240
 s_add_u32 m0, s53, 0
 mf v,96,a,40,a,216
 buffer_load_dwordx4 v147, s[28:31], s62 offen lds
 mf v,112,a,40,a,220
 mf v,68,a,44,a,208
 tr a,60,152,8192
 mf v,84,a,44,a,212
 tr a,62,152,10240
 mf v,100,a,44,a,216
 buffer_load_dwordx4 a[156:159], v128, s[24:27], s57 offen offset:2048 sc1
 mf v,116,a,44,a,220
 s_waitcnt lgkmcnt(4)
 mf v,72,a,48,a,208
 tr a,40,141,8192
 mf v,88,a,48,a,212
 tr a,42,141,10240
 s_add_u32 m0, s53, 1024
 mf v,104,a,48,a,216
 buffer_load_dwordx4 v148, s[28:31], s62 offen lds
 mf v,120,a,48,a,220
 mf v,76,a,52,a,208
 tr a,44,130,8192
 mf v,92,a,52,a,212
 tr a,46,130,10240
 mf v,108,a,52,a,216
 mf v,124,a,52,a,220
 s_waitcnt lgkmcnt(4)
 mf v,0,a,56,a,208
 tr a,48,135,12288
 mf v,16,a,56,a,212
 tr a,50,135,14336
 mf v,32,a,56,a,216
 buffer_load_dwordx4 a[160:163], v128, s[24:27], s54 offen offset:3072 sc1
 s_add_u32 s54, s54, s44
 mf v,48,a,56,a,220
 mf v,4,a,60,a,208
 tr a,52,136,12288
 mf v,20,a,60,a,212
 tr a,54,136,14336
 s_add_u32 m0, s53, 2048
 mf v,36,a,60,a,216
 buffer_load_dwordx4 v149, s[28:31], s62 offen lds
 mf v,52,a,60,a,220
 s_waitcnt lgkmcnt(4)
 mf v,8,a,40,a,208
 tr a,56,138,12288
 mf v,24,a,40,a,212
 tr a,58,138,14336
 s_add_u32 m0, s53, 3072
 mf v,40,a,40,a,216
 buffer_load_dwordx4 v150, s[28:31], s62 offen lds
 s_add_u32 s62, s62, 65536
 mf v,56,a,40,a,220
 mf v,12,a,44,a,208
 tr a,60,140,12288
 mf v,28,a,44,a,212
 tr a,62,140,14336
 mf v,44,a,44,a,216
 mf v,60,a,44,a,220
 s_waitcnt lgkmcnt(4)
f_g13:
 mf v,64,a,48,v,240
 tr a,40,151,12288
 mf v,80,a,48,v,244
 tr a,42,151,14336
 s_add_u32 m0, s53, 4096
 mf v,96,a,48,v,248
 buffer_load_dwordx4 v147, s[28:31], s62 offen lds
 mf v,112,a,48,v,252
 mf v,68,a,52,v,240
 tr a,44,152,12288
 mf v,84,a,52,v,244
 tr a,46,152,14336
 s_mov_b32 s69, f_p96-f_base
 mf v,100,a,52,v,248
 buffer_load_dword v129, v155, s[36:39], s69 offen
 mf v,116,a,52,v,252
 s_waitcnt lgkmcnt(4)
 mf v,72,a,56,v,240
 tr a,48,141,12288
 mf v,88,a,56,v,244
 tr a,50,141,14336
 s_add_u32 m0, s53, 5120
 mf v,104,a,56,v,248
 buffer_load_dwordx4 v148, s[28:31], s62 offen lds
 mf v,120,a,56,v,252
 mf v,76,a,60,v,240
 tr a,52,130,12288
 mf v,92,a,60,v,244
 tr a,54,130,14336
 mf v,108,a,60,v,248
 buffer_load_dwordx4 a[164:167], v128, s[24:27], s55 offen offset:3072 sc1
 s_add_u32 s55, s55, s44
 mf v,124,a,60,v,252
 s_waitcnt lgkmcnt(4)
 s_add_u32 m0, s53, 6144
 mf v,0,a,40,v,240
 buffer_load_dwordx4 v149, s[28:31], s62 offen lds
 mf v,16,a,40,v,244
 mf v,32,a,40,v,248
 buffer_load_dwordx4 a[168:171], v128, s[24:27], s56 offen offset:3072 sc1
 s_add_u32 s56, s56, s44
 mf v,48,a,40,v,252
 s_waitcnt vmcnt(38) lgkmcnt(0)
 s_barrier
 mf v,4,a,44,v,240
 tr a,56,135,16384
 mf v,20,a,44,v,244
 tr a,58,135,18432
 mf v,36,a,44,v,248
 tr a,60,136,16384
 mf v,52,a,44,v,252
 tr a,62,136,18432
 mf v,8,a,48,v,240
 tr a,40,138,16384
 mf v,24,a,48,v,244
 tr a,42,138,18432
 s_add_u32 m0, s53, 7168
 mf v,40,a,48,v,248
 buffer_load_dwordx4 v150, s[28:31], s62 offen lds
 s_add_u32 s62, s62, 65536
 mf v,56,a,48,v,252
 mf v,12,a,52,v,240
 tr a,44,140,16384
 mf v,28,a,52,v,244
 tr a,46,140,18432
 mf v,44,a,52,v,248
 buffer_load_dwordx4 a[172:175], v128, s[24:27], s57 offen offset:3072 sc1
 s_add_u32 s57, s57, s44
 mf v,60,a,52,v,252
 s_waitcnt lgkmcnt(4)
f_g14:
 mf v,64,a,56,a,224
 tr a,48,151,16384
 mf v,80,a,56,a,228
 tr a,50,151,18432
 s_add_u32 m0, s53, 8192
 mf v,96,a,56,a,232
 buffer_load_dwordx4 v147, s[28:31], s62 offen lds
 mf v,112,a,56,a,236
 mf v,68,a,60,a,224
 tr a,52,152,16384
 mf v,84,a,60,a,228
 tr a,54,152,18432
 mf v,100,a,60,a,232
 buffer_load_dwordx4 v[208:211], v128, s[24:27], s54 offen offset:0 sc1
 mf v,116,a,60,a,236
 s_waitcnt lgkmcnt(4)
 mf v,72,a,40,a,224
 tr a,56,141,16384
 mf v,88,a,40,a,228
 tr a,58,141,18432
 s_add_u32 m0, s53, 9216
 mf v,104,a,40,a,232
 buffer_load_dwordx4 v148, s[28:31], s62 offen lds
 mf v,120,a,40,a,236
 mf v,76,a,44,a,224
 tr a,60,130,16384
 mf v,92,a,44,a,228
 tr a,62,130,18432
 mf v,108,a,44,a,232
 mf v,124,a,44,a,236
 s_waitcnt lgkmcnt(4)
 mf v,0,a,48,a,224
 tr a,40,135,20480
 mf v,16,a,48,a,228
 tr a,42,135,22528
 mf v,32,a,48,a,232
 buffer_load_dwordx4 v[212:215], v128, s[24:27], s55 offen offset:0 sc1
 mf v,48,a,48,a,236
 mf v,4,a,52,a,224
 tr a,44,136,20480
 mf v,20,a,52,a,228
 tr a,46,136,22528
 s_add_u32 m0, s53, 10240
 mf v,36,a,52,a,232
 buffer_load_dwordx4 v149, s[28:31], s62 offen lds
 mf v,52,a,52,a,236
 s_waitcnt lgkmcnt(4)
 mf v,8,a,56,a,224
 tr a,48,138,20480
 mf v,24,a,56,a,228
 tr a,50,138,22528
 s_add_u32 m0, s53, 11264
 mf v,40,a,56,a,232
 buffer_load_dwordx4 v150, s[28:31], s62 offen lds
 s_add_u32 s62, s62, 65536
 mf v,56,a,56,a,236
 mf v,12,a,60,a,224
 tr a,52,140,20480
 mf v,28,a,60,a,228
 tr a,54,140,22528
 mf v,44,a,60,a,232
 mf v,60,a,60,a,236
 s_waitcnt lgkmcnt(4)
f_g15:
 mf v,64,a,40,a,240
 tr a,56,151,20480
 mf v,80,a,40,a,244
 tr a,58,151,22528
 s_add_u32 m0, s53, 12288
 mf v,96,a,40,a,248
 buffer_load_dwordx4 v147, s[28:31], s62 offen lds
 mf v,112,a,40,a,252
 mf v,68,a,44,a,240
 tr a,60,152,20480
 mf v,84,a,44,a,244
 tr a,62,152,22528
 mf v,100,a,44,a,248
 buffer_load_dwordx4 v[216:219], v128, s[24:27], s56 offen offset:0 sc1
 mf v,116,a,44,a,252
 s_waitcnt lgkmcnt(4)
 mf v,72,a,48,a,240
 tr a,40,141,20480
 mf v,88,a,48,a,244
 tr a,42,141,22528
 s_add_u32 m0, s53, 13312
 mf v,104,a,48,a,248
 buffer_load_dwordx4 v148, s[28:31], s62 offen lds
 mf v,120,a,48,a,252
 mf v,76,a,52,a,240
 tr a,44,130,20480
 mf v,92,a,52,a,244
 tr a,46,130,22528
 mf v,108,a,52,a,248
 mf v,124,a,52,a,252
 s_waitcnt lgkmcnt(4)
 mf v,0,a,56,a,240
 buffer_load_dwordx4 v[220:223], v128, s[24:27], s57 offen offset:0 sc1
 mf v,16,a,56,a,244
 s_add_u32 m0, s53, 14336
 mf v,32,a,56,a,248
 buffer_load_dwordx4 v149, s[28:31], s62 offen lds
 mf v,48,a,56,a,252
 s_waitcnt vmcnt(38) lgkmcnt(0)
 s_barrier
 mf v,4,a,60,a,240
 tr a,48,135,24576
 mf v,20,a,60,a,244
 tr a,50,135,26624
 mf v,36,a,60,a,248
 tr a,52,136,24576
 mf v,52,a,60,a,252
 tr a,54,136,26624
 mf v,8,a,40,a,240
 tr a,56,138,24576
 mf v,24,a,40,a,244
 tr a,58,138,26624
 s_add_u32 m0, s53, 15360
 mf v,40,a,40,a,248
 buffer_load_dwordx4 v150, s[28:31], s62 offen lds
 s_add_u32 s62, s62, s46
 mf v,56,a,40,a,252
 mf v,12,a,44,a,240
 tr a,60,140,24576
 mf v,28,a,44,a,244
 tr a,62,140,26624
 mf v,44,a,44,a,248
 mf v,60,a,44,a,252
 s_waitcnt lgkmcnt(4)
f_g16:
 mf v,64,a,48,v,160
 tr a,40,151,24576
 mf v,80,a,48,v,164
 tr a,42,151,26624
 s_add_u32 m0, s53, 16384
 mf v,96,a,48,v,168
 buffer_load_dwordx4 v147, s[28:31], s62 offen lds
 mf v,112,a,48,v,172
 mf v,68,a,52,v,160
 tr a,44,152,24576
 mf v,84,a,52,v,164
 tr a,46,152,26624
 mf v,100,a,52,v,168
 buffer_load_dwordx4 a[176:179], v128, s[24:27], s54 offen offset:1024 sc1
 mf v,116,a,52,v,172
 s_waitcnt lgkmcnt(4)
 mf v,72,a,56,v,160
 tr a,48,141,24576
 mf v,88,a,56,v,164
 tr a,50,141,26624
 s_add_u32 m0, s53, 17408
 mf v,104,a,56,v,168
 buffer_load_dwordx4 v148, s[28:31], s62 offen lds
 mf v,120,a,56,v,172
 mf v,76,a,60,v,160
 tr a,52,130,24576
 mf v,92,a,60,v,164
 tr a,54,130,26624
 mf v,108,a,60,v,168
 buffer_load_dwordx4 a[180:183], v128, s[24:27], s55 offen offset:1024 sc1
 mf v,124,a,60,v,172
 s_waitcnt lgkmcnt(4)
 mf v,0,a,40,v,160
 tr a,56,135,28672
 mf v,16,a,40,v,164
 tr a,58,135,30720
 s_add_u32 m0, s53, 18432
 mf v,32,a,40,v,168
 buffer_load_dwordx4 v149, s[28:31], s62 offen lds
 mf v,48,a,40,v,172
 mf v,4,a,44,v,160
 tr a,60,136,28672
 mf v,20,a,44,v,164
 tr a,62,136,30720
 mf v,36,a,44,v,168
 buffer_load_dwordx4 a[184:187], v128, s[24:27], s56 offen offset:1024 sc1
 mf v,52,a,44,v,172
 s_waitcnt lgkmcnt(4)
 mf v,8,a,48,v,160
 tr a,40,138,28672
 mf v,24,a,48,v,164
 tr a,42,138,30720
 s_add_u32 m0, s53, 19456
 mf v,40,a,48,v,168
 buffer_load_dwordx4 v150, s[28:31], s62 offen lds
 s_add_u32 s62, s62, 65536
 mf v,56,a,48,v,172
 mf v,12,a,52,v,160
 tr a,44,140,28672
 mf v,28,a,52,v,164
 tr a,46,140,30720
 mf v,44,a,52,v,168
 mf v,60,a,52,v,172
 s_waitcnt lgkmcnt(4)
f_g17:
 mf v,64,a,56,a,96
 tr a,48,151,28672
 mf v,80,a,56,a,100
 tr a,50,151,30720
 s_add_u32 m0, s53, 20480
 mf v,96,a,56,a,104
 buffer_load_dwordx4 v147, s[28:31], s62 offen lds
 mf v,112,a,56,a,108
 mf v,68,a,60,a,96
 tr a,52,152,28672
 mf v,84,a,60,a,100
 tr a,54,152,30720
 mf v,100,a,60,a,104
 buffer_load_dwordx4 a[188:191], v128, s[24:27], s57 offen offset:1024 sc1
 mf v,116,a,60,a,108
 s_waitcnt lgkmcnt(4)
 mf v,72,a,40,a,96
 tr a,56,141,28672
 mf v,88,a,40,a,100
 tr a,58,141,30720
 s_add_u32 m0, s53, 21504
 mf v,104,a,40,a,104
 buffer_load_dwordx4 v148, s[28:31], s62 offen lds
 mf v,120,a,40,a,108
 mf v,76,a,44,a,96
 tr a,60,130,28672
 mf v,92,a,44,a,100
 tr a,62,130,30720
 mf v,108,a,44,a,104
 mf v,124,a,44,a,108
 s_waitcnt lgkmcnt(4)
 mf v,0,a,48,a,96
 buffer_load_dwordx4 a[192:195], v128, s[24:27], s54 offen offset:2048 sc1
 mf v,16,a,48,a,100
 s_add_u32 m0, s53, 22528
 mf v,32,a,48,a,104
 buffer_load_dwordx4 v149, s[28:31], s62 offen lds
 mf v,48,a,48,a,108
 s_waitcnt vmcnt(38) lgkmcnt(0)
 s_barrier
 mf v,4,a,52,a,96
 tr a,40,135,32768
 mf v,20,a,52,a,100
 tr a,42,135,34816
 mf v,36,a,52,a,104
 tr a,44,136,32768
 mf v,52,a,52,a,108
 tr a,46,136,34816
 mf v,8,a,56,a,96
 tr a,48,138,32768
 mf v,24,a,56,a,100
 tr a,50,138,34816
 s_add_u32 m0, s53, 23552
 mf v,40,a,56,a,104
 buffer_load_dwordx4 v150, s[28:31], s62 offen lds
 s_add_u32 s62, s62, 65536
 mf v,56,a,56,a,108
 mf v,12,a,60,a,96
 tr a,52,140,32768
 mf v,28,a,60,a,100
 tr a,54,140,34816
 mf v,44,a,60,a,104
 mf v,60,a,60,a,108
 s_waitcnt lgkmcnt(4)
f_g18:
 mf v,64,a,40,a,112
 tr a,56,151,32768
 mf v,80,a,40,a,116
 tr a,58,151,34816
 s_add_u32 m0, s53, 24576
 mf v,96,a,40,a,120
 buffer_load_dwordx4 v147, s[28:31], s62 offen lds
 mf v,112,a,40,a,124
 mf v,68,a,44,a,112
 tr a,60,152,32768
 mf v,84,a,44,a,116
 tr a,62,152,34816
 mf v,100,a,44,a,120
 buffer_load_dwordx4 a[196:199], v128, s[24:27], s55 offen offset:2048 sc1
 mf v,116,a,44,a,124
 s_waitcnt lgkmcnt(4)
 mf v,72,a,48,a,112
 tr a,40,141,32768
 mf v,88,a,48,a,116
 tr a,42,141,34816
 s_add_u32 m0, s53, 25600
 mf v,104,a,48,a,120
 buffer_load_dwordx4 v148, s[28:31], s62 offen lds
 mf v,120,a,48,a,124
 mf v,76,a,52,a,112
 tr a,44,130,32768
 mf v,92,a,52,a,116
 tr a,46,130,34816
 mf v,108,a,52,a,120
 buffer_load_dwordx4 a[200:203], v128, s[24:27], s56 offen offset:2048 sc1
 mf v,124,a,52,a,124
 s_waitcnt lgkmcnt(4)
 mf v,0,a,56,a,112
 tr a,48,135,36864
 mf v,16,a,56,a,116
 tr a,50,135,38912
 s_add_u32 m0, s53, 26624
 mf v,32,a,56,a,120
 buffer_load_dwordx4 v149, s[28:31], s62 offen lds
 mf v,48,a,56,a,124
 mf v,4,a,60,a,112
 tr a,52,136,36864
 mf v,20,a,60,a,116
 tr a,54,136,38912
 mf v,36,a,60,a,120
 buffer_load_dwordx4 a[204:207], v128, s[24:27], s57 offen offset:2048 sc1
 mf v,52,a,60,a,124
 s_waitcnt lgkmcnt(4)
 mf v,8,a,40,a,112
 tr a,56,138,36864
 mf v,24,a,40,a,116
 tr a,58,138,38912
 s_add_u32 m0, s53, 27648
 mf v,40,a,40,a,120
 buffer_load_dwordx4 v150, s[28:31], s62 offen lds
 s_add_u32 s62, s62, 65536
 mf v,56,a,40,a,124
 mf v,12,a,44,a,112
 tr a,60,140,36864
 mf v,28,a,44,a,116
 tr a,62,140,38912
 mf v,44,a,44,a,120
 mf v,60,a,44,a,124
 s_waitcnt lgkmcnt(4)
f_g19:
 mf v,64,a,48,v,176
 tr a,40,151,36864
 mf v,80,a,48,v,180
 tr a,42,151,38912
 s_add_u32 m0, s53, 28672
 mf v,96,a,48,v,184
 buffer_load_dwordx4 v147, s[28:31], s62 offen lds
 mf v,112,a,48,v,188
 mf v,68,a,52,v,176
 tr a,44,152,36864
 mf v,84,a,52,v,180
 tr a,46,152,38912
 mf v,100,a,52,v,184
 buffer_load_dwordx4 v[224:227], v128, s[24:27], s54 offen offset:3072 sc1
 s_add_u32 s54, s54, s9
 mf v,116,a,52,v,188
 s_waitcnt lgkmcnt(4)
 mf v,72,a,56,v,176
 tr a,48,141,36864
 mf v,88,a,56,v,180
 tr a,50,141,38912
 s_add_u32 m0, s53, 29696
 mf v,104,a,56,v,184
 buffer_load_dwordx4 v148, s[28:31], s62 offen lds
 mf v,120,a,56,v,188
 mf v,76,a,60,v,176
 tr a,52,130,36864
 mf v,92,a,60,v,180
 tr a,54,130,38912
 mf v,108,a,60,v,184
 mf v,124,a,60,v,188
 s_waitcnt lgkmcnt(4)
 mf v,0,a,40,v,176
 buffer_load_dwordx4 v[228:231], v128, s[24:27], s55 offen offset:3072 sc1
 s_add_u32 s55, s55, s9
 mf v,16,a,40,v,180
 s_add_u32 m0, s53, 30720
 mf v,32,a,40,v,184
 buffer_load_dwordx4 v149, s[28:31], s62 offen lds
 mf v,48,a,40,v,188
 s_waitcnt vmcnt(38) lgkmcnt(0)
 s_barrier
 mf v,4,a,44,v,176
 tr a,56,135,0
 mf v,20,a,44,v,180
 tr a,58,135,2048
 mf v,36,a,44,v,184
 tr a,60,136,0
 mf v,52,a,44,v,188
 tr a,62,136,2048
 mf v,8,a,48,v,176
 tr a,40,138,0
 mf v,24,a,48,v,180
 tr a,42,138,2048
 s_add_u32 m0, s53, 31744
 mf v,40,a,48,v,184
 buffer_load_dwordx4 v150, s[28:31], s62 offen lds
 s_mov_b32 s62, s8
 mf v,56,a,48,v,188
 mf v,12,a,52,v,176
 tr a,44,140,0
 mf v,28,a,52,v,180
 tr a,46,140,2048
 mf v,44,a,52,v,184
 mf v,60,a,52,v,188
 s_waitcnt lgkmcnt(4)
f_g20:
 mf v,64,a,56,a,128
 tr a,48,151,0
 mf v,80,a,56,a,132
 tr a,50,151,2048
 s_add_u32 m0, s53, 32768
 mf v,96,a,56,a,136
 buffer_load_dwordx4 v147, s[32:35], s62 offen lds
 mf v,112,a,56,a,140
 mf v,68,a,60,a,128
 tr a,52,152,0
 mf v,84,a,60,a,132
 tr a,54,152,2048
 mf v,100,a,60,a,136
 buffer_load_dword v154, v145, s[24:27], s76 offen offset:0 sc1
 mf v,116,a,60,a,140
 s_waitcnt lgkmcnt(4)
 mf v,72,a,40,a,128
 tr a,56,141,0
 mf v,88,a,40,a,132
 tr a,58,141,2048
 s_add_u32 m0, s53, 33792
 mf v,104,a,40,a,136
 buffer_load_dwordx4 v148, s[32:35], s62 offen lds
 mf v,120,a,40,a,140
 mf v,76,a,44,a,128
 tr a,60,130,0
 mf v,92,a,44,a,132
 tr a,62,130,2048
 mf v,108,a,44,a,136
 buffer_load_dwordx4 v[232:235], v128, s[24:27], s56 offen offset:3072 sc1
 s_add_u32 s56, s56, s9
 mf v,124,a,44,a,140
 s_waitcnt lgkmcnt(4)
 mf v,0,a,48,a,128
 tr a,40,135,4096
 mf v,16,a,48,a,132
 tr a,42,135,6144
 s_add_u32 m0, s53, 34816
 mf v,32,a,48,a,136
 buffer_load_dwordx4 v149, s[32:35], s62 offen lds
 mf v,48,a,48,a,140
 mf v,4,a,52,a,128
 tr a,44,136,4096
 mf v,20,a,52,a,132
 tr a,46,136,6144
 mf v,36,a,52,a,136
 buffer_load_dwordx4 v[236:239], v128, s[24:27], s57 offen offset:3072 sc1
 s_add_u32 s57, s57, s9
 mf v,52,a,52,a,140
 s_waitcnt lgkmcnt(4)
 mf v,8,a,56,a,128
 tr a,48,138,4096
 mf v,24,a,56,a,132
 tr a,50,138,6144
 s_add_u32 m0, s53, 35840
 mf v,40,a,56,a,136
 buffer_load_dwordx4 v150, s[32:35], s62 offen lds
 s_add_u32 s62, s62, 65536
 mf v,56,a,56,a,140
 mf v,12,a,60,a,128
 tr a,52,140,4096
 mf v,28,a,60,a,132
 tr a,54,140,6144
 mf v,44,a,60,a,136
 mf v,60,a,60,a,140
 s_waitcnt lgkmcnt(4)
f_g21:
 mf v,64,a,40,v,192
 tr a,56,151,4096
 mf v,80,a,40,v,196
 tr a,58,151,6144
 s_add_u32 m0, s53, 36864
 mf v,96,a,40,v,200
 buffer_load_dwordx4 v147, s[32:35], s62 offen lds
 mf v,112,a,40,v,204
 mf v,68,a,44,v,192
 tr a,60,152,4096
 mf v,84,a,44,v,196
 tr a,62,152,6144
 mf v,100,a,44,v,200
 mf v,116,a,44,v,204
 s_waitcnt lgkmcnt(4)
 mf v,72,a,48,v,192
 tr a,40,141,4096
 mf v,88,a,48,v,196
 tr a,42,141,6144
 s_add_u32 m0, s53, 37888
 mf v,104,a,48,v,200
 buffer_load_dwordx4 v148, s[32:35], s62 offen lds
 mf v,120,a,48,v,204
 mf v,76,a,52,v,192
 tr a,44,130,4096
 mf v,92,a,52,v,196
 tr a,46,130,6144
 mf v,108,a,52,v,200
 mf v,124,a,52,v,204
 s_waitcnt lgkmcnt(4)
 s_add_u32 m0, s53, 38912
 mf v,0,a,56,v,192
 buffer_load_dwordx4 v149, s[32:35], s62 offen lds
 mf v,16,a,56,v,196
 mf v,32,a,56,v,200
 mf v,48,a,56,v,204
 s_waitcnt vmcnt(36) lgkmcnt(0)
 s_barrier
 mf v,4,a,60,v,192
 tr a,48,135,8192
 mf v,20,a,60,v,196
 tr a,50,135,10240
 mf v,36,a,60,v,200
 tr a,52,136,8192
 mf v,52,a,60,v,204
 tr a,54,136,10240
 mf v,8,a,40,v,192
 tr a,56,138,8192
 mf v,24,a,40,v,196
 tr a,58,138,10240
 s_add_u32 m0, s53, 39936
 mf v,40,a,40,v,200
 buffer_load_dwordx4 v150, s[32:35], s62 offen lds
 s_add_u32 s62, s62, 65536
 mf v,56,a,40,v,204
 mf v,12,a,44,v,192
 tr a,60,140,8192
 mf v,28,a,44,v,196
 tr a,62,140,10240
 mf v,44,a,44,v,200
 mf v,60,a,44,v,204
 s_waitcnt lgkmcnt(4)
f_g22:
 s_waitcnt vmcnt(9)
 v_cmp_ne_u32 vcc, v144, v154
 s_cbranch_vccnz f_po
f_po_back:
 mf v,64,a,48,a,144
 tr a,40,151,8192
 mf v,80,a,48,a,148
 tr a,42,151,10240
 s_add_u32 m0, s53, 0
 mf v,96,a,48,a,152
 buffer_load_dwordx4 v147, s[32:35], s62 offen lds
 mf v,112,a,48,a,156
 mf v,68,a,52,a,144
 tr a,44,152,8192
 mf v,84,a,52,a,148
 tr a,46,152,10240
 mf v,100,a,52,a,152
 buffer_load_dwordx4 a[208:211], v128, s[24:27], s54 offen offset:0 sc1
 mf v,116,a,52,a,156
 s_waitcnt lgkmcnt(4)
 mf v,72,a,56,a,144
 tr a,48,141,8192
 mf v,88,a,56,a,148
 tr a,50,141,10240
 s_add_u32 m0, s53, 1024
 mf v,104,a,56,a,152
 buffer_load_dwordx4 v148, s[32:35], s62 offen lds
 mf v,120,a,56,a,156
 mf v,76,a,60,a,144
 tr a,52,130,8192
 mf v,92,a,60,a,148
 tr a,54,130,10240
 mf v,108,a,60,a,152
 buffer_load_dwordx4 a[212:215], v128, s[24:27], s55 offen offset:0 sc1
 mf v,124,a,60,a,156
 s_waitcnt lgkmcnt(4)
 mf v,0,a,40,a,144
 tr a,56,135,12288
 mf v,16,a,40,a,148
 tr a,58,135,14336
 s_add_u32 m0, s53, 2048
 mf v,32,a,40,a,152
 buffer_load_dwordx4 v149, s[32:35], s62 offen lds
 mf v,48,a,40,a,156
 mf v,4,a,44,a,144
 tr a,60,136,12288
 mf v,20,a,44,a,148
 tr a,62,136,14336
 mf v,36,a,44,a,152
 buffer_load_dwordx4 a[216:219], v128, s[24:27], s56 offen offset:0 sc1
 mf v,52,a,44,a,156
 s_waitcnt lgkmcnt(4)
 mf v,8,a,48,a,144
 tr a,40,138,12288
 mf v,24,a,48,a,148
 tr a,42,138,14336
 s_add_u32 m0, s53, 3072
 mf v,40,a,48,a,152
 buffer_load_dwordx4 v150, s[32:35], s62 offen lds
 s_add_u32 s62, s62, 65536
 mf v,56,a,48,a,156
 mf v,12,a,52,a,144
 tr a,44,140,12288
 mf v,28,a,52,a,148
 tr a,46,140,14336
 mf v,44,a,52,a,152
 buffer_load_dwordx4 a[220:223], v128, s[24:27], s57 offen offset:0 sc1
 mf v,60,a,52,a,156
 s_waitcnt lgkmcnt(4)
f_g23:
 mf v,64,a,56,a,160
 tr a,48,151,12288
 mf v,80,a,56,a,164
 tr a,50,151,14336
 s_add_u32 m0, s53, 4096
 mf v,96,a,56,a,168
 buffer_load_dwordx4 v147, s[32:35], s62 offen lds
 mf v,112,a,56,a,172
 mf v,68,a,60,a,160
 tr a,52,152,12288
 mf v,84,a,60,a,164
 tr a,54,152,14336
 mf v,100,a,60,a,168
 buffer_load_dwordx4 v[240:243], v128, s[24:27], s54 offen offset:1024 sc1
 mf v,116,a,60,a,172
 s_waitcnt lgkmcnt(4)
 mf v,72,a,40,a,160
 tr a,56,141,12288
 mf v,88,a,40,a,164
 tr a,58,141,14336
 s_add_u32 m0, s53, 5120
 mf v,104,a,40,a,168
 buffer_load_dwordx4 v148, s[32:35], s62 offen lds
 mf v,120,a,40,a,172
 mf v,76,a,44,a,160
 tr a,60,130,12288
 mf v,92,a,44,a,164
 tr a,62,130,14336
 mf v,108,a,44,a,168
 buffer_load_dwordx4 v[244:247], v128, s[24:27], s55 offen offset:1024 sc1
 mf v,124,a,44,a,172
 s_waitcnt lgkmcnt(4)
 s_add_u32 m0, s53, 6144
 mf v,0,a,48,a,160
 buffer_load_dwordx4 v149, s[32:35], s62 offen lds
 mf v,16,a,48,a,164
 mf v,32,a,48,a,168
 buffer_load_dwordx4 v[248:251], v128, s[24:27], s56 offen offset:1024 sc1
 mf v,48,a,48,a,172
 s_waitcnt lgkmcnt(0)
 s_barrier
 mf v,4,a,52,a,160
 tr a,40,135,16384
 mf v,20,a,52,a,164
 tr a,42,135,18432
 mf v,36,a,52,a,168
 tr a,44,136,16384
 mf v,52,a,52,a,172
 tr a,46,136,18432
 mf v,8,a,56,a,160
 tr a,48,138,16384
 mf v,24,a,56,a,164
 tr a,50,138,18432
 s_add_u32 m0, s53, 7168
 mf v,40,a,56,a,168
 buffer_load_dwordx4 v150, s[32:35], s62 offen lds
 s_add_u32 s62, s62, 65536
 mf v,56,a,56,a,172
 mf v,12,a,60,a,160
 tr a,52,140,16384
 mf v,28,a,60,a,164
 tr a,54,140,18432
 mf v,44,a,60,a,168
 buffer_load_dwordx4 v[252:255], v128, s[24:27], s57 offen offset:1024 sc1
 mf v,60,a,60,a,172
 s_waitcnt lgkmcnt(4)
f_g24:
f_p96:
 mf v,64,a,40,v,208
 tr a,56,151,16384
 mf v,80,a,40,v,212
 tr a,58,151,18432
 s_add_u32 m0, s53, 8192
 mf v,96,a,40,v,216
 buffer_load_dwordx4 v147, s[32:35], s62 offen lds
 mf v,112,a,40,v,220
 mf v,68,a,44,v,208
 tr a,60,152,16384
 mf v,84,a,44,v,212
 tr a,62,152,18432
 mf v,100,a,44,v,216
 buffer_load_dwordx4 a[224:227], v128, s[24:27], s54 offen offset:2048 sc1
 mf v,116,a,44,v,220
 s_waitcnt lgkmcnt(4)
 mf v,72,a,48,v,208
 tr a,40,141,16384
 mf v,88,a,48,v,212
 tr a,42,141,18432
 s_add_u32 m0, s53, 9216
 mf v,104,a,48,v,216
 buffer_load_dwordx4 v148, s[32:35], s62 offen lds
 mf v,120,a,48,v,220
 mf v,76,a,52,v,208
 tr a,44,130,16384
 mf v,92,a,52,v,212
 tr a,46,130,18432
 mf v,108,a,52,v,216
 buffer_load_dwordx4 a[228:231], v128, s[24:27], s55 offen offset:2048 sc1
 mf v,124,a,52,v,220
 s_waitcnt lgkmcnt(4)
 mf v,0,a,56,v,208
 tr a,48,135,20480
 mf v,16,a,56,v,212
 tr a,50,135,22528
 s_add_u32 m0, s53, 10240
 mf v,32,a,56,v,216
 buffer_load_dwordx4 v149, s[32:35], s62 offen lds
 mf v,48,a,56,v,220
 mf v,4,a,60,v,208
 tr a,52,136,20480
 mf v,20,a,60,v,212
 tr a,54,136,22528
 mf v,36,a,60,v,216
 buffer_load_dwordx4 a[232:235], v128, s[24:27], s56 offen offset:2048 sc1
 mf v,52,a,60,v,220
 s_waitcnt lgkmcnt(4)
 mf v,8,a,40,v,208
 tr a,56,138,20480
 mf v,24,a,40,v,212
 tr a,58,138,22528
 s_add_u32 m0, s53, 11264
 mf v,40,a,40,v,216
 buffer_load_dwordx4 v150, s[32:35], s62 offen lds
 s_add_u32 s62, s62, 65536
 mf v,56,a,40,v,220
 mf v,12,a,44,v,208
 tr a,60,140,20480
 mf v,28,a,44,v,212
 tr a,62,140,22528
 mf v,44,a,44,v,216
 buffer_load_dwordx4 a[236:239], v128, s[24:27], s57 offen offset:2048 sc1
 mf v,60,a,44,v,220
 s_waitcnt lgkmcnt(4)
f_g25:
 mf v,64,a,48,a,176
 tr a,40,151,20480
 mf v,80,a,48,a,180
 tr a,42,151,22528
 s_add_u32 m0, s53, 12288
 mf v,96,a,48,a,184
 buffer_load_dwordx4 v147, s[32:35], s62 offen lds
 mf v,112,a,48,a,188
 mf v,68,a,52,a,176
 tr a,44,152,20480
 mf v,84,a,52,a,180
 tr a,46,152,22528
 mf v,100,a,52,a,184
 buffer_load_dwordx4 a[240:243], v128, s[24:27], s54 offen offset:3072 sc1
 s_add_u32 s54, s54, 4096
 mf v,116,a,52,a,188
 s_waitcnt lgkmcnt(4)
 mf v,72,a,56,a,176
 tr a,48,141,20480
 mf v,88,a,56,a,180
 tr a,50,141,22528
 s_add_u32 m0, s53, 13312
 mf v,104,a,56,a,184
 buffer_load_dwordx4 v148, s[32:35], s62 offen lds
 mf v,120,a,56,a,188
 mf v,76,a,60,a,176
 tr a,52,130,20480
 mf v,92,a,60,a,180
 tr a,54,130,22528
 mf v,108,a,60,a,184
 buffer_load_dwordx4 a[244:247], v128, s[24:27], s55 offen offset:3072 sc1
 s_add_u32 s55, s55, 4096
 mf v,124,a,60,a,188
 s_waitcnt lgkmcnt(4)
 s_add_u32 m0, s53, 14336
 mf v,0,a,40,a,176
 buffer_load_dwordx4 v149, s[32:35], s62 offen lds
 mf v,16,a,40,a,180
 mf v,32,a,40,a,184
 buffer_load_dwordx4 a[248:251], v128, s[24:27], s56 offen offset:3072 sc1
 s_add_u32 s56, s56, 4096
 mf v,48,a,40,a,188
 s_waitcnt lgkmcnt(0)
 s_barrier
 mf v,4,a,44,a,176
 tr a,56,135,24576
 mf v,20,a,44,a,180
 tr a,58,135,26624
 mf v,36,a,44,a,184
 tr a,60,136,24576
 mf v,52,a,44,a,188
 tr a,62,136,26624
 mf v,8,a,48,a,176
 tr a,40,138,24576
 mf v,24,a,48,a,180
 tr a,42,138,26624
 s_add_u32 m0, s53, 15360
 mf v,40,a,48,a,184
 buffer_load_dwordx4 v150, s[32:35], s62 offen lds
 s_add_u32 s62, s62, 65536
 mf v,56,a,48,a,188
 mf v,12,a,52,a,176
 tr a,44,140,24576
 mf v,28,a,52,a,180
 tr a,46,140,26624
 mf v,44,a,52,a,184
 buffer_load_dwordx4 a[252:255], v128, s[24:27], s57 offen offset:3072 sc1
 s_add_u32 s57, s57, 4096
 mf v,60,a,52,a,188
 s_waitcnt lgkmcnt(4)
f_g26:
 mf v,64,a,56,a,192
 tr a,48,151,24576
 mf v,80,a,56,a,196
 tr a,50,151,26624
 s_add_u32 m0, s53, 16384
 mf v,96,a,56,a,200
 buffer_load_dwordx4 v147, s[32:35], s62 offen lds
 mf v,112,a,56,a,204
 mf v,68,a,60,a,192
 tr a,52,152,24576
 mf v,84,a,60,a,196
 tr a,54,152,26624
 mf v,100,a,60,a,200
 buffer_load_dwordx4 v[160:163], v128, s[24:27], s54 offen offset:0 sc1
 mf v,116,a,60,a,204
 s_waitcnt lgkmcnt(4)
 mf v,72,a,40,a,192
 tr a,56,141,24576
 mf v,88,a,40,a,196
 tr a,58,141,26624
 s_add_u32 m0, s53, 17408
 mf v,104,a,40,a,200
 buffer_load_dwordx4 v148, s[32:35], s62 offen lds
 mf v,120,a,40,a,204
 mf v,76,a,44,a,192
 tr a,60,130,24576
 mf v,92,a,44,a,196
 tr a,62,130,26624
 mf v,108,a,44,a,200
 buffer_load_dwordx4 v[164:167], v128, s[24:27], s55 offen offset:0 sc1
 mf v,124,a,44,a,204
 s_waitcnt lgkmcnt(4)
 mf v,0,a,48,a,192
 tr a,40,135,28672
 mf v,16,a,48,a,196
 tr a,42,135,30720
 s_add_u32 m0, s53, 18432
 mf v,32,a,48,a,200
 buffer_load_dwordx4 v149, s[32:35], s62 offen lds
 mf v,48,a,48,a,204
 mf v,4,a,52,a,192
 tr a,44,136,28672
 mf v,20,a,52,a,196
 tr a,46,136,30720
 mf v,36,a,52,a,200
 buffer_load_dwordx4 v[168:171], v128, s[24:27], s56 offen offset:0 sc1
 mf v,52,a,52,a,204
 s_waitcnt lgkmcnt(4)
 mf v,8,a,56,a,192
 tr a,48,138,28672
 mf v,24,a,56,a,196
 tr a,50,138,30720
 s_add_u32 m0, s53, 19456
 mf v,40,a,56,a,200
 buffer_load_dwordx4 v150, s[32:35], s62 offen lds
 s_add_u32 s62, s62, 65536
 mf v,56,a,56,a,204
 mf v,12,a,60,a,192
 tr a,52,140,28672
 mf v,28,a,60,a,196
 tr a,54,140,30720
 mf v,44,a,60,a,200
 buffer_load_dwordx4 v[172:175], v128, s[24:27], s57 offen offset:0 sc1
 mf v,60,a,60,a,204
 s_waitcnt vmcnt(45) lgkmcnt(4)
f_g27:
 mf v,64,a,40,v,224
 tr a,56,151,28672
 mf v,80,a,40,v,228
 tr a,58,151,30720
 s_add_u32 m0, s53, 20480
 mf v,96,a,40,v,232
 buffer_load_dwordx4 v147, s[32:35], s62 offen lds
 mf v,112,a,40,v,236
 mf v,68,a,44,v,224
 tr a,60,152,28672
 mf v,84,a,44,v,228
 tr a,62,152,30720
 mf v,100,a,44,v,232
 buffer_load_dwordx4 a[96:99], v128, s[24:27], s54 offen offset:1024 sc1
 mf v,116,a,44,v,236
 s_waitcnt lgkmcnt(4)
 mf v,72,a,48,v,224
 tr a,40,141,28672
 mf v,88,a,48,v,228
 tr a,42,141,30720
 s_add_u32 m0, s53, 21504
 mf v,104,a,48,v,232
 buffer_load_dwordx4 v148, s[32:35], s62 offen lds
 mf v,120,a,48,v,236
 mf v,76,a,52,v,224
 tr a,44,130,28672
 mf v,92,a,52,v,228
 tr a,46,130,30720
 mf v,108,a,52,v,232
 buffer_load_dwordx4 a[100:103], v128, s[24:27], s55 offen offset:1024 sc1
 mf v,124,a,52,v,236
 s_waitcnt lgkmcnt(4)
 s_add_u32 m0, s53, 22528
 mf v,0,a,56,v,224
 buffer_load_dwordx4 v149, s[32:35], s62 offen lds
 mf v,16,a,56,v,228
 mf v,32,a,56,v,232
 buffer_load_dwordx4 a[104:107], v128, s[24:27], s56 offen offset:1024 sc1
 mf v,48,a,56,v,236
 s_waitcnt vmcnt(46) lgkmcnt(0)
 s_barrier
 mf v,4,a,60,v,224
 tr a,48,135,32768
 mf v,20,a,60,v,228
 tr a,50,135,34816
 mf v,36,a,60,v,232
 tr a,52,136,32768
 mf v,52,a,60,v,236
 tr a,54,136,34816
 mf v,8,a,40,v,224
 tr a,56,138,32768
 mf v,24,a,40,v,228
 tr a,58,138,34816
 s_add_u32 m0, s53, 23552
 mf v,40,a,40,v,232
 buffer_load_dwordx4 v150, s[32:35], s62 offen lds
 mf v,56,a,40,v,236
 mf v,12,a,44,v,224
 tr a,60,140,32768
 mf v,28,a,44,v,228
 tr a,62,140,34816
 mf v,44,a,44,v,232
 buffer_load_dwordx4 a[108:111], v128, s[24:27], s57 offen offset:1024 sc1
 mf v,60,a,44,v,236
 s_waitcnt vmcnt(40) lgkmcnt(4)
f_o0:
 mf v,64,a,48,a,208
 tr a,40,135,36864
 mf v,80,a,48,a,212
 tr a,42,135,38912
 mf v,96,a,48,a,216
 buffer_load_dwordx4 a[112:115], v128, s[24:27], s54 offen offset:2048 sc1
 mf v,112,a,48,a,220
 mf v,68,a,52,a,208
 tr a,44,136,36864
 mf v,84,a,52,a,212
 tr a,46,136,38912
 mf v,100,a,52,a,216
 buffer_load_dwordx4 a[116:119], v128, s[24:27], s55 offen offset:2048 sc1
 mf v,116,a,52,a,220
 s_waitcnt lgkmcnt(4)
f_o1:
 mf v,72,a,56,a,208
 tr a,48,138,36864
 mf v,88,a,56,a,212
 tr a,50,138,38912
 mf v,104,a,56,a,216
 buffer_load_dwordx4 a[120:123], v128, s[24:27], s56 offen offset:2048 sc1
 mf v,120,a,56,a,220
 mf v,76,a,60,a,208
 tr a,52,140,36864
 mf v,92,a,60,a,212
 tr a,54,140,38912
 mf v,108,a,60,a,216
 buffer_load_dwordx4 a[124:127], v128, s[24:27], s57 offen offset:2048 sc1
 mf v,124,a,60,a,220
 s_waitcnt vmcnt(36) lgkmcnt(4)
f_o2:
 mf v,64,a,40,v,240
 buffer_load_dwordx4 v[176:179], v128, s[24:27], s54 offen offset:3072 sc1
 mf v,80,a,40,v,244
 mf v,96,a,40,v,248
 buffer_load_dwordx4 v[180:183], v128, s[24:27], s55 offen offset:3072 sc1
 mf v,112,a,40,v,252
 s_waitcnt lgkmcnt(0)
 s_barrier
 mf v,68,a,44,v,240
 tr a,56,135,0
 mf v,84,a,44,v,244
 tr a,58,135,2048
 mf v,100,a,44,v,248
 tr a,60,136,0
 mf v,116,a,44,v,252
 tr a,62,136,2048
f_o3:
 mf v,72,a,48,v,240
 tr a,40,138,0
 mf v,88,a,48,v,244
 tr a,42,138,2048
 mf v,104,a,48,v,248
 buffer_load_dwordx4 v[184:187], v128, s[24:27], s56 offen offset:3072 sc1
 mf v,120,a,48,v,252
 mf v,76,a,52,v,240
 tr a,44,140,0
 mf v,92,a,52,v,244
 tr a,46,140,2048
 mf v,108,a,52,v,248
 buffer_load_dwordx4 v[188:191], v128, s[24:27], s57 offen offset:3072 sc1
 mf v,124,a,52,v,252
 s_waitcnt vmcnt(32) lgkmcnt(4)
f_o4:
 mf v,64,a,56,a,224
 tr a,48,135,4096
 mf v,80,a,56,a,228
 tr a,50,135,6144
 mf v,96,a,56,a,232
 buffer_load_dwordx4 v[192:195], v153, s[40:43], s6 offen offset:0
 mf v,112,a,56,a,236
 mf v,68,a,60,a,224
 tr a,52,136,4096
 mf v,84,a,60,a,228
 tr a,54,136,6144
 mf v,100,a,60,a,232
 buffer_load_dwordx4 v[196:199], v153, s[40:43], s6 offen offset:64
 mf v,116,a,60,a,236
 s_waitcnt lgkmcnt(4)
f_o5:
 mf v,72,a,40,a,224
 tr a,56,138,4096
 mf v,88,a,40,a,228
 tr a,58,138,6144
 mf v,104,a,40,a,232
 buffer_load_dwordx4 v[200:203], v153, s[40:43], s7 offen offset:0
 mf v,120,a,40,a,236
 mf v,76,a,44,a,224
 tr a,60,140,4096
 mf v,92,a,44,a,228
 tr a,62,140,6144
 mf v,108,a,44,a,232
 buffer_load_dwordx4 v[204:207], v153, s[40:43], s7 offen offset:64
 mf v,124,a,44,a,236
 s_waitcnt vmcnt(28) lgkmcnt(4)
f_o6:
 mf v,64,a,48,a,240
 mf v,80,a,48,a,244
 mf v,96,a,48,a,248
 mf v,112,a,48,a,252
 s_waitcnt lgkmcnt(0)
 s_barrier
 mf v,68,a,52,a,240
 tr a,40,135,8192
 mf v,84,a,52,a,244
 tr a,42,135,10240
 mf v,100,a,52,a,248
 tr a,44,136,8192
 mf v,116,a,52,a,252
 tr a,46,136,10240
f_o7:
 mf v,72,a,56,a,240
 tr a,48,138,8192
 mf v,88,a,56,a,244
 tr a,50,138,10240
 mf v,104,a,56,a,248
 mf v,120,a,56,a,252
 mf v,76,a,60,a,240
 tr a,52,140,8192
 mf v,92,a,60,a,244
 tr a,54,140,10240
 mf v,108,a,60,a,248
 mf v,124,a,60,a,252
 s_waitcnt vmcnt(20) lgkmcnt(4)
f_o8:
 mf v,64,a,40,v,160
 tr a,56,135,12288
 mf v,80,a,40,v,164
 tr a,58,135,14336
 mf v,96,a,40,v,168
 mf v,112,a,40,v,172
 mf v,68,a,44,v,160
 tr a,60,136,12288
 mf v,84,a,44,v,164
 tr a,62,136,14336
 mf v,100,a,44,v,168
 mf v,116,a,44,v,172
 s_waitcnt lgkmcnt(4)
f_o9:
 mf v,72,a,48,v,160
 tr a,40,138,12288
 mf v,88,a,48,v,164
 tr a,42,138,14336
 mf v,104,a,48,v,168
 mf v,120,a,48,v,172
 mf v,76,a,52,v,160
 tr a,44,140,12288
 mf v,92,a,52,v,164
 tr a,46,140,14336
 mf v,108,a,52,v,168
 mf v,124,a,52,v,172
 s_waitcnt vmcnt(12) lgkmcnt(4)
f_o10:
 mf v,64,a,56,a,96
 mf v,80,a,56,a,100
 mf v,96,a,56,a,104
 mf v,112,a,56,a,108
 s_waitcnt lgkmcnt(0)
 s_barrier
 mf v,68,a,60,a,96
 tr a,48,135,16384
 mf v,84,a,60,a,100
 tr a,50,135,18432
 mf v,100,a,60,a,104
 tr a,52,136,16384
 mf v,116,a,60,a,108
 tr a,54,136,18432
f_o11:
 mf v,72,a,40,a,96
 tr a,56,138,16384
 mf v,88,a,40,a,100
 tr a,58,138,18432
 mf v,104,a,40,a,104
 mf v,120,a,40,a,108
 mf v,76,a,44,a,96
 tr a,60,140,16384
 mf v,92,a,44,a,100
 tr a,62,140,18432
 mf v,108,a,44,a,104
 mf v,124,a,44,a,108
 s_waitcnt vmcnt(8) lgkmcnt(4)
f_o12:
 mf v,64,a,48,a,112
 tr a,40,135,20480
 mf v,80,a,48,a,116
 tr a,42,135,22528
 mf v,96,a,48,a,120
 mf v,112,a,48,a,124
 mf v,68,a,52,a,112
 tr a,44,136,20480
 mf v,84,a,52,a,116
 tr a,46,136,22528
 mf v,100,a,52,a,120
 mf v,116,a,52,a,124
 s_waitcnt lgkmcnt(4)
f_o13:
 mf v,72,a,56,a,112
 tr a,48,138,20480
 mf v,88,a,56,a,116
 tr a,50,138,22528
 mf v,104,a,56,a,120
 mf v,120,a,56,a,124
 mf v,76,a,60,a,112
 tr a,52,140,20480
 mf v,92,a,60,a,116
 tr a,54,140,22528
 mf v,108,a,60,a,120
 mf v,124,a,60,a,124
 s_waitcnt vmcnt(4) lgkmcnt(4)
f_o14:
 mf v,96,a,40,v,184
 tr a,56,151,32768
 mf v,112,a,40,v,188
 tr a,58,151,34816
 mf v,64,a,40,v,176
 mf v,80,a,40,v,180
 mf v,100,a,44,v,184
 tr a,60,152,32768
 mf v,116,a,44,v,188
 tr a,62,152,34816
 mf v,68,a,44,v,176
 mf v,84,a,44,v,180
 s_waitcnt lgkmcnt(4)
f_o15:
 mf v,104,a,48,v,184
 tr a,40,151,36864
 mf v,120,a,48,v,188
 tr a,42,151,38912
 mf v,72,a,48,v,176
 ds_write_b128 v137, v[96:99] offset:24576
 mf v,88,a,48,v,180
 ds_write_b128 v137, v[112:115] offset:28672
 mf v,108,a,52,v,184
 tr a,44,152,36864
 mf v,124,a,52,v,188
 tr a,46,152,38912
 mf v,76,a,52,v,176
 ds_write_b128 v137, v[100:103] offset:25600
 mf v,92,a,52,v,180
 s_waitcnt lgkmcnt(7)
 ds_write_b128 v137, v[116:119] offset:29696
f_own:
f_o16:
 mf v,0,a,56,a,208
 tr a,48,151,0
 mf v,16,a,56,a,212
 tr a,50,151,2048
 ds_write_b128 v137, v[104:107] offset:26624
 mf v,32,a,56,a,216
 ds_write_b128 v137, v[120:123] offset:30720
 ds_write_b128 v137, v[108:111] offset:27648
 mf v,48,a,56,a,220
 ds_write_b128 v137, v[124:127] offset:31744
 s_waitcnt lgkmcnt(0)
 s_barrier
 mf v,4,a,60,a,208
 tr a,52,152,0
 ds_read_b128 v[96:99], v132 offset:24576
 mf v,20,a,60,a,212
 tr a,54,152,2048
 ds_read_b128 v[100:103], v132 offset:25600
 mf v,36,a,60,a,216
 ds_read_b128 v[104:107], v132 offset:26624
 ds_read_b128 v[108:111], v132 offset:27648
 mf v,52,a,60,a,220
 ds_read_b128 v[112:115], v132 offset:28672
 ds_read_b128 v[116:119], v132 offset:29696
f_o17:
 mf v,0,a,40,v,240
 tr a,56,151,4096
 ds_read_b128 v[120:123], v132 offset:30720
 mf v,16,a,40,v,244
 tr a,58,151,6144
 ds_read_b128 v[124:127], v132 offset:31744
 s_waitcnt lgkmcnt(10)
 mf v,32,a,40,v,248
 v_add_f32 v64, v64, v96
 v_add_f32 v65, v65, v97
 v_cvt_pk_bf16_f32 v64, v64, v65
 v_add_f32 v66, v66, v98
 mf v,48,a,40,v,252
 v_add_f32 v67, v67, v99
 v_cvt_pk_bf16_f32 v65, v66, v67
 s_waitcnt lgkmcnt(8)
 v_add_f32 v68, v68, v100
 mf v,4,a,44,v,240
 tr a,60,152,4096
 v_add_f32 v69, v69, v101
 v_mov_b32 v67, v144
 v_cvt_pk_bf16_f32 v66, v68, v69
 mf v,20,a,44,v,244
 tr a,62,152,6144
 buffer_store_dwordx4 v[64:67], v128, s[24:27], s58 offen offset:0 sc1
 v_add_f32 v70, v70, v102
 mf v,36,a,44,v,248
 v_add_f32 v71, v71, v103
 v_cvt_pk_bf16_f32 v68, v70, v71
 s_waitcnt lgkmcnt(9)
 v_add_f32 v72, v72, v104
 mf v,52,a,44,v,252
 v_add_f32 v73, v73, v105
 v_cvt_pk_bf16_f32 v69, v72, v73
 v_add_f32 v74, v74, v106
 v_add_f32 v75, v75, v107
f_o18:
 mf v,0,a,48,a,224
 tr a,40,151,8192
 v_mov_b32 v71, v144
 v_cvt_pk_bf16_f32 v70, v74, v75
 mf v,16,a,48,a,228
 tr a,42,151,10240
 buffer_store_dwordx4 v[68:71], v128, s[24:27], s58 offen offset:1024 sc1
 s_waitcnt lgkmcnt(10)
 mf v,32,a,48,a,232
 v_add_f32 v76, v76, v108
 v_add_f32 v77, v77, v109
 v_cvt_pk_bf16_f32 v72, v76, v77
 v_add_f32 v78, v78, v110
 mf v,48,a,48,a,236
 v_add_f32 v79, v79, v111
 v_cvt_pk_bf16_f32 v73, v78, v79
 s_waitcnt lgkmcnt(9)
 v_add_f32 v80, v80, v112
 mf v,4,a,52,a,224
 tr a,44,152,8192
 v_add_f32 v81, v81, v113
 v_mov_b32 v75, v144
 v_cvt_pk_bf16_f32 v74, v80, v81
 mf v,20,a,52,a,228
 tr a,46,152,10240
 buffer_store_dwordx4 v[72:75], v128, s[24:27], s58 offen offset:2048 sc1
 v_add_f32 v82, v82, v114
 mf v,36,a,52,a,232
 v_add_f32 v83, v83, v115
 v_cvt_pk_bf16_f32 v76, v82, v83
 s_waitcnt lgkmcnt(10)
 v_add_f32 v84, v84, v116
 mf v,52,a,52,a,236
 s_waitcnt lgkmcnt(4)
 v_add_f32 v85, v85, v117
 v_cvt_pk_bf16_f32 v77, v84, v85
 v_add_f32 v86, v86, v118
 v_add_f32 v87, v87, v119
f_o19:
 mf v,0,a,56,a,240
 tr a,48,151,12288
 v_mov_b32 v79, v144
 v_cvt_pk_bf16_f32 v78, v86, v87
 mf v,16,a,56,a,244
 tr a,50,151,14336
 buffer_store_dwordx4 v[76:79], v128, s[24:27], s58 offen offset:3072 sc1
 mf v,32,a,56,a,248
 v_add_f32 v88, v88, v120
 v_add_f32 v89, v89, v121
 v_cvt_pk_bf16_f32 v80, v88, v89
 v_add_f32 v90, v90, v122
 mf v,48,a,56,a,252
 v_add_f32 v91, v91, v123
 v_cvt_pk_bf16_f32 v81, v90, v91
 v_add_f32 v92, v92, v124
 mf v,4,a,60,a,240
 tr a,52,152,12288
 v_add_f32 v93, v93, v125
 v_mov_b32 v83, v144
 v_cvt_pk_bf16_f32 v82, v92, v93
 mf v,20,a,60,a,244
 tr a,54,152,14336
 buffer_store_dwordx4 v[80:83], v128, s[24:27], s59 offen offset:0 sc1
 v_add_f32 v94, v94, v126
 mf v,36,a,60,a,248
 v_add_f32 v95, v95, v127
 v_mov_b32 v85, v144
 v_cvt_pk_bf16_f32 v84, v94, v95
 mf v,52,a,60,a,252
 s_waitcnt lgkmcnt(4)
 buffer_store_dwordx2 v[84:85], v128, s[24:27], s59 offen offset:1024 sc1
 s_barrier
 s_waitcnt vmcnt(6)
f_o20:
 mf v,0,a,40,v,160
 tr a,56,151,16384
 s_mov_b32 s10, 0xffff0000
 v_permlane16_swap_b32 v192, v194
 v_permlane16_swap_b32 v193, v195
 mf v,16,a,40,v,164
 tr a,58,151,18432
 v_permlane16_swap_b32 v196, v198
 v_permlane16_swap_b32 v197, v199
 v_permlane16_swap_b32 v200, v202
 mf v,32,a,40,v,168
 v_permlane16_swap_b32 v201, v203
 v_permlane16_swap_b32 v204, v206
 v_permlane16_swap_b32 v205, v207
 v_lshlrev_b32 v96, 16, v192
 mf v,48,a,40,v,172
 v_and_b32 v97, s10, v192
 v_lshlrev_b32 v98, 16, v193
 v_and_b32 v99, s10, v193
 v_lshlrev_b32 v100, 16, v194
 mf v,4,a,44,v,160
 tr a,60,152,16384
 v_and_b32 v101, s10, v194
 v_lshlrev_b32 v102, 16, v195
 v_and_b32 v103, s10, v195
 mf v,20,a,44,v,164
 tr a,62,152,18432
 v_lshlrev_b32 v104, 16, v196
 v_and_b32 v105, s10, v196
 v_lshlrev_b32 v106, 16, v197
 mf v,36,a,44,v,168
 v_and_b32 v107, s10, v197
 v_lshlrev_b32 v108, 16, v198
 v_and_b32 v109, s10, v198
 v_lshlrev_b32 v110, 16, v199
 mf v,52,a,44,v,172
 s_waitcnt lgkmcnt(4)
 v_and_b32 v111, s10, v199
 v_lshlrev_b32 v112, 16, v200
 v_and_b32 v113, s10, v200
 v_lshlrev_b32 v114, 16, v201
f_o21:
 mf v,0,a,48,a,96
 tr a,40,151,20480
 v_and_b32 v115, s10, v201
 mf v,16,a,48,a,100
 tr a,42,151,22528
 v_lshlrev_b32 v116, 16, v202
 mf v,32,a,48,a,104
 v_and_b32 v117, s10, v202
 v_lshlrev_b32 v118, 16, v203
 mf v,48,a,48,a,108
 v_and_b32 v119, s10, v203
 v_lshlrev_b32 v120, 16, v204
 mf v,4,a,52,a,96
 tr a,44,152,20480
 v_and_b32 v121, s10, v204
 mf v,20,a,52,a,100
 tr a,46,152,22528
 v_lshlrev_b32 v122, 16, v205
 mf v,36,a,52,a,104
 v_and_b32 v123, s10, v205
 v_lshlrev_b32 v124, 16, v206
 mf v,52,a,52,a,108
 s_waitcnt lgkmcnt(4)
 v_and_b32 v125, s10, v206
 v_lshlrev_b32 v126, 16, v207
f_o22:
 mf v,0,a,56,a,112
 tr a,48,141,32768
 v_and_b32 v127, s10, v207
 mf v,16,a,56,a,116
 tr a,50,141,34816
 mf v,32,a,56,a,120
 mf v,48,a,56,a,124
 mf v,4,a,60,a,112
 tr a,52,130,32768
 mf v,20,a,60,a,116
 tr a,54,130,34816
 mf v,36,a,60,a,120
 mf v,52,a,60,a,124
 s_waitcnt lgkmcnt(4)
f_o23:
 mf v,32,a,40,v,184
 tr a,56,141,36864
 mf v,48,a,40,v,188
 tr a,58,141,38912
 mf v,0,a,40,v,176
 mf v,16,a,40,v,180
 mf v,36,a,44,v,184
 tr a,60,130,36864
 mf v,52,a,44,v,188
 tr a,62,130,38912
 mf v,4,a,44,v,176
 mf v,20,a,44,v,180
 s_waitcnt lgkmcnt(4)
f_o24:
 mf v,8,a,48,a,208
 tr a,40,141,0
 mf v,24,a,48,a,212
 tr a,42,141,2048
 mf v,40,a,48,a,216
 ds_write_b128 v137, v[32:35] offset:24576
 mf v,56,a,48,a,220
 ds_write_b128 v137, v[48:51] offset:28672
 mf v,12,a,52,a,208
 tr a,44,130,0
 mf v,28,a,52,a,212
 tr a,46,130,2048
 mf v,44,a,52,a,216
 ds_write_b128 v137, v[36:39] offset:25600
 mf v,60,a,52,a,220
 s_waitcnt lgkmcnt(7)
 ds_write_b128 v137, v[52:55] offset:29696
f_o25:
 mf v,8,a,56,v,240
 tr a,48,141,4096
 v_add_f32 v0, v0, v96
 mf v,24,a,56,v,244
 tr a,50,141,6144
 v_add_f32 v1, v1, v97
 mf v,40,a,56,v,248
 v_add_f32 v2, v2, v98
 v_add_f32 v3, v3, v99
 mf v,56,a,56,v,252
 v_add_f32 v4, v4, v100
 v_add_f32 v5, v5, v101
 mf v,12,a,60,v,240
 tr a,52,130,4096
 v_add_f32 v6, v6, v102
 mf v,28,a,60,v,244
 tr a,54,130,6144
 v_add_f32 v7, v7, v103
 mf v,44,a,60,v,248
 s_waitcnt lgkmcnt(4)
 s_barrier
 mf v,60,a,60,v,252
 ds_read_b128 v[32:35], v132 offset:24576
f_o26:
 mf v,8,a,40,a,224
 tr a,56,141,8192
 mf v,24,a,40,a,228
 tr a,58,141,10240
 mf v,40,a,40,a,232
 ds_read_b128 v[36:39], v132 offset:25600
 mf v,56,a,40,a,236
 ds_read_b128 v[48:51], v132 offset:28672
 mf v,12,a,44,a,224
 tr a,60,130,8192
 mf v,28,a,44,a,228
 tr a,62,130,10240
 mf v,44,a,44,a,232
 ds_read_b128 v[52:55], v132 offset:29696
 v_add_f32 v16, v16, v112
 mf v,60,a,44,a,236
 s_waitcnt lgkmcnt(8)
 v_add_f32 v17, v17, v113
 v_add_f32 v18, v18, v114
f_o27:
 mf v,8,a,48,a,240
 tr a,40,141,12288
 v_add_f32 v19, v19, v115
 mf v,24,a,48,a,244
 tr a,42,141,14336
 v_add_f32 v20, v20, v116
 mf v,40,a,48,a,248
 v_add_f32 v21, v21, v117
 v_add_f32 v22, v22, v118
 mf v,56,a,48,a,252
 v_add_f32 v23, v23, v119
 s_waitcnt lgkmcnt(9)
 mf v,12,a,52,a,240
 tr a,44,130,12288
 v_add_f32 v0, v0, v32
 mf v,28,a,52,a,244
 tr a,46,130,14336
 v_add_f32 v1, v1, v33
 mf v,44,a,52,a,248
 v_add_f32 v2, v2, v34
 v_add_f32 v3, v3, v35
 mf v,60,a,52,a,252
 s_waitcnt lgkmcnt(5)
 v_add_f32 v4, v4, v36
f_o28:
 mf v,8,a,56,v,160
 tr a,48,141,16384
 v_add_f32 v5, v5, v37
 mf v,24,a,56,v,164
 tr a,50,141,18432
 v_add_f32 v6, v6, v38
 mf v,40,a,56,v,168
 buffer_load_dwordx4 v[208:211], v128, s[24:27], s60 offen offset:0 sc1
 v_add_f32 v7, v7, v39
 mf v,56,a,56,v,172
 v_add_f32 v16, v16, v48
 v_add_f32 v17, v17, v49
 mf v,12,a,60,v,160
 tr a,52,130,16384
 v_add_f32 v18, v18, v50
 mf v,28,a,60,v,164
 tr a,54,130,18432
 v_add_f32 v19, v19, v51
 mf v,44,a,60,v,168
 buffer_load_dwordx4 v[212:215], v128, s[24:27], s60 offen offset:1024 sc1
 s_waitcnt lgkmcnt(8)
 mf v,60,a,60,v,172
 s_waitcnt lgkmcnt(4)
 v_add_f32 v20, v20, v52
 v_add_f32 v21, v21, v53
f_o29:
 mf v,8,a,40,a,96
 tr a,56,141,20480
 v_add_f32 v22, v22, v54
 mf v,24,a,40,a,100
 tr a,58,141,22528
 v_add_f32 v23, v23, v55
 mf v,40,a,40,a,104
 buffer_load_dwordx4 v[216:219], v128, s[24:27], s60 offen offset:2048 sc1
 mf v,56,a,40,a,108
 mf v,12,a,44,a,96
 tr a,60,130,20480
 mf v,28,a,44,a,100
 tr a,62,130,22528
 mf v,44,a,44,a,104
 buffer_load_dwordx4 v[220:223], v128, s[24:27], s60 offen offset:3072 sc1
 mf v,60,a,44,a,108
 s_waitcnt lgkmcnt(4)
f_o30:
 mf v,8,a,48,a,112
 mf v,24,a,48,a,116
 mf v,40,a,48,a,120
 buffer_load_dwordx4 v[224:227], v128, s[24:27], s61 offen offset:0 sc1
 mf v,56,a,48,a,124
 mf v,12,a,52,a,112
 mf v,28,a,52,a,116
 mf v,44,a,52,a,120
 buffer_load_dwordx2 v[228:229], v128, s[24:27], s61 offen offset:1024 sc1
 mf v,60,a,52,a,124
 s_waitcnt lgkmcnt(0)
f_o31:
 mf v,40,a,56,v,184
 mf v,56,a,56,v,188
 mf v,8,a,56,v,176
 mf v,24,a,56,v,180
 mf v,44,a,60,v,184
 mf v,60,a,60,v,188
 mf v,12,a,60,v,176
 mf v,28,a,60,v,180
 s_mov_b32 s69, 0
 ds_write_b128 v137, v[40:43] offset:26624
 ds_write_b128 v137, v[56:59] offset:30720
 s_nop 2
 ds_write_b128 v137, v[44:47] offset:27648
 ds_write_b128 v137, v[60:63] offset:31744
f_lm:
 v_pk_add_f32 v[8:9], v[8:9], v[104:105]
 v_pk_add_f32 v[10:11], v[10:11], v[106:107]
 v_pk_add_f32 v[24:25], v[24:25], v[120:121]
 v_pk_add_f32 v[26:27], v[26:27], v[122:123]
 v_pk_add_f32 v[12:13], v[12:13], v[108:109]
 v_pk_add_f32 v[14:15], v[14:15], v[110:111]
 v_pk_add_f32 v[28:29], v[28:29], v[124:125]
 v_pk_add_f32 v[30:31], v[30:31], v[126:127]
 s_waitcnt lgkmcnt(0)
 s_barrier
 ds_read_b128 v[40:43], v132 offset:26624
 ds_read_b128 v[44:47], v132 offset:27648
 ds_read_b128 v[56:59], v132 offset:30720
 ds_read_b128 v[60:63], v132 offset:31744
f_xa:
f_x1:
 s_waitcnt vmcnt(0)
 v_min3_u32 v64, v211, v215, v144
 v_max3_u32 v65, v211, v215, v144
 v_min3_u32 v64, v219, v223, v64
 v_max3_u32 v65, v219, v223, v65
 v_min3_u32 v64, v227, v229, v64
 v_max3_u32 v65, v227, v229, v65
 v_cmp_ne_u32 vcc, v64, v65
 s_cbranch_vccnz f_x0
f_x2:
 v_lshlrev_b32 v64, 16, v208
 v_and_b32 v65, s10, v208
 v_lshlrev_b32 v66, 16, v209
 v_and_b32 v67, s10, v209
 v_lshlrev_b32 v68, 16, v210
 v_and_b32 v69, s10, v210
 v_lshlrev_b32 v70, 16, v212
 v_and_b32 v71, s10, v212
 v_pk_add_f32 v[0:1], v[0:1], v[64:65]
 v_pk_add_f32 v[2:3], v[2:3], v[66:67]
 v_pk_add_f32 v[4:5], v[4:5], v[68:69]
 v_pk_add_f32 v[6:7], v[6:7], v[70:71]
 v_cvt_pk_bf16_f32 v72, v0, v1
 v_cvt_pk_bf16_f32 v74, v4, v5
 v_cvt_pk_bf16_f32 v73, v2, v3
 v_cvt_pk_bf16_f32 v75, v6, v7
 v_permlane16_swap_b32 v72, v74
 s_nop 0
 v_permlane16_swap_b32 v73, v75
 buffer_store_dwordx4 v[72:75], v153, s[20:23], s6 offen offset:0 sc1
 v_lshlrev_b32 v64, 16, v218
 v_and_b32 v65, s10, v218
 v_lshlrev_b32 v66, 16, v220
 v_and_b32 v67, s10, v220
 v_lshlrev_b32 v68, 16, v221
 v_and_b32 v69, s10, v221
 v_lshlrev_b32 v70, 16, v222
 v_and_b32 v71, s10, v222
 v_pk_add_f32 v[16:17], v[16:17], v[64:65]
 v_pk_add_f32 v[18:19], v[18:19], v[66:67]
 v_pk_add_f32 v[20:21], v[20:21], v[68:69]
 v_pk_add_f32 v[22:23], v[22:23], v[70:71]
 v_cvt_pk_bf16_f32 v80, v16, v17
 v_cvt_pk_bf16_f32 v82, v20, v21
 v_cvt_pk_bf16_f32 v81, v18, v19
 v_cvt_pk_bf16_f32 v83, v22, v23
 v_permlane16_swap_b32 v80, v82
 s_nop 0
 v_permlane16_swap_b32 v81, v83
 buffer_store_dwordx4 v[80:83], v153, s[20:23], s7 offen offset:0 sc1
 v_lshlrev_b32 v64, 16, v213
 v_and_b32 v65, s10, v213
 v_lshlrev_b32 v66, 16, v214
 v_and_b32 v67, s10, v214
 v_lshlrev_b32 v68, 16, v216
 v_and_b32 v69, s10, v216
 v_lshlrev_b32 v70, 16, v217
 v_and_b32 v71, s10, v217
 v_pk_add_f32 v[8:9], v[8:9], v[64:65]
 v_pk_add_f32 v[10:11], v[10:11], v[66:67]
 v_pk_add_f32 v[12:13], v[12:13], v[68:69]
 v_pk_add_f32 v[14:15], v[14:15], v[70:71]
 s_waitcnt lgkmcnt(2)
 v_pk_add_f32 v[8:9], v[8:9], v[40:41]
 v_pk_add_f32 v[10:11], v[10:11], v[42:43]
 v_pk_add_f32 v[12:13], v[12:13], v[44:45]
 v_pk_add_f32 v[14:15], v[14:15], v[46:47]
 v_cvt_pk_bf16_f32 v76, v8, v9
 v_cvt_pk_bf16_f32 v78, v12, v13
 v_cvt_pk_bf16_f32 v77, v10, v11
 v_cvt_pk_bf16_f32 v79, v14, v15
 v_permlane16_swap_b32 v76, v78
 s_nop 0
 v_permlane16_swap_b32 v77, v79
 buffer_store_dwordx4 v[76:79], v153, s[20:23], s6 offen offset:64 sc1
 v_lshlrev_b32 v64, 16, v224
 v_and_b32 v65, s10, v224
 v_lshlrev_b32 v66, 16, v225
 v_and_b32 v67, s10, v225
 v_lshlrev_b32 v68, 16, v226
 v_and_b32 v69, s10, v226
 v_lshlrev_b32 v70, 16, v228
 v_and_b32 v71, s10, v228
 v_pk_add_f32 v[24:25], v[24:25], v[64:65]
 v_pk_add_f32 v[26:27], v[26:27], v[66:67]
 v_pk_add_f32 v[28:29], v[28:29], v[68:69]
 v_pk_add_f32 v[30:31], v[30:31], v[70:71]
 s_waitcnt lgkmcnt(0)
 v_pk_add_f32 v[24:25], v[24:25], v[56:57]
 v_pk_add_f32 v[26:27], v[26:27], v[58:59]
 v_pk_add_f32 v[28:29], v[28:29], v[60:61]
 v_pk_add_f32 v[30:31], v[30:31], v[62:63]
 v_cvt_pk_bf16_f32 v84, v24, v25
 v_cvt_pk_bf16_f32 v86, v28, v29
 v_cvt_pk_bf16_f32 v85, v26, v27
 v_cvt_pk_bf16_f32 v87, v30, v31
 v_permlane16_swap_b32 v84, v86
 s_nop 0
 v_permlane16_swap_b32 v85, v87
 buffer_store_dwordx4 v[84:87], v153, s[20:23], s7 offen offset:64 sc1
f_end:
 s_endpgm
f_x0:
 s_add_u32 s69, s69, 1
 s_cmp_lt_u32 s69, 0x8000
 s_cbranch_scc0 f_x2
 buffer_load_dwordx4 v[208:211], v128, s[24:27], s60 offen offset:0 sc1
 buffer_load_dwordx4 v[212:215], v128, s[24:27], s60 offen offset:1024 sc1
 buffer_load_dwordx4 v[216:219], v128, s[24:27], s60 offen offset:2048 sc1
 buffer_load_dwordx4 v[220:223], v128, s[24:27], s60 offen offset:3072 sc1
 buffer_load_dwordx4 v[224:227], v128, s[24:27], s61 offen offset:0 sc1
 buffer_load_dwordx2 v[228:229], v128, s[24:27], s61 offen offset:1024 sc1
 s_branch f_x1
f_po:
 s_mov_b32 s69, 0
f_po_1:
 s_sleep 1
 buffer_load_dword v154, v145, s[24:27], s76 offen offset:0 sc1
 s_add_u32 s69, s69, 1
 s_waitcnt vmcnt(0)
 v_cmp_ne_u32 vcc, v144, v154
 s_cmp_lt_u32 s69, 0x8000
 s_cbranch_scc0 f_po_back
 s_cbranch_vccnz f_po_1
 s_branch f_po_back
f_S0g:
 s_waitcnt lgkmcnt(4)
f_S0g0:
 v_mfma_f32_16x16x32_bf16 v[64:67], a[40:43], v[160:163], 0
 tr a,56,151,0
 v_mfma_f32_16x16x32_bf16 v[80:83], a[40:43], v[164:167], 0
 tr a,58,151,2048
 s_add_u32 m0, s53, 32768
 v_mfma_f32_16x16x32_bf16 v[96:99], a[40:43], v[168:171], 0
 buffer_load_dwordx4 v147, s[28:31], s62 offen lds
 s_mul_i32 s10, s44, 5
 v_mfma_f32_16x16x32_bf16 v[112:115], a[40:43], v[172:175], 0
 s_sub_u32 s9, s9, s10
 v_mfma_f32_16x16x32_bf16 v[68:71], a[44:47], v[160:163], 0
 tr a,60,152,0
 v_mfma_f32_16x16x32_bf16 v[84:87], a[44:47], v[164:167], 0
 tr a,62,152,2048
 v_mfma_f32_16x16x32_bf16 v[100:103], a[44:47], v[168:171], 0
 v_mfma_f32_16x16x32_bf16 v[116:119], a[44:47], v[172:175], 0
 s_waitcnt lgkmcnt(4)
 v_mfma_f32_16x16x32_bf16 v[72:75], a[48:51], v[160:163], 0
 tr a,40,141,0
 v_mfma_f32_16x16x32_bf16 v[88:91], a[48:51], v[164:167], 0
 tr a,42,141,2048
 s_add_u32 m0, s53, 33792
 v_mfma_f32_16x16x32_bf16 v[104:107], a[48:51], v[168:171], 0
 buffer_load_dwordx4 v148, s[28:31], s62 offen lds
 v_mfma_f32_16x16x32_bf16 v[120:123], a[48:51], v[172:175], 0
 v_mfma_f32_16x16x32_bf16 v[76:79], a[52:55], v[160:163], 0
 tr a,44,130,0
 v_mfma_f32_16x16x32_bf16 v[92:95], a[52:55], v[164:167], 0
 tr a,46,130,2048
 v_mfma_f32_16x16x32_bf16 v[108:111], a[52:55], v[168:171], 0
 v_mfma_f32_16x16x32_bf16 v[124:127], a[52:55], v[172:175], 0
 s_waitcnt lgkmcnt(4)
 v_mfma_f32_16x16x32_bf16 v[0:3], a[56:59], v[160:163], 0
 tr a,48,135,4096
 v_mfma_f32_16x16x32_bf16 v[16:19], a[56:59], v[164:167], 0
 tr a,50,135,6144
 s_add_u32 m0, s53, 34816
 v_mfma_f32_16x16x32_bf16 v[32:35], a[56:59], v[168:171], 0
 buffer_load_dwordx4 v149, s[28:31], s62 offen lds
 v_mfma_f32_16x16x32_bf16 v[48:51], a[56:59], v[172:175], 0
 v_mfma_f32_16x16x32_bf16 v[4:7], a[60:63], v[160:163], 0
 tr a,52,136,4096
 v_mfma_f32_16x16x32_bf16 v[20:23], a[60:63], v[164:167], 0
 tr a,54,136,6144
 v_mfma_f32_16x16x32_bf16 v[36:39], a[60:63], v[168:171], 0
 v_mfma_f32_16x16x32_bf16 v[52:55], a[60:63], v[172:175], 0
 s_waitcnt lgkmcnt(4)
 v_mfma_f32_16x16x32_bf16 v[8:11], a[40:43], v[160:163], 0
 tr a,56,138,4096
 v_mfma_f32_16x16x32_bf16 v[24:27], a[40:43], v[164:167], 0
 tr a,58,138,6144
 s_add_u32 m0, s53, 35840
 v_mfma_f32_16x16x32_bf16 v[40:43], a[40:43], v[168:171], 0
 buffer_load_dwordx4 v150, s[28:31], s62 offen lds
 s_add_u32 s62, s62, 65536
 v_mfma_f32_16x16x32_bf16 v[56:59], a[40:43], v[172:175], 0
 v_mfma_f32_16x16x32_bf16 v[12:15], a[44:47], v[160:163], 0
 tr a,60,140,4096
 v_mfma_f32_16x16x32_bf16 v[28:31], a[44:47], v[164:167], 0
 tr a,62,140,6144
 v_mfma_f32_16x16x32_bf16 v[44:47], a[44:47], v[168:171], 0
 v_mfma_f32_16x16x32_bf16 v[60:63], a[44:47], v[172:175], 0
 s_waitcnt lgkmcnt(4)
f_S0g1:
 mf v,64,a,48,a,96
 tr a,40,151,4096
 mf v,80,a,48,a,100
 tr a,42,151,6144
 s_add_u32 m0, s53, 36864
 mf v,96,a,48,a,104
 buffer_load_dwordx4 v147, s[28:31], s62 offen lds
 mf v,112,a,48,a,108
 mf v,68,a,52,a,96
 tr a,44,152,4096
 mf v,84,a,52,a,100
 tr a,46,152,6144
 mf v,100,a,52,a,104
 buffer_load_dwordx4 v[160:163], v128, s[24:27], s54 offen offset:0 sc1
 mf v,116,a,52,a,108
 s_waitcnt lgkmcnt(4)
 mf v,72,a,56,a,96
 tr a,48,141,4096
 mf v,88,a,56,a,100
 tr a,50,141,6144
 s_add_u32 m0, s53, 37888
 mf v,104,a,56,a,104
 buffer_load_dwordx4 v148, s[28:31], s62 offen lds
 mf v,120,a,56,a,108
 mf v,76,a,60,a,96
 tr a,52,130,4096
 mf v,92,a,60,a,100
 tr a,54,130,6144
 mf v,108,a,60,a,104
 mf v,124,a,60,a,108
 s_waitcnt lgkmcnt(4)
 mf v,0,a,40,a,96
 buffer_load_dwordx4 v[164:167], v128, s[24:27], s55 offen offset:0 sc1
 mf v,16,a,40,a,100
 s_add_u32 m0, s53, 38912
 mf v,32,a,40,a,104
 buffer_load_dwordx4 v149, s[28:31], s62 offen lds
 mf v,48,a,40,a,108
 s_waitcnt lgkmcnt(0)
 s_barrier
 mf v,4,a,44,a,96
 tr a,56,135,8192
 mf v,20,a,44,a,100
 tr a,58,135,10240
 mf v,36,a,44,a,104
 tr a,60,136,8192
 mf v,52,a,44,a,108
 tr a,62,136,10240
 mf v,8,a,48,a,96
 tr a,40,138,8192
 mf v,24,a,48,a,100
 tr a,42,138,10240
 s_add_u32 m0, s53, 39936
 mf v,40,a,48,a,104
 buffer_load_dwordx4 v150, s[28:31], s62 offen lds
 s_add_u32 s62, s62, 65536
 mf v,56,a,48,a,108
 mf v,12,a,52,a,96
 tr a,44,140,8192
 mf v,28,a,52,a,100
 tr a,46,140,10240
 mf v,44,a,52,a,104
 mf v,60,a,52,a,108
 s_waitcnt lgkmcnt(4)
f_S0g2:
 mf v,64,a,56,a,112
 tr a,48,151,8192
 mf v,80,a,56,a,116
 tr a,50,151,10240
 s_add_u32 m0, s53, 0
 mf v,96,a,56,a,120
 buffer_load_dwordx4 v147, s[28:31], s62 offen lds
 mf v,112,a,56,a,124
 mf v,68,a,60,a,112
 tr a,52,152,8192
 mf v,84,a,60,a,116
 tr a,54,152,10240
 mf v,100,a,60,a,120
 buffer_load_dwordx4 v[168:171], v128, s[24:27], s56 offen offset:0 sc1
 mf v,116,a,60,a,124
 s_waitcnt lgkmcnt(4)
 mf v,72,a,40,a,112
 tr a,56,141,8192
 mf v,88,a,40,a,116
 tr a,58,141,10240
 s_add_u32 m0, s53, 1024
 mf v,104,a,40,a,120
 buffer_load_dwordx4 v148, s[28:31], s62 offen lds
 mf v,120,a,40,a,124
 mf v,76,a,44,a,112
 tr a,60,130,8192
 mf v,92,a,44,a,116
 tr a,62,130,10240
 mf v,108,a,44,a,120
 mf v,124,a,44,a,124
 s_waitcnt lgkmcnt(4)
 mf v,0,a,48,a,112
 tr a,40,135,12288
 mf v,16,a,48,a,116
 tr a,42,135,14336
 mf v,32,a,48,a,120
 buffer_load_dwordx4 v[172:175], v128, s[24:27], s57 offen offset:0 sc1
 mf v,48,a,48,a,124
 mf v,4,a,52,a,112
 tr a,44,136,12288
 mf v,20,a,52,a,116
 tr a,46,136,14336
 s_add_u32 m0, s53, 2048
 mf v,36,a,52,a,120
 buffer_load_dwordx4 v149, s[28:31], s62 offen lds
 mf v,52,a,52,a,124
 s_waitcnt lgkmcnt(4)
 mf v,8,a,56,a,112
 tr a,48,138,12288
 mf v,24,a,56,a,116
 tr a,50,138,14336
 s_add_u32 m0, s53, 3072
 mf v,40,a,56,a,120
 buffer_load_dwordx4 v150, s[28:31], s62 offen lds
 s_add_u32 s62, s62, 65536
 mf v,56,a,56,a,124
 mf v,12,a,60,a,112
 tr a,52,140,12288
 mf v,28,a,60,a,116
 tr a,54,140,14336
 mf v,44,a,60,a,120
 mf v,60,a,60,a,124
 s_waitcnt lgkmcnt(4)
 s_waitcnt vmcnt(16)
f_S0g3:
 mf v,64,a,40,v,176
 tr a,56,151,12288
 mf v,80,a,40,v,180
 tr a,58,151,14336
 s_add_u32 m0, s53, 4096
 mf v,96,a,40,v,184
 buffer_load_dwordx4 v147, s[28:31], s62 offen lds
 mf v,112,a,40,v,188
 mf v,68,a,44,v,176
 tr a,60,152,12288
 mf v,84,a,44,v,180
 tr a,62,152,14336
 mf v,100,a,44,v,184
 buffer_store_dword v144, v143, s[24:27], s75 offen sc1
 s_add_u32 s76, s76, 65536
 mf v,116,a,44,v,188
 s_waitcnt lgkmcnt(4)
 mf v,72,a,48,v,176
 tr a,40,141,12288
 mf v,88,a,48,v,180
 tr a,42,141,14336
 s_add_u32 m0, s53, 5120
 mf v,104,a,48,v,184
 buffer_load_dwordx4 v148, s[28:31], s62 offen lds
 mf v,120,a,48,v,188
 mf v,76,a,52,v,176
 tr a,44,130,12288
 mf v,92,a,52,v,180
 tr a,46,130,14336
 mf v,108,a,52,v,184
 buffer_load_dwordx4 a[96:99], v128, s[24:27], s54 offen offset:1024 sc1
 mf v,124,a,52,v,188
 s_waitcnt lgkmcnt(4)
 s_add_u32 m0, s53, 6144
 mf v,0,a,56,v,176
 buffer_load_dwordx4 v149, s[28:31], s62 offen lds
 mf v,16,a,56,v,180
 mf v,32,a,56,v,184
 buffer_load_dwordx4 a[100:103], v128, s[24:27], s55 offen offset:1024 sc1
 mf v,48,a,56,v,188
 s_waitcnt lgkmcnt(0)
 s_barrier
 mf v,4,a,60,v,176
 tr a,48,135,16384
 mf v,20,a,60,v,180
 tr a,50,135,18432
 mf v,36,a,60,v,184
 tr a,52,136,16384
 mf v,52,a,60,v,188
 tr a,54,136,18432
 mf v,8,a,40,v,176
 tr a,56,138,16384
 mf v,24,a,40,v,180
 tr a,58,138,18432
 s_add_u32 m0, s53, 7168
 mf v,40,a,40,v,184
 buffer_load_dwordx4 v150, s[28:31], s62 offen lds
 s_add_u32 s62, s62, s46
 mf v,56,a,40,v,188
 mf v,12,a,44,v,176
 tr a,60,140,16384
 mf v,28,a,44,v,180
 tr a,62,140,18432
 mf v,44,a,44,v,184
 mf v,60,a,44,v,188
 s_waitcnt lgkmcnt(4)
f_S0g4:
 mf v,64,a,48,a,128
 tr a,40,151,16384
 mf v,80,a,48,a,132
 tr a,42,151,18432
 s_add_u32 m0, s53, 8192
 mf v,96,a,48,a,136
 buffer_load_dwordx4 v147, s[28:31], s62 offen lds
 mf v,112,a,48,a,140
 mf v,68,a,52,a,128
 tr a,44,152,16384
 mf v,84,a,52,a,132
 tr a,46,152,18432
 mf v,100,a,52,a,136
 buffer_load_dwordx4 a[104:107], v128, s[24:27], s56 offen offset:1024 sc1
 mf v,116,a,52,a,140
 s_waitcnt lgkmcnt(4)
 mf v,72,a,56,a,128
 tr a,48,141,16384
 mf v,88,a,56,a,132
 tr a,50,141,18432
 s_add_u32 m0, s53, 9216
 mf v,104,a,56,a,136
 buffer_load_dwordx4 v148, s[28:31], s62 offen lds
 mf v,120,a,56,a,140
 mf v,76,a,60,a,128
 tr a,52,130,16384
 mf v,92,a,60,a,132
 tr a,54,130,18432
 mf v,108,a,60,a,136
 mf v,124,a,60,a,140
 s_waitcnt lgkmcnt(4)
 mf v,0,a,40,a,128
 tr a,56,135,20480
 mf v,16,a,40,a,132
 tr a,58,135,22528
 mf v,32,a,40,a,136
 buffer_load_dwordx4 a[108:111], v128, s[24:27], s57 offen offset:1024 sc1
 mf v,48,a,40,a,140
 mf v,4,a,44,a,128
 tr a,60,136,20480
 mf v,20,a,44,a,132
 tr a,62,136,22528
 s_add_u32 m0, s53, 10240
 mf v,36,a,44,a,136
 buffer_load_dwordx4 v149, s[28:31], s62 offen lds
 mf v,52,a,44,a,140
 s_waitcnt lgkmcnt(4)
 mf v,8,a,48,a,128
 tr a,40,138,20480
 mf v,24,a,48,a,132
 tr a,42,138,22528
 s_add_u32 m0, s53, 11264
 mf v,40,a,48,a,136
 buffer_load_dwordx4 v150, s[28:31], s62 offen lds
 s_add_u32 s62, s62, 65536
 mf v,56,a,48,a,140
 mf v,12,a,52,a,128
 tr a,44,140,20480
 mf v,28,a,52,a,132
 tr a,46,140,22528
 mf v,44,a,52,a,136
 mf v,60,a,52,a,140
 s_waitcnt lgkmcnt(4)
f_S0g5:
 mf v,64,a,56,v,192
 tr a,48,151,20480
 mf v,80,a,56,v,196
 tr a,50,151,22528
 s_add_u32 m0, s53, 12288
 mf v,96,a,56,v,200
 buffer_load_dwordx4 v147, s[28:31], s62 offen lds
 mf v,112,a,56,v,204
 mf v,68,a,60,v,192
 tr a,52,152,20480
 mf v,84,a,60,v,196
 tr a,54,152,22528
 mf v,100,a,60,v,200
 buffer_load_dwordx4 a[112:115], v128, s[24:27], s54 offen offset:2048 sc1
 mf v,116,a,60,v,204
 s_waitcnt lgkmcnt(4)
 mf v,72,a,40,v,192
 tr a,56,141,20480
 mf v,88,a,40,v,196
 tr a,58,141,22528
 s_add_u32 m0, s53, 13312
 mf v,104,a,40,v,200
 buffer_load_dwordx4 v148, s[28:31], s62 offen lds
 mf v,120,a,40,v,204
 mf v,76,a,44,v,192
 tr a,60,130,20480
 mf v,92,a,44,v,196
 tr a,62,130,22528
 mf v,108,a,44,v,200
 mf v,124,a,44,v,204
 s_waitcnt lgkmcnt(4)
 mf v,0,a,48,v,192
 buffer_load_dwordx4 a[116:119], v128, s[24:27], s55 offen offset:2048 sc1
 mf v,16,a,48,v,196
 s_add_u32 m0, s53, 14336
 mf v,32,a,48,v,200
 buffer_load_dwordx4 v149, s[28:31], s62 offen lds
 mf v,48,a,48,v,204
 s_waitcnt lgkmcnt(0)
 s_barrier
 mf v,4,a,52,v,192
 tr a,40,135,24576
 mf v,20,a,52,v,196
 tr a,42,135,26624
 mf v,36,a,52,v,200
 tr a,44,136,24576
 mf v,52,a,52,v,204
 tr a,46,136,26624
 mf v,8,a,56,v,192
 tr a,48,138,24576
 mf v,24,a,56,v,196
 tr a,50,138,26624
 s_add_u32 m0, s53, 15360
 mf v,40,a,56,v,200
 buffer_load_dwordx4 v150, s[28:31], s62 offen lds
 s_add_u32 s62, s62, 65536
 mf v,56,a,56,v,204
 mf v,12,a,60,v,192
 tr a,52,140,24576
 mf v,28,a,60,v,196
 tr a,54,140,26624
 mf v,44,a,60,v,200
 mf v,60,a,60,v,204
 s_waitcnt lgkmcnt(4)
f_S0g6:
 mf v,64,a,40,a,144
 tr a,56,151,24576
 mf v,80,a,40,a,148
 tr a,58,151,26624
 s_add_u32 m0, s53, 16384
 mf v,96,a,40,a,152
 buffer_load_dwordx4 v147, s[28:31], s62 offen lds
 mf v,112,a,40,a,156
 mf v,68,a,44,a,144
 tr a,60,152,24576
 mf v,84,a,44,a,148
 tr a,62,152,26624
 s_mov_b32 s69, f_S0p48-f_base
 mf v,100,a,44,a,152
 buffer_load_dword v129, v155, s[36:39], s69 offen
 mf v,116,a,44,a,156
 s_waitcnt lgkmcnt(4)
 mf v,72,a,48,a,144
 tr a,40,141,24576
 mf v,88,a,48,a,148
 tr a,42,141,26624
 s_add_u32 m0, s53, 17408
 mf v,104,a,48,a,152
 buffer_load_dwordx4 v148, s[28:31], s62 offen lds
 mf v,120,a,48,a,156
 mf v,76,a,52,a,144
 tr a,44,130,24576
 mf v,92,a,52,a,148
 tr a,46,130,26624
 mf v,108,a,52,a,152
 buffer_load_dwordx4 a[120:123], v128, s[24:27], s56 offen offset:2048 sc1
 mf v,124,a,52,a,156
 s_waitcnt lgkmcnt(4)
 mf v,0,a,56,a,144
 tr a,48,135,28672
 mf v,16,a,56,a,148
 tr a,50,135,30720
 s_add_u32 m0, s53, 18432
 mf v,32,a,56,a,152
 buffer_load_dwordx4 v149, s[28:31], s62 offen lds
 mf v,48,a,56,a,156
 mf v,4,a,60,a,144
 tr a,52,136,28672
 mf v,20,a,60,a,148
 tr a,54,136,30720
 mf v,36,a,60,a,152
 buffer_load_dwordx4 a[124:127], v128, s[24:27], s57 offen offset:2048 sc1
 mf v,52,a,60,a,156
 s_waitcnt lgkmcnt(4)
 mf v,8,a,40,a,144
 tr a,56,138,28672
 mf v,24,a,40,a,148
 tr a,58,138,30720
 s_add_u32 m0, s53, 19456
 mf v,40,a,40,a,152
 buffer_load_dwordx4 v150, s[28:31], s62 offen lds
 s_add_u32 s62, s62, 65536
 mf v,56,a,40,a,156
 mf v,12,a,44,a,144
 tr a,60,140,28672
 mf v,28,a,44,a,148
 tr a,62,140,30720
 mf v,44,a,44,a,152
 mf v,60,a,44,a,156
 s_waitcnt lgkmcnt(4)
f_S0g7:
 mf v,64,a,48,a,160
 tr a,40,151,28672
 mf v,80,a,48,a,164
 tr a,42,151,30720
 s_add_u32 m0, s53, 20480
 mf v,96,a,48,a,168
 buffer_load_dwordx4 v147, s[28:31], s62 offen lds
 mf v,112,a,48,a,172
 mf v,68,a,52,a,160
 tr a,44,152,28672
 mf v,84,a,52,a,164
 tr a,46,152,30720
 mf v,100,a,52,a,168
 buffer_load_dwordx4 v[176:179], v128, s[24:27], s54 offen offset:3072 sc1
 s_add_u32 s54, s54, s44
 mf v,116,a,52,a,172
 s_waitcnt lgkmcnt(4)
 mf v,72,a,56,a,160
 tr a,48,141,28672
 mf v,88,a,56,a,164
 tr a,50,141,30720
 s_add_u32 m0, s53, 21504
 mf v,104,a,56,a,168
 buffer_load_dwordx4 v148, s[28:31], s62 offen lds
 mf v,120,a,56,a,172
 mf v,76,a,60,a,160
 tr a,52,130,28672
 mf v,92,a,60,a,164
 tr a,54,130,30720
 mf v,108,a,60,a,168
 mf v,124,a,60,a,172
 s_waitcnt lgkmcnt(4)
 mf v,0,a,40,a,160
 buffer_load_dwordx4 v[180:183], v128, s[24:27], s55 offen offset:3072 sc1
 s_add_u32 s55, s55, s44
 mf v,16,a,40,a,164
 s_add_u32 m0, s53, 22528
 mf v,32,a,40,a,168
 buffer_load_dwordx4 v149, s[28:31], s62 offen lds
 mf v,48,a,40,a,172
 s_waitcnt vmcnt(37) lgkmcnt(0)
 s_barrier
 mf v,4,a,44,a,160
 tr a,56,135,32768
 mf v,20,a,44,a,164
 tr a,58,135,34816
 mf v,36,a,44,a,168
 tr a,60,136,32768
 mf v,52,a,44,a,172
 tr a,62,136,34816
 mf v,8,a,48,a,160
 tr a,40,138,32768
 mf v,24,a,48,a,164
 tr a,42,138,34816
 s_add_u32 m0, s53, 23552
 mf v,40,a,48,a,168
 buffer_load_dwordx4 v150, s[28:31], s62 offen lds
 s_add_u32 s62, s62, s46
 mf v,56,a,48,a,172
 mf v,12,a,52,a,160
 tr a,44,140,32768
 mf v,28,a,52,a,164
 tr a,46,140,34816
 mf v,44,a,52,a,168
 mf v,60,a,52,a,172
 s_waitcnt lgkmcnt(4)
f_S0g8:
 mf v,64,a,56,v,208
 tr a,48,151,32768
 mf v,80,a,56,v,212
 tr a,50,151,34816
 s_add_u32 m0, s53, 24576
 mf v,96,a,56,v,216
 buffer_load_dwordx4 v147, s[28:31], s62 offen lds
 mf v,112,a,56,v,220
 mf v,68,a,60,v,208
 tr a,52,152,32768
 mf v,84,a,60,v,212
 tr a,54,152,34816
 mf v,100,a,60,v,216
 buffer_load_dwordx4 v[184:187], v128, s[24:27], s56 offen offset:3072 sc1
 s_add_u32 s56, s56, s44
 mf v,116,a,60,v,220
 s_waitcnt lgkmcnt(4)
 mf v,72,a,40,v,208
 tr a,56,141,32768
 mf v,88,a,40,v,212
 tr a,58,141,34816
 s_add_u32 m0, s53, 25600
 mf v,104,a,40,v,216
 buffer_load_dwordx4 v148, s[28:31], s62 offen lds
 mf v,120,a,40,v,220
 mf v,76,a,44,v,208
 tr a,60,130,32768
 mf v,92,a,44,v,212
 tr a,62,130,34816
 mf v,108,a,44,v,216
 mf v,124,a,44,v,220
 s_waitcnt lgkmcnt(4)
 mf v,0,a,48,v,208
 tr a,40,135,36864
 mf v,16,a,48,v,212
 tr a,42,135,38912
 mf v,32,a,48,v,216
 buffer_load_dwordx4 v[188:191], v128, s[24:27], s57 offen offset:3072 sc1
 s_add_u32 s57, s57, s44
 mf v,48,a,48,v,220
 mf v,4,a,52,v,208
 tr a,44,136,36864
 mf v,20,a,52,v,212
 tr a,46,136,38912
 s_add_u32 m0, s53, 26624
 mf v,36,a,52,v,216
 buffer_load_dwordx4 v149, s[28:31], s62 offen lds
 mf v,52,a,52,v,220
 s_waitcnt lgkmcnt(4)
 mf v,8,a,56,v,208
 tr a,48,138,36864
 mf v,24,a,56,v,212
 tr a,50,138,38912
 s_add_u32 m0, s53, 27648
 mf v,40,a,56,v,216
 buffer_load_dwordx4 v150, s[28:31], s62 offen lds
 s_add_u32 s62, s62, 65536
 mf v,56,a,56,v,220
 mf v,12,a,60,v,208
 tr a,52,140,36864
 mf v,28,a,60,v,212
 tr a,54,140,38912
 mf v,44,a,60,v,216
 mf v,60,a,60,v,220
 s_waitcnt lgkmcnt(4)
f_S0g9:
 mf v,64,a,40,a,176
 tr a,56,151,36864
 mf v,80,a,40,a,180
 tr a,58,151,38912
 s_add_u32 m0, s53, 28672
 mf v,96,a,40,a,184
 buffer_load_dwordx4 v147, s[28:31], s62 offen lds
 mf v,112,a,40,a,188
 mf v,68,a,44,a,176
 tr a,60,152,36864
 mf v,84,a,44,a,180
 tr a,62,152,38912
 mf v,100,a,44,a,184
 buffer_load_dwordx4 a[128:131], v128, s[24:27], s54 offen offset:0 sc1
 mf v,116,a,44,a,188
 s_waitcnt lgkmcnt(4)
 mf v,72,a,48,a,176
 tr a,40,141,36864
 mf v,88,a,48,a,180
 tr a,42,141,38912
 s_add_u32 m0, s53, 29696
 mf v,104,a,48,a,184
 buffer_load_dwordx4 v148, s[28:31], s62 offen lds
 mf v,120,a,48,a,188
 mf v,76,a,52,a,176
 tr a,44,130,36864
 mf v,92,a,52,a,180
 tr a,46,130,38912
 mf v,108,a,52,a,184
 mf v,124,a,52,a,188
 s_waitcnt lgkmcnt(4)
 mf v,0,a,56,a,176
 buffer_load_dwordx4 a[132:135], v128, s[24:27], s55 offen offset:0 sc1
 mf v,16,a,56,a,180
 s_add_u32 m0, s53, 30720
 mf v,32,a,56,a,184
 buffer_load_dwordx4 v149, s[28:31], s62 offen lds
 mf v,48,a,56,a,188
 s_waitcnt vmcnt(36) lgkmcnt(0)
 s_barrier
 mf v,4,a,60,a,176
 tr a,48,135,0
 mf v,20,a,60,a,180
 tr a,50,135,2048
 mf v,36,a,60,a,184
 tr a,52,136,0
 mf v,52,a,60,a,188
 tr a,54,136,2048
 mf v,8,a,40,a,176
 tr a,56,138,0
 mf v,24,a,40,a,180
 tr a,58,138,2048
 s_add_u32 m0, s53, 31744
 mf v,40,a,40,a,184
 buffer_load_dwordx4 v150, s[28:31], s62 offen lds
 s_add_u32 s62, s62, 65536
 mf v,56,a,40,a,188
 mf v,12,a,44,a,176
 tr a,60,140,0
 mf v,28,a,44,a,180
 tr a,62,140,2048
 mf v,44,a,44,a,184
 mf v,60,a,44,a,188
 s_waitcnt lgkmcnt(4)
f_S0g10:
 mf v,64,a,48,a,192
 tr a,40,151,0
 mf v,80,a,48,a,196
 tr a,42,151,2048
 s_add_u32 m0, s53, 32768
 mf v,96,a,48,a,200
 buffer_load_dwordx4 v147, s[28:31], s62 offen lds
 mf v,112,a,48,a,204
 mf v,68,a,52,a,192
 tr a,44,152,0
 mf v,84,a,52,a,196
 tr a,46,152,2048
 mf v,100,a,52,a,200
 buffer_load_dwordx4 a[136:139], v128, s[24:27], s56 offen offset:0 sc1
 mf v,116,a,52,a,204
 s_waitcnt lgkmcnt(4)
 mf v,72,a,56,a,192
 tr a,48,141,0
 mf v,88,a,56,a,196
 tr a,50,141,2048
 s_add_u32 m0, s53, 33792
 mf v,104,a,56,a,200
 buffer_load_dwordx4 v148, s[28:31], s62 offen lds
 mf v,120,a,56,a,204
 mf v,76,a,60,a,192
 tr a,52,130,0
 mf v,92,a,60,a,196
 tr a,54,130,2048
 mf v,108,a,60,a,200
 mf v,124,a,60,a,204
 s_waitcnt lgkmcnt(4)
 mf v,0,a,40,a,192
 tr a,56,135,4096
 mf v,16,a,40,a,196
 tr a,58,135,6144
 mf v,32,a,40,a,200
 buffer_load_dwordx4 a[140:143], v128, s[24:27], s57 offen offset:0 sc1
 mf v,48,a,40,a,204
 mf v,4,a,44,a,192
 tr a,60,136,4096
 mf v,20,a,44,a,196
 tr a,62,136,6144
 s_add_u32 m0, s53, 34816
 mf v,36,a,44,a,200
 buffer_load_dwordx4 v149, s[28:31], s62 offen lds
 mf v,52,a,44,a,204
 s_waitcnt lgkmcnt(4)
 mf v,8,a,48,a,192
 tr a,40,138,4096
 mf v,24,a,48,a,196
 tr a,42,138,6144
 s_add_u32 m0, s53, 35840
 mf v,40,a,48,a,200
 buffer_load_dwordx4 v150, s[28:31], s62 offen lds
 s_add_u32 s62, s62, 65536
 mf v,56,a,48,a,204
 mf v,12,a,52,a,192
 tr a,44,140,4096
 mf v,28,a,52,a,196
 tr a,46,140,6144
 mf v,44,a,52,a,200
 mf v,60,a,52,a,204
 s_waitcnt lgkmcnt(4)
f_S0g11:
 mf v,64,a,56,v,224
 tr a,48,151,4096
 mf v,80,a,56,v,228
 tr a,50,151,6144
 s_add_u32 m0, s53, 36864
 mf v,96,a,56,v,232
 buffer_load_dwordx4 v147, s[28:31], s62 offen lds
 mf v,112,a,56,v,236
 mf v,68,a,60,v,224
 tr a,52,152,4096
 mf v,84,a,60,v,228
 tr a,54,152,6144
 mf v,100,a,60,v,232
 buffer_load_dwordx4 v[192:195], v128, s[24:27], s54 offen offset:1024 sc1
 mf v,116,a,60,v,236
 s_waitcnt lgkmcnt(4)
 mf v,72,a,40,v,224
 tr a,56,141,4096
 mf v,88,a,40,v,228
 tr a,58,141,6144
 s_add_u32 m0, s53, 37888
 mf v,104,a,40,v,232
 buffer_load_dwordx4 v148, s[28:31], s62 offen lds
 mf v,120,a,40,v,236
 mf v,76,a,44,v,224
 tr a,60,130,4096
 mf v,92,a,44,v,228
 tr a,62,130,6144
 mf v,108,a,44,v,232
 mf v,124,a,44,v,236
 s_waitcnt lgkmcnt(4)
 mf v,0,a,48,v,224
 buffer_load_dwordx4 v[196:199], v128, s[24:27], s55 offen offset:1024 sc1
 mf v,16,a,48,v,228
 s_add_u32 m0, s53, 38912
 mf v,32,a,48,v,232
 buffer_load_dwordx4 v149, s[28:31], s62 offen lds
 mf v,48,a,48,v,236
 s_waitcnt vmcnt(36) lgkmcnt(0)
 s_barrier
 mf v,4,a,52,v,224
 tr a,40,135,8192
 mf v,20,a,52,v,228
 tr a,42,135,10240
 mf v,36,a,52,v,232
 tr a,44,136,8192
 mf v,52,a,52,v,236
 tr a,46,136,10240
 mf v,8,a,56,v,224
 tr a,48,138,8192
 mf v,24,a,56,v,228
 tr a,50,138,10240
 s_add_u32 m0, s53, 39936
 mf v,40,a,56,v,232
 buffer_load_dwordx4 v150, s[28:31], s62 offen lds
 s_add_u32 s62, s62, s46
 mf v,56,a,56,v,236
 mf v,12,a,60,v,224
 tr a,52,140,8192
 mf v,28,a,60,v,228
 tr a,54,140,10240
 mf v,44,a,60,v,232
 mf v,60,a,60,v,236
 s_waitcnt lgkmcnt(4)
f_S0g12:
f_S0p48:
 mf v,64,a,40,a,208
 tr a,56,151,8192
 mf v,80,a,40,a,212
 tr a,58,151,10240
 s_add_u32 m0, s53, 0
 mf v,96,a,40,a,216
 buffer_load_dwordx4 v147, s[28:31], s62 offen lds
 mf v,112,a,40,a,220
 mf v,68,a,44,a,208
 tr a,60,152,8192
 mf v,84,a,44,a,212
 tr a,62,152,10240
 mf v,100,a,44,a,216
 buffer_load_dwordx4 v[200:203], v128, s[24:27], s56 offen offset:1024 sc1
 mf v,116,a,44,a,220
 s_waitcnt lgkmcnt(4)
 mf v,72,a,48,a,208
 tr a,40,141,8192
 mf v,88,a,48,a,212
 tr a,42,141,10240
 s_add_u32 m0, s53, 1024
 mf v,104,a,48,a,216
 buffer_load_dwordx4 v148, s[28:31], s62 offen lds
 mf v,120,a,48,a,220
 mf v,76,a,52,a,208
 tr a,44,130,8192
 mf v,92,a,52,a,212
 tr a,46,130,10240
 mf v,108,a,52,a,216
 mf v,124,a,52,a,220
 s_waitcnt lgkmcnt(4)
 mf v,0,a,56,a,208
 tr a,48,135,12288
 mf v,16,a,56,a,212
 tr a,50,135,14336
 mf v,32,a,56,a,216
 buffer_load_dwordx4 v[204:207], v128, s[24:27], s57 offen offset:1024 sc1
 mf v,48,a,56,a,220
 mf v,4,a,60,a,208
 tr a,52,136,12288
 mf v,20,a,60,a,212
 tr a,54,136,14336
 s_add_u32 m0, s53, 2048
 mf v,36,a,60,a,216
 buffer_load_dwordx4 v149, s[28:31], s62 offen lds
 mf v,52,a,60,a,220
 s_waitcnt lgkmcnt(4)
 mf v,8,a,40,a,208
 tr a,56,138,12288
 mf v,24,a,40,a,212
 tr a,58,138,14336
 s_add_u32 m0, s53, 3072
 mf v,40,a,40,a,216
 buffer_load_dwordx4 v150, s[28:31], s62 offen lds
 s_add_u32 s62, s62, 65536
 mf v,56,a,40,a,220
 mf v,12,a,44,a,208
 tr a,60,140,12288
 mf v,28,a,44,a,212
 tr a,62,140,14336
 mf v,44,a,44,a,216
 mf v,60,a,44,a,220
 s_waitcnt lgkmcnt(4)
f_S0g13:
 mf v,64,a,48,v,240
 tr a,40,151,12288
 mf v,80,a,48,v,244
 tr a,42,151,14336
 s_add_u32 m0, s53, 4096
 mf v,96,a,48,v,248
 buffer_load_dwordx4 v147, s[28:31], s62 offen lds
 mf v,112,a,48,v,252
 mf v,68,a,52,v,240
 tr a,44,152,12288
 mf v,84,a,52,v,244
 tr a,46,152,14336
 s_mov_b32 s69, f_S0p96-f_base
 mf v,100,a,52,v,248
 buffer_load_dword v129, v155, s[36:39], s69 offen
 mf v,116,a,52,v,252
 s_waitcnt lgkmcnt(4)
 mf v,72,a,56,v,240
 tr a,48,141,12288
 mf v,88,a,56,v,244
 tr a,50,141,14336
 s_add_u32 m0, s53, 5120
 mf v,104,a,56,v,248
 buffer_load_dwordx4 v148, s[28:31], s62 offen lds
 mf v,120,a,56,v,252
 mf v,76,a,60,v,240
 tr a,52,130,12288
 mf v,92,a,60,v,244
 tr a,54,130,14336
 mf v,108,a,60,v,248
 buffer_load_dwordx4 a[144:147], v128, s[24:27], s54 offen offset:2048 sc1
 mf v,124,a,60,v,252
 s_waitcnt lgkmcnt(4)
 s_add_u32 m0, s53, 6144
 mf v,0,a,40,v,240
 buffer_load_dwordx4 v149, s[28:31], s62 offen lds
 mf v,16,a,40,v,244
 mf v,32,a,40,v,248
 buffer_load_dwordx4 a[148:151], v128, s[24:27], s55 offen offset:2048 sc1
 mf v,48,a,40,v,252
 s_waitcnt vmcnt(36) lgkmcnt(0)
 s_barrier
 mf v,4,a,44,v,240
 tr a,56,135,16384
 mf v,20,a,44,v,244
 tr a,58,135,18432
 mf v,36,a,44,v,248
 tr a,60,136,16384
 mf v,52,a,44,v,252
 tr a,62,136,18432
 mf v,8,a,48,v,240
 tr a,40,138,16384
 mf v,24,a,48,v,244
 tr a,42,138,18432
 s_add_u32 m0, s53, 7168
 mf v,40,a,48,v,248
 buffer_load_dwordx4 v150, s[28:31], s62 offen lds
 s_add_u32 s62, s62, 65536
 mf v,56,a,48,v,252
 mf v,12,a,52,v,240
 tr a,44,140,16384
 mf v,28,a,52,v,244
 tr a,46,140,18432
 mf v,44,a,52,v,248
 mf v,60,a,52,v,252
 s_waitcnt lgkmcnt(4)
f_S0g14:
 mf v,64,a,56,a,224
 tr a,48,151,16384
 mf v,80,a,56,a,228
 tr a,50,151,18432
 s_add_u32 m0, s53, 8192
 mf v,96,a,56,a,232
 buffer_load_dwordx4 v147, s[28:31], s62 offen lds
 mf v,112,a,56,a,236
 mf v,68,a,60,a,224
 tr a,52,152,16384
 mf v,84,a,60,a,228
 tr a,54,152,18432
 mf v,100,a,60,a,232
 buffer_load_dwordx4 a[152:155], v128, s[24:27], s56 offen offset:2048 sc1
 mf v,116,a,60,a,236
 s_waitcnt lgkmcnt(4)
 mf v,72,a,40,a,224
 tr a,56,141,16384
 mf v,88,a,40,a,228
 tr a,58,141,18432
 s_add_u32 m0, s53, 9216
 mf v,104,a,40,a,232
 buffer_load_dwordx4 v148, s[28:31], s62 offen lds
 mf v,120,a,40,a,236
 mf v,76,a,44,a,224
 tr a,60,130,16384
 mf v,92,a,44,a,228
 tr a,62,130,18432
 mf v,108,a,44,a,232
 mf v,124,a,44,a,236
 s_waitcnt lgkmcnt(4)
 mf v,0,a,48,a,224
 tr a,40,135,20480
 mf v,16,a,48,a,228
 tr a,42,135,22528
 mf v,32,a,48,a,232
 buffer_load_dwordx4 a[156:159], v128, s[24:27], s57 offen offset:2048 sc1
 mf v,48,a,48,a,236
 mf v,4,a,52,a,224
 tr a,44,136,20480
 mf v,20,a,52,a,228
 tr a,46,136,22528
 s_add_u32 m0, s53, 10240
 mf v,36,a,52,a,232
 buffer_load_dwordx4 v149, s[28:31], s62 offen lds
 mf v,52,a,52,a,236
 s_waitcnt lgkmcnt(4)
 mf v,8,a,56,a,224
 tr a,48,138,20480
 mf v,24,a,56,a,228
 tr a,50,138,22528
 s_add_u32 m0, s53, 11264
 mf v,40,a,56,a,232
 buffer_load_dwordx4 v150, s[28:31], s62 offen lds
 s_add_u32 s62, s62, 65536
 mf v,56,a,56,a,236
 mf v,12,a,60,a,224
 tr a,52,140,20480
 mf v,28,a,60,a,228
 tr a,54,140,22528
 mf v,44,a,60,a,232
 mf v,60,a,60,a,236
 s_waitcnt lgkmcnt(4)
f_S0g15:
 mf v,64,a,40,a,240
 tr a,56,151,20480
 mf v,80,a,40,a,244
 tr a,58,151,22528
 s_add_u32 m0, s53, 12288
 mf v,96,a,40,a,248
 buffer_load_dwordx4 v147, s[28:31], s62 offen lds
 mf v,112,a,40,a,252
 mf v,68,a,44,a,240
 tr a,60,152,20480
 mf v,84,a,44,a,244
 tr a,62,152,22528
 mf v,100,a,44,a,248
 buffer_load_dwordx4 a[160:163], v128, s[24:27], s54 offen offset:3072 sc1
 s_add_u32 s54, s54, s9
 mf v,116,a,44,a,252
 s_waitcnt lgkmcnt(4)
 mf v,72,a,48,a,240
 tr a,40,141,20480
 mf v,88,a,48,a,244
 tr a,42,141,22528
 s_add_u32 m0, s53, 13312
 mf v,104,a,48,a,248
 buffer_load_dwordx4 v148, s[28:31], s62 offen lds
 mf v,120,a,48,a,252
 mf v,76,a,52,a,240
 tr a,44,130,20480
 mf v,92,a,52,a,244
 tr a,46,130,22528
 mf v,108,a,52,a,248
 mf v,124,a,52,a,252
 s_waitcnt lgkmcnt(4)
 mf v,0,a,56,a,240
 buffer_load_dwordx4 a[164:167], v128, s[24:27], s55 offen offset:3072 sc1
 s_add_u32 s55, s55, s9
 mf v,16,a,56,a,244
 s_add_u32 m0, s53, 14336
 mf v,32,a,56,a,248
 buffer_load_dwordx4 v149, s[28:31], s62 offen lds
 mf v,48,a,56,a,252
 s_waitcnt vmcnt(36) lgkmcnt(0)
 s_barrier
 mf v,4,a,60,a,240
 tr a,48,135,24576
 mf v,20,a,60,a,244
 tr a,50,135,26624
 mf v,36,a,60,a,248
 tr a,52,136,24576
 mf v,52,a,60,a,252
 tr a,54,136,26624
 mf v,8,a,40,a,240
 tr a,56,138,24576
 mf v,24,a,40,a,244
 tr a,58,138,26624
 s_add_u32 m0, s53, 15360
 mf v,40,a,40,a,248
 buffer_load_dwordx4 v150, s[28:31], s62 offen lds
 s_mov_b32 s62, s8
 mf v,56,a,40,a,252
 mf v,12,a,44,a,240
 tr a,60,140,24576
 mf v,28,a,44,a,244
 tr a,62,140,26624
 mf v,44,a,44,a,248
 mf v,60,a,44,a,252
 s_waitcnt lgkmcnt(4)
f_S0g16:
 mf v,64,a,48,v,160
 tr a,40,151,24576
 mf v,80,a,48,v,164
 tr a,42,151,26624
 s_add_u32 m0, s53, 16384
 mf v,96,a,48,v,168
 buffer_load_dwordx4 v147, s[32:35], s62 offen lds
 mf v,112,a,48,v,172
 mf v,68,a,52,v,160
 tr a,44,152,24576
 mf v,84,a,52,v,164
 tr a,46,152,26624
 mf v,100,a,52,v,168
 buffer_load_dword v154, v145, s[24:27], s76 offen offset:0 sc1
 mf v,116,a,52,v,172
 s_waitcnt lgkmcnt(4)
 mf v,72,a,56,v,160
 tr a,48,141,24576
 mf v,88,a,56,v,164
 tr a,50,141,26624
 s_add_u32 m0, s53, 17408
 mf v,104,a,56,v,168
 buffer_load_dwordx4 v148, s[32:35], s62 offen lds
 mf v,120,a,56,v,172
 mf v,76,a,60,v,160
 tr a,52,130,24576
 mf v,92,a,60,v,164
 tr a,54,130,26624
 mf v,108,a,60,v,168
 buffer_load_dwordx4 a[168:171], v128, s[24:27], s56 offen offset:3072 sc1
 s_add_u32 s56, s56, s9
 mf v,124,a,60,v,172
 s_waitcnt lgkmcnt(4)
 mf v,0,a,40,v,160
 tr a,56,135,28672
 mf v,16,a,40,v,164
 tr a,58,135,30720
 s_add_u32 m0, s53, 18432
 mf v,32,a,40,v,168
 buffer_load_dwordx4 v149, s[32:35], s62 offen lds
 mf v,48,a,40,v,172
 mf v,4,a,44,v,160
 tr a,60,136,28672
 mf v,20,a,44,v,164
 tr a,62,136,30720
 mf v,36,a,44,v,168
 buffer_load_dwordx4 a[172:175], v128, s[24:27], s57 offen offset:3072 sc1
 s_add_u32 s57, s57, s9
 mf v,52,a,44,v,172
 s_waitcnt lgkmcnt(4)
 mf v,8,a,48,v,160
 tr a,40,138,28672
 mf v,24,a,48,v,164
 tr a,42,138,30720
 s_add_u32 m0, s53, 19456
 mf v,40,a,48,v,168
 buffer_load_dwordx4 v150, s[32:35], s62 offen lds
 s_add_u32 s62, s62, 65536
 mf v,56,a,48,v,172
 mf v,12,a,52,v,160
 tr a,44,140,28672
 mf v,28,a,52,v,164
 tr a,46,140,30720
 mf v,44,a,52,v,168
 mf v,60,a,52,v,172
 s_waitcnt lgkmcnt(4)
f_S0g17:
 mf v,64,a,56,a,96
 tr a,48,151,28672
 mf v,80,a,56,a,100
 tr a,50,151,30720
 s_add_u32 m0, s53, 20480
 mf v,96,a,56,a,104
 buffer_load_dwordx4 v147, s[32:35], s62 offen lds
 mf v,112,a,56,a,108
 mf v,68,a,60,a,96
 tr a,52,152,28672
 mf v,84,a,60,a,100
 tr a,54,152,30720
 mf v,100,a,60,a,104
 mf v,116,a,60,a,108
 s_waitcnt lgkmcnt(4)
 mf v,72,a,40,a,96
 tr a,56,141,28672
 mf v,88,a,40,a,100
 tr a,58,141,30720
 s_add_u32 m0, s53, 21504
 mf v,104,a,40,a,104
 buffer_load_dwordx4 v148, s[32:35], s62 offen lds
 mf v,120,a,40,a,108
 mf v,76,a,44,a,96
 tr a,60,130,28672
 mf v,92,a,44,a,100
 tr a,62,130,30720
 mf v,108,a,44,a,104
 mf v,124,a,44,a,108
 s_waitcnt lgkmcnt(4)
 s_add_u32 m0, s53, 22528
 mf v,0,a,48,a,96
 buffer_load_dwordx4 v149, s[32:35], s62 offen lds
 mf v,16,a,48,a,100
 mf v,32,a,48,a,104
 mf v,48,a,48,a,108
 s_waitcnt vmcnt(35) lgkmcnt(0)
 s_barrier
 mf v,4,a,52,a,96
 tr a,40,135,32768
 mf v,20,a,52,a,100
 tr a,42,135,34816
 mf v,36,a,52,a,104
 tr a,44,136,32768
 mf v,52,a,52,a,108
 tr a,46,136,34816
 mf v,8,a,56,a,96
 tr a,48,138,32768
 mf v,24,a,56,a,100
 tr a,50,138,34816
 s_add_u32 m0, s53, 23552
 mf v,40,a,56,a,104
 buffer_load_dwordx4 v150, s[32:35], s62 offen lds
 s_add_u32 s62, s62, 65536
 mf v,56,a,56,a,108
 mf v,12,a,60,a,96
 tr a,52,140,32768
 mf v,28,a,60,a,100
 tr a,54,140,34816
 mf v,44,a,60,a,104
 mf v,60,a,60,a,108
 s_waitcnt lgkmcnt(4)
f_S0g18:
 s_waitcnt vmcnt(9)
 v_cmp_ne_u32 vcc, v144, v154
 s_cbranch_vccnz f_S0po
f_S0po_back:
 mf v,64,a,40,a,112
 tr a,56,151,32768
 mf v,80,a,40,a,116
 tr a,58,151,34816
 s_add_u32 m0, s53, 24576
 mf v,96,a,40,a,120
 buffer_load_dwordx4 v147, s[32:35], s62 offen lds
 mf v,112,a,40,a,124
 mf v,68,a,44,a,112
 tr a,60,152,32768
 mf v,84,a,44,a,116
 tr a,62,152,34816
 mf v,100,a,44,a,120
 buffer_load_dwordx4 v[208:211], v128, s[24:27], s54 offen offset:0 sc1
 mf v,116,a,44,a,124
 s_waitcnt lgkmcnt(4)
 mf v,72,a,48,a,112
 tr a,40,141,32768
 mf v,88,a,48,a,116
 tr a,42,141,34816
 s_add_u32 m0, s53, 25600
 mf v,104,a,48,a,120
 buffer_load_dwordx4 v148, s[32:35], s62 offen lds
 mf v,120,a,48,a,124
 mf v,76,a,52,a,112
 tr a,44,130,32768
 mf v,92,a,52,a,116
 tr a,46,130,34816
 mf v,108,a,52,a,120
 buffer_load_dwordx4 v[212:215], v128, s[24:27], s55 offen offset:0 sc1
 mf v,124,a,52,a,124
 s_waitcnt lgkmcnt(4)
 mf v,0,a,56,a,112
 tr a,48,135,36864
 mf v,16,a,56,a,116
 tr a,50,135,38912
 s_add_u32 m0, s53, 26624
 mf v,32,a,56,a,120
 buffer_load_dwordx4 v149, s[32:35], s62 offen lds
 mf v,48,a,56,a,124
 mf v,4,a,60,a,112
 tr a,52,136,36864
 mf v,20,a,60,a,116
 tr a,54,136,38912
 mf v,36,a,60,a,120
 buffer_load_dwordx4 v[216:219], v128, s[24:27], s56 offen offset:0 sc1
 mf v,52,a,60,a,124
 s_waitcnt lgkmcnt(4)
 mf v,8,a,40,a,112
 tr a,56,138,36864
 mf v,24,a,40,a,116
 tr a,58,138,38912
 s_add_u32 m0, s53, 27648
 mf v,40,a,40,a,120
 buffer_load_dwordx4 v150, s[32:35], s62 offen lds
 s_add_u32 s62, s62, 65536
 mf v,56,a,40,a,124
 mf v,12,a,44,a,112
 tr a,60,140,36864
 mf v,28,a,44,a,116
 tr a,62,140,38912
 mf v,44,a,44,a,120
 buffer_load_dwordx4 v[220:223], v128, s[24:27], s57 offen offset:0 sc1
 mf v,60,a,44,a,124
 s_waitcnt lgkmcnt(4)
f_S0g19:
 mf v,64,a,48,v,176
 tr a,40,151,36864
 mf v,80,a,48,v,180
 tr a,42,151,38912
 s_add_u32 m0, s53, 28672
 mf v,96,a,48,v,184
 buffer_load_dwordx4 v147, s[32:35], s62 offen lds
 mf v,112,a,48,v,188
 mf v,68,a,52,v,176
 tr a,44,152,36864
 mf v,84,a,52,v,180
 tr a,46,152,38912
 mf v,100,a,52,v,184
 buffer_load_dwordx4 a[176:179], v128, s[24:27], s54 offen offset:1024 sc1
 mf v,116,a,52,v,188
 s_waitcnt lgkmcnt(4)
 mf v,72,a,56,v,176
 tr a,48,141,36864
 mf v,88,a,56,v,180
 tr a,50,141,38912
 s_add_u32 m0, s53, 29696
 mf v,104,a,56,v,184
 buffer_load_dwordx4 v148, s[32:35], s62 offen lds
 mf v,120,a,56,v,188
 mf v,76,a,60,v,176
 tr a,52,130,36864
 mf v,92,a,60,v,180
 tr a,54,130,38912
 mf v,108,a,60,v,184
 buffer_load_dwordx4 a[180:183], v128, s[24:27], s55 offen offset:1024 sc1
 mf v,124,a,60,v,188
 s_waitcnt lgkmcnt(4)
 s_add_u32 m0, s53, 30720
 mf v,0,a,40,v,176
 buffer_load_dwordx4 v149, s[32:35], s62 offen lds
 mf v,16,a,40,v,180
 mf v,32,a,40,v,184
 buffer_load_dwordx4 a[184:187], v128, s[24:27], s56 offen offset:1024 sc1
 mf v,48,a,40,v,188
 s_waitcnt lgkmcnt(0)
 s_barrier
 mf v,4,a,44,v,176
 tr a,56,135,0
 mf v,20,a,44,v,180
 tr a,58,135,2048
 mf v,36,a,44,v,184
 tr a,60,136,0
 mf v,52,a,44,v,188
 tr a,62,136,2048
 mf v,8,a,48,v,176
 tr a,40,138,0
 mf v,24,a,48,v,180
 tr a,42,138,2048
 s_add_u32 m0, s53, 31744
 mf v,40,a,48,v,184
 buffer_load_dwordx4 v150, s[32:35], s62 offen lds
 s_add_u32 s62, s62, 65536
 mf v,56,a,48,v,188
 mf v,12,a,52,v,176
 tr a,44,140,0
 mf v,28,a,52,v,180
 tr a,46,140,2048
 mf v,44,a,52,v,184
 buffer_load_dwordx4 a[188:191], v128, s[24:27], s57 offen offset:1024 sc1
 mf v,60,a,52,v,188
 s_waitcnt lgkmcnt(4)
f_S0g20:
 mf v,64,a,56,a,128
 tr a,48,151,0
 mf v,80,a,56,a,132
 tr a,50,151,2048
 s_add_u32 m0, s53, 32768
 mf v,96,a,56,a,136
 buffer_load_dwordx4 v147, s[32:35], s62 offen lds
 mf v,112,a,56,a,140
 mf v,68,a,60,a,128
 tr a,52,152,0
 mf v,84,a,60,a,132
 tr a,54,152,2048
 mf v,100,a,60,a,136
 buffer_load_dwordx4 a[192:195], v128, s[24:27], s54 offen offset:2048 sc1
 mf v,116,a,60,a,140
 s_waitcnt lgkmcnt(4)
 mf v,72,a,40,a,128
 tr a,56,141,0
 mf v,88,a,40,a,132
 tr a,58,141,2048
 s_add_u32 m0, s53, 33792
 mf v,104,a,40,a,136
 buffer_load_dwordx4 v148, s[32:35], s62 offen lds
 mf v,120,a,40,a,140
 mf v,76,a,44,a,128
 tr a,60,130,0
 mf v,92,a,44,a,132
 tr a,62,130,2048
 mf v,108,a,44,a,136
 buffer_load_dwordx4 a[196:199], v128, s[24:27], s55 offen offset:2048 sc1
 mf v,124,a,44,a,140
 s_waitcnt lgkmcnt(4)
 mf v,0,a,48,a,128
 tr a,40,135,4096
 mf v,16,a,48,a,132
 tr a,42,135,6144
 s_add_u32 m0, s53, 34816
 mf v,32,a,48,a,136
 buffer_load_dwordx4 v149, s[32:35], s62 offen lds
 mf v,48,a,48,a,140
 mf v,4,a,52,a,128
 tr a,44,136,4096
 mf v,20,a,52,a,132
 tr a,46,136,6144
 mf v,36,a,52,a,136
 buffer_load_dwordx4 a[200:203], v128, s[24:27], s56 offen offset:2048 sc1
 mf v,52,a,52,a,140
 s_waitcnt lgkmcnt(4)
 mf v,8,a,56,a,128
 tr a,48,138,4096
 mf v,24,a,56,a,132
 tr a,50,138,6144
 s_add_u32 m0, s53, 35840
 mf v,40,a,56,a,136
 buffer_load_dwordx4 v150, s[32:35], s62 offen lds
 s_add_u32 s62, s62, 65536
 mf v,56,a,56,a,140
 mf v,12,a,60,a,128
 tr a,52,140,4096
 mf v,28,a,60,a,132
 tr a,54,140,6144
 mf v,44,a,60,a,136
 buffer_load_dwordx4 a[204:207], v128, s[24:27], s57 offen offset:2048 sc1
 mf v,60,a,60,a,140
 s_waitcnt lgkmcnt(4)
f_S0g21:
 mf v,64,a,40,v,192
 tr a,56,151,4096
 mf v,80,a,40,v,196
 tr a,58,151,6144
 s_add_u32 m0, s53, 36864
 mf v,96,a,40,v,200
 buffer_load_dwordx4 v147, s[32:35], s62 offen lds
 mf v,112,a,40,v,204
 mf v,68,a,44,v,192
 tr a,60,152,4096
 mf v,84,a,44,v,196
 tr a,62,152,6144
 mf v,100,a,44,v,200
 buffer_load_dwordx4 v[224:227], v128, s[24:27], s54 offen offset:3072 sc1
 s_add_u32 s54, s54, 4096
 mf v,116,a,44,v,204
 s_waitcnt lgkmcnt(4)
 mf v,72,a,48,v,192
 tr a,40,141,4096
 mf v,88,a,48,v,196
 tr a,42,141,6144
 s_add_u32 m0, s53, 37888
 mf v,104,a,48,v,200
 buffer_load_dwordx4 v148, s[32:35], s62 offen lds
 mf v,120,a,48,v,204
 mf v,76,a,52,v,192
 tr a,44,130,4096
 mf v,92,a,52,v,196
 tr a,46,130,6144
 mf v,108,a,52,v,200
 buffer_load_dwordx4 v[228:231], v128, s[24:27], s55 offen offset:3072 sc1
 s_add_u32 s55, s55, 4096
 mf v,124,a,52,v,204
 s_waitcnt lgkmcnt(4)
 s_add_u32 m0, s53, 38912
 mf v,0,a,56,v,192
 buffer_load_dwordx4 v149, s[32:35], s62 offen lds
 mf v,16,a,56,v,196
 mf v,32,a,56,v,200
 buffer_load_dwordx4 v[232:235], v128, s[24:27], s56 offen offset:3072 sc1
 s_add_u32 s56, s56, 4096
 mf v,48,a,56,v,204
 s_waitcnt lgkmcnt(0)
 s_barrier
 mf v,4,a,60,v,192
 tr a,48,135,8192
 mf v,20,a,60,v,196
 tr a,50,135,10240
 mf v,36,a,60,v,200
 tr a,52,136,8192
 mf v,52,a,60,v,204
 tr a,54,136,10240
 mf v,8,a,40,v,192
 tr a,56,138,8192
 mf v,24,a,40,v,196
 tr a,58,138,10240
 s_add_u32 m0, s53, 39936
 mf v,40,a,40,v,200
 buffer_load_dwordx4 v150, s[32:35], s62 offen lds
 s_add_u32 s62, s62, 65536
 mf v,56,a,40,v,204
 mf v,12,a,44,v,192
 tr a,60,140,8192
 mf v,28,a,44,v,196
 tr a,62,140,10240
 mf v,44,a,44,v,200
 buffer_load_dwordx4 v[236:239], v128, s[24:27], s57 offen offset:3072 sc1
 s_add_u32 s57, s57, 4096
 mf v,60,a,44,v,204
 s_waitcnt lgkmcnt(4)
f_S0g22:
 mf v,64,a,48,a,144
 tr a,40,151,8192
 mf v,80,a,48,a,148
 tr a,42,151,10240
 s_add_u32 m0, s53, 0
 mf v,96,a,48,a,152
 buffer_load_dwordx4 v147, s[32:35], s62 offen lds
 mf v,112,a,48,a,156
 mf v,68,a,52,a,144
 tr a,44,152,8192
 mf v,84,a,52,a,148
 tr a,46,152,10240
 mf v,100,a,52,a,152
 buffer_load_dwordx4 a[208:211], v128, s[24:27], s54 offen offset:0 sc1
 mf v,116,a,52,a,156
 s_waitcnt lgkmcnt(4)
 mf v,72,a,56,a,144
 tr a,48,141,8192
 mf v,88,a,56,a,148
 tr a,50,141,10240
 s_add_u32 m0, s53, 1024
 mf v,104,a,56,a,152
 buffer_load_dwordx4 v148, s[32:35], s62 offen lds
 mf v,120,a,56,a,156
 mf v,76,a,60,a,144
 tr a,52,130,8192
 mf v,92,a,60,a,148
 tr a,54,130,10240
 mf v,108,a,60,a,152
 buffer_load_dwordx4 a[212:215], v128, s[24:27], s55 offen offset:0 sc1
 mf v,124,a,60,a,156
 s_waitcnt lgkmcnt(4)
 mf v,0,a,40,a,144
 tr a,56,135,12288
 mf v,16,a,40,a,148
 tr a,58,135,14336
 s_add_u32 m0, s53, 2048
 mf v,32,a,40,a,152
 buffer_load_dwordx4 v149, s[32:35], s62 offen lds
 mf v,48,a,40,a,156
 mf v,4,a,44,a,144
 tr a,60,136,12288
 mf v,20,a,44,a,148
 tr a,62,136,14336
 mf v,36,a,44,a,152
 buffer_load_dwordx4 a[216:219], v128, s[24:27], s56 offen offset:0 sc1
 mf v,52,a,44,a,156
 s_waitcnt lgkmcnt(4)
 mf v,8,a,48,a,144
 tr a,40,138,12288
 mf v,24,a,48,a,148
 tr a,42,138,14336
 s_add_u32 m0, s53, 3072
 mf v,40,a,48,a,152
 buffer_load_dwordx4 v150, s[32:35], s62 offen lds
 s_add_u32 s62, s62, 65536
 mf v,56,a,48,a,156
 mf v,12,a,52,a,144
 tr a,44,140,12288
 mf v,28,a,52,a,148
 tr a,46,140,14336
 mf v,44,a,52,a,152
 buffer_load_dwordx4 a[220:223], v128, s[24:27], s57 offen offset:0 sc1
 mf v,60,a,52,a,156
 s_waitcnt vmcnt(45) lgkmcnt(4)
f_S0g23:
 mf v,64,a,56,a,160
 tr a,48,151,12288
 mf v,80,a,56,a,164
 tr a,50,151,14336
 s_add_u32 m0, s53, 4096
 mf v,96,a,56,a,168
 buffer_load_dwordx4 v147, s[32:35], s62 offen lds
 mf v,112,a,56,a,172
 mf v,68,a,60,a,160
 tr a,52,152,12288
 mf v,84,a,60,a,164
 tr a,54,152,14336
 mf v,100,a,60,a,168
 buffer_load_dwordx4 v[240:243], v128, s[24:27], s54 offen offset:1024 sc1
 mf v,116,a,60,a,172
 s_waitcnt lgkmcnt(4)
 mf v,72,a,40,a,160
 tr a,56,141,12288
 mf v,88,a,40,a,164
 tr a,58,141,14336
 s_add_u32 m0, s53, 5120
 mf v,104,a,40,a,168
 buffer_load_dwordx4 v148, s[32:35], s62 offen lds
 mf v,120,a,40,a,172
 mf v,76,a,44,a,160
 tr a,60,130,12288
 mf v,92,a,44,a,164
 tr a,62,130,14336
 mf v,108,a,44,a,168
 buffer_load_dwordx4 v[244:247], v128, s[24:27], s55 offen offset:1024 sc1
 mf v,124,a,44,a,172
 s_waitcnt lgkmcnt(4)
 s_add_u32 m0, s53, 6144
 mf v,0,a,48,a,160
 buffer_load_dwordx4 v149, s[32:35], s62 offen lds
 mf v,16,a,48,a,164
 mf v,32,a,48,a,168
 buffer_load_dwordx4 v[248:251], v128, s[24:27], s56 offen offset:1024 sc1
 mf v,48,a,48,a,172
 s_waitcnt vmcnt(46) lgkmcnt(0)
 s_barrier
 mf v,4,a,52,a,160
 tr a,40,135,16384
 mf v,20,a,52,a,164
 tr a,42,135,18432
 mf v,36,a,52,a,168
 tr a,44,136,16384
 mf v,52,a,52,a,172
 tr a,46,136,18432
 mf v,8,a,56,a,160
 tr a,48,138,16384
 mf v,24,a,56,a,164
 tr a,50,138,18432
 s_add_u32 m0, s53, 7168
 mf v,40,a,56,a,168
 buffer_load_dwordx4 v150, s[32:35], s62 offen lds
 mf v,56,a,56,a,172
 mf v,12,a,60,a,160
 tr a,52,140,16384
 mf v,28,a,60,a,164
 tr a,54,140,18432
 mf v,44,a,60,a,168
 buffer_load_dwordx4 v[252:255], v128, s[24:27], s57 offen offset:1024 sc1
 mf v,60,a,60,a,172
 s_waitcnt vmcnt(40) lgkmcnt(4)
f_S0p96:
f_S0o0:
 mf v,64,a,40,v,208
 tr a,56,135,20480
 mf v,80,a,40,v,212
 tr a,58,135,22528
 mf v,96,a,40,v,216
 buffer_load_dwordx4 a[224:227], v128, s[24:27], s54 offen offset:2048 sc1
 mf v,112,a,40,v,220
 mf v,68,a,44,v,208
 tr a,60,136,20480
 mf v,84,a,44,v,212
 tr a,62,136,22528
 mf v,100,a,44,v,216
 buffer_load_dwordx4 a[228:231], v128, s[24:27], s55 offen offset:2048 sc1
 mf v,116,a,44,v,220
 s_waitcnt lgkmcnt(4)
f_S0o1:
 mf v,72,a,48,v,208
 tr a,40,138,20480
 mf v,88,a,48,v,212
 tr a,42,138,22528
 mf v,104,a,48,v,216
 buffer_load_dwordx4 a[232:235], v128, s[24:27], s56 offen offset:2048 sc1
 mf v,120,a,48,v,220
 mf v,76,a,52,v,208
 tr a,44,140,20480
 mf v,92,a,52,v,212
 tr a,46,140,22528
 mf v,108,a,52,v,216
 buffer_load_dwordx4 a[236:239], v128, s[24:27], s57 offen offset:2048 sc1
 mf v,124,a,52,v,220
 s_waitcnt vmcnt(36) lgkmcnt(4)
f_S0o2:
 mf v,64,a,56,a,176
 buffer_load_dwordx4 a[240:243], v128, s[24:27], s54 offen offset:3072 sc1
 mf v,80,a,56,a,180
 mf v,96,a,56,a,184
 buffer_load_dwordx4 a[244:247], v128, s[24:27], s55 offen offset:3072 sc1
 mf v,112,a,56,a,188
 s_waitcnt lgkmcnt(0)
 s_barrier
 mf v,68,a,60,a,176
 tr a,48,135,24576
 mf v,84,a,60,a,180
 tr a,50,135,26624
 mf v,100,a,60,a,184
 tr a,52,136,24576
 mf v,116,a,60,a,188
 tr a,54,136,26624
f_S0o3:
 mf v,72,a,40,a,176
 tr a,56,138,24576
 mf v,88,a,40,a,180
 tr a,58,138,26624
 mf v,104,a,40,a,184
 buffer_load_dwordx4 a[248:251], v128, s[24:27], s56 offen offset:3072 sc1
 mf v,120,a,40,a,188
 mf v,76,a,44,a,176
 tr a,60,140,24576
 mf v,92,a,44,a,180
 tr a,62,140,26624
 mf v,108,a,44,a,184
 buffer_load_dwordx4 a[252:255], v128, s[24:27], s57 offen offset:3072 sc1
 mf v,124,a,44,a,188
 s_waitcnt vmcnt(32) lgkmcnt(4)
f_S0o4:
 mf v,64,a,48,a,192
 tr a,40,135,28672
 mf v,80,a,48,a,196
 tr a,42,135,30720
 mf v,96,a,48,a,200
 buffer_load_dwordx4 v[160:163], v153, s[40:43], s6 offen offset:0
 mf v,112,a,48,a,204
 mf v,68,a,52,a,192
 tr a,44,136,28672
 mf v,84,a,52,a,196
 tr a,46,136,30720
 mf v,100,a,52,a,200
 buffer_load_dwordx4 v[164:167], v153, s[40:43], s6 offen offset:64
 mf v,116,a,52,a,204
 s_waitcnt lgkmcnt(4)
f_S0o5:
 mf v,72,a,56,a,192
 tr a,48,138,28672
 mf v,88,a,56,a,196
 tr a,50,138,30720
 mf v,104,a,56,a,200
 buffer_load_dwordx4 v[168:171], v153, s[40:43], s7 offen offset:0
 mf v,120,a,56,a,204
 mf v,76,a,60,a,192
 tr a,52,140,28672
 mf v,92,a,60,a,196
 tr a,54,140,30720
 mf v,108,a,60,a,200
 buffer_load_dwordx4 v[172:175], v153, s[40:43], s7 offen offset:64
 mf v,124,a,60,a,204
 s_waitcnt vmcnt(28) lgkmcnt(4)
f_S0o6:
 mf v,64,a,40,v,224
 mf v,80,a,40,v,228
 mf v,96,a,40,v,232
 mf v,112,a,40,v,236
 s_waitcnt lgkmcnt(0)
 s_barrier
 mf v,68,a,44,v,224
 tr a,56,135,32768
 mf v,84,a,44,v,228
 tr a,58,135,34816
 mf v,100,a,44,v,232
 tr a,60,136,32768
 mf v,116,a,44,v,236
 tr a,62,136,34816
f_S0o7:
 mf v,72,a,48,v,224
 tr a,40,138,32768
 mf v,88,a,48,v,228
 tr a,42,138,34816
 mf v,104,a,48,v,232
 mf v,120,a,48,v,236
 mf v,76,a,52,v,224
 tr a,44,140,32768
 mf v,92,a,52,v,228
 tr a,46,140,34816
 mf v,108,a,52,v,232
 mf v,124,a,52,v,236
 s_waitcnt vmcnt(20) lgkmcnt(4)
f_S0o8:
 mf v,64,a,56,a,208
 tr a,48,135,36864
 mf v,80,a,56,a,212
 tr a,50,135,38912
 mf v,96,a,56,a,216
 mf v,112,a,56,a,220
 mf v,68,a,60,a,208
 tr a,52,136,36864
 mf v,84,a,60,a,212
 tr a,54,136,38912
 mf v,100,a,60,a,216
 mf v,116,a,60,a,220
 s_waitcnt lgkmcnt(4)
f_S0o9:
 mf v,72,a,40,a,208
 tr a,56,138,36864
 mf v,88,a,40,a,212
 tr a,58,138,38912
 mf v,104,a,40,a,216
 mf v,120,a,40,a,220
 mf v,76,a,44,a,208
 tr a,60,140,36864
 mf v,92,a,44,a,212
 tr a,62,140,38912
 mf v,108,a,44,a,216
 mf v,124,a,44,a,220
 s_waitcnt vmcnt(12) lgkmcnt(4)
f_S0o10:
 mf v,64,a,48,v,240
 mf v,80,a,48,v,244
 mf v,96,a,48,v,248
 mf v,112,a,48,v,252
 s_waitcnt lgkmcnt(0)
 s_barrier
 mf v,68,a,52,v,240
 tr a,40,135,0
 mf v,84,a,52,v,244
 tr a,42,135,2048
 mf v,100,a,52,v,248
 tr a,44,136,0
 mf v,116,a,52,v,252
 tr a,46,136,2048
f_S0o11:
 mf v,72,a,56,v,240
 tr a,48,138,0
 mf v,88,a,56,v,244
 tr a,50,138,2048
 mf v,104,a,56,v,248
 mf v,120,a,56,v,252
 mf v,76,a,60,v,240
 tr a,52,140,0
 mf v,92,a,60,v,244
 tr a,54,140,2048
 mf v,108,a,60,v,248
 mf v,124,a,60,v,252
 s_waitcnt vmcnt(8) lgkmcnt(4)
f_S0o12:
 mf v,64,a,40,a,224
 tr a,56,135,4096
 mf v,80,a,40,a,228
 tr a,58,135,6144
 mf v,96,a,40,a,232
 mf v,112,a,40,a,236
 mf v,68,a,44,a,224
 tr a,60,136,4096
 mf v,84,a,44,a,228
 tr a,62,136,6144
 mf v,100,a,44,a,232
 mf v,116,a,44,a,236
 s_waitcnt lgkmcnt(4)
f_S0o13:
 mf v,72,a,48,a,224
 tr a,40,138,4096
 mf v,88,a,48,a,228
 tr a,42,138,6144
 mf v,104,a,48,a,232
 mf v,120,a,48,a,236
 mf v,76,a,52,a,224
 tr a,44,140,4096
 mf v,92,a,52,a,228
 tr a,46,140,6144
 mf v,108,a,52,a,232
 mf v,124,a,52,a,236
 s_waitcnt vmcnt(4) lgkmcnt(4)
f_S0o14:
 mf v,96,a,56,a,248
 tr a,48,151,16384
 mf v,112,a,56,a,252
 tr a,50,151,18432
 mf v,64,a,56,a,240
 mf v,80,a,56,a,244
 mf v,100,a,60,a,248
 tr a,52,152,16384
 mf v,116,a,60,a,252
 tr a,54,152,18432
 mf v,68,a,60,a,240
 mf v,84,a,60,a,244
 s_waitcnt lgkmcnt(4)
f_S0o15:
 mf v,104,a,40,a,248
 tr a,56,151,20480
 mf v,120,a,40,a,252
 tr a,58,151,22528
 mf v,72,a,40,a,240
 ds_write_b128 v137, v[96:99] offset:8192
 mf v,88,a,40,a,244
 ds_write_b128 v137, v[112:115] offset:12288
 mf v,108,a,44,a,248
 tr a,60,152,20480
 mf v,124,a,44,a,252
 tr a,62,152,22528
 mf v,76,a,44,a,240
 ds_write_b128 v137, v[100:103] offset:9216
 mf v,92,a,44,a,244
 s_waitcnt lgkmcnt(7)
 ds_write_b128 v137, v[116:119] offset:13312
f_S0own:
f_S0o16:
 mf v,0,a,48,v,208
 tr a,40,151,24576
 mf v,16,a,48,v,212
 tr a,42,151,26624
 ds_write_b128 v137, v[104:107] offset:10240
 mf v,32,a,48,v,216
 ds_write_b128 v137, v[120:123] offset:14336
 ds_write_b128 v137, v[108:111] offset:11264
 mf v,48,a,48,v,220
 ds_write_b128 v137, v[124:127] offset:15360
 s_waitcnt lgkmcnt(0)
 s_barrier
 mf v,4,a,52,v,208
 tr a,44,152,24576
 ds_read_b128 v[96:99], v132 offset:8192
 mf v,20,a,52,v,212
 tr a,46,152,26624
 ds_read_b128 v[100:103], v132 offset:9216
 mf v,36,a,52,v,216
 ds_read_b128 v[104:107], v132 offset:10240
 ds_read_b128 v[108:111], v132 offset:11264
 mf v,52,a,52,v,220
 ds_read_b128 v[112:115], v132 offset:12288
 ds_read_b128 v[116:119], v132 offset:13312
f_S0o17:
 mf v,0,a,56,a,176
 tr a,48,151,28672
 ds_read_b128 v[120:123], v132 offset:14336
 mf v,16,a,56,a,180
 tr a,50,151,30720
 ds_read_b128 v[124:127], v132 offset:15360
 s_waitcnt lgkmcnt(10)
 mf v,32,a,56,a,184
 v_add_f32 v64, v64, v96
 v_add_f32 v65, v65, v97
 v_cvt_pk_bf16_f32 v64, v64, v65
 v_add_f32 v66, v66, v98
 mf v,48,a,56,a,188
 v_add_f32 v67, v67, v99
 v_cvt_pk_bf16_f32 v65, v66, v67
 s_waitcnt lgkmcnt(8)
 v_add_f32 v68, v68, v100
 mf v,4,a,60,a,176
 tr a,52,152,28672
 v_add_f32 v69, v69, v101
 v_mov_b32 v67, v144
 v_cvt_pk_bf16_f32 v66, v68, v69
 mf v,20,a,60,a,180
 tr a,54,152,30720
 buffer_store_dwordx4 v[64:67], v128, s[24:27], s58 offen offset:0 sc1
 v_add_f32 v70, v70, v102
 mf v,36,a,60,a,184
 v_add_f32 v71, v71, v103
 v_cvt_pk_bf16_f32 v68, v70, v71
 s_waitcnt lgkmcnt(9)
 v_add_f32 v72, v72, v104
 mf v,52,a,60,a,188
 v_add_f32 v73, v73, v105
 v_cvt_pk_bf16_f32 v69, v72, v73
 v_add_f32 v74, v74, v106
 v_add_f32 v75, v75, v107
f_S0o18:
 mf v,0,a,40,a,192
 tr a,56,151,32768
 v_mov_b32 v71, v144
 v_cvt_pk_bf16_f32 v70, v74, v75
 mf v,16,a,40,a,196
 tr a,58,151,34816
 buffer_store_dwordx4 v[68:71], v128, s[24:27], s58 offen offset:1024 sc1
 s_waitcnt lgkmcnt(10)
 mf v,32,a,40,a,200
 v_add_f32 v76, v76, v108
 v_add_f32 v77, v77, v109
 v_cvt_pk_bf16_f32 v72, v76, v77
 v_add_f32 v78, v78, v110
 mf v,48,a,40,a,204
 v_add_f32 v79, v79, v111
 v_cvt_pk_bf16_f32 v73, v78, v79
 s_waitcnt lgkmcnt(9)
 v_add_f32 v80, v80, v112
 mf v,4,a,44,a,192
 tr a,60,152,32768
 v_add_f32 v81, v81, v113
 v_mov_b32 v75, v144
 v_cvt_pk_bf16_f32 v74, v80, v81
 mf v,20,a,44,a,196
 tr a,62,152,34816
 buffer_store_dwordx4 v[72:75], v128, s[24:27], s58 offen offset:2048 sc1
 v_add_f32 v82, v82, v114
 mf v,36,a,44,a,200
 v_add_f32 v83, v83, v115
 v_cvt_pk_bf16_f32 v76, v82, v83
 s_waitcnt lgkmcnt(10)
 v_add_f32 v84, v84, v116
 mf v,52,a,44,a,204
 s_waitcnt lgkmcnt(4)
 v_add_f32 v85, v85, v117
 v_cvt_pk_bf16_f32 v77, v84, v85
 v_add_f32 v86, v86, v118
 v_add_f32 v87, v87, v119
f_S0o19:
 mf v,0,a,48,v,224
 tr a,40,151,36864
 v_mov_b32 v79, v144
 v_cvt_pk_bf16_f32 v78, v86, v87
 mf v,16,a,48,v,228
 tr a,42,151,38912
 buffer_store_dwordx4 v[76:79], v128, s[24:27], s58 offen offset:3072 sc1
 mf v,32,a,48,v,232
 v_add_f32 v88, v88, v120
 v_add_f32 v89, v89, v121
 v_cvt_pk_bf16_f32 v80, v88, v89
 v_add_f32 v90, v90, v122
 mf v,48,a,48,v,236
 v_add_f32 v91, v91, v123
 v_cvt_pk_bf16_f32 v81, v90, v91
 v_add_f32 v92, v92, v124
 mf v,4,a,52,v,224
 tr a,44,152,36864
 v_add_f32 v93, v93, v125
 v_mov_b32 v83, v144
 v_cvt_pk_bf16_f32 v82, v92, v93
 mf v,20,a,52,v,228
 tr a,46,152,38912
 buffer_store_dwordx4 v[80:83], v128, s[24:27], s59 offen offset:0 sc1
 v_add_f32 v94, v94, v126
 mf v,36,a,52,v,232
 v_add_f32 v95, v95, v127
 v_mov_b32 v85, v144
 v_cvt_pk_bf16_f32 v84, v94, v95
 mf v,52,a,52,v,236
 s_waitcnt lgkmcnt(4)
 buffer_store_dwordx2 v[84:85], v128, s[24:27], s59 offen offset:1024 sc1
 s_barrier
 s_waitcnt vmcnt(6)
f_S0o20:
 mf v,0,a,56,a,208
 tr a,48,151,0
 s_mov_b32 s10, 0xffff0000
 v_permlane16_swap_b32 v160, v162
 v_permlane16_swap_b32 v161, v163
 mf v,16,a,56,a,212
 tr a,50,151,2048
 v_permlane16_swap_b32 v164, v166
 v_permlane16_swap_b32 v165, v167
 v_permlane16_swap_b32 v168, v170
 mf v,32,a,56,a,216
 v_permlane16_swap_b32 v169, v171
 v_permlane16_swap_b32 v172, v174
 v_permlane16_swap_b32 v173, v175
 v_lshlrev_b32 v96, 16, v160
 mf v,48,a,56,a,220
 v_and_b32 v97, s10, v160
 v_lshlrev_b32 v98, 16, v161
 v_and_b32 v99, s10, v161
 v_lshlrev_b32 v100, 16, v162
 mf v,4,a,60,a,208
 tr a,52,152,0
 v_and_b32 v101, s10, v162
 v_lshlrev_b32 v102, 16, v163
 v_and_b32 v103, s10, v163
 mf v,20,a,60,a,212
 tr a,54,152,2048
 v_lshlrev_b32 v104, 16, v164
 v_and_b32 v105, s10, v164
 v_lshlrev_b32 v106, 16, v165
 mf v,36,a,60,a,216
 v_and_b32 v107, s10, v165
 v_lshlrev_b32 v108, 16, v166
 v_and_b32 v109, s10, v166
 v_lshlrev_b32 v110, 16, v167
 mf v,52,a,60,a,220
 s_waitcnt lgkmcnt(4)
 v_and_b32 v111, s10, v167
 v_lshlrev_b32 v112, 16, v168
 v_and_b32 v113, s10, v168
 v_lshlrev_b32 v114, 16, v169
f_S0o21:
 mf v,0,a,40,v,240
 tr a,56,151,4096
 v_and_b32 v115, s10, v169
 mf v,16,a,40,v,244
 tr a,58,151,6144
 v_lshlrev_b32 v116, 16, v170
 mf v,32,a,40,v,248
 v_and_b32 v117, s10, v170
 v_lshlrev_b32 v118, 16, v171
 mf v,48,a,40,v,252
 v_and_b32 v119, s10, v171
 v_lshlrev_b32 v120, 16, v172
 mf v,4,a,44,v,240
 tr a,60,152,4096
 v_and_b32 v121, s10, v172
 mf v,20,a,44,v,244
 tr a,62,152,6144
 v_lshlrev_b32 v122, 16, v173
 mf v,36,a,44,v,248
 v_and_b32 v123, s10, v173
 v_lshlrev_b32 v124, 16, v174
 mf v,52,a,44,v,252
 s_waitcnt lgkmcnt(4)
 v_and_b32 v125, s10, v174
 v_lshlrev_b32 v126, 16, v175
f_S0o22:
 mf v,0,a,48,a,224
 tr a,40,141,16384
 v_and_b32 v127, s10, v175
 mf v,16,a,48,a,228
 tr a,42,141,18432
 mf v,32,a,48,a,232
 mf v,48,a,48,a,236
 mf v,4,a,52,a,224
 tr a,44,130,16384
 mf v,20,a,52,a,228
 tr a,46,130,18432
 mf v,36,a,52,a,232
 mf v,52,a,52,a,236
 s_waitcnt lgkmcnt(4)
f_S0o23:
 mf v,32,a,56,a,248
 tr a,48,141,20480
 mf v,48,a,56,a,252
 tr a,50,141,22528
 mf v,0,a,56,a,240
 mf v,16,a,56,a,244
 mf v,36,a,60,a,248
 tr a,52,130,20480
 mf v,52,a,60,a,252
 tr a,54,130,22528
 mf v,4,a,60,a,240
 mf v,20,a,60,a,244
 s_waitcnt lgkmcnt(4)
f_S0o24:
 mf v,8,a,40,v,208
 tr a,56,141,24576
 mf v,24,a,40,v,212
 tr a,58,141,26624
 mf v,40,a,40,v,216
 ds_write_b128 v137, v[32:35] offset:8192
 mf v,56,a,40,v,220
 ds_write_b128 v137, v[48:51] offset:12288
 mf v,12,a,44,v,208
 tr a,60,130,24576
 mf v,28,a,44,v,212
 tr a,62,130,26624
 mf v,44,a,44,v,216
 ds_write_b128 v137, v[36:39] offset:9216
 mf v,60,a,44,v,220
 s_waitcnt lgkmcnt(7)
 ds_write_b128 v137, v[52:55] offset:13312
f_S0o25:
 mf v,8,a,48,a,176
 tr a,40,141,28672
 v_add_f32 v0, v0, v96
 mf v,24,a,48,a,180
 tr a,42,141,30720
 v_add_f32 v1, v1, v97
 mf v,40,a,48,a,184
 v_add_f32 v2, v2, v98
 v_add_f32 v3, v3, v99
 mf v,56,a,48,a,188
 v_add_f32 v4, v4, v100
 v_add_f32 v5, v5, v101
 mf v,12,a,52,a,176
 tr a,44,130,28672
 v_add_f32 v6, v6, v102
 mf v,28,a,52,a,180
 tr a,46,130,30720
 v_add_f32 v7, v7, v103
 mf v,44,a,52,a,184
 s_waitcnt lgkmcnt(4)
 s_barrier
 mf v,60,a,52,a,188
 ds_read_b128 v[32:35], v132 offset:8192
f_S0o26:
 mf v,8,a,56,a,192
 tr a,48,141,32768
 mf v,24,a,56,a,196
 tr a,50,141,34816
 mf v,40,a,56,a,200
 ds_read_b128 v[36:39], v132 offset:9216
 mf v,56,a,56,a,204
 ds_read_b128 v[48:51], v132 offset:12288
 mf v,12,a,60,a,192
 tr a,52,130,32768
 mf v,28,a,60,a,196
 tr a,54,130,34816
 mf v,44,a,60,a,200
 ds_read_b128 v[52:55], v132 offset:13312
 v_add_f32 v16, v16, v112
 mf v,60,a,60,a,204
 s_waitcnt lgkmcnt(8)
 v_add_f32 v17, v17, v113
 v_add_f32 v18, v18, v114
f_S0o27:
 mf v,8,a,40,v,224
 tr a,56,141,36864
 v_add_f32 v19, v19, v115
 mf v,24,a,40,v,228
 tr a,58,141,38912
 v_add_f32 v20, v20, v116
 mf v,40,a,40,v,232
 v_add_f32 v21, v21, v117
 v_add_f32 v22, v22, v118
 mf v,56,a,40,v,236
 v_add_f32 v23, v23, v119
 s_waitcnt lgkmcnt(9)
 mf v,12,a,44,v,224
 tr a,60,130,36864
 v_add_f32 v0, v0, v32
 mf v,28,a,44,v,228
 tr a,62,130,38912
 v_add_f32 v1, v1, v33
 mf v,44,a,44,v,232
 v_add_f32 v2, v2, v34
 v_add_f32 v3, v3, v35
 mf v,60,a,44,v,236
 s_waitcnt lgkmcnt(5)
 v_add_f32 v4, v4, v36
f_S0o28:
 mf v,8,a,48,a,208
 tr a,40,141,0
 v_add_f32 v5, v5, v37
 mf v,24,a,48,a,212
 tr a,42,141,2048
 v_add_f32 v6, v6, v38
 mf v,40,a,48,a,216
 buffer_load_dwordx4 v[176:179], v128, s[24:27], s60 offen offset:0 sc1
 v_add_f32 v7, v7, v39
 mf v,56,a,48,a,220
 v_add_f32 v16, v16, v48
 v_add_f32 v17, v17, v49
 mf v,12,a,52,a,208
 tr a,44,130,0
 v_add_f32 v18, v18, v50
 mf v,28,a,52,a,212
 tr a,46,130,2048
 v_add_f32 v19, v19, v51
 mf v,44,a,52,a,216
 buffer_load_dwordx4 v[180:183], v128, s[24:27], s60 offen offset:1024 sc1
 s_waitcnt lgkmcnt(8)
 mf v,60,a,52,a,220
 s_waitcnt lgkmcnt(4)
 v_add_f32 v20, v20, v52
 v_add_f32 v21, v21, v53
f_S0o29:
 mf v,8,a,56,v,240
 tr a,48,141,4096
 v_add_f32 v22, v22, v54
 mf v,24,a,56,v,244
 tr a,50,141,6144
 v_add_f32 v23, v23, v55
 mf v,40,a,56,v,248
 buffer_load_dwordx4 v[184:187], v128, s[24:27], s60 offen offset:2048 sc1
 mf v,56,a,56,v,252
 mf v,12,a,60,v,240
 tr a,52,130,4096
 mf v,28,a,60,v,244
 tr a,54,130,6144
 mf v,44,a,60,v,248
 buffer_load_dwordx4 v[188:191], v128, s[24:27], s60 offen offset:3072 sc1
 mf v,60,a,60,v,252
 s_waitcnt lgkmcnt(4)
f_S0o30:
 mf v,8,a,40,a,224
 mf v,24,a,40,a,228
 mf v,40,a,40,a,232
 buffer_load_dwordx4 v[192:195], v128, s[24:27], s61 offen offset:0 sc1
 mf v,56,a,40,a,236
 mf v,12,a,44,a,224
 mf v,28,a,44,a,228
 mf v,44,a,44,a,232
 buffer_load_dwordx2 v[196:197], v128, s[24:27], s61 offen offset:1024 sc1
 mf v,60,a,44,a,236
 s_waitcnt lgkmcnt(0)
f_S0o31:
 mf v,40,a,48,a,248
 mf v,56,a,48,a,252
 mf v,8,a,48,a,240
 mf v,24,a,48,a,244
 mf v,44,a,52,a,248
 mf v,60,a,52,a,252
 mf v,12,a,52,a,240
 mf v,28,a,52,a,244
 s_mov_b32 s69, 0
 ds_write_b128 v137, v[40:43] offset:10240
 ds_write_b128 v137, v[56:59] offset:14336
 s_nop 2
 ds_write_b128 v137, v[44:47] offset:11264
 ds_write_b128 v137, v[60:63] offset:15360
f_S0lm:
 v_pk_add_f32 v[8:9], v[8:9], v[104:105]
 v_pk_add_f32 v[10:11], v[10:11], v[106:107]
 v_pk_add_f32 v[24:25], v[24:25], v[120:121]
 v_pk_add_f32 v[26:27], v[26:27], v[122:123]
 v_pk_add_f32 v[12:13], v[12:13], v[108:109]
 v_pk_add_f32 v[14:15], v[14:15], v[110:111]
 v_pk_add_f32 v[28:29], v[28:29], v[124:125]
 v_pk_add_f32 v[30:31], v[30:31], v[126:127]
 s_waitcnt lgkmcnt(0)
 s_barrier
 ds_read_b128 v[40:43], v132 offset:10240
 ds_read_b128 v[44:47], v132 offset:11264
 ds_read_b128 v[56:59], v132 offset:14336
 ds_read_b128 v[60:63], v132 offset:15360
f_S0xa:
f_S0x1:
 s_waitcnt vmcnt(0)
 v_min3_u32 v64, v179, v183, v144
 v_max3_u32 v65, v179, v183, v144
 v_min3_u32 v64, v187, v191, v64
 v_max3_u32 v65, v187, v191, v65
 v_min3_u32 v64, v195, v197, v64
 v_max3_u32 v65, v195, v197, v65
 v_cmp_ne_u32 vcc, v64, v65
 s_cbranch_vccnz f_S0x0
f_S0x2:
 v_lshlrev_b32 v64, 16, v176
 v_and_b32 v65, s10, v176
 v_lshlrev_b32 v66, 16, v177
 v_and_b32 v67, s10, v177
 v_lshlrev_b32 v68, 16, v178
 v_and_b32 v69, s10, v178
 v_lshlrev_b32 v70, 16, v180
 v_and_b32 v71, s10, v180
 v_pk_add_f32 v[0:1], v[0:1], v[64:65]
 v_pk_add_f32 v[2:3], v[2:3], v[66:67]
 v_pk_add_f32 v[4:5], v[4:5], v[68:69]
 v_pk_add_f32 v[6:7], v[6:7], v[70:71]
 v_cvt_pk_bf16_f32 v72, v0, v1
 v_cvt_pk_bf16_f32 v74, v4, v5
 v_cvt_pk_bf16_f32 v73, v2, v3
 v_cvt_pk_bf16_f32 v75, v6, v7
 v_permlane16_swap_b32 v72, v74
 s_nop 0
 v_permlane16_swap_b32 v73, v75
 buffer_store_dwordx4 v[72:75], v153, s[20:23], s6 offen offset:0 sc1
 v_lshlrev_b32 v64, 16, v186
 v_and_b32 v65, s10, v186
 v_lshlrev_b32 v66, 16, v188
 v_and_b32 v67, s10, v188
 v_lshlrev_b32 v68, 16, v189
 v_and_b32 v69, s10, v189
 v_lshlrev_b32 v70, 16, v190
 v_and_b32 v71, s10, v190
 v_pk_add_f32 v[16:17], v[16:17], v[64:65]
 v_pk_add_f32 v[18:19], v[18:19], v[66:67]
 v_pk_add_f32 v[20:21], v[20:21], v[68:69]
 v_pk_add_f32 v[22:23], v[22:23], v[70:71]
 v_cvt_pk_bf16_f32 v80, v16, v17
 v_cvt_pk_bf16_f32 v82, v20, v21
 v_cvt_pk_bf16_f32 v81, v18, v19
 v_cvt_pk_bf16_f32 v83, v22, v23
 v_permlane16_swap_b32 v80, v82
 s_nop 0
 v_permlane16_swap_b32 v81, v83
 buffer_store_dwordx4 v[80:83], v153, s[20:23], s7 offen offset:0 sc1
 v_lshlrev_b32 v64, 16, v181
 v_and_b32 v65, s10, v181
 v_lshlrev_b32 v66, 16, v182
 v_and_b32 v67, s10, v182
 v_lshlrev_b32 v68, 16, v184
 v_and_b32 v69, s10, v184
 v_lshlrev_b32 v70, 16, v185
 v_and_b32 v71, s10, v185
 v_pk_add_f32 v[8:9], v[8:9], v[64:65]
 v_pk_add_f32 v[10:11], v[10:11], v[66:67]
 v_pk_add_f32 v[12:13], v[12:13], v[68:69]
 v_pk_add_f32 v[14:15], v[14:15], v[70:71]
 s_waitcnt lgkmcnt(2)
 v_pk_add_f32 v[8:9], v[8:9], v[40:41]
 v_pk_add_f32 v[10:11], v[10:11], v[42:43]
 v_pk_add_f32 v[12:13], v[12:13], v[44:45]
 v_pk_add_f32 v[14:15], v[14:15], v[46:47]
 v_cvt_pk_bf16_f32 v76, v8, v9
 v_cvt_pk_bf16_f32 v78, v12, v13
 v_cvt_pk_bf16_f32 v77, v10, v11
 v_cvt_pk_bf16_f32 v79, v14, v15
 v_permlane16_swap_b32 v76, v78
 s_nop 0
 v_permlane16_swap_b32 v77, v79
 buffer_store_dwordx4 v[76:79], v153, s[20:23], s6 offen offset:64 sc1
 v_lshlrev_b32 v64, 16, v192
 v_and_b32 v65, s10, v192
 v_lshlrev_b32 v66, 16, v193
 v_and_b32 v67, s10, v193
 v_lshlrev_b32 v68, 16, v194
 v_and_b32 v69, s10, v194
 v_lshlrev_b32 v70, 16, v196
 v_and_b32 v71, s10, v196
 v_pk_add_f32 v[24:25], v[24:25], v[64:65]
 v_pk_add_f32 v[26:27], v[26:27], v[66:67]
 v_pk_add_f32 v[28:29], v[28:29], v[68:69]
 v_pk_add_f32 v[30:31], v[30:31], v[70:71]
 s_waitcnt lgkmcnt(0)
 v_pk_add_f32 v[24:25], v[24:25], v[56:57]
 v_pk_add_f32 v[26:27], v[26:27], v[58:59]
 v_pk_add_f32 v[28:29], v[28:29], v[60:61]
 v_pk_add_f32 v[30:31], v[30:31], v[62:63]
 v_cvt_pk_bf16_f32 v84, v24, v25
 v_cvt_pk_bf16_f32 v86, v28, v29
 v_cvt_pk_bf16_f32 v85, v26, v27
 v_cvt_pk_bf16_f32 v87, v30, v31
 v_permlane16_swap_b32 v84, v86
 s_nop 0
 v_permlane16_swap_b32 v85, v87
 buffer_store_dwordx4 v[84:87], v153, s[20:23], s7 offen offset:64 sc1
f_S0end:
 s_endpgm
f_S0x0:
 s_add_u32 s69, s69, 1
 s_cmp_lt_u32 s69, 0x8000
 s_cbranch_scc0 f_S0x2
 buffer_load_dwordx4 v[176:179], v128, s[24:27], s60 offen offset:0 sc1
 buffer_load_dwordx4 v[180:183], v128, s[24:27], s60 offen offset:1024 sc1
 buffer_load_dwordx4 v[184:187], v128, s[24:27], s60 offen offset:2048 sc1
 buffer_load_dwordx4 v[188:191], v128, s[24:27], s60 offen offset:3072 sc1
 buffer_load_dwordx4 v[192:195], v128, s[24:27], s61 offen offset:0 sc1
 buffer_load_dwordx2 v[196:197], v128, s[24:27], s61 offen offset:1024 sc1
 s_branch f_S0x1
f_S0po:
 s_mov_b32 s69, 0
f_S0po_1:
 s_sleep 1
 buffer_load_dword v154, v145, s[24:27], s76 offen offset:0 sc1
 s_add_u32 s69, s69, 1
 s_waitcnt vmcnt(0)
 v_cmp_ne_u32 vcc, v144, v154
 s_cmp_lt_u32 s69, 0x8000
 s_cbranch_scc0 f_S0po_back
 s_cbranch_vccnz f_S0po_1
 s_branch f_S0po_back
f_L0g:
 s_waitcnt lgkmcnt(4)
f_L0g0:
 v_mfma_f32_16x16x32_bf16 v[64:67], a[40:43], v[160:163], 0
 tr a,56,151,0
 v_mfma_f32_16x16x32_bf16 v[80:83], a[40:43], v[164:167], 0
 tr a,58,151,2048
 s_add_u32 m0, s53, 32768
 v_mfma_f32_16x16x32_bf16 v[96:99], a[40:43], v[168:171], 0
 buffer_load_dwordx4 v147, s[28:31], s62 offen lds
 s_mul_i32 s10, s44, 7
 v_mfma_f32_16x16x32_bf16 v[112:115], a[40:43], v[172:175], 0
 s_sub_u32 s9, s9, s10
 v_mfma_f32_16x16x32_bf16 v[68:71], a[44:47], v[160:163], 0
 tr a,60,152,0
 v_mfma_f32_16x16x32_bf16 v[84:87], a[44:47], v[164:167], 0
 tr a,62,152,2048
 v_mfma_f32_16x16x32_bf16 v[100:103], a[44:47], v[168:171], 0
 v_mfma_f32_16x16x32_bf16 v[116:119], a[44:47], v[172:175], 0
 s_waitcnt lgkmcnt(4)
 v_mfma_f32_16x16x32_bf16 v[72:75], a[48:51], v[160:163], 0
 tr a,40,141,0
 v_mfma_f32_16x16x32_bf16 v[88:91], a[48:51], v[164:167], 0
 tr a,42,141,2048
 s_add_u32 m0, s53, 33792
 v_mfma_f32_16x16x32_bf16 v[104:107], a[48:51], v[168:171], 0
 buffer_load_dwordx4 v148, s[28:31], s62 offen lds
 v_mfma_f32_16x16x32_bf16 v[120:123], a[48:51], v[172:175], 0
 v_mfma_f32_16x16x32_bf16 v[76:79], a[52:55], v[160:163], 0
 tr a,44,130,0
 v_mfma_f32_16x16x32_bf16 v[92:95], a[52:55], v[164:167], 0
 tr a,46,130,2048
 v_mfma_f32_16x16x32_bf16 v[108:111], a[52:55], v[168:171], 0
 v_mfma_f32_16x16x32_bf16 v[124:127], a[52:55], v[172:175], 0
 s_waitcnt lgkmcnt(4)
 v_mfma_f32_16x16x32_bf16 v[0:3], a[56:59], v[160:163], 0
 tr a,48,135,4096
 v_mfma_f32_16x16x32_bf16 v[16:19], a[56:59], v[164:167], 0
 tr a,50,135,6144
 s_add_u32 m0, s53, 34816
 v_mfma_f32_16x16x32_bf16 v[32:35], a[56:59], v[168:171], 0
 buffer_load_dwordx4 v149, s[28:31], s62 offen lds
 v_mfma_f32_16x16x32_bf16 v[48:51], a[56:59], v[172:175], 0
 v_mfma_f32_16x16x32_bf16 v[4:7], a[60:63], v[160:163], 0
 tr a,52,136,4096
 v_mfma_f32_16x16x32_bf16 v[20:23], a[60:63], v[164:167], 0
 tr a,54,136,6144
 v_mfma_f32_16x16x32_bf16 v[36:39], a[60:63], v[168:171], 0
 v_mfma_f32_16x16x32_bf16 v[52:55], a[60:63], v[172:175], 0
 s_waitcnt lgkmcnt(4)
 v_mfma_f32_16x16x32_bf16 v[8:11], a[40:43], v[160:163], 0
 tr a,56,138,4096
 v_mfma_f32_16x16x32_bf16 v[24:27], a[40:43], v[164:167], 0
 tr a,58,138,6144
 s_add_u32 m0, s53, 35840
 v_mfma_f32_16x16x32_bf16 v[40:43], a[40:43], v[168:171], 0
 buffer_load_dwordx4 v150, s[28:31], s62 offen lds
 s_add_u32 s62, s62, 65536
 v_mfma_f32_16x16x32_bf16 v[56:59], a[40:43], v[172:175], 0
 v_mfma_f32_16x16x32_bf16 v[12:15], a[44:47], v[160:163], 0
 tr a,60,140,4096
 v_mfma_f32_16x16x32_bf16 v[28:31], a[44:47], v[164:167], 0
 tr a,62,140,6144
 v_mfma_f32_16x16x32_bf16 v[44:47], a[44:47], v[168:171], 0
 v_mfma_f32_16x16x32_bf16 v[60:63], a[44:47], v[172:175], 0
 s_waitcnt lgkmcnt(4)
f_L0g1:
 mf v,64,a,48,a,96
 tr a,40,151,4096
 mf v,80,a,48,a,100
 tr a,42,151,6144
 s_add_u32 m0, s53, 36864
 mf v,96,a,48,a,104
 buffer_load_dwordx4 v147, s[28:31], s62 offen lds
 mf v,112,a,48,a,108
 mf v,68,a,52,a,96
 tr a,44,152,4096
 mf v,84,a,52,a,100
 tr a,46,152,6144
 mf v,100,a,52,a,104
 buffer_load_dwordx4 v[160:163], v128, s[24:27], s54 offen offset:0 sc1
 mf v,116,a,52,a,108
 s_waitcnt lgkmcnt(4)
 mf v,72,a,56,a,96
 tr a,48,141,4096
 mf v,88,a,56,a,100
 tr a,50,141,6144
 s_add_u32 m0, s53, 37888
 mf v,104,a,56,a,104
 buffer_load_dwordx4 v148, s[28:31], s62 offen lds
 mf v,120,a,56,a,108
 mf v,76,a,60,a,96
 tr a,52,130,4096
 mf v,92,a,60,a,100
 tr a,54,130,6144
 mf v,108,a,60,a,104
 buffer_load_dwordx4 v[164:167], v128, s[24:27], s55 offen offset:0 sc1
 mf v,124,a,60,a,108
 s_waitcnt lgkmcnt(4)
 s_add_u32 m0, s53, 38912
 mf v,0,a,40,a,96
 buffer_load_dwordx4 v149, s[28:31], s62 offen lds
 mf v,16,a,40,a,100
 mf v,32,a,40,a,104
 buffer_load_dwordx4 v[168:171], v128, s[24:27], s56 offen offset:0 sc1
 mf v,48,a,40,a,108
 s_waitcnt lgkmcnt(0)
 s_barrier
 mf v,4,a,44,a,96
 tr a,56,135,8192
 mf v,20,a,44,a,100
 tr a,58,135,10240
 mf v,36,a,44,a,104
 tr a,60,136,8192
 mf v,52,a,44,a,108
 tr a,62,136,10240
 mf v,8,a,48,a,96
 tr a,40,138,8192
 mf v,24,a,48,a,100
 tr a,42,138,10240
 s_add_u32 m0, s53, 39936
 mf v,40,a,48,a,104
 buffer_load_dwordx4 v150, s[28:31], s62 offen lds
 s_add_u32 s62, s62, 65536
 mf v,56,a,48,a,108
 mf v,12,a,52,a,96
 tr a,44,140,8192
 mf v,28,a,52,a,100
 tr a,46,140,10240
 mf v,44,a,52,a,104
 mf v,60,a,52,a,108
 s_waitcnt lgkmcnt(4)
f_L0g2:
 mf v,64,a,56,a,112
 tr a,48,151,8192
 mf v,80,a,56,a,116
 tr a,50,151,10240
 s_add_u32 m0, s53, 0
 mf v,96,a,56,a,120
 buffer_load_dwordx4 v147, s[28:31], s62 offen lds
 mf v,112,a,56,a,124
 mf v,68,a,60,a,112
 tr a,52,152,8192
 mf v,84,a,60,a,116
 tr a,54,152,10240
 mf v,100,a,60,a,120
 buffer_load_dwordx4 v[172:175], v128, s[24:27], s57 offen offset:0 sc1
 mf v,116,a,60,a,124
 s_waitcnt lgkmcnt(4)
 mf v,72,a,40,a,112
 tr a,56,141,8192
 mf v,88,a,40,a,116
 tr a,58,141,10240
 s_add_u32 m0, s53, 1024
 mf v,104,a,40,a,120
 buffer_load_dwordx4 v148, s[28:31], s62 offen lds
 mf v,120,a,40,a,124
 mf v,76,a,44,a,112
 tr a,60,130,8192
 mf v,92,a,44,a,116
 tr a,62,130,10240
 mf v,108,a,44,a,120
 buffer_load_dwordx4 a[96:99], v128, s[24:27], s54 offen offset:1024 sc1
 mf v,124,a,44,a,124
 s_waitcnt lgkmcnt(4)
 mf v,0,a,48,a,112
 tr a,40,135,12288
 mf v,16,a,48,a,116
 tr a,42,135,14336
 s_add_u32 m0, s53, 2048
 mf v,32,a,48,a,120
 buffer_load_dwordx4 v149, s[28:31], s62 offen lds
 mf v,48,a,48,a,124
 mf v,4,a,52,a,112
 tr a,44,136,12288
 mf v,20,a,52,a,116
 tr a,46,136,14336
 mf v,36,a,52,a,120
 buffer_load_dwordx4 a[100:103], v128, s[24:27], s55 offen offset:1024 sc1
 mf v,52,a,52,a,124
 s_waitcnt lgkmcnt(4)
 mf v,8,a,56,a,112
 tr a,48,138,12288
 mf v,24,a,56,a,116
 tr a,50,138,14336
 s_add_u32 m0, s53, 3072
 mf v,40,a,56,a,120
 buffer_load_dwordx4 v150, s[28:31], s62 offen lds
 s_add_u32 s62, s62, 65536
 mf v,56,a,56,a,124
 mf v,12,a,60,a,112
 tr a,52,140,12288
 mf v,28,a,60,a,116
 tr a,54,140,14336
 mf v,44,a,60,a,120
 mf v,60,a,60,a,124
 s_waitcnt lgkmcnt(4)
 s_waitcnt vmcnt(18)
f_L0g3:
 mf v,64,a,40,v,176
 tr a,56,151,12288
 mf v,80,a,40,v,180
 tr a,58,151,14336
 s_add_u32 m0, s53, 4096
 mf v,96,a,40,v,184
 buffer_load_dwordx4 v147, s[28:31], s62 offen lds
 mf v,112,a,40,v,188
 mf v,68,a,44,v,176
 tr a,60,152,12288
 mf v,84,a,44,v,180
 tr a,62,152,14336
 mf v,100,a,44,v,184
 buffer_store_dword v144, v143, s[24:27], s75 offen sc1
 s_add_u32 s76, s76, 65536
 mf v,116,a,44,v,188
 s_waitcnt lgkmcnt(4)
 mf v,72,a,48,v,176
 tr a,40,141,12288
 mf v,88,a,48,v,180
 tr a,42,141,14336
 s_add_u32 m0, s53, 5120
 mf v,104,a,48,v,184
 buffer_load_dwordx4 v148, s[28:31], s62 offen lds
 mf v,120,a,48,v,188
 mf v,76,a,52,v,176
 tr a,44,130,12288
 mf v,92,a,52,v,180
 tr a,46,130,14336
 mf v,108,a,52,v,184
 buffer_load_dwordx4 a[104:107], v128, s[24:27], s56 offen offset:1024 sc1
 mf v,124,a,52,v,188
 s_waitcnt lgkmcnt(4)
 s_add_u32 m0, s53, 6144
 mf v,0,a,56,v,176
 buffer_load_dwordx4 v149, s[28:31], s62 offen lds
 mf v,16,a,56,v,180
 mf v,32,a,56,v,184
 buffer_load_dwordx4 a[108:111], v128, s[24:27], s57 offen offset:1024 sc1
 mf v,48,a,56,v,188
 s_waitcnt lgkmcnt(0)
 s_barrier
 mf v,4,a,60,v,176
 tr a,48,135,16384
 mf v,20,a,60,v,180
 tr a,50,135,18432
 mf v,36,a,60,v,184
 tr a,52,136,16384
 mf v,52,a,60,v,188
 tr a,54,136,18432
 mf v,8,a,40,v,176
 tr a,56,138,16384
 mf v,24,a,40,v,180
 tr a,58,138,18432
 s_add_u32 m0, s53, 7168
 mf v,40,a,40,v,184
 buffer_load_dwordx4 v150, s[28:31], s62 offen lds
 s_add_u32 s62, s62, s46
 mf v,56,a,40,v,188
 mf v,12,a,44,v,176
 tr a,60,140,16384
 mf v,28,a,44,v,180
 tr a,62,140,18432
 mf v,44,a,44,v,184
 mf v,60,a,44,v,188
 s_waitcnt lgkmcnt(4)
f_L0g4:
 mf v,64,a,48,a,128
 tr a,40,151,16384
 mf v,80,a,48,a,132
 tr a,42,151,18432
 s_add_u32 m0, s53, 8192
 mf v,96,a,48,a,136
 buffer_load_dwordx4 v147, s[28:31], s62 offen lds
 mf v,112,a,48,a,140
 mf v,68,a,52,a,128
 tr a,44,152,16384
 mf v,84,a,52,a,132
 tr a,46,152,18432
 mf v,100,a,52,a,136
 buffer_load_dwordx4 a[112:115], v128, s[24:27], s54 offen offset:2048 sc1
 mf v,116,a,52,a,140
 s_waitcnt lgkmcnt(4)
 mf v,72,a,56,a,128
 tr a,48,141,16384
 mf v,88,a,56,a,132
 tr a,50,141,18432
 s_add_u32 m0, s53, 9216
 mf v,104,a,56,a,136
 buffer_load_dwordx4 v148, s[28:31], s62 offen lds
 mf v,120,a,56,a,140
 mf v,76,a,60,a,128
 tr a,52,130,16384
 mf v,92,a,60,a,132
 tr a,54,130,18432
 mf v,108,a,60,a,136
 buffer_load_dwordx4 a[116:119], v128, s[24:27], s55 offen offset:2048 sc1
 mf v,124,a,60,a,140
 s_waitcnt lgkmcnt(4)
 mf v,0,a,40,a,128
 tr a,56,135,20480
 mf v,16,a,40,a,132
 tr a,58,135,22528
 s_add_u32 m0, s53, 10240
 mf v,32,a,40,a,136
 buffer_load_dwordx4 v149, s[28:31], s62 offen lds
 mf v,48,a,40,a,140
 mf v,4,a,44,a,128
 tr a,60,136,20480
 mf v,20,a,44,a,132
 tr a,62,136,22528
 mf v,36,a,44,a,136
 buffer_load_dwordx4 a[120:123], v128, s[24:27], s56 offen offset:2048 sc1
 mf v,52,a,44,a,140
 s_waitcnt lgkmcnt(4)
 mf v,8,a,48,a,128
 tr a,40,138,20480
 mf v,24,a,48,a,132
 tr a,42,138,22528
 s_add_u32 m0, s53, 11264
 mf v,40,a,48,a,136
 buffer_load_dwordx4 v150, s[28:31], s62 offen lds
 s_add_u32 s62, s62, 65536
 mf v,56,a,48,a,140
 mf v,12,a,52,a,128
 tr a,44,140,20480
 mf v,28,a,52,a,132
 tr a,46,140,22528
 mf v,44,a,52,a,136
 mf v,60,a,52,a,140
 s_waitcnt lgkmcnt(4)
f_L0g5:
 mf v,64,a,56,v,192
 tr a,48,151,20480
 mf v,80,a,56,v,196
 tr a,50,151,22528
 s_add_u32 m0, s53, 12288
 mf v,96,a,56,v,200
 buffer_load_dwordx4 v147, s[28:31], s62 offen lds
 mf v,112,a,56,v,204
 mf v,68,a,60,v,192
 tr a,52,152,20480
 mf v,84,a,60,v,196
 tr a,54,152,22528
 mf v,100,a,60,v,200
 buffer_load_dwordx4 a[124:127], v128, s[24:27], s57 offen offset:2048 sc1
 mf v,116,a,60,v,204
 s_waitcnt lgkmcnt(4)
 mf v,72,a,40,v,192
 tr a,56,141,20480
 mf v,88,a,40,v,196
 tr a,58,141,22528
 s_add_u32 m0, s53, 13312
 mf v,104,a,40,v,200
 buffer_load_dwordx4 v148, s[28:31], s62 offen lds
 mf v,120,a,40,v,204
 mf v,76,a,44,v,192
 tr a,60,130,20480
 mf v,92,a,44,v,196
 tr a,62,130,22528
 mf v,108,a,44,v,200
 buffer_load_dwordx4 v[176:179], v128, s[24:27], s54 offen offset:3072 sc1
 s_add_u32 s54, s54, s44
 mf v,124,a,44,v,204
 s_waitcnt lgkmcnt(4)
 s_add_u32 m0, s53, 14336
 mf v,0,a,48,v,192
 buffer_load_dwordx4 v149, s[28:31], s62 offen lds
 mf v,16,a,48,v,196
 mf v,32,a,48,v,200
 buffer_load_dwordx4 v[180:183], v128, s[24:27], s55 offen offset:3072 sc1
 s_add_u32 s55, s55, s44
 mf v,48,a,48,v,204
 s_waitcnt lgkmcnt(0)
 s_barrier
 mf v,4,a,52,v,192
 tr a,40,135,24576
 mf v,20,a,52,v,196
 tr a,42,135,26624
 mf v,36,a,52,v,200
 tr a,44,136,24576
 mf v,52,a,52,v,204
 tr a,46,136,26624
 mf v,8,a,56,v,192
 tr a,48,138,24576
 mf v,24,a,56,v,196
 tr a,50,138,26624
 s_add_u32 m0, s53, 15360
 mf v,40,a,56,v,200
 buffer_load_dwordx4 v150, s[28:31], s62 offen lds
 s_add_u32 s62, s62, 65536
 mf v,56,a,56,v,204
 mf v,12,a,60,v,192
 tr a,52,140,24576
 mf v,28,a,60,v,196
 tr a,54,140,26624
 mf v,44,a,60,v,200
 mf v,60,a,60,v,204
 s_waitcnt lgkmcnt(4)
f_L0g6:
 mf v,64,a,40,a,144
 tr a,56,151,24576
 mf v,80,a,40,a,148
 tr a,58,151,26624
 s_add_u32 m0, s53, 16384
 mf v,96,a,40,a,152
 buffer_load_dwordx4 v147, s[28:31], s62 offen lds
 mf v,112,a,40,a,156
 mf v,68,a,44,a,144
 tr a,60,152,24576
 mf v,84,a,44,a,148
 tr a,62,152,26624
 s_mov_b32 s69, f_L0p48-f_base
 mf v,100,a,44,a,152
 buffer_load_dword v129, v155, s[36:39], s69 offen
 mf v,116,a,44,a,156
 s_waitcnt lgkmcnt(4)
 mf v,72,a,48,a,144
 tr a,40,141,24576
 mf v,88,a,48,a,148
 tr a,42,141,26624
 s_add_u32 m0, s53, 17408
 mf v,104,a,48,a,152
 buffer_load_dwordx4 v148, s[28:31], s62 offen lds
 mf v,120,a,48,a,156
 mf v,76,a,52,a,144
 tr a,44,130,24576
 mf v,92,a,52,a,148
 tr a,46,130,26624
 mf v,108,a,52,a,152
 buffer_load_dwordx4 v[184:187], v128, s[24:27], s56 offen offset:3072 sc1
 s_add_u32 s56, s56, s44
 mf v,124,a,52,a,156
 s_waitcnt lgkmcnt(4)
 mf v,0,a,56,a,144
 tr a,48,135,28672
 mf v,16,a,56,a,148
 tr a,50,135,30720
 s_add_u32 m0, s53, 18432
 mf v,32,a,56,a,152
 buffer_load_dwordx4 v149, s[28:31], s62 offen lds
 mf v,48,a,56,a,156
 mf v,4,a,60,a,144
 tr a,52,136,28672
 mf v,20,a,60,a,148
 tr a,54,136,30720
 mf v,36,a,60,a,152
 buffer_load_dwordx4 v[188:191], v128, s[24:27], s57 offen offset:3072 sc1
 s_add_u32 s57, s57, s44
 mf v,52,a,60,a,156
 s_waitcnt lgkmcnt(4)
 mf v,8,a,40,a,144
 tr a,56,138,28672
 mf v,24,a,40,a,148
 tr a,58,138,30720
 s_add_u32 m0, s53, 19456
 mf v,40,a,40,a,152
 buffer_load_dwordx4 v150, s[28:31], s62 offen lds
 s_add_u32 s62, s62, 65536
 mf v,56,a,40,a,156
 mf v,12,a,44,a,144
 tr a,60,140,28672
 mf v,28,a,44,a,148
 tr a,62,140,30720
 mf v,44,a,44,a,152
 mf v,60,a,44,a,156
 s_waitcnt lgkmcnt(4)
f_L0g7:
 mf v,64,a,48,a,160
 tr a,40,151,28672
 mf v,80,a,48,a,164
 tr a,42,151,30720
 s_add_u32 m0, s53, 20480
 mf v,96,a,48,a,168
 buffer_load_dwordx4 v147, s[28:31], s62 offen lds
 mf v,112,a,48,a,172
 mf v,68,a,52,a,160
 tr a,44,152,28672
 mf v,84,a,52,a,164
 tr a,46,152,30720
 mf v,100,a,52,a,168
 buffer_load_dwordx4 a[128:131], v128, s[24:27], s54 offen offset:0 sc1
 mf v,116,a,52,a,172
 s_waitcnt lgkmcnt(4)
 mf v,72,a,56,a,160
 tr a,48,141,28672
 mf v,88,a,56,a,164
 tr a,50,141,30720
 s_add_u32 m0, s53, 21504
 mf v,104,a,56,a,168
 buffer_load_dwordx4 v148, s[28:31], s62 offen lds
 mf v,120,a,56,a,172
 mf v,76,a,60,a,160
 tr a,52,130,28672
 mf v,92,a,60,a,164
 tr a,54,130,30720
 mf v,108,a,60,a,168
 buffer_load_dwordx4 a[132:135], v128, s[24:27], s55 offen offset:0 sc1
 mf v,124,a,60,a,172
 s_waitcnt lgkmcnt(4)
 s_add_u32 m0, s53, 22528
 mf v,0,a,40,a,160
 buffer_load_dwordx4 v149, s[28:31], s62 offen lds
 mf v,16,a,40,a,164
 mf v,32,a,40,a,168
 buffer_load_dwordx4 a[136:139], v128, s[24:27], s56 offen offset:0 sc1
 mf v,48,a,40,a,172
 s_waitcnt vmcnt(41) lgkmcnt(0)
 s_barrier
 mf v,4,a,44,a,160
 tr a,56,135,32768
 mf v,20,a,44,a,164
 tr a,58,135,34816
 mf v,36,a,44,a,168
 tr a,60,136,32768
 mf v,52,a,44,a,172
 tr a,62,136,34816
 mf v,8,a,48,a,160
 tr a,40,138,32768
 mf v,24,a,48,a,164
 tr a,42,138,34816
 s_add_u32 m0, s53, 23552
 mf v,40,a,48,a,168
 buffer_load_dwordx4 v150, s[28:31], s62 offen lds
 s_add_u32 s62, s62, s46
 mf v,56,a,48,a,172
 mf v,12,a,52,a,160
 tr a,44,140,32768
 mf v,28,a,52,a,164
 tr a,46,140,34816
 mf v,44,a,52,a,168
 mf v,60,a,52,a,172
 s_waitcnt lgkmcnt(4)
f_L0g8:
 mf v,64,a,56,v,208
 tr a,48,151,32768
 mf v,80,a,56,v,212
 tr a,50,151,34816
 s_add_u32 m0, s53, 24576
 mf v,96,a,56,v,216
 buffer_load_dwordx4 v147, s[28:31], s62 offen lds
 mf v,112,a,56,v,220
 mf v,68,a,60,v,208
 tr a,52,152,32768
 mf v,84,a,60,v,212
 tr a,54,152,34816
 mf v,100,a,60,v,216
 buffer_load_dwordx4 a[140:143], v128, s[24:27], s57 offen offset:0 sc1
 mf v,116,a,60,v,220
 s_waitcnt lgkmcnt(4)
 mf v,72,a,40,v,208
 tr a,56,141,32768
 mf v,88,a,40,v,212
 tr a,58,141,34816
 s_add_u32 m0, s53, 25600
 mf v,104,a,40,v,216
 buffer_load_dwordx4 v148, s[28:31], s62 offen lds
 mf v,120,a,40,v,220
 mf v,76,a,44,v,208
 tr a,60,130,32768
 mf v,92,a,44,v,212
 tr a,62,130,34816
 mf v,108,a,44,v,216
 buffer_load_dwordx4 v[192:195], v128, s[24:27], s54 offen offset:1024 sc1
 mf v,124,a,44,v,220
 s_waitcnt lgkmcnt(4)
 mf v,0,a,48,v,208
 tr a,40,135,36864
 mf v,16,a,48,v,212
 tr a,42,135,38912
 s_add_u32 m0, s53, 26624
 mf v,32,a,48,v,216
 buffer_load_dwordx4 v149, s[28:31], s62 offen lds
 mf v,48,a,48,v,220
 mf v,4,a,52,v,208
 tr a,44,136,36864
 mf v,20,a,52,v,212
 tr a,46,136,38912
 mf v,36,a,52,v,216
 buffer_load_dwordx4 v[196:199], v128, s[24:27], s55 offen offset:1024 sc1
 mf v,52,a,52,v,220
 s_waitcnt lgkmcnt(4)
 mf v,8,a,56,v,208
 tr a,48,138,36864
 mf v,24,a,56,v,212
 tr a,50,138,38912
 s_add_u32 m0, s53, 27648
 mf v,40,a,56,v,216
 buffer_load_dwordx4 v150, s[28:31], s62 offen lds
 s_add_u32 s62, s62, 65536
 mf v,56,a,56,v,220
 mf v,12,a,60,v,208
 tr a,52,140,36864
 mf v,28,a,60,v,212
 tr a,54,140,38912
 mf v,44,a,60,v,216
 mf v,60,a,60,v,220
 s_waitcnt lgkmcnt(4)
f_L0g9:
 mf v,64,a,40,a,176
 tr a,56,151,36864
 mf v,80,a,40,a,180
 tr a,58,151,38912
 s_add_u32 m0, s53, 28672
 mf v,96,a,40,a,184
 buffer_load_dwordx4 v147, s[28:31], s62 offen lds
 mf v,112,a,40,a,188
 mf v,68,a,44,a,176
 tr a,60,152,36864
 mf v,84,a,44,a,180
 tr a,62,152,38912
 mf v,100,a,44,a,184
 buffer_load_dwordx4 v[200:203], v128, s[24:27], s56 offen offset:1024 sc1
 mf v,116,a,44,a,188
 s_waitcnt lgkmcnt(4)
 mf v,72,a,48,a,176
 tr a,40,141,36864
 mf v,88,a,48,a,180
 tr a,42,141,38912
 s_add_u32 m0, s53, 29696
 mf v,104,a,48,a,184
 buffer_load_dwordx4 v148, s[28:31], s62 offen lds
 mf v,120,a,48,a,188
 mf v,76,a,52,a,176
 tr a,44,130,36864
 mf v,92,a,52,a,180
 tr a,46,130,38912
 mf v,108,a,52,a,184
 mf v,124,a,52,a,188
 s_waitcnt lgkmcnt(4)
 mf v,0,a,56,a,176
 buffer_load_dwordx4 v[204:207], v128, s[24:27], s57 offen offset:1024 sc1
 mf v,16,a,56,a,180
 s_add_u32 m0, s53, 30720
 mf v,32,a,56,a,184
 buffer_load_dwordx4 v149, s[28:31], s62 offen lds
 mf v,48,a,56,a,188
 s_waitcnt vmcnt(40) lgkmcnt(0)
 s_barrier
 mf v,4,a,60,a,176
 tr a,48,135,0
 mf v,20,a,60,a,180
 tr a,50,135,2048
 mf v,36,a,60,a,184
 tr a,52,136,0
 mf v,52,a,60,a,188
 tr a,54,136,2048
 mf v,8,a,40,a,176
 tr a,56,138,0
 mf v,24,a,40,a,180
 tr a,58,138,2048
 s_add_u32 m0, s53, 31744
 mf v,40,a,40,a,184
 buffer_load_dwordx4 v150, s[28:31], s62 offen lds
 s_add_u32 s62, s62, 65536
 mf v,56,a,40,a,188
 mf v,12,a,44,a,176
 tr a,60,140,0
 mf v,28,a,44,a,180
 tr a,62,140,2048
 mf v,44,a,44,a,184
 mf v,60,a,44,a,188
 s_waitcnt lgkmcnt(4)
f_L0g10:
 mf v,64,a,48,a,192
 tr a,40,151,0
 mf v,80,a,48,a,196
 tr a,42,151,2048
 s_add_u32 m0, s53, 32768
 mf v,96,a,48,a,200
 buffer_load_dwordx4 v147, s[28:31], s62 offen lds
 mf v,112,a,48,a,204
 mf v,68,a,52,a,192
 tr a,44,152,0
 mf v,84,a,52,a,196
 tr a,46,152,2048
 mf v,100,a,52,a,200
 buffer_load_dwordx4 a[144:147], v128, s[24:27], s54 offen offset:2048 sc1
 mf v,116,a,52,a,204
 s_waitcnt lgkmcnt(4)
 mf v,72,a,56,a,192
 tr a,48,141,0
 mf v,88,a,56,a,196
 tr a,50,141,2048
 s_add_u32 m0, s53, 33792
 mf v,104,a,56,a,200
 buffer_load_dwordx4 v148, s[28:31], s62 offen lds
 mf v,120,a,56,a,204
 mf v,76,a,60,a,192
 tr a,52,130,0
 mf v,92,a,60,a,196
 tr a,54,130,2048
 mf v,108,a,60,a,200
 buffer_load_dwordx4 a[148:151], v128, s[24:27], s55 offen offset:2048 sc1
 mf v,124,a,60,a,204
 s_waitcnt lgkmcnt(4)
 mf v,0,a,40,a,192
 tr a,56,135,4096
 mf v,16,a,40,a,196
 tr a,58,135,6144
 s_add_u32 m0, s53, 34816
 mf v,32,a,40,a,200
 buffer_load_dwordx4 v149, s[28:31], s62 offen lds
 mf v,48,a,40,a,204
 mf v,4,a,44,a,192
 tr a,60,136,4096
 mf v,20,a,44,a,196
 tr a,62,136,6144
 mf v,36,a,44,a,200
 buffer_load_dwordx4 a[152:155], v128, s[24:27], s56 offen offset:2048 sc1
 mf v,52,a,44,a,204
 s_waitcnt lgkmcnt(4)
 mf v,8,a,48,a,192
 tr a,40,138,4096
 mf v,24,a,48,a,196
 tr a,42,138,6144
 s_add_u32 m0, s53, 35840
 mf v,40,a,48,a,200
 buffer_load_dwordx4 v150, s[28:31], s62 offen lds
 s_add_u32 s62, s62, 65536
 mf v,56,a,48,a,204
 mf v,12,a,52,a,192
 tr a,44,140,4096
 mf v,28,a,52,a,196
 tr a,46,140,6144
 mf v,44,a,52,a,200
 mf v,60,a,52,a,204
 s_waitcnt lgkmcnt(4)
f_L0g11:
 mf v,64,a,56,v,224
 tr a,48,151,4096
 mf v,80,a,56,v,228
 tr a,50,151,6144
 s_add_u32 m0, s53, 36864
 mf v,96,a,56,v,232
 buffer_load_dwordx4 v147, s[28:31], s62 offen lds
 mf v,112,a,56,v,236
 mf v,68,a,60,v,224
 tr a,52,152,4096
 mf v,84,a,60,v,228
 tr a,54,152,6144
 mf v,100,a,60,v,232
 buffer_load_dwordx4 a[156:159], v128, s[24:27], s57 offen offset:2048 sc1
 mf v,116,a,60,v,236
 s_waitcnt lgkmcnt(4)
 mf v,72,a,40,v,224
 tr a,56,141,4096
 mf v,88,a,40,v,228
 tr a,58,141,6144
 s_add_u32 m0, s53, 37888
 mf v,104,a,40,v,232
 buffer_load_dwordx4 v148, s[28:31], s62 offen lds
 mf v,120,a,40,v,236
 mf v,76,a,44,v,224
 tr a,60,130,4096
 mf v,92,a,44,v,228
 tr a,62,130,6144
 mf v,108,a,44,v,232
 buffer_load_dwordx4 a[160:163], v128, s[24:27], s54 offen offset:3072 sc1
 s_add_u32 s54, s54, s44
 mf v,124,a,44,v,236
 s_waitcnt lgkmcnt(4)
 s_add_u32 m0, s53, 38912
 mf v,0,a,48,v,224
 buffer_load_dwordx4 v149, s[28:31], s62 offen lds
 mf v,16,a,48,v,228
 mf v,32,a,48,v,232
 buffer_load_dwordx4 a[164:167], v128, s[24:27], s55 offen offset:3072 sc1
 s_add_u32 s55, s55, s44
 mf v,48,a,48,v,236
 s_waitcnt vmcnt(40) lgkmcnt(0)
 s_barrier
 mf v,4,a,52,v,224
 tr a,40,135,8192
 mf v,20,a,52,v,228
 tr a,42,135,10240
 mf v,36,a,52,v,232
 tr a,44,136,8192
 mf v,52,a,52,v,236
 tr a,46,136,10240
 mf v,8,a,56,v,224
 tr a,48,138,8192
 mf v,24,a,56,v,228
 tr a,50,138,10240
 s_add_u32 m0, s53, 39936
 mf v,40,a,56,v,232
 buffer_load_dwordx4 v150, s[28:31], s62 offen lds
 s_add_u32 s62, s62, s46
 mf v,56,a,56,v,236
 mf v,12,a,60,v,224
 tr a,52,140,8192
 mf v,28,a,60,v,228
 tr a,54,140,10240
 mf v,44,a,60,v,232
 mf v,60,a,60,v,236
 s_waitcnt lgkmcnt(4)
f_L0g12:
f_L0p48:
 mf v,64,a,40,a,208
 tr a,56,151,8192
 mf v,80,a,40,a,212
 tr a,58,151,10240
 s_add_u32 m0, s53, 0
 mf v,96,a,40,a,216
 buffer_load_dwordx4 v147, s[28:31], s62 offen lds
 mf v,112,a,40,a,220
 mf v,68,a,44,a,208
 tr a,60,152,8192
 mf v,84,a,44,a,212
 tr a,62,152,10240
 mf v,100,a,44,a,216
 buffer_load_dwordx4 a[168:171], v128, s[24:27], s56 offen offset:3072 sc1
 s_add_u32 s56, s56, s44
 mf v,116,a,44,a,220
 s_waitcnt lgkmcnt(4)
 mf v,72,a,48,a,208
 tr a,40,141,8192
 mf v,88,a,48,a,212
 tr a,42,141,10240
 s_add_u32 m0, s53, 1024
 mf v,104,a,48,a,216
 buffer_load_dwordx4 v148, s[28:31], s62 offen lds
 mf v,120,a,48,a,220
 mf v,76,a,52,a,208
 tr a,44,130,8192
 mf v,92,a,52,a,212
 tr a,46,130,10240
 mf v,108,a,52,a,216
 mf v,124,a,52,a,220
 s_waitcnt lgkmcnt(4)
 mf v,0,a,56,a,208
 tr a,48,135,12288
 mf v,16,a,56,a,212
 tr a,50,135,14336
 mf v,32,a,56,a,216
 buffer_load_dwordx4 a[172:175], v128, s[24:27], s57 offen offset:3072 sc1
 s_add_u32 s57, s57, s44
 mf v,48,a,56,a,220
 mf v,4,a,60,a,208
 tr a,52,136,12288
 mf v,20,a,60,a,212
 tr a,54,136,14336
 s_add_u32 m0, s53, 2048
 mf v,36,a,60,a,216
 buffer_load_dwordx4 v149, s[28:31], s62 offen lds
 mf v,52,a,60,a,220
 s_waitcnt lgkmcnt(4)
 mf v,8,a,40,a,208
 tr a,56,138,12288
 mf v,24,a,40,a,212
 tr a,58,138,14336
 s_add_u32 m0, s53, 3072
 mf v,40,a,40,a,216
 buffer_load_dwordx4 v150, s[28:31], s62 offen lds
 s_add_u32 s62, s62, 65536
 mf v,56,a,40,a,220
 mf v,12,a,44,a,208
 tr a,60,140,12288
 mf v,28,a,44,a,212
 tr a,62,140,14336
 mf v,44,a,44,a,216
 mf v,60,a,44,a,220
 s_waitcnt lgkmcnt(4)
f_L0g13:
 mf v,64,a,48,v,240
 tr a,40,151,12288
 mf v,80,a,48,v,244
 tr a,42,151,14336
 s_add_u32 m0, s53, 4096
 mf v,96,a,48,v,248
 buffer_load_dwordx4 v147, s[28:31], s62 offen lds
 mf v,112,a,48,v,252
 mf v,68,a,52,v,240
 tr a,44,152,12288
 mf v,84,a,52,v,244
 tr a,46,152,14336
 s_mov_b32 s69, f_L0p96-f_base
 mf v,100,a,52,v,248
 buffer_load_dword v129, v155, s[36:39], s69 offen
 mf v,116,a,52,v,252
 s_waitcnt lgkmcnt(4)
 mf v,72,a,56,v,240
 tr a,48,141,12288
 mf v,88,a,56,v,244
 tr a,50,141,14336
 s_add_u32 m0, s53, 5120
 mf v,104,a,56,v,248
 buffer_load_dwordx4 v148, s[28:31], s62 offen lds
 mf v,120,a,56,v,252
 mf v,76,a,60,v,240
 tr a,52,130,12288
 mf v,92,a,60,v,244
 tr a,54,130,14336
 mf v,108,a,60,v,248
 buffer_load_dwordx4 v[208:211], v128, s[24:27], s54 offen offset:0 sc1
 mf v,124,a,60,v,252
 s_waitcnt lgkmcnt(4)
 s_add_u32 m0, s53, 6144
 mf v,0,a,40,v,240
 buffer_load_dwordx4 v149, s[28:31], s62 offen lds
 mf v,16,a,40,v,244
 mf v,32,a,40,v,248
 buffer_load_dwordx4 v[212:215], v128, s[24:27], s55 offen offset:0 sc1
 mf v,48,a,40,v,252
 s_waitcnt vmcnt(39) lgkmcnt(0)
 s_barrier
 mf v,4,a,44,v,240
 tr a,56,135,16384
 mf v,20,a,44,v,244
 tr a,58,135,18432
 mf v,36,a,44,v,248
 tr a,60,136,16384
 mf v,52,a,44,v,252
 tr a,62,136,18432
 mf v,8,a,48,v,240
 tr a,40,138,16384
 mf v,24,a,48,v,244
 tr a,42,138,18432
 s_add_u32 m0, s53, 7168
 mf v,40,a,48,v,248
 buffer_load_dwordx4 v150, s[28:31], s62 offen lds
 s_add_u32 s62, s62, 65536
 mf v,56,a,48,v,252
 mf v,12,a,52,v,240
 tr a,44,140,16384
 mf v,28,a,52,v,244
 tr a,46,140,18432
 mf v,44,a,52,v,248
 buffer_load_dwordx4 v[216:219], v128, s[24:27], s56 offen offset:0 sc1
 mf v,60,a,52,v,252
 s_waitcnt lgkmcnt(4)
f_L0g14:
 mf v,64,a,56,a,224
 tr a,48,151,16384
 mf v,80,a,56,a,228
 tr a,50,151,18432
 s_add_u32 m0, s53, 8192
 mf v,96,a,56,a,232
 buffer_load_dwordx4 v147, s[28:31], s62 offen lds
 mf v,112,a,56,a,236
 mf v,68,a,60,a,224
 tr a,52,152,16384
 mf v,84,a,60,a,228
 tr a,54,152,18432
 mf v,100,a,60,a,232
 buffer_load_dwordx4 v[220:223], v128, s[24:27], s57 offen offset:0 sc1
 mf v,116,a,60,a,236
 s_waitcnt lgkmcnt(4)
 mf v,72,a,40,a,224
 tr a,56,141,16384
 mf v,88,a,40,a,228
 tr a,58,141,18432
 s_add_u32 m0, s53, 9216
 mf v,104,a,40,a,232
 buffer_load_dwordx4 v148, s[28:31], s62 offen lds
 mf v,120,a,40,a,236
 mf v,76,a,44,a,224
 tr a,60,130,16384
 mf v,92,a,44,a,228
 tr a,62,130,18432
 mf v,108,a,44,a,232
 buffer_load_dwordx4 a[176:179], v128, s[24:27], s54 offen offset:1024 sc1
 mf v,124,a,44,a,236
 s_waitcnt lgkmcnt(4)
 mf v,0,a,48,a,224
 tr a,40,135,20480
 mf v,16,a,48,a,228
 tr a,42,135,22528
 s_add_u32 m0, s53, 10240
 mf v,32,a,48,a,232
 buffer_load_dwordx4 v149, s[28:31], s62 offen lds
 mf v,48,a,48,a,236
 mf v,4,a,52,a,224
 tr a,44,136,20480
 mf v,20,a,52,a,228
 tr a,46,136,22528
 mf v,36,a,52,a,232
 buffer_load_dwordx4 a[180:183], v128, s[24:27], s55 offen offset:1024 sc1
 mf v,52,a,52,a,236
 s_waitcnt lgkmcnt(4)
 mf v,8,a,56,a,224
 tr a,48,138,20480
 mf v,24,a,56,a,228
 tr a,50,138,22528
 s_add_u32 m0, s53, 11264
 mf v,40,a,56,a,232
 buffer_load_dwordx4 v150, s[28:31], s62 offen lds
 s_add_u32 s62, s62, 65536
 mf v,56,a,56,a,236
 mf v,12,a,60,a,224
 tr a,52,140,20480
 mf v,28,a,60,a,228
 tr a,54,140,22528
 mf v,44,a,60,a,232
 mf v,60,a,60,a,236
 s_waitcnt lgkmcnt(4)
f_L0g15:
 mf v,64,a,40,a,240
 tr a,56,151,20480
 mf v,80,a,40,a,244
 tr a,58,151,22528
 s_add_u32 m0, s53, 12288
 mf v,96,a,40,a,248
 buffer_load_dwordx4 v147, s[28:31], s62 offen lds
 mf v,112,a,40,a,252
 mf v,68,a,44,a,240
 tr a,60,152,20480
 mf v,84,a,44,a,244
 tr a,62,152,22528
 mf v,100,a,44,a,248
 buffer_load_dwordx4 a[184:187], v128, s[24:27], s56 offen offset:1024 sc1
 mf v,116,a,44,a,252
 s_waitcnt lgkmcnt(4)
 mf v,72,a,48,a,240
 tr a,40,141,20480
 mf v,88,a,48,a,244
 tr a,42,141,22528
 s_add_u32 m0, s53, 13312
 mf v,104,a,48,a,248
 buffer_load_dwordx4 v148, s[28:31], s62 offen lds
 mf v,120,a,48,a,252
 mf v,76,a,52,a,240
 tr a,44,130,20480
 mf v,92,a,52,a,244
 tr a,46,130,22528
 mf v,108,a,52,a,248
 mf v,124,a,52,a,252
 s_waitcnt lgkmcnt(4)
 mf v,0,a,56,a,240
 buffer_load_dwordx4 a[188:191], v128, s[24:27], s57 offen offset:1024 sc1
 mf v,16,a,56,a,244
 s_add_u32 m0, s53, 14336
 mf v,32,a,56,a,248
 buffer_load_dwordx4 v149, s[28:31], s62 offen lds
 mf v,48,a,56,a,252
 s_waitcnt vmcnt(40) lgkmcnt(0)
 s_barrier
 mf v,4,a,60,a,240
 tr a,48,135,24576
 mf v,20,a,60,a,244
 tr a,50,135,26624
 mf v,36,a,60,a,248
 tr a,52,136,24576
 mf v,52,a,60,a,252
 tr a,54,136,26624
 mf v,8,a,40,a,240
 tr a,56,138,24576
 mf v,24,a,40,a,244
 tr a,58,138,26624
 s_add_u32 m0, s53, 15360
 mf v,40,a,40,a,248
 buffer_load_dwordx4 v150, s[28:31], s62 offen lds
 s_add_u32 s62, s62, s46
 mf v,56,a,40,a,252
 mf v,12,a,44,a,240
 tr a,60,140,24576
 mf v,28,a,44,a,244
 tr a,62,140,26624
 mf v,44,a,44,a,248
 mf v,60,a,44,a,252
 s_waitcnt lgkmcnt(4)
f_L0g16:
 mf v,64,a,48,v,160
 tr a,40,151,24576
 mf v,80,a,48,v,164
 tr a,42,151,26624
 s_add_u32 m0, s53, 16384
 mf v,96,a,48,v,168
 buffer_load_dwordx4 v147, s[28:31], s62 offen lds
 mf v,112,a,48,v,172
 mf v,68,a,52,v,160
 tr a,44,152,24576
 mf v,84,a,52,v,164
 tr a,46,152,26624
 mf v,100,a,52,v,168
 buffer_load_dwordx4 a[192:195], v128, s[24:27], s54 offen offset:2048 sc1
 mf v,116,a,52,v,172
 s_waitcnt lgkmcnt(4)
 mf v,72,a,56,v,160
 tr a,48,141,24576
 mf v,88,a,56,v,164
 tr a,50,141,26624
 s_add_u32 m0, s53, 17408
 mf v,104,a,56,v,168
 buffer_load_dwordx4 v148, s[28:31], s62 offen lds
 mf v,120,a,56,v,172
 mf v,76,a,60,v,160
 tr a,52,130,24576
 mf v,92,a,60,v,164
 tr a,54,130,26624
 mf v,108,a,60,v,168
 buffer_load_dwordx4 a[196:199], v128, s[24:27], s55 offen offset:2048 sc1
 mf v,124,a,60,v,172
 s_waitcnt lgkmcnt(4)
 mf v,0,a,40,v,160
 tr a,56,135,28672
 mf v,16,a,40,v,164
 tr a,58,135,30720
 s_add_u32 m0, s53, 18432
 mf v,32,a,40,v,168
 buffer_load_dwordx4 v149, s[28:31], s62 offen lds
 mf v,48,a,40,v,172
 mf v,4,a,44,v,160
 tr a,60,136,28672
 mf v,20,a,44,v,164
 tr a,62,136,30720
 mf v,36,a,44,v,168
 buffer_load_dwordx4 a[200:203], v128, s[24:27], s56 offen offset:2048 sc1
 mf v,52,a,44,v,172
 s_waitcnt lgkmcnt(4)
 mf v,8,a,48,v,160
 tr a,40,138,28672
 mf v,24,a,48,v,164
 tr a,42,138,30720
 s_add_u32 m0, s53, 19456
 mf v,40,a,48,v,168
 buffer_load_dwordx4 v150, s[28:31], s62 offen lds
 s_add_u32 s62, s62, 65536
 mf v,56,a,48,v,172
 mf v,12,a,52,v,160
 tr a,44,140,28672
 mf v,28,a,52,v,164
 tr a,46,140,30720
 mf v,44,a,52,v,168
 mf v,60,a,52,v,172
 s_waitcnt lgkmcnt(4)
f_L0g17:
 mf v,64,a,56,a,96
 tr a,48,151,28672
 mf v,80,a,56,a,100
 tr a,50,151,30720
 s_add_u32 m0, s53, 20480
 mf v,96,a,56,a,104
 buffer_load_dwordx4 v147, s[28:31], s62 offen lds
 mf v,112,a,56,a,108
 mf v,68,a,60,a,96
 tr a,52,152,28672
 mf v,84,a,60,a,100
 tr a,54,152,30720
 mf v,100,a,60,a,104
 buffer_load_dwordx4 a[204:207], v128, s[24:27], s57 offen offset:2048 sc1
 mf v,116,a,60,a,108
 s_waitcnt lgkmcnt(4)
 mf v,72,a,40,a,96
 tr a,56,141,28672
 mf v,88,a,40,a,100
 tr a,58,141,30720
 s_add_u32 m0, s53, 21504
 mf v,104,a,40,a,104
 buffer_load_dwordx4 v148, s[28:31], s62 offen lds
 mf v,120,a,40,a,108
 mf v,76,a,44,a,96
 tr a,60,130,28672
 mf v,92,a,44,a,100
 tr a,62,130,30720
 mf v,108,a,44,a,104
 buffer_load_dwordx4 v[224:227], v128, s[24:27], s54 offen offset:3072 sc1
 s_add_u32 s54, s54, s44
 mf v,124,a,44,a,108
 s_waitcnt lgkmcnt(4)
 s_add_u32 m0, s53, 22528
 mf v,0,a,48,a,96
 buffer_load_dwordx4 v149, s[28:31], s62 offen lds
 mf v,16,a,48,a,100
 mf v,32,a,48,a,104
 buffer_load_dwordx4 v[228:231], v128, s[24:27], s55 offen offset:3072 sc1
 s_add_u32 s55, s55, s44
 mf v,48,a,48,a,108
 s_waitcnt vmcnt(40) lgkmcnt(0)
 s_barrier
 mf v,4,a,52,a,96
 tr a,40,135,32768
 mf v,20,a,52,a,100
 tr a,42,135,34816
 mf v,36,a,52,a,104
 tr a,44,136,32768
 mf v,52,a,52,a,108
 tr a,46,136,34816
 mf v,8,a,56,a,96
 tr a,48,138,32768
 mf v,24,a,56,a,100
 tr a,50,138,34816
 s_add_u32 m0, s53, 23552
 mf v,40,a,56,a,104
 buffer_load_dwordx4 v150, s[28:31], s62 offen lds
 s_add_u32 s62, s62, 65536
 mf v,56,a,56,a,108
 mf v,12,a,60,a,96
 tr a,52,140,32768
 mf v,28,a,60,a,100
 tr a,54,140,34816
 mf v,44,a,60,a,104
 mf v,60,a,60,a,108
 s_waitcnt lgkmcnt(4)
f_L0g18:
 mf v,64,a,40,a,112
 tr a,56,151,32768
 mf v,80,a,40,a,116
 tr a,58,151,34816
 s_add_u32 m0, s53, 24576
 mf v,96,a,40,a,120
 buffer_load_dwordx4 v147, s[28:31], s62 offen lds
 mf v,112,a,40,a,124
 mf v,68,a,44,a,112
 tr a,60,152,32768
 mf v,84,a,44,a,116
 tr a,62,152,34816
 mf v,100,a,44,a,120
 buffer_load_dwordx4 v[232:235], v128, s[24:27], s56 offen offset:3072 sc1
 s_add_u32 s56, s56, s44
 mf v,116,a,44,a,124
 s_waitcnt lgkmcnt(4)
 mf v,72,a,48,a,112
 tr a,40,141,32768
 mf v,88,a,48,a,116
 tr a,42,141,34816
 s_add_u32 m0, s53, 25600
 mf v,104,a,48,a,120
 buffer_load_dwordx4 v148, s[28:31], s62 offen lds
 mf v,120,a,48,a,124
 mf v,76,a,52,a,112
 tr a,44,130,32768
 mf v,92,a,52,a,116
 tr a,46,130,34816
 mf v,108,a,52,a,120
 mf v,124,a,52,a,124
 s_waitcnt lgkmcnt(4)
 mf v,0,a,56,a,112
 tr a,48,135,36864
 mf v,16,a,56,a,116
 tr a,50,135,38912
 mf v,32,a,56,a,120
 buffer_load_dwordx4 v[236:239], v128, s[24:27], s57 offen offset:3072 sc1
 s_add_u32 s57, s57, s44
 mf v,48,a,56,a,124
 mf v,4,a,60,a,112
 tr a,52,136,36864
 mf v,20,a,60,a,116
 tr a,54,136,38912
 s_add_u32 m0, s53, 26624
 mf v,36,a,60,a,120
 buffer_load_dwordx4 v149, s[28:31], s62 offen lds
 mf v,52,a,60,a,124
 s_waitcnt lgkmcnt(4)
 mf v,8,a,40,a,112
 tr a,56,138,36864
 mf v,24,a,40,a,116
 tr a,58,138,38912
 s_add_u32 m0, s53, 27648
 mf v,40,a,40,a,120
 buffer_load_dwordx4 v150, s[28:31], s62 offen lds
 s_add_u32 s62, s62, 65536
 mf v,56,a,40,a,124
 mf v,12,a,44,a,112
 tr a,60,140,36864
 mf v,28,a,44,a,116
 tr a,62,140,38912
 mf v,44,a,44,a,120
 mf v,60,a,44,a,124
 s_waitcnt lgkmcnt(4)
f_L0g19:
 mf v,64,a,48,v,176
 tr a,40,151,36864
 mf v,80,a,48,v,180
 tr a,42,151,38912
 s_add_u32 m0, s53, 28672
 mf v,96,a,48,v,184
 buffer_load_dwordx4 v147, s[28:31], s62 offen lds
 mf v,112,a,48,v,188
 mf v,68,a,52,v,176
 tr a,44,152,36864
 mf v,84,a,52,v,180
 tr a,46,152,38912
 mf v,100,a,52,v,184
 buffer_load_dwordx4 a[208:211], v128, s[24:27], s54 offen offset:0 sc1
 mf v,116,a,52,v,188
 s_waitcnt lgkmcnt(4)
 mf v,72,a,56,v,176
 tr a,48,141,36864
 mf v,88,a,56,v,180
 tr a,50,141,38912
 s_add_u32 m0, s53, 29696
 mf v,104,a,56,v,184
 buffer_load_dwordx4 v148, s[28:31], s62 offen lds
 mf v,120,a,56,v,188
 mf v,76,a,60,v,176
 tr a,52,130,36864
 mf v,92,a,60,v,180
 tr a,54,130,38912
 mf v,108,a,60,v,184
 buffer_load_dwordx4 a[212:215], v128, s[24:27], s55 offen offset:0 sc1
 mf v,124,a,60,v,188
 s_waitcnt lgkmcnt(4)
 s_add_u32 m0, s53, 30720
 mf v,0,a,40,v,176
 buffer_load_dwordx4 v149, s[28:31], s62 offen lds
 mf v,16,a,40,v,180
 mf v,32,a,40,v,184
 buffer_load_dwordx4 a[216:219], v128, s[24:27], s56 offen offset:0 sc1
 mf v,48,a,40,v,188
 s_waitcnt vmcnt(40) lgkmcnt(0)
 s_barrier
 mf v,4,a,44,v,176
 tr a,56,135,0
 mf v,20,a,44,v,180
 tr a,58,135,2048
 mf v,36,a,44,v,184
 tr a,60,136,0
 mf v,52,a,44,v,188
 tr a,62,136,2048
 mf v,8,a,48,v,176
 tr a,40,138,0
 mf v,24,a,48,v,180
 tr a,42,138,2048
 s_add_u32 m0, s53, 31744
 mf v,40,a,48,v,184
 buffer_load_dwordx4 v150, s[28:31], s62 offen lds
 s_add_u32 s62, s62, s46
 mf v,56,a,48,v,188
 mf v,12,a,52,v,176
 tr a,44,140,0
 mf v,28,a,52,v,180
 tr a,46,140,2048
 mf v,44,a,52,v,184
 mf v,60,a,52,v,188
 s_waitcnt lgkmcnt(4)
f_L0g20:
 mf v,64,a,56,a,128
 tr a,48,151,0
 mf v,80,a,56,a,132
 tr a,50,151,2048
 s_add_u32 m0, s53, 32768
 mf v,96,a,56,a,136
 buffer_load_dwordx4 v147, s[28:31], s62 offen lds
 mf v,112,a,56,a,140
 mf v,68,a,60,a,128
 tr a,52,152,0
 mf v,84,a,60,a,132
 tr a,54,152,2048
 mf v,100,a,60,a,136
 buffer_load_dwordx4 a[220:223], v128, s[24:27], s57 offen offset:0 sc1
 mf v,116,a,60,a,140
 s_waitcnt lgkmcnt(4)
 mf v,72,a,40,a,128
 tr a,56,141,0
 mf v,88,a,40,a,132
 tr a,58,141,2048
 s_add_u32 m0, s53, 33792
 mf v,104,a,40,a,136
 buffer_load_dwordx4 v148, s[28:31], s62 offen lds
 mf v,120,a,40,a,140
 mf v,76,a,44,a,128
 tr a,60,130,0
 mf v,92,a,44,a,132
 tr a,62,130,2048
 mf v,108,a,44,a,136
 buffer_load_dwordx4 v[240:243], v128, s[24:27], s54 offen offset:1024 sc1
 mf v,124,a,44,a,140
 s_waitcnt lgkmcnt(4)
 mf v,0,a,48,a,128
 tr a,40,135,4096
 mf v,16,a,48,a,132
 tr a,42,135,6144
 s_add_u32 m0, s53, 34816
 mf v,32,a,48,a,136
 buffer_load_dwordx4 v149, s[28:31], s62 offen lds
 mf v,48,a,48,a,140
 mf v,4,a,52,a,128
 tr a,44,136,4096
 mf v,20,a,52,a,132
 tr a,46,136,6144
 mf v,36,a,52,a,136
 buffer_load_dwordx4 v[244:247], v128, s[24:27], s55 offen offset:1024 sc1
 mf v,52,a,52,a,140
 s_waitcnt lgkmcnt(4)
 mf v,8,a,56,a,128
 tr a,48,138,4096
 mf v,24,a,56,a,132
 tr a,50,138,6144
 s_add_u32 m0, s53, 35840
 mf v,40,a,56,a,136
 buffer_load_dwordx4 v150, s[28:31], s62 offen lds
 s_add_u32 s62, s62, 65536
 mf v,56,a,56,a,140
 mf v,12,a,60,a,128
 tr a,52,140,4096
 mf v,28,a,60,a,132
 tr a,54,140,6144
 mf v,44,a,60,a,136
 mf v,60,a,60,a,140
 s_waitcnt lgkmcnt(4)
f_L0g21:
 mf v,64,a,40,v,192
 tr a,56,151,4096
 mf v,80,a,40,v,196
 tr a,58,151,6144
 s_add_u32 m0, s53, 36864
 mf v,96,a,40,v,200
 buffer_load_dwordx4 v147, s[28:31], s62 offen lds
 mf v,112,a,40,v,204
 mf v,68,a,44,v,192
 tr a,60,152,4096
 mf v,84,a,44,v,196
 tr a,62,152,6144
 mf v,100,a,44,v,200
 buffer_load_dwordx4 v[248:251], v128, s[24:27], s56 offen offset:1024 sc1
 mf v,116,a,44,v,204
 s_waitcnt lgkmcnt(4)
 mf v,72,a,48,v,192
 tr a,40,141,4096
 mf v,88,a,48,v,196
 tr a,42,141,6144
 s_add_u32 m0, s53, 37888
 mf v,104,a,48,v,200
 buffer_load_dwordx4 v148, s[28:31], s62 offen lds
 mf v,120,a,48,v,204
 mf v,76,a,52,v,192
 tr a,44,130,4096
 mf v,92,a,52,v,196
 tr a,46,130,6144
 mf v,108,a,52,v,200
 mf v,124,a,52,v,204
 s_waitcnt lgkmcnt(4)
 mf v,0,a,56,v,192
 buffer_load_dwordx4 v[252:255], v128, s[24:27], s57 offen offset:1024 sc1
 mf v,16,a,56,v,196
 s_add_u32 m0, s53, 38912
 mf v,32,a,56,v,200
 buffer_load_dwordx4 v149, s[28:31], s62 offen lds
 mf v,48,a,56,v,204
 s_waitcnt vmcnt(39) lgkmcnt(0)
 s_barrier
 mf v,4,a,60,v,192
 tr a,48,135,8192
 mf v,20,a,60,v,196
 tr a,50,135,10240
 mf v,36,a,60,v,200
 tr a,52,136,8192
 mf v,52,a,60,v,204
 tr a,54,136,10240
 mf v,8,a,40,v,192
 tr a,56,138,8192
 mf v,24,a,40,v,196
 tr a,58,138,10240
 s_add_u32 m0, s53, 39936
 mf v,40,a,40,v,200
 buffer_load_dwordx4 v150, s[28:31], s62 offen lds
 s_add_u32 s62, s62, 65536
 mf v,56,a,40,v,204
 mf v,12,a,44,v,192
 tr a,60,140,8192
 mf v,28,a,44,v,196
 tr a,62,140,10240
 mf v,44,a,44,v,200
 mf v,60,a,44,v,204
 s_waitcnt lgkmcnt(4)
f_L0g22:
 mf v,64,a,48,a,144
 tr a,40,151,8192
 mf v,80,a,48,a,148
 tr a,42,151,10240
 s_add_u32 m0, s53, 0
 mf v,96,a,48,a,152
 buffer_load_dwordx4 v147, s[28:31], s62 offen lds
 mf v,112,a,48,a,156
 mf v,68,a,52,a,144
 tr a,44,152,8192
 mf v,84,a,52,a,148
 tr a,46,152,10240
 mf v,100,a,52,a,152
 buffer_load_dwordx4 a[224:227], v128, s[24:27], s54 offen offset:2048 sc1
 mf v,116,a,52,a,156
 s_waitcnt lgkmcnt(4)
 mf v,72,a,56,a,144
 tr a,48,141,8192
 mf v,88,a,56,a,148
 tr a,50,141,10240
 s_add_u32 m0, s53, 1024
 mf v,104,a,56,a,152
 buffer_load_dwordx4 v148, s[28:31], s62 offen lds
 mf v,120,a,56,a,156
 mf v,76,a,60,a,144
 tr a,52,130,8192
 mf v,92,a,60,a,148
 tr a,54,130,10240
 mf v,108,a,60,a,152
 buffer_load_dwordx4 a[228:231], v128, s[24:27], s55 offen offset:2048 sc1
 mf v,124,a,60,a,156
 s_waitcnt lgkmcnt(4)
 mf v,0,a,40,a,144
 tr a,56,135,12288
 mf v,16,a,40,a,148
 tr a,58,135,14336
 s_add_u32 m0, s53, 2048
 mf v,32,a,40,a,152
 buffer_load_dwordx4 v149, s[28:31], s62 offen lds
 mf v,48,a,40,a,156
 mf v,4,a,44,a,144
 tr a,60,136,12288
 mf v,20,a,44,a,148
 tr a,62,136,14336
 mf v,36,a,44,a,152
 buffer_load_dwordx4 a[232:235], v128, s[24:27], s56 offen offset:2048 sc1
 mf v,52,a,44,a,156
 s_waitcnt lgkmcnt(4)
 mf v,8,a,48,a,144
 tr a,40,138,12288
 mf v,24,a,48,a,148
 tr a,42,138,14336
 s_add_u32 m0, s53, 3072
 mf v,40,a,48,a,152
 buffer_load_dwordx4 v150, s[28:31], s62 offen lds
 s_add_u32 s62, s62, 65536
 mf v,56,a,48,a,156
 mf v,12,a,52,a,144
 tr a,44,140,12288
 mf v,28,a,52,a,148
 tr a,46,140,14336
 mf v,44,a,52,a,152
 mf v,60,a,52,a,156
 s_waitcnt lgkmcnt(4)
f_L0g23:
 mf v,64,a,56,a,160
 tr a,48,151,12288
 mf v,80,a,56,a,164
 tr a,50,151,14336
 s_add_u32 m0, s53, 4096
 mf v,96,a,56,a,168
 buffer_load_dwordx4 v147, s[28:31], s62 offen lds
 mf v,112,a,56,a,172
 mf v,68,a,60,a,160
 tr a,52,152,12288
 mf v,84,a,60,a,164
 tr a,54,152,14336
 mf v,100,a,60,a,168
 buffer_load_dwordx4 a[236:239], v128, s[24:27], s57 offen offset:2048 sc1
 mf v,116,a,60,a,172
 s_waitcnt lgkmcnt(4)
 mf v,72,a,40,a,160
 tr a,56,141,12288
 mf v,88,a,40,a,164
 tr a,58,141,14336
 s_add_u32 m0, s53, 5120
 mf v,104,a,40,a,168
 buffer_load_dwordx4 v148, s[28:31], s62 offen lds
 mf v,120,a,40,a,172
 mf v,76,a,44,a,160
 tr a,60,130,12288
 mf v,92,a,44,a,164
 tr a,62,130,14336
 mf v,108,a,44,a,168
 buffer_load_dwordx4 a[240:243], v128, s[24:27], s54 offen offset:3072 sc1
 s_add_u32 s54, s54, s9
 mf v,124,a,44,a,172
 s_waitcnt lgkmcnt(4)
 s_add_u32 m0, s53, 6144
 mf v,0,a,48,a,160
 buffer_load_dwordx4 v149, s[28:31], s62 offen lds
 mf v,16,a,48,a,164
 mf v,32,a,48,a,168
 buffer_load_dwordx4 a[244:247], v128, s[24:27], s55 offen offset:3072 sc1
 s_add_u32 s55, s55, s9
 mf v,48,a,48,a,172
 s_waitcnt vmcnt(39) lgkmcnt(0)
 s_barrier
 mf v,4,a,52,a,160
 tr a,40,135,16384
 mf v,20,a,52,a,164
 tr a,42,135,18432
 mf v,36,a,52,a,168
 tr a,44,136,16384
 mf v,52,a,52,a,172
 tr a,46,136,18432
 mf v,8,a,56,a,160
 tr a,48,138,16384
 mf v,24,a,56,a,164
 tr a,50,138,18432
 s_add_u32 m0, s53, 7168
 mf v,40,a,56,a,168
 buffer_load_dwordx4 v150, s[28:31], s62 offen lds
 s_mov_b32 s62, s8
 mf v,56,a,56,a,172
 mf v,12,a,60,a,160
 tr a,52,140,16384
 mf v,28,a,60,a,164
 tr a,54,140,18432
 mf v,44,a,60,a,168
 mf v,60,a,60,a,172
 s_waitcnt lgkmcnt(4)
f_L0g24:
f_L0p96:
 mf v,64,a,40,v,208
 tr a,56,151,16384
 mf v,80,a,40,v,212
 tr a,58,151,18432
 s_add_u32 m0, s53, 8192
 mf v,96,a,40,v,216
 buffer_load_dwordx4 v147, s[32:35], s62 offen lds
 mf v,112,a,40,v,220
 mf v,68,a,44,v,208
 tr a,60,152,16384
 mf v,84,a,44,v,212
 tr a,62,152,18432
 mf v,100,a,44,v,216
 buffer_load_dword v154, v145, s[24:27], s76 offen offset:0 sc1
 mf v,116,a,44,v,220
 s_waitcnt lgkmcnt(4)
 mf v,72,a,48,v,208
 tr a,40,141,16384
 mf v,88,a,48,v,212
 tr a,42,141,18432
 s_add_u32 m0, s53, 9216
 mf v,104,a,48,v,216
 buffer_load_dwordx4 v148, s[32:35], s62 offen lds
 mf v,120,a,48,v,220
 mf v,76,a,52,v,208
 tr a,44,130,16384
 mf v,92,a,52,v,212
 tr a,46,130,18432
 mf v,108,a,52,v,216
 buffer_load_dwordx4 a[248:251], v128, s[24:27], s56 offen offset:3072 sc1
 s_add_u32 s56, s56, s9
 mf v,124,a,52,v,220
 s_waitcnt lgkmcnt(4)
 mf v,0,a,56,v,208
 tr a,48,135,20480
 mf v,16,a,56,v,212
 tr a,50,135,22528
 s_add_u32 m0, s53, 10240
 mf v,32,a,56,v,216
 buffer_load_dwordx4 v149, s[32:35], s62 offen lds
 mf v,48,a,56,v,220
 mf v,4,a,60,v,208
 tr a,52,136,20480
 mf v,20,a,60,v,212
 tr a,54,136,22528
 mf v,36,a,60,v,216
 buffer_load_dwordx4 a[252:255], v128, s[24:27], s57 offen offset:3072 sc1
 s_add_u32 s57, s57, s9
 mf v,52,a,60,v,220
 s_waitcnt lgkmcnt(4)
 mf v,8,a,40,v,208
 tr a,56,138,20480
 mf v,24,a,40,v,212
 tr a,58,138,22528
 s_add_u32 m0, s53, 11264
 mf v,40,a,40,v,216
 buffer_load_dwordx4 v150, s[32:35], s62 offen lds
 s_add_u32 s62, s62, 65536
 mf v,56,a,40,v,220
 mf v,12,a,44,v,208
 tr a,60,140,20480
 mf v,28,a,44,v,212
 tr a,62,140,22528
 mf v,44,a,44,v,216
 mf v,60,a,44,v,220
 s_waitcnt lgkmcnt(4)
f_L0g25:
 mf v,64,a,48,a,176
 tr a,40,151,20480
 mf v,80,a,48,a,180
 tr a,42,151,22528
 s_add_u32 m0, s53, 12288
 mf v,96,a,48,a,184
 buffer_load_dwordx4 v147, s[32:35], s62 offen lds
 mf v,112,a,48,a,188
 mf v,68,a,52,a,176
 tr a,44,152,20480
 mf v,84,a,52,a,180
 tr a,46,152,22528
 mf v,100,a,52,a,184
 mf v,116,a,52,a,188
 s_waitcnt lgkmcnt(4)
 mf v,72,a,56,a,176
 tr a,48,141,20480
 mf v,88,a,56,a,180
 tr a,50,141,22528
 s_add_u32 m0, s53, 13312
 mf v,104,a,56,a,184
 buffer_load_dwordx4 v148, s[32:35], s62 offen lds
 mf v,120,a,56,a,188
 mf v,76,a,60,a,176
 tr a,52,130,20480
 mf v,92,a,60,a,180
 tr a,54,130,22528
 mf v,108,a,60,a,184
 mf v,124,a,60,a,188
 s_waitcnt lgkmcnt(4)
 s_add_u32 m0, s53, 14336
 mf v,0,a,40,a,176
 buffer_load_dwordx4 v149, s[32:35], s62 offen lds
 mf v,16,a,40,a,180
 mf v,32,a,40,a,184
 mf v,48,a,40,a,188
 s_waitcnt vmcnt(37) lgkmcnt(0)
 s_barrier
 mf v,4,a,44,a,176
 tr a,56,135,24576
 mf v,20,a,44,a,180
 tr a,58,135,26624
 mf v,36,a,44,a,184
 tr a,60,136,24576
 mf v,52,a,44,a,188
 tr a,62,136,26624
 mf v,8,a,48,a,176
 tr a,40,138,24576
 mf v,24,a,48,a,180
 tr a,42,138,26624
 s_add_u32 m0, s53, 15360
 mf v,40,a,48,a,184
 buffer_load_dwordx4 v150, s[32:35], s62 offen lds
 s_add_u32 s62, s62, 65536
 mf v,56,a,48,a,188
 mf v,12,a,52,a,176
 tr a,44,140,24576
 mf v,28,a,52,a,180
 tr a,46,140,26624
 mf v,44,a,52,a,184
 mf v,60,a,52,a,188
 s_waitcnt lgkmcnt(4)
f_L0g26:
 s_waitcnt vmcnt(9)
 v_cmp_ne_u32 vcc, v144, v154
 s_cbranch_vccnz f_L0po
f_L0po_back:
 mf v,64,a,56,a,192
 tr a,48,151,24576
 mf v,80,a,56,a,196
 tr a,50,151,26624
 s_add_u32 m0, s53, 16384
 mf v,96,a,56,a,200
 buffer_load_dwordx4 v147, s[32:35], s62 offen lds
 mf v,112,a,56,a,204
 mf v,68,a,60,a,192
 tr a,52,152,24576
 mf v,84,a,60,a,196
 tr a,54,152,26624
 mf v,100,a,60,a,200
 buffer_load_dwordx4 v[160:163], v128, s[24:27], s54 offen offset:0 sc1
 mf v,116,a,60,a,204
 s_waitcnt lgkmcnt(4)
 mf v,72,a,40,a,192
 tr a,56,141,24576
 mf v,88,a,40,a,196
 tr a,58,141,26624
 s_add_u32 m0, s53, 17408
 mf v,104,a,40,a,200
 buffer_load_dwordx4 v148, s[32:35], s62 offen lds
 mf v,120,a,40,a,204
 mf v,76,a,44,a,192
 tr a,60,130,24576
 mf v,92,a,44,a,196
 tr a,62,130,26624
 mf v,108,a,44,a,200
 buffer_load_dwordx4 v[164:167], v128, s[24:27], s55 offen offset:0 sc1
 mf v,124,a,44,a,204
 s_waitcnt lgkmcnt(4)
 mf v,0,a,48,a,192
 tr a,40,135,28672
 mf v,16,a,48,a,196
 tr a,42,135,30720
 s_add_u32 m0, s53, 18432
 mf v,32,a,48,a,200
 buffer_load_dwordx4 v149, s[32:35], s62 offen lds
 mf v,48,a,48,a,204
 mf v,4,a,52,a,192
 tr a,44,136,28672
 mf v,20,a,52,a,196
 tr a,46,136,30720
 mf v,36,a,52,a,200
 buffer_load_dwordx4 v[168:171], v128, s[24:27], s56 offen offset:0 sc1
 mf v,52,a,52,a,204
 s_waitcnt lgkmcnt(4)
 mf v,8,a,56,a,192
 tr a,48,138,28672
 mf v,24,a,56,a,196
 tr a,50,138,30720
 s_add_u32 m0, s53, 19456
 mf v,40,a,56,a,200
 buffer_load_dwordx4 v150, s[32:35], s62 offen lds
 s_add_u32 s62, s62, 65536
 mf v,56,a,56,a,204
 mf v,12,a,60,a,192
 tr a,52,140,28672
 mf v,28,a,60,a,196
 tr a,54,140,30720
 mf v,44,a,60,a,200
 buffer_load_dwordx4 v[172:175], v128, s[24:27], s57 offen offset:0 sc1
 mf v,60,a,60,a,204
 s_waitcnt lgkmcnt(4)
f_L0g27:
 mf v,64,a,40,v,224
 tr a,56,151,28672
 mf v,80,a,40,v,228
 tr a,58,151,30720
 s_add_u32 m0, s53, 20480
 mf v,96,a,40,v,232
 buffer_load_dwordx4 v147, s[32:35], s62 offen lds
 mf v,112,a,40,v,236
 mf v,68,a,44,v,224
 tr a,60,152,28672
 mf v,84,a,44,v,228
 tr a,62,152,30720
 mf v,100,a,44,v,232
 buffer_load_dwordx4 a[96:99], v128, s[24:27], s54 offen offset:1024 sc1
 mf v,116,a,44,v,236
 s_waitcnt lgkmcnt(4)
 mf v,72,a,48,v,224
 tr a,40,141,28672
 mf v,88,a,48,v,228
 tr a,42,141,30720
 s_add_u32 m0, s53, 21504
 mf v,104,a,48,v,232
 buffer_load_dwordx4 v148, s[32:35], s62 offen lds
 mf v,120,a,48,v,236
 mf v,76,a,52,v,224
 tr a,44,130,28672
 mf v,92,a,52,v,228
 tr a,46,130,30720
 mf v,108,a,52,v,232
 buffer_load_dwordx4 a[100:103], v128, s[24:27], s55 offen offset:1024 sc1
 mf v,124,a,52,v,236
 s_waitcnt lgkmcnt(4)
 s_add_u32 m0, s53, 22528
 mf v,0,a,56,v,224
 buffer_load_dwordx4 v149, s[32:35], s62 offen lds
 mf v,16,a,56,v,228
 mf v,32,a,56,v,232
 buffer_load_dwordx4 a[104:107], v128, s[24:27], s56 offen offset:1024 sc1
 mf v,48,a,56,v,236
 s_waitcnt lgkmcnt(0)
 s_barrier
 mf v,4,a,60,v,224
 tr a,48,135,32768
 mf v,20,a,60,v,228
 tr a,50,135,34816
 mf v,36,a,60,v,232
 tr a,52,136,32768
 mf v,52,a,60,v,236
 tr a,54,136,34816
 mf v,8,a,40,v,224
 tr a,56,138,32768
 mf v,24,a,40,v,228
 tr a,58,138,34816
 s_add_u32 m0, s53, 23552
 mf v,40,a,40,v,232
 buffer_load_dwordx4 v150, s[32:35], s62 offen lds
 s_add_u32 s62, s62, 65536
 mf v,56,a,40,v,236
 mf v,12,a,44,v,224
 tr a,60,140,32768
 mf v,28,a,44,v,228
 tr a,62,140,34816
 mf v,44,a,44,v,232
 buffer_load_dwordx4 a[108:111], v128, s[24:27], s57 offen offset:1024 sc1
 mf v,60,a,44,v,236
 s_waitcnt lgkmcnt(4)
f_L0g28:
 mf v,64,a,48,a,208
 tr a,40,151,32768
 mf v,80,a,48,a,212
 tr a,42,151,34816
 s_add_u32 m0, s53, 24576
 mf v,96,a,48,a,216
 buffer_load_dwordx4 v147, s[32:35], s62 offen lds
 mf v,112,a,48,a,220
 mf v,68,a,52,a,208
 tr a,44,152,32768
 mf v,84,a,52,a,212
 tr a,46,152,34816
 mf v,100,a,52,a,216
 buffer_load_dwordx4 a[112:115], v128, s[24:27], s54 offen offset:2048 sc1
 mf v,116,a,52,a,220
 s_waitcnt lgkmcnt(4)
 mf v,72,a,56,a,208
 tr a,48,141,32768
 mf v,88,a,56,a,212
 tr a,50,141,34816
 s_add_u32 m0, s53, 25600
 mf v,104,a,56,a,216
 buffer_load_dwordx4 v148, s[32:35], s62 offen lds
 mf v,120,a,56,a,220
 mf v,76,a,60,a,208
 tr a,52,130,32768
 mf v,92,a,60,a,212
 tr a,54,130,34816
 mf v,108,a,60,a,216
 buffer_load_dwordx4 a[116:119], v128, s[24:27], s55 offen offset:2048 sc1
 mf v,124,a,60,a,220
 s_waitcnt lgkmcnt(4)
 mf v,0,a,40,a,208
 tr a,56,135,36864
 mf v,16,a,40,a,212
 tr a,58,135,38912
 s_add_u32 m0, s53, 26624
 mf v,32,a,40,a,216
 buffer_load_dwordx4 v149, s[32:35], s62 offen lds
 mf v,48,a,40,a,220
 mf v,4,a,44,a,208
 tr a,60,136,36864
 mf v,20,a,44,a,212
 tr a,62,136,38912
 mf v,36,a,44,a,216
 buffer_load_dwordx4 a[120:123], v128, s[24:27], s56 offen offset:2048 sc1
 mf v,52,a,44,a,220
 s_waitcnt lgkmcnt(4)
 mf v,8,a,48,a,208
 tr a,40,138,36864
 mf v,24,a,48,a,212
 tr a,42,138,38912
 s_add_u32 m0, s53, 27648
 mf v,40,a,48,a,216
 buffer_load_dwordx4 v150, s[32:35], s62 offen lds
 s_add_u32 s62, s62, 65536
 mf v,56,a,48,a,220
 mf v,12,a,52,a,208
 tr a,44,140,36864
 mf v,28,a,52,a,212
 tr a,46,140,38912
 mf v,44,a,52,a,216
 buffer_load_dwordx4 a[124:127], v128, s[24:27], s57 offen offset:2048 sc1
 mf v,60,a,52,a,220
 s_waitcnt lgkmcnt(4)
f_L0g29:
 mf v,64,a,56,v,240
 tr a,48,151,36864
 mf v,80,a,56,v,244
 tr a,50,151,38912
 s_add_u32 m0, s53, 28672
 mf v,96,a,56,v,248
 buffer_load_dwordx4 v147, s[32:35], s62 offen lds
 mf v,112,a,56,v,252
 mf v,68,a,60,v,240
 tr a,52,152,36864
 mf v,84,a,60,v,244
 tr a,54,152,38912
 mf v,100,a,60,v,248
 buffer_load_dwordx4 v[176:179], v128, s[24:27], s54 offen offset:3072 sc1
 s_add_u32 s54, s54, 4096
 mf v,116,a,60,v,252
 s_waitcnt lgkmcnt(4)
 mf v,72,a,40,v,240
 tr a,56,141,36864
 mf v,88,a,40,v,244
 tr a,58,141,38912
 s_add_u32 m0, s53, 29696
 mf v,104,a,40,v,248
 buffer_load_dwordx4 v148, s[32:35], s62 offen lds
 mf v,120,a,40,v,252
 mf v,76,a,44,v,240
 tr a,60,130,36864
 mf v,92,a,44,v,244
 tr a,62,130,38912
 mf v,108,a,44,v,248
 buffer_load_dwordx4 v[180:183], v128, s[24:27], s55 offen offset:3072 sc1
 s_add_u32 s55, s55, 4096
 mf v,124,a,44,v,252
 s_waitcnt lgkmcnt(4)
 s_add_u32 m0, s53, 30720
 mf v,0,a,48,v,240
 buffer_load_dwordx4 v149, s[32:35], s62 offen lds
 mf v,16,a,48,v,244
 mf v,32,a,48,v,248
 buffer_load_dwordx4 v[184:187], v128, s[24:27], s56 offen offset:3072 sc1
 s_add_u32 s56, s56, 4096
 mf v,48,a,48,v,252
 s_waitcnt lgkmcnt(0)
 s_barrier
 mf v,4,a,52,v,240
 tr a,40,135,0
 mf v,20,a,52,v,244
 tr a,42,135,2048
 mf v,36,a,52,v,248
 tr a,44,136,0
 mf v,52,a,52,v,252
 tr a,46,136,2048
 mf v,8,a,56,v,240
 tr a,48,138,0
 mf v,24,a,56,v,244
 tr a,50,138,2048
 s_add_u32 m0, s53, 31744
 mf v,40,a,56,v,248
 buffer_load_dwordx4 v150, s[32:35], s62 offen lds
 s_add_u32 s62, s62, 65536
 mf v,56,a,56,v,252
 mf v,12,a,60,v,240
 tr a,52,140,0
 mf v,28,a,60,v,244
 tr a,54,140,2048
 mf v,44,a,60,v,248
 buffer_load_dwordx4 v[188:191], v128, s[24:27], s57 offen offset:3072 sc1
 s_add_u32 s57, s57, 4096
 mf v,60,a,60,v,252
 s_waitcnt lgkmcnt(4)
f_L0g30:
 mf v,64,a,40,a,224
 tr a,56,151,0
 mf v,80,a,40,a,228
 tr a,58,151,2048
 s_add_u32 m0, s53, 32768
 mf v,96,a,40,a,232
 buffer_load_dwordx4 v147, s[32:35], s62 offen lds
 mf v,112,a,40,a,236
 mf v,68,a,44,a,224
 tr a,60,152,0
 mf v,84,a,44,a,228
 tr a,62,152,2048
 mf v,100,a,44,a,232
 buffer_load_dwordx4 a[128:131], v128, s[24:27], s54 offen offset:0 sc1
 mf v,116,a,44,a,236
 s_waitcnt lgkmcnt(4)
 mf v,72,a,48,a,224
 tr a,40,141,0
 mf v,88,a,48,a,228
 tr a,42,141,2048
 s_add_u32 m0, s53, 33792
 mf v,104,a,48,a,232
 buffer_load_dwordx4 v148, s[32:35], s62 offen lds
 mf v,120,a,48,a,236
 mf v,76,a,52,a,224
 tr a,44,130,0
 mf v,92,a,52,a,228
 tr a,46,130,2048
 mf v,108,a,52,a,232
 buffer_load_dwordx4 a[132:135], v128, s[24:27], s55 offen offset:0 sc1
 mf v,124,a,52,a,236
 s_waitcnt lgkmcnt(4)
 mf v,0,a,56,a,224
 tr a,48,135,4096
 mf v,16,a,56,a,228
 tr a,50,135,6144
 s_add_u32 m0, s53, 34816
 mf v,32,a,56,a,232
 buffer_load_dwordx4 v149, s[32:35], s62 offen lds
 mf v,48,a,56,a,236
 mf v,4,a,60,a,224
 tr a,52,136,4096
 mf v,20,a,60,a,228
 tr a,54,136,6144
 mf v,36,a,60,a,232
 buffer_load_dwordx4 a[136:139], v128, s[24:27], s56 offen offset:0 sc1
 mf v,52,a,60,a,236
 s_waitcnt lgkmcnt(4)
 mf v,8,a,40,a,224
 tr a,56,138,4096
 mf v,24,a,40,a,228
 tr a,58,138,6144
 s_add_u32 m0, s53, 35840
 mf v,40,a,40,a,232
 buffer_load_dwordx4 v150, s[32:35], s62 offen lds
 s_add_u32 s62, s62, 65536
 mf v,56,a,40,a,236
 mf v,12,a,44,a,224
 tr a,60,140,4096
 mf v,28,a,44,a,228
 tr a,62,140,6144
 mf v,44,a,44,a,232
 buffer_load_dwordx4 a[140:143], v128, s[24:27], s57 offen offset:0 sc1
 mf v,60,a,44,a,236
 s_waitcnt vmcnt(45) lgkmcnt(4)
f_L0g31:
 mf v,64,a,48,a,240
 tr a,40,151,4096
 mf v,80,a,48,a,244
 tr a,42,151,6144
 s_add_u32 m0, s53, 36864
 mf v,96,a,48,a,248
 buffer_load_dwordx4 v147, s[32:35], s62 offen lds
 mf v,112,a,48,a,252
 mf v,68,a,52,a,240
 tr a,44,152,4096
 mf v,84,a,52,a,244
 tr a,46,152,6144
 mf v,100,a,52,a,248
 buffer_load_dwordx4 v[192:195], v128, s[24:27], s54 offen offset:1024 sc1
 mf v,116,a,52,a,252
 s_waitcnt lgkmcnt(4)
 mf v,72,a,56,a,240
 tr a,48,141,4096
 mf v,88,a,56,a,244
 tr a,50,141,6144
 s_add_u32 m0, s53, 37888
 mf v,104,a,56,a,248
 buffer_load_dwordx4 v148, s[32:35], s62 offen lds
 mf v,120,a,56,a,252
 mf v,76,a,60,a,240
 tr a,52,130,4096
 mf v,92,a,60,a,244
 tr a,54,130,6144
 mf v,108,a,60,a,248
 buffer_load_dwordx4 v[196:199], v128, s[24:27], s55 offen offset:1024 sc1
 mf v,124,a,60,a,252
 s_waitcnt lgkmcnt(4)
 s_add_u32 m0, s53, 38912
 mf v,0,a,40,a,240
 buffer_load_dwordx4 v149, s[32:35], s62 offen lds
 mf v,16,a,40,a,244
 mf v,32,a,40,a,248
 buffer_load_dwordx4 v[200:203], v128, s[24:27], s56 offen offset:1024 sc1
 mf v,48,a,40,a,252
 s_waitcnt vmcnt(46) lgkmcnt(0)
 s_barrier
 mf v,4,a,44,a,240
 tr a,56,135,8192
 mf v,20,a,44,a,244
 tr a,58,135,10240
 mf v,36,a,44,a,248
 tr a,60,136,8192
 mf v,52,a,44,a,252
 tr a,62,136,10240
 mf v,8,a,48,a,240
 tr a,40,138,8192
 mf v,24,a,48,a,244
 tr a,42,138,10240
 s_add_u32 m0, s53, 39936
 mf v,40,a,48,a,248
 buffer_load_dwordx4 v150, s[32:35], s62 offen lds
 mf v,56,a,48,a,252
 mf v,12,a,52,a,240
 tr a,44,140,8192
 mf v,28,a,52,a,244
 tr a,46,140,10240
 mf v,44,a,52,a,248
 buffer_load_dwordx4 v[204:207], v128, s[24:27], s57 offen offset:1024 sc1
 mf v,60,a,52,a,252
 s_waitcnt vmcnt(40) lgkmcnt(4)
f_L0o0:
 mf v,64,a,56,v,160
 tr a,48,135,12288
 mf v,80,a,56,v,164
 tr a,50,135,14336
 mf v,96,a,56,v,168
 buffer_load_dwordx4 a[144:147], v128, s[24:27], s54 offen offset:2048 sc1
 mf v,112,a,56,v,172
 mf v,68,a,60,v,160
 tr a,52,136,12288
 mf v,84,a,60,v,164
 tr a,54,136,14336
 mf v,100,a,60,v,168
 buffer_load_dwordx4 a[148:151], v128, s[24:27], s55 offen offset:2048 sc1
 mf v,116,a,60,v,172
 s_waitcnt lgkmcnt(4)
f_L0o1:
 mf v,72,a,40,v,160
 tr a,56,138,12288
 mf v,88,a,40,v,164
 tr a,58,138,14336
 mf v,104,a,40,v,168
 buffer_load_dwordx4 a[152:155], v128, s[24:27], s56 offen offset:2048 sc1
 mf v,120,a,40,v,172
 mf v,76,a,44,v,160
 tr a,60,140,12288
 mf v,92,a,44,v,164
 tr a,62,140,14336
 mf v,108,a,44,v,168
 buffer_load_dwordx4 a[156:159], v128, s[24:27], s57 offen offset:2048 sc1
 mf v,124,a,44,v,172
 s_waitcnt vmcnt(36) lgkmcnt(4)
f_L0o2:
 mf v,64,a,48,a,96
 buffer_load_dwordx4 a[160:163], v128, s[24:27], s54 offen offset:3072 sc1
 mf v,80,a,48,a,100
 mf v,96,a,48,a,104
 buffer_load_dwordx4 a[164:167], v128, s[24:27], s55 offen offset:3072 sc1
 mf v,112,a,48,a,108
 s_waitcnt lgkmcnt(0)
 s_barrier
 mf v,68,a,52,a,96
 tr a,40,135,16384
 mf v,84,a,52,a,100
 tr a,42,135,18432
 mf v,100,a,52,a,104
 tr a,44,136,16384
 mf v,116,a,52,a,108
 tr a,46,136,18432
f_L0o3:
 mf v,72,a,56,a,96
 tr a,48,138,16384
 mf v,88,a,56,a,100
 tr a,50,138,18432
 mf v,104,a,56,a,104
 buffer_load_dwordx4 a[168:171], v128, s[24:27], s56 offen offset:3072 sc1
 mf v,120,a,56,a,108
 mf v,76,a,60,a,96
 tr a,52,140,16384
 mf v,92,a,60,a,100
 tr a,54,140,18432
 mf v,108,a,60,a,104
 buffer_load_dwordx4 a[172:175], v128, s[24:27], s57 offen offset:3072 sc1
 mf v,124,a,60,a,108
 s_waitcnt vmcnt(32) lgkmcnt(4)
f_L0o4:
 mf v,64,a,40,a,112
 tr a,56,135,20480
 mf v,80,a,40,a,116
 tr a,58,135,22528
 mf v,96,a,40,a,120
 buffer_load_dwordx4 v[208:211], v153, s[40:43], s6 offen offset:0
 mf v,112,a,40,a,124
 mf v,68,a,44,a,112
 tr a,60,136,20480
 mf v,84,a,44,a,116
 tr a,62,136,22528
 mf v,100,a,44,a,120
 buffer_load_dwordx4 v[212:215], v153, s[40:43], s6 offen offset:64
 mf v,116,a,44,a,124
 s_waitcnt lgkmcnt(4)
f_L0o5:
 mf v,72,a,48,a,112
 tr a,40,138,20480
 mf v,88,a,48,a,116
 tr a,42,138,22528
 mf v,104,a,48,a,120
 buffer_load_dwordx4 v[216:219], v153, s[40:43], s7 offen offset:0
 mf v,120,a,48,a,124
 mf v,76,a,52,a,112
 tr a,44,140,20480
 mf v,92,a,52,a,116
 tr a,46,140,22528
 mf v,108,a,52,a,120
 buffer_load_dwordx4 v[220:223], v153, s[40:43], s7 offen offset:64
 mf v,124,a,52,a,124
 s_waitcnt vmcnt(28) lgkmcnt(4)
f_L0o6:
 mf v,64,a,56,v,176
 mf v,80,a,56,v,180
 mf v,96,a,56,v,184
 mf v,112,a,56,v,188
 s_waitcnt lgkmcnt(0)
 s_barrier
 mf v,68,a,60,v,176
 tr a,48,135,24576
 mf v,84,a,60,v,180
 tr a,50,135,26624
 mf v,100,a,60,v,184
 tr a,52,136,24576
 mf v,116,a,60,v,188
 tr a,54,136,26624
f_L0o7:
 mf v,72,a,40,v,176
 tr a,56,138,24576
 mf v,88,a,40,v,180
 tr a,58,138,26624
 mf v,104,a,40,v,184
 mf v,120,a,40,v,188
 mf v,76,a,44,v,176
 tr a,60,140,24576
 mf v,92,a,44,v,180
 tr a,62,140,26624
 mf v,108,a,44,v,184
 mf v,124,a,44,v,188
 s_waitcnt vmcnt(20) lgkmcnt(4)
f_L0o8:
 mf v,64,a,48,a,128
 tr a,40,135,28672
 mf v,80,a,48,a,132
 tr a,42,135,30720
 mf v,96,a,48,a,136
 mf v,112,a,48,a,140
 mf v,68,a,52,a,128
 tr a,44,136,28672
 mf v,84,a,52,a,132
 tr a,46,136,30720
 mf v,100,a,52,a,136
 mf v,116,a,52,a,140
 s_waitcnt lgkmcnt(4)
f_L0o9:
 mf v,72,a,56,a,128
 tr a,48,138,28672
 mf v,88,a,56,a,132
 tr a,50,138,30720
 mf v,104,a,56,a,136
 mf v,120,a,56,a,140
 mf v,76,a,60,a,128
 tr a,52,140,28672
 mf v,92,a,60,a,132
 tr a,54,140,30720
 mf v,108,a,60,a,136
 mf v,124,a,60,a,140
 s_waitcnt vmcnt(12) lgkmcnt(4)
f_L0o10:
 mf v,64,a,40,v,192
 mf v,80,a,40,v,196
 mf v,96,a,40,v,200
 mf v,112,a,40,v,204
 s_waitcnt lgkmcnt(0)
 s_barrier
 mf v,68,a,44,v,192
 tr a,56,135,32768
 mf v,84,a,44,v,196
 tr a,58,135,34816
 mf v,100,a,44,v,200
 tr a,60,136,32768
 mf v,116,a,44,v,204
 tr a,62,136,34816
f_L0o11:
 mf v,72,a,48,v,192
 tr a,40,138,32768
 mf v,88,a,48,v,196
 tr a,42,138,34816
 mf v,104,a,48,v,200
 mf v,120,a,48,v,204
 mf v,76,a,52,v,192
 tr a,44,140,32768
 mf v,92,a,52,v,196
 tr a,46,140,34816
 mf v,108,a,52,v,200
 mf v,124,a,52,v,204
 s_waitcnt vmcnt(8) lgkmcnt(4)
f_L0o12:
 mf v,64,a,56,a,144
 tr a,48,135,36864
 mf v,80,a,56,a,148
 tr a,50,135,38912
 mf v,96,a,56,a,152
 mf v,112,a,56,a,156
 mf v,68,a,60,a,144
 tr a,52,136,36864
 mf v,84,a,60,a,148
 tr a,54,136,38912
 mf v,100,a,60,a,152
 mf v,116,a,60,a,156
 s_waitcnt lgkmcnt(4)
f_L0o13:
 mf v,72,a,40,a,144
 tr a,56,138,36864
 mf v,88,a,40,a,148
 tr a,58,138,38912
 mf v,104,a,40,a,152
 mf v,120,a,40,a,156
 mf v,76,a,44,a,144
 tr a,60,140,36864
 mf v,92,a,44,a,148
 tr a,62,140,38912
 mf v,108,a,44,a,152
 mf v,124,a,44,a,156
 s_waitcnt vmcnt(4) lgkmcnt(4)
f_L0o14:
 mf v,96,a,48,a,168
 tr a,40,151,8192
 mf v,112,a,48,a,172
 tr a,42,151,10240
 mf v,64,a,48,a,160
 mf v,80,a,48,a,164
 mf v,100,a,52,a,168
 tr a,44,152,8192
 mf v,116,a,52,a,172
 tr a,46,152,10240
 mf v,68,a,52,a,160
 mf v,84,a,52,a,164
 s_waitcnt lgkmcnt(4)
f_L0o15:
 mf v,104,a,56,a,168
 tr a,48,151,12288
 mf v,120,a,56,a,172
 tr a,50,151,14336
 mf v,72,a,56,a,160
 ds_write_b128 v137, v[96:99] offset:0
 mf v,88,a,56,a,164
 ds_write_b128 v137, v[112:115] offset:4096
 mf v,108,a,60,a,168
 tr a,52,152,12288
 mf v,124,a,60,a,172
 tr a,54,152,14336
 mf v,76,a,60,a,160
 ds_write_b128 v137, v[100:103] offset:1024
 mf v,92,a,60,a,164
 s_waitcnt lgkmcnt(7)
 ds_write_b128 v137, v[116:119] offset:5120
f_L0p144:
f_L0own:
f_L0o16:
 mf v,0,a,40,v,160
 tr a,56,151,16384
 mf v,16,a,40,v,164
 tr a,58,151,18432
 ds_write_b128 v137, v[104:107] offset:2048
 mf v,32,a,40,v,168
 ds_write_b128 v137, v[120:123] offset:6144
 ds_write_b128 v137, v[108:111] offset:3072
 mf v,48,a,40,v,172
 ds_write_b128 v137, v[124:127] offset:7168
 s_waitcnt lgkmcnt(0)
 s_barrier
 mf v,4,a,44,v,160
 tr a,60,152,16384
 ds_read_b128 v[96:99], v132 offset:0
 mf v,20,a,44,v,164
 tr a,62,152,18432
 ds_read_b128 v[100:103], v132 offset:1024
 mf v,36,a,44,v,168
 ds_read_b128 v[104:107], v132 offset:2048
 ds_read_b128 v[108:111], v132 offset:3072
 mf v,52,a,44,v,172
 ds_read_b128 v[112:115], v132 offset:4096
 ds_read_b128 v[116:119], v132 offset:5120
f_L0o17:
 mf v,0,a,48,a,96
 tr a,40,151,20480
 ds_read_b128 v[120:123], v132 offset:6144
 mf v,16,a,48,a,100
 tr a,42,151,22528
 ds_read_b128 v[124:127], v132 offset:7168
 s_waitcnt lgkmcnt(10)
 mf v,32,a,48,a,104
 v_add_f32 v64, v64, v96
 v_add_f32 v65, v65, v97
 v_cvt_pk_bf16_f32 v64, v64, v65
 v_add_f32 v66, v66, v98
 mf v,48,a,48,a,108
 v_add_f32 v67, v67, v99
 v_cvt_pk_bf16_f32 v65, v66, v67
 s_waitcnt lgkmcnt(8)
 v_add_f32 v68, v68, v100
 mf v,4,a,52,a,96
 tr a,44,152,20480
 v_add_f32 v69, v69, v101
 v_mov_b32 v67, v144
 v_cvt_pk_bf16_f32 v66, v68, v69
 mf v,20,a,52,a,100
 tr a,46,152,22528
 buffer_store_dwordx4 v[64:67], v128, s[24:27], s58 offen offset:0 sc1
 v_add_f32 v70, v70, v102
 mf v,36,a,52,a,104
 v_add_f32 v71, v71, v103
 v_cvt_pk_bf16_f32 v68, v70, v71
 s_waitcnt lgkmcnt(9)
 v_add_f32 v72, v72, v104
 mf v,52,a,52,a,108
 v_add_f32 v73, v73, v105
 v_cvt_pk_bf16_f32 v69, v72, v73
 v_add_f32 v74, v74, v106
 v_add_f32 v75, v75, v107
f_L0o18:
 mf v,0,a,56,a,112
 tr a,48,151,24576
 v_mov_b32 v71, v144
 v_cvt_pk_bf16_f32 v70, v74, v75
 mf v,16,a,56,a,116
 tr a,50,151,26624
 buffer_store_dwordx4 v[68:71], v128, s[24:27], s58 offen offset:1024 sc1
 s_waitcnt lgkmcnt(10)
 mf v,32,a,56,a,120
 v_add_f32 v76, v76, v108
 v_add_f32 v77, v77, v109
 v_cvt_pk_bf16_f32 v72, v76, v77
 v_add_f32 v78, v78, v110
 mf v,48,a,56,a,124
 v_add_f32 v79, v79, v111
 v_cvt_pk_bf16_f32 v73, v78, v79
 s_waitcnt lgkmcnt(9)
 v_add_f32 v80, v80, v112
 mf v,4,a,60,a,112
 tr a,52,152,24576
 v_add_f32 v81, v81, v113
 v_mov_b32 v75, v144
 v_cvt_pk_bf16_f32 v74, v80, v81
 mf v,20,a,60,a,116
 tr a,54,152,26624
 buffer_store_dwordx4 v[72:75], v128, s[24:27], s58 offen offset:2048 sc1
 v_add_f32 v82, v82, v114
 mf v,36,a,60,a,120
 v_add_f32 v83, v83, v115
 v_cvt_pk_bf16_f32 v76, v82, v83
 s_waitcnt lgkmcnt(10)
 v_add_f32 v84, v84, v116
 mf v,52,a,60,a,124
 s_waitcnt lgkmcnt(4)
 v_add_f32 v85, v85, v117
 v_cvt_pk_bf16_f32 v77, v84, v85
 v_add_f32 v86, v86, v118
 v_add_f32 v87, v87, v119
f_L0o19:
 mf v,0,a,40,v,176
 tr a,56,151,28672
 v_mov_b32 v79, v144
 v_cvt_pk_bf16_f32 v78, v86, v87
 mf v,16,a,40,v,180
 tr a,58,151,30720
 buffer_store_dwordx4 v[76:79], v128, s[24:27], s58 offen offset:3072 sc1
 mf v,32,a,40,v,184
 v_add_f32 v88, v88, v120
 v_add_f32 v89, v89, v121
 v_cvt_pk_bf16_f32 v80, v88, v89
 v_add_f32 v90, v90, v122
 mf v,48,a,40,v,188
 v_add_f32 v91, v91, v123
 v_cvt_pk_bf16_f32 v81, v90, v91
 v_add_f32 v92, v92, v124
 mf v,4,a,44,v,176
 tr a,60,152,28672
 v_add_f32 v93, v93, v125
 v_mov_b32 v83, v144
 v_cvt_pk_bf16_f32 v82, v92, v93
 mf v,20,a,44,v,180
 tr a,62,152,30720
 buffer_store_dwordx4 v[80:83], v128, s[24:27], s59 offen offset:0 sc1
 v_add_f32 v94, v94, v126
 mf v,36,a,44,v,184
 v_add_f32 v95, v95, v127
 v_mov_b32 v85, v144
 v_cvt_pk_bf16_f32 v84, v94, v95
 mf v,52,a,44,v,188
 s_waitcnt lgkmcnt(4)
 buffer_store_dwordx2 v[84:85], v128, s[24:27], s59 offen offset:1024 sc1
 s_barrier
 s_waitcnt vmcnt(6)
f_L0o20:
 mf v,0,a,48,a,128
 tr a,40,151,32768
 s_mov_b32 s10, 0xffff0000
 v_permlane16_swap_b32 v208, v210
 v_permlane16_swap_b32 v209, v211
 mf v,16,a,48,a,132
 tr a,42,151,34816
 v_permlane16_swap_b32 v212, v214
 v_permlane16_swap_b32 v213, v215
 v_permlane16_swap_b32 v216, v218
 mf v,32,a,48,a,136
 v_permlane16_swap_b32 v217, v219
 v_permlane16_swap_b32 v220, v222
 v_permlane16_swap_b32 v221, v223
 v_lshlrev_b32 v96, 16, v208
 mf v,48,a,48,a,140
 v_and_b32 v97, s10, v208
 v_lshlrev_b32 v98, 16, v209
 v_and_b32 v99, s10, v209
 v_lshlrev_b32 v100, 16, v210
 mf v,4,a,52,a,128
 tr a,44,152,32768
 v_and_b32 v101, s10, v210
 v_lshlrev_b32 v102, 16, v211
 v_and_b32 v103, s10, v211
 mf v,20,a,52,a,132
 tr a,46,152,34816
 v_lshlrev_b32 v104, 16, v212
 v_and_b32 v105, s10, v212
 v_lshlrev_b32 v106, 16, v213
 mf v,36,a,52,a,136
 v_and_b32 v107, s10, v213
 v_lshlrev_b32 v108, 16, v214
 v_and_b32 v109, s10, v214
 v_lshlrev_b32 v110, 16, v215
 mf v,52,a,52,a,140
 s_waitcnt lgkmcnt(4)
 v_and_b32 v111, s10, v215
 v_lshlrev_b32 v112, 16, v216
 v_and_b32 v113, s10, v216
 v_lshlrev_b32 v114, 16, v217
f_L0o21:
 mf v,0,a,56,v,192
 tr a,48,151,36864
 v_and_b32 v115, s10, v217
 mf v,16,a,56,v,196
 tr a,50,151,38912
 v_lshlrev_b32 v116, 16, v218
 mf v,32,a,56,v,200
 v_and_b32 v117, s10, v218
 v_lshlrev_b32 v118, 16, v219
 mf v,48,a,56,v,204
 v_and_b32 v119, s10, v219
 v_lshlrev_b32 v120, 16, v220
 mf v,4,a,60,v,192
 tr a,52,152,36864
 v_and_b32 v121, s10, v220
 mf v,20,a,60,v,196
 tr a,54,152,38912
 v_lshlrev_b32 v122, 16, v221
 mf v,36,a,60,v,200
 v_and_b32 v123, s10, v221
 v_lshlrev_b32 v124, 16, v222
 mf v,52,a,60,v,204
 s_waitcnt lgkmcnt(4)
 v_and_b32 v125, s10, v222
 v_lshlrev_b32 v126, 16, v223
f_L0o22:
 mf v,0,a,40,a,144
 tr a,56,141,8192
 v_and_b32 v127, s10, v223
 mf v,16,a,40,a,148
 tr a,58,141,10240
 mf v,32,a,40,a,152
 mf v,48,a,40,a,156
 mf v,4,a,44,a,144
 tr a,60,130,8192
 mf v,20,a,44,a,148
 tr a,62,130,10240
 mf v,36,a,44,a,152
 mf v,52,a,44,a,156
 s_waitcnt lgkmcnt(4)
f_L0o23:
 mf v,32,a,48,a,168
 tr a,40,141,12288
 mf v,48,a,48,a,172
 tr a,42,141,14336
 mf v,0,a,48,a,160
 mf v,16,a,48,a,164
 mf v,36,a,52,a,168
 tr a,44,130,12288
 mf v,52,a,52,a,172
 tr a,46,130,14336
 mf v,4,a,52,a,160
 mf v,20,a,52,a,164
 s_waitcnt lgkmcnt(4)
f_L0o24:
 mf v,8,a,56,v,160
 tr a,48,141,16384
 mf v,24,a,56,v,164
 tr a,50,141,18432
 mf v,40,a,56,v,168
 ds_write_b128 v137, v[32:35] offset:0
 mf v,56,a,56,v,172
 ds_write_b128 v137, v[48:51] offset:4096
 mf v,12,a,60,v,160
 tr a,52,130,16384
 mf v,28,a,60,v,164
 tr a,54,130,18432
 mf v,44,a,60,v,168
 ds_write_b128 v137, v[36:39] offset:1024
 mf v,60,a,60,v,172
 s_waitcnt lgkmcnt(7)
 ds_write_b128 v137, v[52:55] offset:5120
f_L0o25:
 mf v,8,a,40,a,96
 tr a,56,141,20480
 v_add_f32 v0, v0, v96
 mf v,24,a,40,a,100
 tr a,58,141,22528
 v_add_f32 v1, v1, v97
 mf v,40,a,40,a,104
 v_add_f32 v2, v2, v98
 v_add_f32 v3, v3, v99
 mf v,56,a,40,a,108
 v_add_f32 v4, v4, v100
 v_add_f32 v5, v5, v101
 mf v,12,a,44,a,96
 tr a,60,130,20480
 v_add_f32 v6, v6, v102
 mf v,28,a,44,a,100
 tr a,62,130,22528
 v_add_f32 v7, v7, v103
 mf v,44,a,44,a,104
 s_waitcnt lgkmcnt(4)
 s_barrier
 mf v,60,a,44,a,108
 ds_read_b128 v[32:35], v132 offset:0
f_L0o26:
 mf v,8,a,48,a,112
 tr a,40,141,24576
 mf v,24,a,48,a,116
 tr a,42,141,26624
 mf v,40,a,48,a,120
 ds_read_b128 v[36:39], v132 offset:1024
 mf v,56,a,48,a,124
 ds_read_b128 v[48:51], v132 offset:4096
 mf v,12,a,52,a,112
 tr a,44,130,24576
 mf v,28,a,52,a,116
 tr a,46,130,26624
 mf v,44,a,52,a,120
 ds_read_b128 v[52:55], v132 offset:5120
 v_add_f32 v16, v16, v112
 mf v,60,a,52,a,124
 s_waitcnt lgkmcnt(8)
 v_add_f32 v17, v17, v113
 v_add_f32 v18, v18, v114
f_L0o27:
 mf v,8,a,56,v,176
 tr a,48,141,28672
 v_add_f32 v19, v19, v115
 mf v,24,a,56,v,180
 tr a,50,141,30720
 v_add_f32 v20, v20, v116
 mf v,40,a,56,v,184
 v_add_f32 v21, v21, v117
 v_add_f32 v22, v22, v118
 mf v,56,a,56,v,188
 v_add_f32 v23, v23, v119
 s_waitcnt lgkmcnt(9)
 mf v,12,a,60,v,176
 tr a,52,130,28672
 v_add_f32 v0, v0, v32
 mf v,28,a,60,v,180
 tr a,54,130,30720
 v_add_f32 v1, v1, v33
 mf v,44,a,60,v,184
 v_add_f32 v2, v2, v34
 v_add_f32 v3, v3, v35
 mf v,60,a,60,v,188
 s_waitcnt lgkmcnt(5)
 v_add_f32 v4, v4, v36
f_L0o28:
 mf v,8,a,40,a,128
 tr a,56,141,32768
 v_add_f32 v5, v5, v37
 mf v,24,a,40,a,132
 tr a,58,141,34816
 v_add_f32 v6, v6, v38
 mf v,40,a,40,a,136
 buffer_load_dwordx4 v[224:227], v128, s[24:27], s60 offen offset:0 sc1
 v_add_f32 v7, v7, v39
 mf v,56,a,40,a,140
 v_add_f32 v16, v16, v48
 v_add_f32 v17, v17, v49
 mf v,12,a,44,a,128
 tr a,60,130,32768
 v_add_f32 v18, v18, v50
 mf v,28,a,44,a,132
 tr a,62,130,34816
 v_add_f32 v19, v19, v51
 mf v,44,a,44,a,136
 buffer_load_dwordx4 v[228:231], v128, s[24:27], s60 offen offset:1024 sc1
 s_waitcnt lgkmcnt(8)
 mf v,60,a,44,a,140
 s_waitcnt lgkmcnt(4)
 v_add_f32 v20, v20, v52
 v_add_f32 v21, v21, v53
f_L0o29:
 mf v,8,a,48,v,192
 tr a,40,141,36864
 v_add_f32 v22, v22, v54
 mf v,24,a,48,v,196
 tr a,42,141,38912
 v_add_f32 v23, v23, v55
 mf v,40,a,48,v,200
 buffer_load_dwordx4 v[232:235], v128, s[24:27], s60 offen offset:2048 sc1
 mf v,56,a,48,v,204
 mf v,12,a,52,v,192
 tr a,44,130,36864
 mf v,28,a,52,v,196
 tr a,46,130,38912
 mf v,44,a,52,v,200
 buffer_load_dwordx4 v[236:239], v128, s[24:27], s60 offen offset:3072 sc1
 mf v,60,a,52,v,204
 s_waitcnt lgkmcnt(4)
f_L0o30:
 mf v,8,a,56,a,144
 mf v,24,a,56,a,148
 mf v,40,a,56,a,152
 buffer_load_dwordx4 v[240:243], v128, s[24:27], s61 offen offset:0 sc1
 mf v,56,a,56,a,156
 mf v,12,a,60,a,144
 mf v,28,a,60,a,148
 mf v,44,a,60,a,152
 buffer_load_dwordx2 v[244:245], v128, s[24:27], s61 offen offset:1024 sc1
 mf v,60,a,60,a,156
 s_waitcnt lgkmcnt(0)
f_L0o31:
 mf v,40,a,40,a,168
 mf v,56,a,40,a,172
 mf v,8,a,40,a,160
 mf v,24,a,40,a,164
 mf v,44,a,44,a,168
 mf v,60,a,44,a,172
 mf v,12,a,44,a,160
 mf v,28,a,44,a,164
 s_mov_b32 s69, 0
 ds_write_b128 v137, v[40:43] offset:2048
 ds_write_b128 v137, v[56:59] offset:6144
 s_nop 2
 ds_write_b128 v137, v[44:47] offset:3072
 ds_write_b128 v137, v[60:63] offset:7168
f_L0lm:
 v_pk_add_f32 v[8:9], v[8:9], v[104:105]
 v_pk_add_f32 v[10:11], v[10:11], v[106:107]
 v_pk_add_f32 v[24:25], v[24:25], v[120:121]
 v_pk_add_f32 v[26:27], v[26:27], v[122:123]
 v_pk_add_f32 v[12:13], v[12:13], v[108:109]
 v_pk_add_f32 v[14:15], v[14:15], v[110:111]
 v_pk_add_f32 v[28:29], v[28:29], v[124:125]
 v_pk_add_f32 v[30:31], v[30:31], v[126:127]
 s_waitcnt lgkmcnt(0)
 s_barrier
 ds_read_b128 v[40:43], v132 offset:2048
 ds_read_b128 v[44:47], v132 offset:3072
 ds_read_b128 v[56:59], v132 offset:6144
 ds_read_b128 v[60:63], v132 offset:7168
f_L0xa:
f_L0x1:
 s_waitcnt vmcnt(0)
 v_min3_u32 v64, v227, v231, v144
 v_max3_u32 v65, v227, v231, v144
 v_min3_u32 v64, v235, v239, v64
 v_max3_u32 v65, v235, v239, v65
 v_min3_u32 v64, v243, v245, v64
 v_max3_u32 v65, v243, v245, v65
 v_cmp_ne_u32 vcc, v64, v65
 s_cbranch_vccnz f_L0x0
f_L0x2:
 v_lshlrev_b32 v64, 16, v224
 v_and_b32 v65, s10, v224
 v_lshlrev_b32 v66, 16, v225
 v_and_b32 v67, s10, v225
 v_lshlrev_b32 v68, 16, v226
 v_and_b32 v69, s10, v226
 v_lshlrev_b32 v70, 16, v228
 v_and_b32 v71, s10, v228
 v_pk_add_f32 v[0:1], v[0:1], v[64:65]
 v_pk_add_f32 v[2:3], v[2:3], v[66:67]
 v_pk_add_f32 v[4:5], v[4:5], v[68:69]
 v_pk_add_f32 v[6:7], v[6:7], v[70:71]
 v_cvt_pk_bf16_f32 v72, v0, v1
 v_cvt_pk_bf16_f32 v74, v4, v5
 v_cvt_pk_bf16_f32 v73, v2, v3
 v_cvt_pk_bf16_f32 v75, v6, v7
 v_permlane16_swap_b32 v72, v74
 s_nop 0
 v_permlane16_swap_b32 v73, v75
 buffer_store_dwordx4 v[72:75], v153, s[20:23], s6 offen offset:0 sc1
 v_lshlrev_b32 v64, 16, v234
 v_and_b32 v65, s10, v234
 v_lshlrev_b32 v66, 16, v236
 v_and_b32 v67, s10, v236
 v_lshlrev_b32 v68, 16, v237
 v_and_b32 v69, s10, v237
 v_lshlrev_b32 v70, 16, v238
 v_and_b32 v71, s10, v238
 v_pk_add_f32 v[16:17], v[16:17], v[64:65]
 v_pk_add_f32 v[18:19], v[18:19], v[66:67]
 v_pk_add_f32 v[20:21], v[20:21], v[68:69]
 v_pk_add_f32 v[22:23], v[22:23], v[70:71]
 v_cvt_pk_bf16_f32 v80, v16, v17
 v_cvt_pk_bf16_f32 v82, v20, v21
 v_cvt_pk_bf16_f32 v81, v18, v19
 v_cvt_pk_bf16_f32 v83, v22, v23
 v_permlane16_swap_b32 v80, v82
 s_nop 0
 v_permlane16_swap_b32 v81, v83
 buffer_store_dwordx4 v[80:83], v153, s[20:23], s7 offen offset:0 sc1
 v_lshlrev_b32 v64, 16, v229
 v_and_b32 v65, s10, v229
 v_lshlrev_b32 v66, 16, v230
 v_and_b32 v67, s10, v230
 v_lshlrev_b32 v68, 16, v232
 v_and_b32 v69, s10, v232
 v_lshlrev_b32 v70, 16, v233
 v_and_b32 v71, s10, v233
 v_pk_add_f32 v[8:9], v[8:9], v[64:65]
 v_pk_add_f32 v[10:11], v[10:11], v[66:67]
 v_pk_add_f32 v[12:13], v[12:13], v[68:69]
 v_pk_add_f32 v[14:15], v[14:15], v[70:71]
 s_waitcnt lgkmcnt(2)
 v_pk_add_f32 v[8:9], v[8:9], v[40:41]
 v_pk_add_f32 v[10:11], v[10:11], v[42:43]
 v_pk_add_f32 v[12:13], v[12:13], v[44:45]
 v_pk_add_f32 v[14:15], v[14:15], v[46:47]
 v_cvt_pk_bf16_f32 v76, v8, v9
 v_cvt_pk_bf16_f32 v78, v12, v13
 v_cvt_pk_bf16_f32 v77, v10, v11
 v_cvt_pk_bf16_f32 v79, v14, v15
 v_permlane16_swap_b32 v76, v78
 s_nop 0
 v_permlane16_swap_b32 v77, v79
 buffer_store_dwordx4 v[76:79], v153, s[20:23], s6 offen offset:64 sc1
 v_lshlrev_b32 v64, 16, v240
 v_and_b32 v65, s10, v240
 v_lshlrev_b32 v66, 16, v241
 v_and_b32 v67, s10, v241
 v_lshlrev_b32 v68, 16, v242
 v_and_b32 v69, s10, v242
 v_lshlrev_b32 v70, 16, v244
 v_and_b32 v71, s10, v244
 v_pk_add_f32 v[24:25], v[24:25], v[64:65]
 v_pk_add_f32 v[26:27], v[26:27], v[66:67]
 v_pk_add_f32 v[28:29], v[28:29], v[68:69]
 v_pk_add_f32 v[30:31], v[30:31], v[70:71]
 s_waitcnt lgkmcnt(0)
 v_pk_add_f32 v[24:25], v[24:25], v[56:57]
 v_pk_add_f32 v[26:27], v[26:27], v[58:59]
 v_pk_add_f32 v[28:29], v[28:29], v[60:61]
 v_pk_add_f32 v[30:31], v[30:31], v[62:63]
 v_cvt_pk_bf16_f32 v84, v24, v25
 v_cvt_pk_bf16_f32 v86, v28, v29
 v_cvt_pk_bf16_f32 v85, v26, v27
 v_cvt_pk_bf16_f32 v87, v30, v31
 v_permlane16_swap_b32 v84, v86
 s_nop 0
 v_permlane16_swap_b32 v85, v87
 buffer_store_dwordx4 v[84:87], v153, s[20:23], s7 offen offset:64 sc1
f_L0end:
 s_endpgm
f_L0x0:
 s_add_u32 s69, s69, 1
 s_cmp_lt_u32 s69, 0x8000
 s_cbranch_scc0 f_L0x2
 buffer_load_dwordx4 v[224:227], v128, s[24:27], s60 offen offset:0 sc1
 buffer_load_dwordx4 v[228:231], v128, s[24:27], s60 offen offset:1024 sc1
 buffer_load_dwordx4 v[232:235], v128, s[24:27], s60 offen offset:2048 sc1
 buffer_load_dwordx4 v[236:239], v128, s[24:27], s60 offen offset:3072 sc1
 buffer_load_dwordx4 v[240:243], v128, s[24:27], s61 offen offset:0 sc1
 buffer_load_dwordx2 v[244:245], v128, s[24:27], s61 offen offset:1024 sc1
 s_branch f_L0x1
f_L0po:
 s_mov_b32 s69, 0
f_L0po_1:
 s_sleep 1
 buffer_load_dword v154, v145, s[24:27], s76 offen offset:0 sc1
 s_add_u32 s69, s69, 1
 s_waitcnt vmcnt(0)
 v_cmp_ne_u32 vcc, v144, v154
 s_cmp_lt_u32 s69, 0x8000
 s_cbranch_scc0 f_L0po_back
 s_cbranch_vccnz f_L0po_1
 s_branch f_L0po_back
f_ph:
 s_mov_b32 s69, 0
f_ph_1:
 s_sleep 1
 buffer_load_dword v154, v145, s[24:27], s76 offen offset:0 sc1
 s_add_u32 s69, s69, 1
 s_waitcnt vmcnt(0)
 v_cmp_ne_u32 vcc, v144, v154
 s_cmp_lt_u32 s69, 0x8000
 s_cbranch_scc0 f_ph_back
 s_cbranch_vccnz f_ph_1
 s_branch f_ph_back
f_slow:
 s_sub_u32 s63, s63, 4096
 s_and_b32 s63, s63, 0xfffe0000
 s_add_u32 s64, s63, 4194304
 s_mov_b32 s10, 64
 v_mov_b32 v48, 0xff800000
 v_mov_b32 v49, 0xff800000
f_slow1:
 buffer_load_dwordx4 a[32:35], v128, s[24:27], s63 offen offset:0 sc1
 buffer_load_dwordx4 a[36:39], v128, s[24:27], s63 offen offset:1024 sc1
 s_add_u32 s63, s63, 2048
 s_sub_u32 s10, s10, 1
 s_waitcnt vmcnt(0)
 v_mfma_f32_32x32x16_bf16 v[0:15], a[32:35], a[16:19], 0
 mg v,0,a,36,a,20
 v_mfma_f32_32x32x16_bf16 v[16:31], a[32:35], a[24:27], 0
 mg v,16,a,36,a,28
 s_nop 7
 s_nop 3
 v_max3_f32 v48, v48, v0, v1
 v_max3_f32 v48, v48, v2, v3
 v_max3_f32 v48, v48, v4, v5
 v_max3_f32 v48, v48, v6, v7
 v_max3_f32 v48, v48, v8, v9
 v_max3_f32 v48, v48, v10, v11
 v_max3_f32 v48, v48, v12, v13
 v_max3_f32 v48, v48, v14, v15
 v_max3_f32 v49, v49, v16, v17
 v_max3_f32 v49, v49, v18, v19
 v_max3_f32 v49, v49, v20, v21
 v_max3_f32 v49, v49, v22, v23
 v_max3_f32 v49, v49, v24, v25
 v_max3_f32 v49, v49, v26, v27
 v_max3_f32 v49, v49, v28, v29
 v_max3_f32 v49, v49, v30, v31
 s_cmp_lg_u32 s10, 0
 s_cbranch_scc1 f_slow1
 v_mov_b32 v50, v48
 v_mov_b32 v51, v49
 s_sub_u32 s63, s63, 4096
 s_and_b32 s63, s63, 0xfffe0000
 s_add_u32 s64, s63, 4194304
 s_mov_b32 s10, 64
 v_permlane32_swap_b32 v48, v50
 v_permlane32_swap_b32 v49, v51
 v_max_f32 v48, v48, v50
 v_max_f32 v49, v49, v51
 v_mov_b32 v64, 0
 v_mov_b32 v65, 0
 v_mov_b32 v66, 0
 v_mov_b32 v67, 0
 v_mov_b32 v68, 0
 v_mov_b32 v69, 0
 v_mov_b32 v70, 0
 v_mov_b32 v71, 0
 v_mov_b32 v72, 0
 v_mov_b32 v73, 0
 v_mov_b32 v74, 0
 v_mov_b32 v75, 0
 v_mov_b32 v76, 0
 v_mov_b32 v77, 0
 v_mov_b32 v78, 0
 v_mov_b32 v79, 0
 v_mov_b32 v80, 0
 v_mov_b32 v81, 0
 v_mov_b32 v82, 0
 v_mov_b32 v83, 0
 v_mov_b32 v84, 0
 v_mov_b32 v85, 0
 v_mov_b32 v86, 0
 v_mov_b32 v87, 0
 v_mov_b32 v88, 0
 v_mov_b32 v89, 0
 v_mov_b32 v90, 0
 v_mov_b32 v91, 0
 v_mov_b32 v92, 0
 v_mov_b32 v93, 0
 v_mov_b32 v94, 0
 v_mov_b32 v95, 0
 v_mov_b32 v96, 0
 v_mov_b32 v97, 0
 v_mov_b32 v98, 0
 v_mov_b32 v99, 0
 v_mov_b32 v100, 0
 v_mov_b32 v101, 0
 v_mov_b32 v102, 0
 v_mov_b32 v103, 0
 v_mov_b32 v104, 0
 v_mov_b32 v105, 0
 v_mov_b32 v106, 0
 v_mov_b32 v107, 0
 v_mov_b32 v108, 0
 v_mov_b32 v109, 0
 v_mov_b32 v110, 0
 v_mov_b32 v111, 0
 v_mov_b32 v120, 0
 v_mov_b32 v121, 0
 v_mov_b32 v122, 0
 v_mov_b32 v123, 0
 v_mov_b32 v124, 0
 v_mov_b32 v125, 0
 v_mov_b32 v126, 0
 v_mov_b32 v127, 0
f_slow2:
 buffer_load_dwordx4 a[32:35], v128, s[24:27], s63 offen offset:0 sc1
 buffer_load_dwordx4 a[36:39], v128, s[24:27], s63 offen offset:1024 sc1
 buffer_load_dwordx4 a[64:67], v128, s[24:27], s64 offen offset:0 sc1
 buffer_load_dwordx4 a[68:71], v128, s[24:27], s64 offen offset:1024 sc1
 s_add_u32 s63, s63, 2048
 s_add_u32 s64, s64, 2048
 s_sub_u32 s10, s10, 1
 s_waitcnt vmcnt(0)
 v_mfma_f32_32x32x16_bf16 v[0:15], a[32:35], a[16:19], 0
 mg v,0,a,36,a,20
 v_mfma_f32_32x32x16_bf16 v[16:31], a[32:35], a[24:27], 0
 mg v,16,a,36,a,28
 s_nop 7
 s_nop 3
 v_sub_f32 v0, v0, v48
 v_sub_f32 v1, v1, v48
 v_sub_f32 v2, v2, v48
 v_sub_f32 v3, v3, v48
 v_sub_f32 v4, v4, v48
 v_sub_f32 v5, v5, v48
 v_sub_f32 v6, v6, v48
 v_sub_f32 v7, v7, v48
 v_sub_f32 v8, v8, v48
 v_sub_f32 v9, v9, v48
 v_sub_f32 v10, v10, v48
 v_sub_f32 v11, v11, v48
 v_sub_f32 v12, v12, v48
 v_sub_f32 v13, v13, v48
 v_sub_f32 v14, v14, v48
 v_sub_f32 v15, v15, v48
 v_exp_f32 v0, v0
 v_exp_f32 v1, v1
 v_exp_f32 v2, v2
 v_exp_f32 v3, v3
 v_exp_f32 v4, v4
 v_exp_f32 v5, v5
 v_exp_f32 v6, v6
 v_exp_f32 v7, v7
 v_exp_f32 v8, v8
 v_exp_f32 v9, v9
 v_exp_f32 v10, v10
 v_exp_f32 v11, v11
 v_exp_f32 v12, v12
 v_exp_f32 v13, v13
 v_exp_f32 v14, v14
 v_exp_f32 v15, v15
 s_nop 0
 v_cvt_pk_bf16_f32 v32, v0, v1
 v_cvt_pk_bf16_f32 v33, v2, v3
 v_cvt_pk_bf16_f32 v34, v4, v5
 v_cvt_pk_bf16_f32 v35, v6, v7
 v_cvt_pk_bf16_f32 v36, v8, v9
 v_cvt_pk_bf16_f32 v37, v10, v11
 v_cvt_pk_bf16_f32 v38, v12, v13
 v_cvt_pk_bf16_f32 v39, v14, v15
 v_sub_f32 v16, v16, v49
 v_sub_f32 v17, v17, v49
 v_sub_f32 v18, v18, v49
 v_sub_f32 v19, v19, v49
 v_sub_f32 v20, v20, v49
 v_sub_f32 v21, v21, v49
 v_sub_f32 v22, v22, v49
 v_sub_f32 v23, v23, v49
 v_sub_f32 v24, v24, v49
 v_sub_f32 v25, v25, v49
 v_sub_f32 v26, v26, v49
 v_sub_f32 v27, v27, v49
 v_sub_f32 v28, v28, v49
 v_sub_f32 v29, v29, v49
 v_sub_f32 v30, v30, v49
 v_sub_f32 v31, v31, v49
 v_exp_f32 v16, v16
 v_exp_f32 v17, v17
 v_exp_f32 v18, v18
 v_exp_f32 v19, v19
 v_exp_f32 v20, v20
 v_exp_f32 v21, v21
 v_exp_f32 v22, v22
 v_exp_f32 v23, v23
 v_exp_f32 v24, v24
 v_exp_f32 v25, v25
 v_exp_f32 v26, v26
 v_exp_f32 v27, v27
 v_exp_f32 v28, v28
 v_exp_f32 v29, v29
 v_exp_f32 v30, v30
 v_exp_f32 v31, v31
 s_nop 0
 v_cvt_pk_bf16_f32 v40, v16, v17
 v_cvt_pk_bf16_f32 v41, v18, v19
 v_cvt_pk_bf16_f32 v42, v20, v21
 v_cvt_pk_bf16_f32 v43, v22, v23
 v_cvt_pk_bf16_f32 v44, v24, v25
 v_cvt_pk_bf16_f32 v45, v26, v27
 v_cvt_pk_bf16_f32 v46, v28, v29
 v_cvt_pk_bf16_f32 v47, v30, v31
 s_nop 1
 mg v,80,a,64,v,32
 mg v,80,a,68,v,36
 v_smfmac_f32_16x16x64_bf16 v[120:123], v[156:159], v[32:39], v137
 mg v,96,a,64,v,40
 mg v,96,a,68,v,44
 v_smfmac_f32_16x16x64_bf16 v[124:127], v[156:159], v[40:47], v137
 s_cmp_lg_u32 s10, 0
 s_cbranch_scc1 f_slow2
 s_nop 7
 s_nop 7
 v_add_f32 v120, v120, v121
 v_add_f32 v124, v124, v125
 v_rcp_f32 v120, v120
 s_nop 0
 v_pk_mul_f32 v[80:81], v[80:81], v[120:121] op_sel_hi:[1,0]
 v_pk_mul_f32 v[82:83], v[82:83], v[120:121] op_sel_hi:[1,0]
 v_pk_mul_f32 v[84:85], v[84:85], v[120:121] op_sel_hi:[1,0]
 v_pk_mul_f32 v[86:87], v[86:87], v[120:121] op_sel_hi:[1,0]
 v_pk_mul_f32 v[88:89], v[88:89], v[120:121] op_sel_hi:[1,0]
 v_pk_mul_f32 v[90:91], v[90:91], v[120:121] op_sel_hi:[1,0]
 v_pk_mul_f32 v[92:93], v[92:93], v[120:121] op_sel_hi:[1,0]
 v_pk_mul_f32 v[94:95], v[94:95], v[120:121] op_sel_hi:[1,0]
 s_branch f_fin
f_last:
.section .rodata,"a"
.p2align 6
.amdhsa_kernel parallel_sum__mha_block__glu_gated_bilinear__prompt_kernel
  .amdhsa_next_free_vgpr 512
  .amdhsa_next_free_sgpr 102
  .amdhsa_accum_offset 256
  .amdhsa_group_segment_fixed_size 0
  .amdhsa_kernarg_size 80
  .amdhsa_user_sgpr_count 2
  .amdhsa_user_sgpr_kernarg_segment_ptr 1
  .amdhsa_system_sgpr_workgroup_id_x 1
.end_amdhsa_kernel
```
